```python
import torch

def _softmax(x, axis=-1):
    return torch.softmax(x, dim=axis)

def _gelu(x):
    return torch.nn.functional.gelu(x, approximate='tanh')

def _silu(x):
    return torch.nn.functional.silu(x)

def _sigmoid(x):
    return torch.sigmoid(x)

def _layernorm(x, axis=-1, eps=1e-05):
    m = x.mean(dim=axis, keepdim=True)
    v = x.var(dim=axis, keepdim=True, unbiased=False)
    return (x - m) / torch.sqrt(v + eps)

def _scatter_add(tgt, idx, src, axis=0):
    return tgt.clone().index_add_(axis, idx, src)

def _segment_sum(src, seg, n):
    out = torch.zeros((n,) + src.shape[1:], dtype=src.dtype)
    return out.index_add_(0, seg, src)

def _pad(x, pw):
    flat = tuple((v for pair in reversed(pw) for v in pair))
    return torch.nn.functional.pad(x, flat)
kernel_name = 'parallel_sum__memory_aug_recurrent_mem_tr__glu_gated_geglu__prompt'

def setup_inputs():

    _w = lambda a: (lambda t: t.to(torch.bfloat16) if t.is_floating_point() else t)(torch.as_tensor(a))

    def _A_setup():
        B, S, Dm = (1, 2048, 640)
        H, Dh = (32, 192)
        M, seg = (8, 32)
        seg = min(seg, S)
        S = S // seg * seg
        return {'x': _w((lambda *s: torch.randn(*s, dtype=torch.bfloat16) * 0.05)(B, S, Dm)), 'mem0': _w((lambda *s: torch.randn(*s, dtype=torch.bfloat16) * 0.2)(B, M, Dm)), 'Wq': _w((lambda *s: torch.randn(*s, dtype=torch.bfloat16) * 1.6)(Dm, H, Dh) * Dm ** (-0.5)), 'Wk': _w((lambda *s: torch.randn(*s, dtype=torch.bfloat16) * 1.6)(Dm, H, Dh) * Dm ** (-0.5)), 'Wv': _w((lambda *s: torch.randn(*s, dtype=torch.bfloat16) * 0.2)(Dm, H, Dh) * Dm ** (-0.5)), 'Wo': _w((lambda *s: torch.randn(*s, dtype=torch.bfloat16) * 0.2)(H, Dh, Dm) * (H * Dh) ** (-0.5)), 'seg_len': seg}
    _A_in = _A_setup()

    def _B_setup():
        B, S, Dm, Df = (1, 2048, 640, 1536)
        return {'x': _w((lambda *s: torch.randn(*s, dtype=torch.bfloat16) * 0.05)(B, S, Dm)), 'w_gate': _w((lambda *s: torch.randn(*s, dtype=torch.bfloat16) * 0.4)(Dm, Df) * Dm ** (-0.5)), 'w_up': _w((lambda *s: torch.randn(*s, dtype=torch.bfloat16) * 0.4)(Dm, Df) * Dm ** (-0.5)), 'w_down': _w((lambda *s: torch.randn(*s, dtype=torch.bfloat16) * 0.4)(Df, Dm) * Df ** (-0.5))}
    _B_in = _B_setup()
    return {'A_x': _A_in['x'], 'A_mem0': _A_in['mem0'], 'A_Wq': _A_in['Wq'], 'A_Wk': _A_in['Wk'], 'A_Wv': _A_in['Wv'], 'A_Wo': _A_in['Wo'], 'A_seg_len': _A_in['seg_len'], 'B_x': _B_in['x'], 'B_w_gate': _B_in['w_gate'], 'B_w_up': _B_in['w_up'], 'B_w_down': _B_in['w_down']}

def reference(A_x, A_mem0, A_Wq, A_Wk, A_Wv, A_Wo, A_seg_len, B_x, B_w_gate, B_w_up, B_w_down):

    def _A_ref(x, mem0, Wq, Wk, Wv, Wo, seg_len):
        B, S, Dm = x.shape
        H, Dh = (Wq.shape[1], Wq.shape[2])
        M = mem0.shape[1]
        scale = Dh ** (-0.5)
        n_seg = S // seg_len
        L = M + seg_len
        idx = torch.arange(L)
        mask = (idx[:, None] < M) | (idx[:, None] >= idx[None, :])
        mem = mem0
        outs = []
        for s in range(n_seg):
            xs = x[:, s * seg_len:(s + 1) * seg_len, :].clone()
            h = torch.concatenate([mem, xs], axis=1)
            q = torch.einsum('btd,dhe->bhte', h, Wq)
            k = torch.einsum('btd,dhe->bhte', h, Wk)
            v = torch.einsum('btd,dhe->bhte', h, Wv)
            scores = torch.einsum('bhqe,bhke->bhqk', q, k) * scale
            scores = torch.where(mask[None, None], scores, -1000000000.0)
            p = _softmax(scores, axis=-1)
            o = torch.einsum('bhqk,bhke->bhqe', p, v)
            o = torch.einsum('bhte,hed->btd', o, Wo)
            mem = o[:, :M, :].clone()
            outs.append(o[:, M:, :])
        return torch.concatenate(outs, axis=1)

    def _B_ref(x, w_gate, w_up, w_down):
        g = torch.einsum('bsd,df->bsf', x, w_gate)
        u = torch.einsum('bsd,df->bsf', x, w_up)
        h = _gelu(g) * u
        return torch.einsum('bsf,fd->bsd', h, w_down)
    x = A_x
    xn = _layernorm(x, axis=-1)
    return x + _A_ref(xn, A_mem0, A_Wq, A_Wk, A_Wv, A_Wo, A_seg_len) + _B_ref(xn, B_w_gate, B_w_up, B_w_down)
```

```asm
; @launch grid=(256,1,1) block=(256,1,1) lds=163840
.amdgcn_target "amdgcn-amd-amdhsa--gfx950"
.text
.globl parallel_sum__memory_aug_recurrent_mem_tr__glu_gated_geglu__prompt_kernel
.p2align 8
.type parallel_sum__memory_aug_recurrent_mem_tr__glu_gated_geglu__prompt_kernel,@function
parallel_sum__memory_aug_recurrent_mem_tr__glu_gated_geglu__prompt_kernel:
    s_cmp_ge_u32 s2, 256
    s_cbranch_scc1 L_end
    s_load_dwordx16 s[24:39], s[0:1], 0
    s_load_dwordx8 s[40:47], s[0:1], 64
    s_load_dwordx4 s[48:51], s[0:1], 96
    v_and_b32 v1, 63, v0
    v_lshrrev_b32 v4, 6, v0
    v_lshrrev_b32 v2, 4, v1
    v_readfirstlane_b32 s53, v4
    v_and_b32 v3, 15, v1
    s_getreg_b32 s56, hwreg(HW_REG_XCC_ID)
    s_getpc_b64 s[58:59]
L_pc0:
    s_lshr_b32 s57, s2, 3
    s_lshl_b32 s57, s57, 5
    v_and_b32 v5, 31, v0
    v_add_lshl_u32 v5, v5, s57, 7
    v_min_u32 v5, L_hot_end - L_pc0, v5
    global_load_dword v253, v5, s[58:59]
    s_waitcnt lgkmcnt(0)
    s_mov_b32 s4, s50
    s_mov_b32 s5, s51
    s_mov_b32 s6, 268435456
    s_mov_b32 s7, 0x20000
    s_mov_b32 s8, s48
    s_mov_b32 s9, s49
    s_mov_b32 s10, 256
    s_mov_b32 s11, 0x20000
    s_mov_b32 s60, 0
    s_and_b32 s56, s56, 7
    s_getpc_b64 s[58:59]
L_pc1:
    s_lshl_b32 s57, s56, 5
    s_add_u32 s57, s57, role_tab - L_pc1
    s_load_dword s64, s[58:59], s57
    s_cmp_eq_u32 s53, 0
    s_cselect_b32 s57, 0, 0x1000
    s_mul_i32 s58, s56, 24
    s_add_u32 s57, s57, s58
    v_mov_b32 v5, 1
    v_mov_b32 v6, s57
    s_mov_b64 exec, 1
    buffer_atomic_add v5, v6, s[8:11], 0 offen offset:64 sc0
    s_mov_b64 exec, -1
    s_waitcnt vmcnt(0) lgkmcnt(0)
    s_cmp_eq_u32 s53, 0
    s_cbranch_scc0 L_noticket
    s_mov_b64 exec, 1
    s_branch L_ticket2
L_ticket:
    v_mov_b32 v5, 1
    s_mul_i32 s57, s56, 24
    v_mov_b32 v6, s57
    buffer_atomic_add v5, v6, s[8:11], 0 offen offset:64 sc0
    s_waitcnt vmcnt(0)
L_ticket2:
    v_readfirstlane_b32 s57, v5
    s_nop 3
    s_cmp_lt_u32 s57, 32
    s_cbranch_scc1 L_gotticket
    v_mov_b32 v5, 1
    v_mov_b32 v6, 0
    buffer_store_dword v5, v6, s[8:11], 0 offen offset:24 sc1
    s_add_u32 s56, s56, 1
    s_and_b32 s56, s56, 7
    s_branch L_ticket
L_gotticket:
    s_lshl_b32 s58, s56, 5
    s_add_u32 s57, s57, s58
    s_getpc_b64 s[58:59]
L_pc:
    s_and_b32 s56, s57, 0xfc
    s_add_u32 s56, s56, role_tab - L_pc
    s_load_dword s56, s[58:59], s56
    s_and_b32 s57, s57, 3
    s_lshl_b32 s57, s57, 3
    s_waitcnt lgkmcnt(0)
    s_lshr_b32 s57, s56, s57
    v_mov_b32 v5, s57
    v_mov_b32 v6, 0
    ds_write_b32 v6, v5
    s_waitcnt lgkmcnt(0)
    s_mov_b64 exec, -1
L_noticket:
    s_barrier
    v_mov_b32 v6, 0
    ds_read_b32 v5, v6
    s_waitcnt lgkmcnt(0)
    v_readfirstlane_b32 s52, v5
    s_nop 3
    s_and_b32 s52, s52, 255
    s_barrier
    s_sub_u32 s56, s52, 120
    s_cmp_lt_u32 s56, 20
    s_cbranch_scc1 L_ln
    s_sub_u32 s56, s52, 152
    s_sub_u32 s57, s52, 172
    s_cmp_lt_u32 s57, 24
    s_cbranch_scc1 L_ln
    s_sub_u32 s56, s52, 200
    s_cmp_ge_u32 s52, 244
    s_cbranch_scc1 L_ln
    s_sub_u32 s57, s52, 32
    s_mul_i32 s56, s57, 205
    s_lshr_b32 s56, s56, 10
    s_mul_i32 s58, s56, 5
    s_add_u32 s56, s56, 56
    s_cmp_lt_u32 s57, 40
    s_cselect_b32 s57, s57, 1
    s_cmp_eq_u32 s57, s58
    s_cbranch_scc1 L_ln
L_dispatch:
    s_cmp_lt_u32 s52, 32
    s_cbranch_scc1 L_roleS
    s_cmp_lt_u32 s52, 72
    s_cbranch_scc1 L_roleC
    s_cmp_lt_u32 s52, 104
    s_cbranch_scc1 L_roleV
    s_cmp_lt_u32 s52, 120
    s_cbranch_scc1 L_roleT
    s_cmp_lt_u32 s52, 132
    s_cbranch_scc1 L_roleO
    s_cmp_lt_u32 s52, 140
    s_cbranch_scc1 L_roleFD
    s_cmp_lt_u32 s52, 172
    s_cbranch_scc1 L_roleOT
    s_branch L_roleXW
L_ln:
    s_mov_b32 s12, s24
    s_mov_b32 s13, s25
    s_mov_b32 s14, 2621440
    s_mov_b32 s15, 0x20000
    s_lshl_b32 s56, s56, 2
    s_add_u32 s56, s56, s53
    v_and_b32 v4, 7, v1
    v_lshrrev_b32 v5, 3, v1
    v_mul_u32_u24 v6, 1280, v4
    v_lshl_add_u32 v6, v5, 4, v6
    v_lshrrev_b32 v7, 2, v5
    v_lshlrev_b32 v7, 11, v7
    v_and_b32 v5, 3, v5
    v_lshl_add_u32 v7, v5, 8, v7
    v_lshl_add_u32 v7, v4, 4, v7
    s_mov_b32 s58, 0x3acccccd
    s_mul_i32 s57, s56, 10240
    buffer_load_dwordx4 v[16:19], v6, s[12:15], s57 offen offset:0
    buffer_load_dwordx4 v[20:23], v6, s[12:15], s57 offen offset:128
    buffer_load_dwordx4 v[24:27], v6, s[12:15], s57 offen offset:256
    buffer_load_dwordx4 v[28:31], v6, s[12:15], s57 offen offset:384
    buffer_load_dwordx4 v[32:35], v6, s[12:15], s57 offen offset:512
    buffer_load_dwordx4 v[36:39], v6, s[12:15], s57 offen offset:640
    buffer_load_dwordx4 v[40:43], v6, s[12:15], s57 offen offset:768
    buffer_load_dwordx4 v[44:47], v6, s[12:15], s57 offen offset:896
    buffer_load_dwordx4 v[48:51], v6, s[12:15], s57 offen offset:1024
    buffer_load_dwordx4 v[52:55], v6, s[12:15], s57 offen offset:1152
    s_lshr_b32 s59, s56, 2
    s_mul_i32 s59, s59, 40960
    s_bfe_u32 s64, s56, 0x10001
    s_lshl_b32 s64, s64, 10
    s_add_u32 s59, s59, s64
    s_and_b32 s64, s56, 1
    s_lshl_b32 s64, s64, 7
    s_add_u32 s59, s59, s64
    s_add_u32 s59, s59, 23068672
    s_waitcnt vmcnt(9)
    v_lshlrev_b32 v96, 16, v16
    v_and_b32 v97, 0xffff0000, v16
    v_lshlrev_b32 v98, 16, v17
    v_and_b32 v99, 0xffff0000, v17
    v_lshlrev_b32 v100, 16, v18
    v_and_b32 v101, 0xffff0000, v18
    v_lshlrev_b32 v102, 16, v19
    v_and_b32 v103, 0xffff0000, v19
    s_waitcnt vmcnt(8)
    v_lshlrev_b32 v104, 16, v20
    v_and_b32 v105, 0xffff0000, v20
    v_lshlrev_b32 v106, 16, v21
    v_and_b32 v107, 0xffff0000, v21
    v_lshlrev_b32 v108, 16, v22
    v_and_b32 v109, 0xffff0000, v22
    v_lshlrev_b32 v110, 16, v23
    v_and_b32 v111, 0xffff0000, v23
    s_waitcnt vmcnt(7)
    v_lshlrev_b32 v112, 16, v24
    v_and_b32 v113, 0xffff0000, v24
    v_lshlrev_b32 v114, 16, v25
    v_and_b32 v115, 0xffff0000, v25
    v_lshlrev_b32 v116, 16, v26
    v_and_b32 v117, 0xffff0000, v26
    v_lshlrev_b32 v118, 16, v27
    v_and_b32 v119, 0xffff0000, v27
    s_waitcnt vmcnt(6)
    v_lshlrev_b32 v120, 16, v28
    v_and_b32 v121, 0xffff0000, v28
    v_lshlrev_b32 v122, 16, v29
    v_and_b32 v123, 0xffff0000, v29
    v_lshlrev_b32 v124, 16, v30
    v_and_b32 v125, 0xffff0000, v30
    v_lshlrev_b32 v126, 16, v31
    v_and_b32 v127, 0xffff0000, v31
    s_waitcnt vmcnt(5)
    v_lshlrev_b32 v128, 16, v32
    v_and_b32 v129, 0xffff0000, v32
    v_lshlrev_b32 v130, 16, v33
    v_and_b32 v131, 0xffff0000, v33
    v_lshlrev_b32 v132, 16, v34
    v_and_b32 v133, 0xffff0000, v34
    v_lshlrev_b32 v134, 16, v35
    v_and_b32 v135, 0xffff0000, v35
    s_waitcnt vmcnt(4)
    v_lshlrev_b32 v136, 16, v36
    v_and_b32 v137, 0xffff0000, v36
    v_lshlrev_b32 v138, 16, v37
    v_and_b32 v139, 0xffff0000, v37
    v_lshlrev_b32 v140, 16, v38
    v_and_b32 v141, 0xffff0000, v38
    v_lshlrev_b32 v142, 16, v39
    v_and_b32 v143, 0xffff0000, v39
    s_waitcnt vmcnt(3)
    v_lshlrev_b32 v144, 16, v40
    v_and_b32 v145, 0xffff0000, v40
    v_lshlrev_b32 v146, 16, v41
    v_and_b32 v147, 0xffff0000, v41
    v_lshlrev_b32 v148, 16, v42
    v_and_b32 v149, 0xffff0000, v42
    v_lshlrev_b32 v150, 16, v43
    v_and_b32 v151, 0xffff0000, v43
    s_waitcnt vmcnt(2)
    v_lshlrev_b32 v152, 16, v44
    v_and_b32 v153, 0xffff0000, v44
    v_lshlrev_b32 v154, 16, v45
    v_and_b32 v155, 0xffff0000, v45
    v_lshlrev_b32 v156, 16, v46
    v_and_b32 v157, 0xffff0000, v46
    v_lshlrev_b32 v158, 16, v47
    v_and_b32 v159, 0xffff0000, v47
    s_waitcnt vmcnt(1)
    v_lshlrev_b32 v160, 16, v48
    v_and_b32 v161, 0xffff0000, v48
    v_lshlrev_b32 v162, 16, v49
    v_and_b32 v163, 0xffff0000, v49
    v_lshlrev_b32 v164, 16, v50
    v_and_b32 v165, 0xffff0000, v50
    v_lshlrev_b32 v166, 16, v51
    v_and_b32 v167, 0xffff0000, v51
    s_waitcnt vmcnt(0)
    v_lshlrev_b32 v168, 16, v52
    v_and_b32 v169, 0xffff0000, v52
    v_lshlrev_b32 v170, 16, v53
    v_and_b32 v171, 0xffff0000, v53
    v_lshlrev_b32 v172, 16, v54
    v_and_b32 v173, 0xffff0000, v54
    v_lshlrev_b32 v174, 16, v55
    v_and_b32 v175, 0xffff0000, v55
    v_add_f32 v10, v96, v97
    v_add_f32 v10, v10, v98
    v_add_f32 v10, v10, v99
    v_add_f32 v10, v10, v100
    v_add_f32 v10, v10, v101
    v_add_f32 v10, v10, v102
    v_add_f32 v10, v10, v103
    v_add_f32 v10, v10, v104
    v_add_f32 v10, v10, v105
    v_add_f32 v10, v10, v106
    v_add_f32 v10, v10, v107
    v_add_f32 v10, v10, v108
    v_add_f32 v10, v10, v109
    v_add_f32 v10, v10, v110
    v_add_f32 v10, v10, v111
    v_add_f32 v10, v10, v112
    v_add_f32 v10, v10, v113
    v_add_f32 v10, v10, v114
    v_add_f32 v10, v10, v115
    v_add_f32 v10, v10, v116
    v_add_f32 v10, v10, v117
    v_add_f32 v10, v10, v118
    v_add_f32 v10, v10, v119
    v_add_f32 v10, v10, v120
    v_add_f32 v10, v10, v121
    v_add_f32 v10, v10, v122
    v_add_f32 v10, v10, v123
    v_add_f32 v10, v10, v124
    v_add_f32 v10, v10, v125
    v_add_f32 v10, v10, v126
    v_add_f32 v10, v10, v127
    v_add_f32 v10, v10, v128
    v_add_f32 v10, v10, v129
    v_add_f32 v10, v10, v130
    v_add_f32 v10, v10, v131
    v_add_f32 v10, v10, v132
    v_add_f32 v10, v10, v133
    v_add_f32 v10, v10, v134
    v_add_f32 v10, v10, v135
    v_add_f32 v10, v10, v136
    v_add_f32 v10, v10, v137
    v_add_f32 v10, v10, v138
    v_add_f32 v10, v10, v139
    v_add_f32 v10, v10, v140
    v_add_f32 v10, v10, v141
    v_add_f32 v10, v10, v142
    v_add_f32 v10, v10, v143
    v_add_f32 v10, v10, v144
    v_add_f32 v10, v10, v145
    v_add_f32 v10, v10, v146
    v_add_f32 v10, v10, v147
    v_add_f32 v10, v10, v148
    v_add_f32 v10, v10, v149
    v_add_f32 v10, v10, v150
    v_add_f32 v10, v10, v151
    v_add_f32 v10, v10, v152
    v_add_f32 v10, v10, v153
    v_add_f32 v10, v10, v154
    v_add_f32 v10, v10, v155
    v_add_f32 v10, v10, v156
    v_add_f32 v10, v10, v157
    v_add_f32 v10, v10, v158
    v_add_f32 v10, v10, v159
    v_add_f32 v10, v10, v160
    v_add_f32 v10, v10, v161
    v_add_f32 v10, v10, v162
    v_add_f32 v10, v10, v163
    v_add_f32 v10, v10, v164
    v_add_f32 v10, v10, v165
    v_add_f32 v10, v10, v166
    v_add_f32 v10, v10, v167
    v_add_f32 v10, v10, v168
    v_add_f32 v10, v10, v169
    v_add_f32 v10, v10, v170
    v_add_f32 v10, v10, v171
    v_add_f32 v10, v10, v172
    v_add_f32 v10, v10, v173
    v_add_f32 v10, v10, v174
    v_add_f32 v10, v10, v175
    s_nop 1
    v_add_f32_dpp v10, v10, v10 row_ror:8 row_mask:0xf bank_mask:0xf
    v_mov_b32 v11, v10
    s_nop 1
    v_permlane16_swap_b32 v10, v11
    v_add_f32 v10, v10, v11
    v_mov_b32 v11, v10
    s_nop 1
    v_permlane32_swap_b32 v10, v11
    v_add_f32 v10, v10, v11
    v_mul_f32 v10, s58, v10
    v_sub_f32 v12, v96, v10
    v_mul_f32 v13, v12, v12
    v_sub_f32 v12, v97, v10
    v_fmac_f32 v13, v12, v12
    v_sub_f32 v12, v98, v10
    v_fmac_f32 v13, v12, v12
    v_sub_f32 v12, v99, v10
    v_fmac_f32 v13, v12, v12
    v_sub_f32 v12, v100, v10
    v_fmac_f32 v13, v12, v12
    v_sub_f32 v12, v101, v10
    v_fmac_f32 v13, v12, v12
    v_sub_f32 v12, v102, v10
    v_fmac_f32 v13, v12, v12
    v_sub_f32 v12, v103, v10
    v_fmac_f32 v13, v12, v12
    v_sub_f32 v12, v104, v10
    v_fmac_f32 v13, v12, v12
    v_sub_f32 v12, v105, v10
    v_fmac_f32 v13, v12, v12
    v_sub_f32 v12, v106, v10
    v_fmac_f32 v13, v12, v12
    v_sub_f32 v12, v107, v10
    v_fmac_f32 v13, v12, v12
    v_sub_f32 v12, v108, v10
    v_fmac_f32 v13, v12, v12
    v_sub_f32 v12, v109, v10
    v_fmac_f32 v13, v12, v12
    v_sub_f32 v12, v110, v10
    v_fmac_f32 v13, v12, v12
    v_sub_f32 v12, v111, v10
    v_fmac_f32 v13, v12, v12
    v_sub_f32 v12, v112, v10
    v_fmac_f32 v13, v12, v12
    v_sub_f32 v12, v113, v10
    v_fmac_f32 v13, v12, v12
    v_sub_f32 v12, v114, v10
    v_fmac_f32 v13, v12, v12
    v_sub_f32 v12, v115, v10
    v_fmac_f32 v13, v12, v12
    v_sub_f32 v12, v116, v10
    v_fmac_f32 v13, v12, v12
    v_sub_f32 v12, v117, v10
    v_fmac_f32 v13, v12, v12
    v_sub_f32 v12, v118, v10
    v_fmac_f32 v13, v12, v12
    v_sub_f32 v12, v119, v10
    v_fmac_f32 v13, v12, v12
    v_sub_f32 v12, v120, v10
    v_fmac_f32 v13, v12, v12
    v_sub_f32 v12, v121, v10
    v_fmac_f32 v13, v12, v12
    v_sub_f32 v12, v122, v10
    v_fmac_f32 v13, v12, v12
    v_sub_f32 v12, v123, v10
    v_fmac_f32 v13, v12, v12
    v_sub_f32 v12, v124, v10
    v_fmac_f32 v13, v12, v12
    v_sub_f32 v12, v125, v10
    v_fmac_f32 v13, v12, v12
    v_sub_f32 v12, v126, v10
    v_fmac_f32 v13, v12, v12
    v_sub_f32 v12, v127, v10
    v_fmac_f32 v13, v12, v12
    v_sub_f32 v12, v128, v10
    v_fmac_f32 v13, v12, v12
    v_sub_f32 v12, v129, v10
    v_fmac_f32 v13, v12, v12
    v_sub_f32 v12, v130, v10
    v_fmac_f32 v13, v12, v12
    v_sub_f32 v12, v131, v10
    v_fmac_f32 v13, v12, v12
    v_sub_f32 v12, v132, v10
    v_fmac_f32 v13, v12, v12
    v_sub_f32 v12, v133, v10
    v_fmac_f32 v13, v12, v12
    v_sub_f32 v12, v134, v10
    v_fmac_f32 v13, v12, v12
    v_sub_f32 v12, v135, v10
    v_fmac_f32 v13, v12, v12
    v_sub_f32 v12, v136, v10
    v_fmac_f32 v13, v12, v12
    v_sub_f32 v12, v137, v10
    v_fmac_f32 v13, v12, v12
    v_sub_f32 v12, v138, v10
    v_fmac_f32 v13, v12, v12
    v_sub_f32 v12, v139, v10
    v_fmac_f32 v13, v12, v12
    v_sub_f32 v12, v140, v10
    v_fmac_f32 v13, v12, v12
    v_sub_f32 v12, v141, v10
    v_fmac_f32 v13, v12, v12
    v_sub_f32 v12, v142, v10
    v_fmac_f32 v13, v12, v12
    v_sub_f32 v12, v143, v10
    v_fmac_f32 v13, v12, v12
    v_sub_f32 v12, v144, v10
    v_fmac_f32 v13, v12, v12
    v_sub_f32 v12, v145, v10
    v_fmac_f32 v13, v12, v12
    v_sub_f32 v12, v146, v10
    v_fmac_f32 v13, v12, v12
    v_sub_f32 v12, v147, v10
    v_fmac_f32 v13, v12, v12
    v_sub_f32 v12, v148, v10
    v_fmac_f32 v13, v12, v12
    v_sub_f32 v12, v149, v10
    v_fmac_f32 v13, v12, v12
    v_sub_f32 v12, v150, v10
    v_fmac_f32 v13, v12, v12
    v_sub_f32 v12, v151, v10
    v_fmac_f32 v13, v12, v12
    v_sub_f32 v12, v152, v10
    v_fmac_f32 v13, v12, v12
    v_sub_f32 v12, v153, v10
    v_fmac_f32 v13, v12, v12
    v_sub_f32 v12, v154, v10
    v_fmac_f32 v13, v12, v12
    v_sub_f32 v12, v155, v10
    v_fmac_f32 v13, v12, v12
    v_sub_f32 v12, v156, v10
    v_fmac_f32 v13, v12, v12
    v_sub_f32 v12, v157, v10
    v_fmac_f32 v13, v12, v12
    v_sub_f32 v12, v158, v10
    v_fmac_f32 v13, v12, v12
    v_sub_f32 v12, v159, v10
    v_fmac_f32 v13, v12, v12
    v_sub_f32 v12, v160, v10
    v_fmac_f32 v13, v12, v12
    v_sub_f32 v12, v161, v10
    v_fmac_f32 v13, v12, v12
    v_sub_f32 v12, v162, v10
    v_fmac_f32 v13, v12, v12
    v_sub_f32 v12, v163, v10
    v_fmac_f32 v13, v12, v12
    v_sub_f32 v12, v164, v10
    v_fmac_f32 v13, v12, v12
    v_sub_f32 v12, v165, v10
    v_fmac_f32 v13, v12, v12
    v_sub_f32 v12, v166, v10
    v_fmac_f32 v13, v12, v12
    v_sub_f32 v12, v167, v10
    v_fmac_f32 v13, v12, v12
    v_sub_f32 v12, v168, v10
    v_fmac_f32 v13, v12, v12
    v_sub_f32 v12, v169, v10
    v_fmac_f32 v13, v12, v12
    v_sub_f32 v12, v170, v10
    v_fmac_f32 v13, v12, v12
    v_sub_f32 v12, v171, v10
    v_fmac_f32 v13, v12, v12
    v_sub_f32 v12, v172, v10
    v_fmac_f32 v13, v12, v12
    v_sub_f32 v12, v173, v10
    v_fmac_f32 v13, v12, v12
    v_sub_f32 v12, v174, v10
    v_fmac_f32 v13, v12, v12
    v_sub_f32 v12, v175, v10
    v_fmac_f32 v13, v12, v12
    s_nop 1
    v_add_f32_dpp v13, v13, v13 row_ror:8 row_mask:0xf bank_mask:0xf
    v_mov_b32 v11, v13
    s_nop 1
    v_permlane16_swap_b32 v13, v11
    v_add_f32 v13, v13, v11
    v_mov_b32 v11, v13
    s_nop 1
    v_permlane32_swap_b32 v13, v11
    v_add_f32 v13, v13, v11
    v_mul_f32 v13, s58, v13
    v_cvt_pk_bf16_f32 v10, v10, v13
    v_and_b32 v13, 0xffff0000, v10
    v_lshlrev_b32 v10, 16, v10
    v_add_f32 v13, 0x3727c5ac, v13
    v_cvt_pk_bf16_f32 v13, v13, v13
    v_lshlrev_b32 v13, 16, v13
    v_sqrt_f32 v13, v13
    s_nop 0
    v_cvt_pk_bf16_f32 v13, v13, v13
    v_lshlrev_b32 v13, 16, v13
    v_rcp_f32 v13, v13
    v_sub_f32 v96, v96, v10
    v_sub_f32 v97, v97, v10
    v_cvt_pk_bf16_f32 v16, v96, v97
    v_lshlrev_b32 v96, 16, v16
    v_and_b32 v97, 0xffff0000, v16
    v_mul_f32 v96, v96, v13
    v_mul_f32 v97, v97, v13
    v_cvt_pk_bf16_f32 v16, v96, v97
    v_sub_f32 v98, v98, v10
    v_sub_f32 v99, v99, v10
    v_cvt_pk_bf16_f32 v17, v98, v99
    v_lshlrev_b32 v98, 16, v17
    v_and_b32 v99, 0xffff0000, v17
    v_mul_f32 v98, v98, v13
    v_mul_f32 v99, v99, v13
    v_cvt_pk_bf16_f32 v17, v98, v99
    v_sub_f32 v100, v100, v10
    v_sub_f32 v101, v101, v10
    v_cvt_pk_bf16_f32 v18, v100, v101
    v_lshlrev_b32 v100, 16, v18
    v_and_b32 v101, 0xffff0000, v18
    v_mul_f32 v100, v100, v13
    v_mul_f32 v101, v101, v13
    v_cvt_pk_bf16_f32 v18, v100, v101
    v_sub_f32 v102, v102, v10
    v_sub_f32 v103, v103, v10
    v_cvt_pk_bf16_f32 v19, v102, v103
    v_lshlrev_b32 v102, 16, v19
    v_and_b32 v103, 0xffff0000, v19
    v_mul_f32 v102, v102, v13
    v_mul_f32 v103, v103, v13
    v_cvt_pk_bf16_f32 v19, v102, v103
    buffer_store_dwordx4 v[16:19], v7, s[4:7], s59 offen sc1
    s_add_u32 s59, s59, 4096
    v_sub_f32 v104, v104, v10
    v_sub_f32 v105, v105, v10
    v_cvt_pk_bf16_f32 v20, v104, v105
    v_lshlrev_b32 v104, 16, v20
    v_and_b32 v105, 0xffff0000, v20
    v_mul_f32 v104, v104, v13
    v_mul_f32 v105, v105, v13
    v_cvt_pk_bf16_f32 v20, v104, v105
    v_sub_f32 v106, v106, v10
    v_sub_f32 v107, v107, v10
    v_cvt_pk_bf16_f32 v21, v106, v107
    v_lshlrev_b32 v106, 16, v21
    v_and_b32 v107, 0xffff0000, v21
    v_mul_f32 v106, v106, v13
    v_mul_f32 v107, v107, v13
    v_cvt_pk_bf16_f32 v21, v106, v107
    v_sub_f32 v108, v108, v10
    v_sub_f32 v109, v109, v10
    v_cvt_pk_bf16_f32 v22, v108, v109
    v_lshlrev_b32 v108, 16, v22
    v_and_b32 v109, 0xffff0000, v22
    v_mul_f32 v108, v108, v13
    v_mul_f32 v109, v109, v13
    v_cvt_pk_bf16_f32 v22, v108, v109
    v_sub_f32 v110, v110, v10
    v_sub_f32 v111, v111, v10
    v_cvt_pk_bf16_f32 v23, v110, v111
    v_lshlrev_b32 v110, 16, v23
    v_and_b32 v111, 0xffff0000, v23
    v_mul_f32 v110, v110, v13
    v_mul_f32 v111, v111, v13
    v_cvt_pk_bf16_f32 v23, v110, v111
    buffer_store_dwordx4 v[20:23], v7, s[4:7], s59 offen sc1
    s_add_u32 s59, s59, 4096
    v_sub_f32 v112, v112, v10
    v_sub_f32 v113, v113, v10
    v_cvt_pk_bf16_f32 v24, v112, v113
    v_lshlrev_b32 v112, 16, v24
    v_and_b32 v113, 0xffff0000, v24
    v_mul_f32 v112, v112, v13
    v_mul_f32 v113, v113, v13
    v_cvt_pk_bf16_f32 v24, v112, v113
    v_sub_f32 v114, v114, v10
    v_sub_f32 v115, v115, v10
    v_cvt_pk_bf16_f32 v25, v114, v115
    v_lshlrev_b32 v114, 16, v25
    v_and_b32 v115, 0xffff0000, v25
    v_mul_f32 v114, v114, v13
    v_mul_f32 v115, v115, v13
    v_cvt_pk_bf16_f32 v25, v114, v115
    v_sub_f32 v116, v116, v10
    v_sub_f32 v117, v117, v10
    v_cvt_pk_bf16_f32 v26, v116, v117
    v_lshlrev_b32 v116, 16, v26
    v_and_b32 v117, 0xffff0000, v26
    v_mul_f32 v116, v116, v13
    v_mul_f32 v117, v117, v13
    v_cvt_pk_bf16_f32 v26, v116, v117
    v_sub_f32 v118, v118, v10
    v_sub_f32 v119, v119, v10
    v_cvt_pk_bf16_f32 v27, v118, v119
    v_lshlrev_b32 v118, 16, v27
    v_and_b32 v119, 0xffff0000, v27
    v_mul_f32 v118, v118, v13
    v_mul_f32 v119, v119, v13
    v_cvt_pk_bf16_f32 v27, v118, v119
    buffer_store_dwordx4 v[24:27], v7, s[4:7], s59 offen sc1
    s_add_u32 s59, s59, 4096
    v_sub_f32 v120, v120, v10
    v_sub_f32 v121, v121, v10
    v_cvt_pk_bf16_f32 v28, v120, v121
    v_lshlrev_b32 v120, 16, v28
    v_and_b32 v121, 0xffff0000, v28
    v_mul_f32 v120, v120, v13
    v_mul_f32 v121, v121, v13
    v_cvt_pk_bf16_f32 v28, v120, v121
    v_sub_f32 v122, v122, v10
    v_sub_f32 v123, v123, v10
    v_cvt_pk_bf16_f32 v29, v122, v123
    v_lshlrev_b32 v122, 16, v29
    v_and_b32 v123, 0xffff0000, v29
    v_mul_f32 v122, v122, v13
    v_mul_f32 v123, v123, v13
    v_cvt_pk_bf16_f32 v29, v122, v123
    v_sub_f32 v124, v124, v10
    v_sub_f32 v125, v125, v10
    v_cvt_pk_bf16_f32 v30, v124, v125
    v_lshlrev_b32 v124, 16, v30
    v_and_b32 v125, 0xffff0000, v30
    v_mul_f32 v124, v124, v13
    v_mul_f32 v125, v125, v13
    v_cvt_pk_bf16_f32 v30, v124, v125
    v_sub_f32 v126, v126, v10
    v_sub_f32 v127, v127, v10
    v_cvt_pk_bf16_f32 v31, v126, v127
    v_lshlrev_b32 v126, 16, v31
    v_and_b32 v127, 0xffff0000, v31
    v_mul_f32 v126, v126, v13
    v_mul_f32 v127, v127, v13
    v_cvt_pk_bf16_f32 v31, v126, v127
    buffer_store_dwordx4 v[28:31], v7, s[4:7], s59 offen sc1
    s_add_u32 s59, s59, 4096
    v_sub_f32 v128, v128, v10
    v_sub_f32 v129, v129, v10
    v_cvt_pk_bf16_f32 v32, v128, v129
    v_lshlrev_b32 v128, 16, v32
    v_and_b32 v129, 0xffff0000, v32
    v_mul_f32 v128, v128, v13
    v_mul_f32 v129, v129, v13
    v_cvt_pk_bf16_f32 v32, v128, v129
    v_sub_f32 v130, v130, v10
    v_sub_f32 v131, v131, v10
    v_cvt_pk_bf16_f32 v33, v130, v131
    v_lshlrev_b32 v130, 16, v33
    v_and_b32 v131, 0xffff0000, v33
    v_mul_f32 v130, v130, v13
    v_mul_f32 v131, v131, v13
    v_cvt_pk_bf16_f32 v33, v130, v131
    v_sub_f32 v132, v132, v10
    v_sub_f32 v133, v133, v10
    v_cvt_pk_bf16_f32 v34, v132, v133
    v_lshlrev_b32 v132, 16, v34
    v_and_b32 v133, 0xffff0000, v34
    v_mul_f32 v132, v132, v13
    v_mul_f32 v133, v133, v13
    v_cvt_pk_bf16_f32 v34, v132, v133
    v_sub_f32 v134, v134, v10
    v_sub_f32 v135, v135, v10
    v_cvt_pk_bf16_f32 v35, v134, v135
    v_lshlrev_b32 v134, 16, v35
    v_and_b32 v135, 0xffff0000, v35
    v_mul_f32 v134, v134, v13
    v_mul_f32 v135, v135, v13
    v_cvt_pk_bf16_f32 v35, v134, v135
    buffer_store_dwordx4 v[32:35], v7, s[4:7], s59 offen sc1
    s_add_u32 s59, s59, 4096
    v_sub_f32 v136, v136, v10
    v_sub_f32 v137, v137, v10
    v_cvt_pk_bf16_f32 v36, v136, v137
    v_lshlrev_b32 v136, 16, v36
    v_and_b32 v137, 0xffff0000, v36
    v_mul_f32 v136, v136, v13
    v_mul_f32 v137, v137, v13
    v_cvt_pk_bf16_f32 v36, v136, v137
    v_sub_f32 v138, v138, v10
    v_sub_f32 v139, v139, v10
    v_cvt_pk_bf16_f32 v37, v138, v139
    v_lshlrev_b32 v138, 16, v37
    v_and_b32 v139, 0xffff0000, v37
    v_mul_f32 v138, v138, v13
    v_mul_f32 v139, v139, v13
    v_cvt_pk_bf16_f32 v37, v138, v139
    v_sub_f32 v140, v140, v10
    v_sub_f32 v141, v141, v10
    v_cvt_pk_bf16_f32 v38, v140, v141
    v_lshlrev_b32 v140, 16, v38
    v_and_b32 v141, 0xffff0000, v38
    v_mul_f32 v140, v140, v13
    v_mul_f32 v141, v141, v13
    v_cvt_pk_bf16_f32 v38, v140, v141
    v_sub_f32 v142, v142, v10
    v_sub_f32 v143, v143, v10
    v_cvt_pk_bf16_f32 v39, v142, v143
    v_lshlrev_b32 v142, 16, v39
    v_and_b32 v143, 0xffff0000, v39
    v_mul_f32 v142, v142, v13
    v_mul_f32 v143, v143, v13
    v_cvt_pk_bf16_f32 v39, v142, v143
    buffer_store_dwordx4 v[36:39], v7, s[4:7], s59 offen sc1
    s_add_u32 s59, s59, 4096
    v_sub_f32 v144, v144, v10
    v_sub_f32 v145, v145, v10
    v_cvt_pk_bf16_f32 v40, v144, v145
    v_lshlrev_b32 v144, 16, v40
    v_and_b32 v145, 0xffff0000, v40
    v_mul_f32 v144, v144, v13
    v_mul_f32 v145, v145, v13
    v_cvt_pk_bf16_f32 v40, v144, v145
    v_sub_f32 v146, v146, v10
    v_sub_f32 v147, v147, v10
    v_cvt_pk_bf16_f32 v41, v146, v147
    v_lshlrev_b32 v146, 16, v41
    v_and_b32 v147, 0xffff0000, v41
    v_mul_f32 v146, v146, v13
    v_mul_f32 v147, v147, v13
    v_cvt_pk_bf16_f32 v41, v146, v147
    v_sub_f32 v148, v148, v10
    v_sub_f32 v149, v149, v10
    v_cvt_pk_bf16_f32 v42, v148, v149
    v_lshlrev_b32 v148, 16, v42
    v_and_b32 v149, 0xffff0000, v42
    v_mul_f32 v148, v148, v13
    v_mul_f32 v149, v149, v13
    v_cvt_pk_bf16_f32 v42, v148, v149
    v_sub_f32 v150, v150, v10
    v_sub_f32 v151, v151, v10
    v_cvt_pk_bf16_f32 v43, v150, v151
    v_lshlrev_b32 v150, 16, v43
    v_and_b32 v151, 0xffff0000, v43
    v_mul_f32 v150, v150, v13
    v_mul_f32 v151, v151, v13
    v_cvt_pk_bf16_f32 v43, v150, v151
    buffer_store_dwordx4 v[40:43], v7, s[4:7], s59 offen sc1
    s_add_u32 s59, s59, 4096
    v_sub_f32 v152, v152, v10
    v_sub_f32 v153, v153, v10
    v_cvt_pk_bf16_f32 v44, v152, v153
    v_lshlrev_b32 v152, 16, v44
    v_and_b32 v153, 0xffff0000, v44
    v_mul_f32 v152, v152, v13
    v_mul_f32 v153, v153, v13
    v_cvt_pk_bf16_f32 v44, v152, v153
    v_sub_f32 v154, v154, v10
    v_sub_f32 v155, v155, v10
    v_cvt_pk_bf16_f32 v45, v154, v155
    v_lshlrev_b32 v154, 16, v45
    v_and_b32 v155, 0xffff0000, v45
    v_mul_f32 v154, v154, v13
    v_mul_f32 v155, v155, v13
    v_cvt_pk_bf16_f32 v45, v154, v155
    v_sub_f32 v156, v156, v10
    v_sub_f32 v157, v157, v10
    v_cvt_pk_bf16_f32 v46, v156, v157
    v_lshlrev_b32 v156, 16, v46
    v_and_b32 v157, 0xffff0000, v46
    v_mul_f32 v156, v156, v13
    v_mul_f32 v157, v157, v13
    v_cvt_pk_bf16_f32 v46, v156, v157
    v_sub_f32 v158, v158, v10
    v_sub_f32 v159, v159, v10
    v_cvt_pk_bf16_f32 v47, v158, v159
    v_lshlrev_b32 v158, 16, v47
    v_and_b32 v159, 0xffff0000, v47
    v_mul_f32 v158, v158, v13
    v_mul_f32 v159, v159, v13
    v_cvt_pk_bf16_f32 v47, v158, v159
    buffer_store_dwordx4 v[44:47], v7, s[4:7], s59 offen sc1
    s_add_u32 s59, s59, 4096
    v_sub_f32 v160, v160, v10
    v_sub_f32 v161, v161, v10
    v_cvt_pk_bf16_f32 v48, v160, v161
    v_lshlrev_b32 v160, 16, v48
    v_and_b32 v161, 0xffff0000, v48
    v_mul_f32 v160, v160, v13
    v_mul_f32 v161, v161, v13
    v_cvt_pk_bf16_f32 v48, v160, v161
    v_sub_f32 v162, v162, v10
    v_sub_f32 v163, v163, v10
    v_cvt_pk_bf16_f32 v49, v162, v163
    v_lshlrev_b32 v162, 16, v49
    v_and_b32 v163, 0xffff0000, v49
    v_mul_f32 v162, v162, v13
    v_mul_f32 v163, v163, v13
    v_cvt_pk_bf16_f32 v49, v162, v163
    v_sub_f32 v164, v164, v10
    v_sub_f32 v165, v165, v10
    v_cvt_pk_bf16_f32 v50, v164, v165
    v_lshlrev_b32 v164, 16, v50
    v_and_b32 v165, 0xffff0000, v50
    v_mul_f32 v164, v164, v13
    v_mul_f32 v165, v165, v13
    v_cvt_pk_bf16_f32 v50, v164, v165
    v_sub_f32 v166, v166, v10
    v_sub_f32 v167, v167, v10
    v_cvt_pk_bf16_f32 v51, v166, v167
    v_lshlrev_b32 v166, 16, v51
    v_and_b32 v167, 0xffff0000, v51
    v_mul_f32 v166, v166, v13
    v_mul_f32 v167, v167, v13
    v_cvt_pk_bf16_f32 v51, v166, v167
    buffer_store_dwordx4 v[48:51], v7, s[4:7], s59 offen sc1
    s_add_u32 s59, s59, 4096
    v_sub_f32 v168, v168, v10
    v_sub_f32 v169, v169, v10
    v_cvt_pk_bf16_f32 v52, v168, v169
    v_lshlrev_b32 v168, 16, v52
    v_and_b32 v169, 0xffff0000, v52
    v_mul_f32 v168, v168, v13
    v_mul_f32 v169, v169, v13
    v_cvt_pk_bf16_f32 v52, v168, v169
    v_sub_f32 v170, v170, v10
    v_sub_f32 v171, v171, v10
    v_cvt_pk_bf16_f32 v53, v170, v171
    v_lshlrev_b32 v170, 16, v53
    v_and_b32 v171, 0xffff0000, v53
    v_mul_f32 v170, v170, v13
    v_mul_f32 v171, v171, v13
    v_cvt_pk_bf16_f32 v53, v170, v171
    v_sub_f32 v172, v172, v10
    v_sub_f32 v173, v173, v10
    v_cvt_pk_bf16_f32 v54, v172, v173
    v_lshlrev_b32 v172, 16, v54
    v_and_b32 v173, 0xffff0000, v54
    v_mul_f32 v172, v172, v13
    v_mul_f32 v173, v173, v13
    v_cvt_pk_bf16_f32 v54, v172, v173
    v_sub_f32 v174, v174, v10
    v_sub_f32 v175, v175, v10
    v_cvt_pk_bf16_f32 v55, v174, v175
    v_lshlrev_b32 v174, 16, v55
    v_and_b32 v175, 0xffff0000, v55
    v_mul_f32 v174, v174, v13
    v_mul_f32 v175, v175, v13
    v_cvt_pk_bf16_f32 v55, v174, v175
    buffer_store_dwordx4 v[52:55], v7, s[4:7], s59 offen sc1
    s_add_u32 s59, s59, 4096
    s_nop 1
    s_branch L_dispatch
L_roleS:
    s_mov_b32 s54, s52
    s_lshl_b32 s66, s54, 2
    s_add_u32 s66, s66, s53
    s_lshl_b32 s66, s66, 7
    s_add_u32 s66, s66, 18956288
    v_mov_b32 v8, 0
    v_lshlrev_b32 v19, 4, v1
    v_mov_b32 v4, 0
    buffer_store_dword v4, v8, s[4:7], s66 offen sc1
    s_lshl_b32 s64, s54, 9
    s_add_u32 s64, s64, 21037056
    s_lshr_b32 s65, s54, 2
    s_lshl_b32 s65, s65, 10
    s_add_u32 s65, s65, 21053440
    v_mov_b32 v4, -1
    v_mov_b32 v5, -1
    v_lshlrev_b32 v6, 3, v1
    s_and_b32 s56, s54, 3
    s_lshl_b32 s56, s56, 8
    v_lshl_add_u32 v7, v1, 2, s56
    s_and_b32 s59, s53, 1
    s_lshl_b32 s59, s59, 19
    s_add_u32 s56, s59, s64
    s_add_u32 s57, s59, s65
    buffer_store_dwordx2 v[4:5], v6, s[4:7], s56 offen sc1
    buffer_store_dword v4, v7, s[4:7], s57 offen sc1
    s_mov_b32 s12, s28
    s_mov_b32 s13, s29
    s_mov_b32 s14, 7864320
    s_mov_b32 s15, 0x20000
    s_mov_b32 s16, s30
    s_mov_b32 s17, s31
    s_mov_b32 s18, 7864320
    s_mov_b32 s19, 0x20000
    s_mul_i32 s71, s53, 24576
    v_add_u32 v15, s71, v19
    v_mov_b32 v0, v19
    s_mul_i32 s58, s54, 384
    v_add_u32 v4, 0, v1
    v_mul_u32_u24 v5, 171, v4
    v_lshrrev_b32 v5, 12, v5
    v_mul_u32_u24 v6, 24, v5
    v_sub_u32 v4, v4, v6
    v_mul_u32_u24 v5, 12288, v5
    v_lshl_add_u32 v5, v4, 4, v5
    v_add_u32 v16, s58, v5
    v_add_u32 v4, 64, v1
    v_mul_u32_u24 v5, 171, v4
    v_lshrrev_b32 v5, 12, v5
    v_mul_u32_u24 v6, 24, v5
    v_sub_u32 v4, v4, v6
    v_mul_u32_u24 v5, 12288, v5
    v_lshl_add_u32 v5, v4, 4, v5
    v_add_u32 v17, s58, v5
    v_add_u32 v4, 128, v1
    v_mul_u32_u24 v5, 171, v4
    v_lshrrev_b32 v5, 12, v5
    v_mul_u32_u24 v6, 24, v5
    v_sub_u32 v4, v4, v6
    v_mul_u32_u24 v5, 12288, v5
    v_lshl_add_u32 v5, v4, 4, v5
    v_add_u32 v18, s58, v5
    v_lshrrev_b32 v4, 2, v3
    v_lshl_add_u32 v4, v2, 3, v4
    v_mul_u32_u24 v4, 384, v4
    v_and_b32 v5, 3, v3
    v_lshl_add_u32 v4, v5, 3, v4
    s_lshr_b32 s56, s53, 1
    s_lshl_b32 s56, s56, 1
    s_add_u32 s56, s56, s53
    s_lshl_b32 s56, s56, 6
    s_lshl_b32 s57, s53, 5
    s_add_u32 s57, s57, 128
    v_add_u32 v27, s56, v4
    v_add_u32 v28, s57, v4
    s_mul_i32 s70, s53, 12288
    s_xor_b32 s56, s53, 0
    s_mul_i32 s56, s56, 12288
    v_add_u32 v19, s56, v27
    v_add_u32 v20, s56, v28
    s_xor_b32 s56, s53, 1
    s_mul_i32 s56, s56, 12288
    v_add_u32 v21, s56, v27
    v_add_u32 v22, s56, v28
    s_xor_b32 s56, s53, 2
    s_mul_i32 s56, s56, 12288
    v_add_u32 v23, s56, v27
    v_add_u32 v24, s56, v28
    s_xor_b32 s56, s53, 3
    s_mul_i32 s56, s56, 12288
    v_add_u32 v25, s56, v27
    v_add_u32 v26, s56, v28
    s_mul_i32 s72, s53, 1572864
    s_add_u32 s72, s72, 0
    s_add_u32 m0, s70, 0
    s_nop 0
    buffer_load_dwordx4 v16, s[16:19], s72 offen lds
    s_add_u32 m0, s70, 1024
    s_nop 0
    buffer_load_dwordx4 v17, s[16:19], s72 offen lds
    s_add_u32 m0, s70, 2048
    s_nop 0
    buffer_load_dwordx4 v18, s[16:19], s72 offen lds
    s_add_u32 s72, s72, 98304
    s_add_u32 m0, s70, 3072
    s_nop 0
    buffer_load_dwordx4 v16, s[16:19], s72 offen lds
    s_add_u32 m0, s70, 4096
    s_nop 0
    buffer_load_dwordx4 v17, s[16:19], s72 offen lds
    s_add_u32 m0, s70, 5120
    s_nop 0
    buffer_load_dwordx4 v18, s[16:19], s72 offen lds
    s_add_u32 s72, s72, 98304
    s_add_u32 m0, s70, 6144
    s_nop 0
    buffer_load_dwordx4 v16, s[16:19], s72 offen lds
    s_add_u32 m0, s70, 7168
    s_nop 0
    buffer_load_dwordx4 v17, s[16:19], s72 offen lds
    s_add_u32 m0, s70, 8192
    s_nop 0
    buffer_load_dwordx4 v18, s[16:19], s72 offen lds
    s_add_u32 s72, s72, 98304
    s_add_u32 m0, s70, 9216
    s_nop 0
    buffer_load_dwordx4 v16, s[16:19], s72 offen lds
    s_add_u32 m0, s70, 10240
    s_nop 0
    buffer_load_dwordx4 v17, s[16:19], s72 offen lds
    s_add_u32 m0, s70, 11264
    s_nop 0
    buffer_load_dwordx4 v18, s[16:19], s72 offen lds
    s_mul_i32 s72, s53, 1572864
    s_add_u32 s72, s72, 393216
    s_add_u32 m0, s70, 49152
    s_nop 0
    buffer_load_dwordx4 v16, s[16:19], s72 offen lds
    s_add_u32 m0, s70, 50176
    s_nop 0
    buffer_load_dwordx4 v17, s[16:19], s72 offen lds
    s_add_u32 m0, s70, 51200
    s_nop 0
    buffer_load_dwordx4 v18, s[16:19], s72 offen lds
    s_add_u32 s72, s72, 98304
    s_add_u32 m0, s70, 52224
    s_nop 0
    buffer_load_dwordx4 v16, s[16:19], s72 offen lds
    s_add_u32 m0, s70, 53248
    s_nop 0
    buffer_load_dwordx4 v17, s[16:19], s72 offen lds
    s_add_u32 m0, s70, 54272
    s_nop 0
    buffer_load_dwordx4 v18, s[16:19], s72 offen lds
    s_add_u32 s72, s72, 98304
    s_add_u32 m0, s70, 55296
    s_nop 0
    buffer_load_dwordx4 v16, s[16:19], s72 offen lds
    s_add_u32 m0, s70, 56320
    s_nop 0
    buffer_load_dwordx4 v17, s[16:19], s72 offen lds
    s_add_u32 m0, s70, 57344
    s_nop 0
    buffer_load_dwordx4 v18, s[16:19], s72 offen lds
    s_add_u32 s72, s72, 98304
    s_add_u32 m0, s70, 58368
    s_nop 0
    buffer_load_dwordx4 v16, s[16:19], s72 offen lds
    s_add_u32 m0, s70, 59392
    s_nop 0
    buffer_load_dwordx4 v17, s[16:19], s72 offen lds
    s_add_u32 m0, s70, 60416
    s_nop 0
    buffer_load_dwordx4 v18, s[16:19], s72 offen lds
    s_waitcnt vmcnt(24)
    s_barrier
    s_cmp_eq_u32 s53, 3
    s_cbranch_scc0 L_arr_1
    s_mov_b64 exec, 1
    v_mov_b32 v7, 1
    v_mov_b32 v5, 8
    buffer_atomic_add v7, v5, s[8:11], 0 offen sc0
    s_mov_b64 exec, -1
L_arr_1:
    s_waitcnt vmcnt(12)
    s_barrier
    s_mul_i32 s72, s53, 1572864
    s_add_u32 s72, s72, 786432
    s_add_u32 m0, s70, 98304
    s_nop 0
    buffer_load_dwordx4 v16, s[16:19], s72 offen lds
    s_add_u32 m0, s70, 99328
    s_nop 0
    buffer_load_dwordx4 v17, s[16:19], s72 offen lds
    s_add_u32 m0, s70, 100352
    s_nop 0
    buffer_load_dwordx4 v18, s[16:19], s72 offen lds
    s_add_u32 s72, s72, 98304
    s_add_u32 m0, s70, 101376
    s_nop 0
    buffer_load_dwordx4 v16, s[16:19], s72 offen lds
    s_add_u32 m0, s70, 102400
    s_nop 0
    buffer_load_dwordx4 v17, s[16:19], s72 offen lds
    s_add_u32 m0, s70, 103424
    s_nop 0
    buffer_load_dwordx4 v18, s[16:19], s72 offen lds
    s_add_u32 s72, s72, 98304
    s_add_u32 m0, s70, 104448
    s_nop 0
    buffer_load_dwordx4 v16, s[16:19], s72 offen lds
    s_add_u32 m0, s70, 105472
    s_nop 0
    buffer_load_dwordx4 v17, s[16:19], s72 offen lds
    s_add_u32 m0, s70, 106496
    s_nop 0
    buffer_load_dwordx4 v18, s[16:19], s72 offen lds
    s_add_u32 s72, s72, 98304
    s_add_u32 m0, s70, 107520
    s_nop 0
    buffer_load_dwordx4 v16, s[16:19], s72 offen lds
    s_add_u32 m0, s70, 108544
    s_nop 0
    buffer_load_dwordx4 v17, s[16:19], s72 offen lds
    s_add_u32 m0, s70, 109568
    s_nop 0
    buffer_load_dwordx4 v18, s[16:19], s72 offen lds
    ds_read_b64_tr_b16 v[32:33], v19 offset:0
    ds_read_b64_tr_b16 v[34:35], v19 offset:1536
    ds_read_b64_tr_b16 a[72:73], v19 offset:32
    ds_read_b64_tr_b16 a[74:75], v19 offset:1568
    ds_read_b64_tr_b16 a[80:81], v20 offset:0
    ds_read_b64_tr_b16 a[82:83], v20 offset:1536
    ds_read_b64_tr_b16 a[104:105], v21 offset:0
    ds_read_b64_tr_b16 a[106:107], v21 offset:1536
    ds_read_b64_tr_b16 v[40:41], v21 offset:32
    ds_read_b64_tr_b16 v[42:43], v21 offset:1568
    ds_read_b64_tr_b16 a[112:113], v22 offset:0
    ds_read_b64_tr_b16 a[114:115], v22 offset:1536
    ds_read_b64_tr_b16 v[48:49], v23 offset:0
    ds_read_b64_tr_b16 v[50:51], v23 offset:1536
    ds_read_b64_tr_b16 a[144:145], v23 offset:32
    ds_read_b64_tr_b16 a[146:147], v23 offset:1568
    ds_read_b64_tr_b16 a[152:153], v24 offset:0
    ds_read_b64_tr_b16 a[154:155], v24 offset:1536
    ds_read_b64_tr_b16 v[56:57], v25 offset:0
    ds_read_b64_tr_b16 v[58:59], v25 offset:1536
    ds_read_b64_tr_b16 a[184:185], v25 offset:32
    ds_read_b64_tr_b16 a[186:187], v25 offset:1568
    ds_read_b64_tr_b16 a[192:193], v26 offset:0
    ds_read_b64_tr_b16 a[194:195], v26 offset:1536
    s_waitcnt lgkmcnt(0)
    s_waitcnt vmcnt(12)
    s_barrier
    s_mul_i32 s72, s53, 1572864
    s_add_u32 s72, s72, 1179648
    s_add_u32 m0, s70, 0
    s_nop 0
    buffer_load_dwordx4 v16, s[16:19], s72 offen lds
    s_add_u32 m0, s70, 1024
    s_nop 0
    buffer_load_dwordx4 v17, s[16:19], s72 offen lds
    s_add_u32 m0, s70, 2048
    s_nop 0
    buffer_load_dwordx4 v18, s[16:19], s72 offen lds
    s_add_u32 s72, s72, 98304
    s_add_u32 m0, s70, 3072
    s_nop 0
    buffer_load_dwordx4 v16, s[16:19], s72 offen lds
    s_add_u32 m0, s70, 4096
    s_nop 0
    buffer_load_dwordx4 v17, s[16:19], s72 offen lds
    s_add_u32 m0, s70, 5120
    s_nop 0
    buffer_load_dwordx4 v18, s[16:19], s72 offen lds
    s_add_u32 s72, s72, 98304
    s_add_u32 m0, s70, 6144
    s_nop 0
    buffer_load_dwordx4 v16, s[16:19], s72 offen lds
    s_add_u32 m0, s70, 7168
    s_nop 0
    buffer_load_dwordx4 v17, s[16:19], s72 offen lds
    s_add_u32 m0, s70, 8192
    s_nop 0
    buffer_load_dwordx4 v18, s[16:19], s72 offen lds
    s_add_u32 s72, s72, 98304
    s_add_u32 m0, s70, 9216
    s_nop 0
    buffer_load_dwordx4 v16, s[16:19], s72 offen lds
    s_add_u32 m0, s70, 10240
    s_nop 0
    buffer_load_dwordx4 v17, s[16:19], s72 offen lds
    s_add_u32 m0, s70, 11264
    s_nop 0
    buffer_load_dwordx4 v18, s[16:19], s72 offen lds
    v_add_u32 v19, 49152, v19
    v_add_u32 v20, 49152, v20
    v_add_u32 v21, 49152, v21
    v_add_u32 v22, 49152, v22
    v_add_u32 v23, 49152, v23
    v_add_u32 v24, 49152, v24
    v_add_u32 v25, 49152, v25
    v_add_u32 v26, 49152, v26
    v_add_u32 v27, 49152, v27
    v_add_u32 v28, 49152, v28
    ds_read_b64_tr_b16 v[36:37], v19 offset:0
    ds_read_b64_tr_b16 v[38:39], v19 offset:1536
    ds_read_b64_tr_b16 a[76:77], v19 offset:32
    ds_read_b64_tr_b16 a[78:79], v19 offset:1568
    ds_read_b64_tr_b16 a[84:85], v20 offset:0
    ds_read_b64_tr_b16 a[86:87], v20 offset:1536
    ds_read_b64_tr_b16 a[108:109], v21 offset:0
    ds_read_b64_tr_b16 a[110:111], v21 offset:1536
    ds_read_b64_tr_b16 v[44:45], v21 offset:32
    ds_read_b64_tr_b16 v[46:47], v21 offset:1568
    ds_read_b64_tr_b16 a[116:117], v22 offset:0
    ds_read_b64_tr_b16 a[118:119], v22 offset:1536
    ds_read_b64_tr_b16 v[52:53], v23 offset:0
    ds_read_b64_tr_b16 v[54:55], v23 offset:1536
    ds_read_b64_tr_b16 a[148:149], v23 offset:32
    ds_read_b64_tr_b16 a[150:151], v23 offset:1568
    ds_read_b64_tr_b16 a[156:157], v24 offset:0
    ds_read_b64_tr_b16 a[158:159], v24 offset:1536
    ds_read_b64_tr_b16 v[60:61], v25 offset:0
    ds_read_b64_tr_b16 v[62:63], v25 offset:1536
    ds_read_b64_tr_b16 a[188:189], v25 offset:32
    ds_read_b64_tr_b16 a[190:191], v25 offset:1568
    ds_read_b64_tr_b16 a[196:197], v26 offset:0
    ds_read_b64_tr_b16 a[198:199], v26 offset:1536
    s_waitcnt lgkmcnt(0)
    s_waitcnt vmcnt(12)
    s_cmp_eq_u32 s53, 3
    s_cbranch_scc0 L_arr_2
    s_mov_b64 exec, 1
    v_cmp_eq_u32 vcc, 255, v7
    s_cbranch_vccz L_arr_2_x
    v_mov_b32 v5, 8
    buffer_load_dwordx3 v[4:6], v5, s[8:11], 0 offen offset:8 sc1
    s_waitcnt vmcnt(0)
    v_cmp_lt_u32 vcc, v4, v5
    v_mov_b32 v4, 0x2001
    v_lshlrev_b32 v6, 1, v6
    v_cndmask_b32 v4, 1, v4, vcc
    v_or_b32 v4, v4, v6
    v_mov_b32 v5, 252
    buffer_store_dword v4, v5, s[8:11], 0 offen sc1
L_arr_2_x:
    s_mov_b64 exec, -1
L_arr_2:
    s_barrier
    s_mul_i32 s72, s53, 393216
    s_add_u32 s72, s72, 6291456
    s_add_u32 m0, s70, 49152
    s_nop 0
    buffer_load_dwordx4 v16, s[16:19], s72 offen lds
    s_add_u32 m0, s70, 50176
    s_nop 0
    buffer_load_dwordx4 v17, s[16:19], s72 offen lds
    s_add_u32 m0, s70, 51200
    s_nop 0
    buffer_load_dwordx4 v18, s[16:19], s72 offen lds
    s_add_u32 s72, s72, 98304
    s_add_u32 m0, s70, 52224
    s_nop 0
    buffer_load_dwordx4 v16, s[16:19], s72 offen lds
    s_add_u32 m0, s70, 53248
    s_nop 0
    buffer_load_dwordx4 v17, s[16:19], s72 offen lds
    s_add_u32 m0, s70, 54272
    s_nop 0
    buffer_load_dwordx4 v18, s[16:19], s72 offen lds
    s_add_u32 s72, s72, 98304
    s_add_u32 m0, s70, 55296
    s_nop 0
    buffer_load_dwordx4 v16, s[16:19], s72 offen lds
    s_add_u32 m0, s70, 56320
    s_nop 0
    buffer_load_dwordx4 v17, s[16:19], s72 offen lds
    s_add_u32 m0, s70, 57344
    s_nop 0
    buffer_load_dwordx4 v18, s[16:19], s72 offen lds
    s_add_u32 s72, s72, 98304
    s_add_u32 m0, s70, 58368
    s_nop 0
    buffer_load_dwordx4 v16, s[16:19], s72 offen lds
    s_add_u32 m0, s70, 59392
    s_nop 0
    buffer_load_dwordx4 v17, s[16:19], s72 offen lds
    s_add_u32 m0, s70, 60416
    s_nop 0
    buffer_load_dwordx4 v18, s[16:19], s72 offen lds
    v_add_u32 v19, 49152, v19
    v_add_u32 v20, 49152, v20
    v_add_u32 v21, 49152, v21
    v_add_u32 v22, 49152, v22
    v_add_u32 v23, 49152, v23
    v_add_u32 v24, 49152, v24
    v_add_u32 v25, 49152, v25
    v_add_u32 v26, 49152, v26
    v_add_u32 v27, 49152, v27
    v_add_u32 v28, 49152, v28
    ds_read_b64_tr_b16 v[64:65], v19 offset:0
    ds_read_b64_tr_b16 v[66:67], v19 offset:1536
    ds_read_b64_tr_b16 a[88:89], v19 offset:32
    ds_read_b64_tr_b16 a[90:91], v19 offset:1568
    ds_read_b64_tr_b16 a[96:97], v20 offset:0
    ds_read_b64_tr_b16 a[98:99], v20 offset:1536
    ds_read_b64_tr_b16 a[120:121], v21 offset:0
    ds_read_b64_tr_b16 a[122:123], v21 offset:1536
    ds_read_b64_tr_b16 a[128:129], v21 offset:32
    ds_read_b64_tr_b16 a[130:131], v21 offset:1568
    ds_read_b64_tr_b16 a[136:137], v22 offset:0
    ds_read_b64_tr_b16 a[138:139], v22 offset:1536
    ds_read_b64_tr_b16 a[160:161], v23 offset:0
    ds_read_b64_tr_b16 a[162:163], v23 offset:1536
    ds_read_b64_tr_b16 a[168:169], v23 offset:32
    ds_read_b64_tr_b16 a[170:171], v23 offset:1568
    ds_read_b64_tr_b16 a[176:177], v24 offset:0
    ds_read_b64_tr_b16 a[178:179], v24 offset:1536
    ds_read_b64_tr_b16 a[200:201], v25 offset:0
    ds_read_b64_tr_b16 a[202:203], v25 offset:1536
    ds_read_b64_tr_b16 v[72:73], v25 offset:32
    ds_read_b64_tr_b16 v[74:75], v25 offset:1568
    ds_read_b64_tr_b16 a[208:209], v26 offset:0
    ds_read_b64_tr_b16 a[210:211], v26 offset:1536
    s_waitcnt lgkmcnt(0)
    s_waitcnt vmcnt(12)
    s_barrier
    s_mul_i32 s72, s53, 1572864
    s_add_u32 s72, s72, 0
    s_add_u32 m0, s70, 98304
    s_nop 0
    buffer_load_dwordx4 v16, s[12:15], s72 offen lds
    s_add_u32 m0, s70, 99328
    s_nop 0
    buffer_load_dwordx4 v17, s[12:15], s72 offen lds
    s_add_u32 m0, s70, 100352
    s_nop 0
    buffer_load_dwordx4 v18, s[12:15], s72 offen lds
    s_add_u32 s72, s72, 98304
    s_add_u32 m0, s70, 101376
    s_nop 0
    buffer_load_dwordx4 v16, s[12:15], s72 offen lds
    s_add_u32 m0, s70, 102400
    s_nop 0
    buffer_load_dwordx4 v17, s[12:15], s72 offen lds
    s_add_u32 m0, s70, 103424
    s_nop 0
    buffer_load_dwordx4 v18, s[12:15], s72 offen lds
    s_add_u32 s72, s72, 98304
    s_add_u32 m0, s70, 104448
    s_nop 0
    buffer_load_dwordx4 v16, s[12:15], s72 offen lds
    s_add_u32 m0, s70, 105472
    s_nop 0
    buffer_load_dwordx4 v17, s[12:15], s72 offen lds
    s_add_u32 m0, s70, 106496
    s_nop 0
    buffer_load_dwordx4 v18, s[12:15], s72 offen lds
    s_add_u32 s72, s72, 98304
    s_add_u32 m0, s70, 107520
    s_nop 0
    buffer_load_dwordx4 v16, s[12:15], s72 offen lds
    s_add_u32 m0, s70, 108544
    s_nop 0
    buffer_load_dwordx4 v17, s[12:15], s72 offen lds
    s_add_u32 m0, s70, 109568
    s_nop 0
    buffer_load_dwordx4 v18, s[12:15], s72 offen lds
    v_add_u32 v19, -98304, v19
    v_add_u32 v20, -98304, v20
    v_add_u32 v21, -98304, v21
    v_add_u32 v22, -98304, v22
    v_add_u32 v23, -98304, v23
    v_add_u32 v24, -98304, v24
    v_add_u32 v25, -98304, v25
    v_add_u32 v26, -98304, v26
    v_add_u32 v27, -98304, v27
    v_add_u32 v28, -98304, v28
    ds_read_b64_tr_b16 v[68:69], v19 offset:0
    ds_read_b64_tr_b16 v[70:71], v19 offset:1536
    ds_read_b64_tr_b16 a[92:93], v19 offset:32
    ds_read_b64_tr_b16 a[94:95], v19 offset:1568
    ds_read_b64_tr_b16 a[100:101], v20 offset:0
    ds_read_b64_tr_b16 a[102:103], v20 offset:1536
    ds_read_b64_tr_b16 a[124:125], v21 offset:0
    ds_read_b64_tr_b16 a[126:127], v21 offset:1536
    ds_read_b64_tr_b16 a[132:133], v21 offset:32
    ds_read_b64_tr_b16 a[134:135], v21 offset:1568
    ds_read_b64_tr_b16 a[140:141], v22 offset:0
    ds_read_b64_tr_b16 a[142:143], v22 offset:1536
    ds_read_b64_tr_b16 a[164:165], v23 offset:0
    ds_read_b64_tr_b16 a[166:167], v23 offset:1536
    ds_read_b64_tr_b16 a[172:173], v23 offset:32
    ds_read_b64_tr_b16 a[174:175], v23 offset:1568
    ds_read_b64_tr_b16 a[180:181], v24 offset:0
    ds_read_b64_tr_b16 a[182:183], v24 offset:1536
    ds_read_b64_tr_b16 a[204:205], v25 offset:0
    ds_read_b64_tr_b16 a[206:207], v25 offset:1536
    ds_read_b64_tr_b16 v[76:77], v25 offset:32
    ds_read_b64_tr_b16 v[78:79], v25 offset:1568
    ds_read_b64_tr_b16 a[212:213], v26 offset:0
    ds_read_b64_tr_b16 a[214:215], v26 offset:1536
    s_waitcnt lgkmcnt(0)
    s_waitcnt vmcnt(12)
    s_barrier
    s_mul_i32 s72, s53, 1572864
    s_add_u32 s72, s72, 393216
    s_add_u32 m0, s70, 0
    s_nop 0
    buffer_load_dwordx4 v16, s[12:15], s72 offen lds
    s_add_u32 m0, s70, 1024
    s_nop 0
    buffer_load_dwordx4 v17, s[12:15], s72 offen lds
    s_add_u32 m0, s70, 2048
    s_nop 0
    buffer_load_dwordx4 v18, s[12:15], s72 offen lds
    s_add_u32 s72, s72, 98304
    s_add_u32 m0, s70, 3072
    s_nop 0
    buffer_load_dwordx4 v16, s[12:15], s72 offen lds
    s_add_u32 m0, s70, 4096
    s_nop 0
    buffer_load_dwordx4 v17, s[12:15], s72 offen lds
    s_add_u32 m0, s70, 5120
    s_nop 0
    buffer_load_dwordx4 v18, s[12:15], s72 offen lds
    s_add_u32 s72, s72, 98304
    s_add_u32 m0, s70, 6144
    s_nop 0
    buffer_load_dwordx4 v16, s[12:15], s72 offen lds
    s_add_u32 m0, s70, 7168
    s_nop 0
    buffer_load_dwordx4 v17, s[12:15], s72 offen lds
    s_add_u32 m0, s70, 8192
    s_nop 0
    buffer_load_dwordx4 v18, s[12:15], s72 offen lds
    s_add_u32 s72, s72, 98304
    s_add_u32 m0, s70, 9216
    s_nop 0
    buffer_load_dwordx4 v16, s[12:15], s72 offen lds
    s_add_u32 m0, s70, 10240
    s_nop 0
    buffer_load_dwordx4 v17, s[12:15], s72 offen lds
    s_add_u32 m0, s70, 11264
    s_nop 0
    buffer_load_dwordx4 v18, s[12:15], s72 offen lds
    v_add_u32 v19, 49152, v19
    v_add_u32 v20, 49152, v20
    v_add_u32 v21, 49152, v21
    v_add_u32 v22, 49152, v22
    v_add_u32 v23, 49152, v23
    v_add_u32 v24, 49152, v24
    v_add_u32 v25, 49152, v25
    v_add_u32 v26, 49152, v26
    v_add_u32 v27, 49152, v27
    v_add_u32 v28, 49152, v28
    ds_read_b64_tr_b16 a[216:217], v27 offset:0
    ds_read_b64_tr_b16 a[218:219], v27 offset:1536
    ds_read_b64_tr_b16 a[224:225], v27 offset:32
    ds_read_b64_tr_b16 a[226:227], v27 offset:1568
    ds_read_b64_tr_b16 a[232:233], v28 offset:0
    ds_read_b64_tr_b16 a[234:235], v28 offset:1536
    ds_read_b64_tr_b16 a[220:221], v27 offset:12288
    ds_read_b64_tr_b16 a[222:223], v27 offset:13824
    ds_read_b64_tr_b16 a[228:229], v27 offset:12320
    ds_read_b64_tr_b16 a[230:231], v27 offset:13856
    ds_read_b64_tr_b16 a[236:237], v28 offset:12288
    ds_read_b64_tr_b16 a[238:239], v28 offset:13824
    ds_read_b64_tr_b16 v[80:81], v27 offset:24576
    ds_read_b64_tr_b16 v[82:83], v27 offset:26112
    ds_read_b64_tr_b16 a[240:241], v27 offset:24608
    ds_read_b64_tr_b16 a[242:243], v27 offset:26144
    ds_read_b64_tr_b16 a[248:249], v28 offset:24576
    ds_read_b64_tr_b16 a[250:251], v28 offset:26112
    ds_read_b64_tr_b16 v[84:85], v27 offset:36864
    ds_read_b64_tr_b16 v[86:87], v27 offset:38400
    ds_read_b64_tr_b16 a[244:245], v27 offset:36896
    ds_read_b64_tr_b16 a[246:247], v27 offset:38432
    ds_read_b64_tr_b16 a[252:253], v28 offset:36864
    ds_read_b64_tr_b16 a[254:255], v28 offset:38400
    s_waitcnt lgkmcnt(0)
    s_waitcnt vmcnt(12)
    s_barrier
    s_mul_i32 s72, s53, 1572864
    s_add_u32 s72, s72, 786432
    s_add_u32 m0, s70, 49152
    s_nop 0
    buffer_load_dwordx4 v16, s[12:15], s72 offen lds
    s_add_u32 m0, s70, 50176
    s_nop 0
    buffer_load_dwordx4 v17, s[12:15], s72 offen lds
    s_add_u32 m0, s70, 51200
    s_nop 0
    buffer_load_dwordx4 v18, s[12:15], s72 offen lds
    s_add_u32 s72, s72, 98304
    s_add_u32 m0, s70, 52224
    s_nop 0
    buffer_load_dwordx4 v16, s[12:15], s72 offen lds
    s_add_u32 m0, s70, 53248
    s_nop 0
    buffer_load_dwordx4 v17, s[12:15], s72 offen lds
    s_add_u32 m0, s70, 54272
    s_nop 0
    buffer_load_dwordx4 v18, s[12:15], s72 offen lds
    s_add_u32 s72, s72, 98304
    s_add_u32 m0, s70, 55296
    s_nop 0
    buffer_load_dwordx4 v16, s[12:15], s72 offen lds
    s_add_u32 m0, s70, 56320
    s_nop 0
    buffer_load_dwordx4 v17, s[12:15], s72 offen lds
    s_add_u32 m0, s70, 57344
    s_nop 0
    buffer_load_dwordx4 v18, s[12:15], s72 offen lds
    s_add_u32 s72, s72, 98304
    s_add_u32 m0, s70, 58368
    s_nop 0
    buffer_load_dwordx4 v16, s[12:15], s72 offen lds
    s_add_u32 m0, s70, 59392
    s_nop 0
    buffer_load_dwordx4 v17, s[12:15], s72 offen lds
    s_add_u32 m0, s70, 60416
    s_nop 0
    buffer_load_dwordx4 v18, s[12:15], s72 offen lds
    v_add_u32 v19, 49152, v19
    v_add_u32 v20, 49152, v20
    v_add_u32 v21, 49152, v21
    v_add_u32 v22, 49152, v22
    v_add_u32 v23, 49152, v23
    v_add_u32 v24, 49152, v24
    v_add_u32 v25, 49152, v25
    v_add_u32 v26, 49152, v26
    v_add_u32 v27, 49152, v27
    v_add_u32 v28, 49152, v28
    ds_read_b64_tr_b16 v[128:129], v19 offset:0
    ds_read_b64_tr_b16 v[130:131], v19 offset:1536
    ds_read_b64_tr_b16 v[136:137], v19 offset:32
    ds_read_b64_tr_b16 v[138:139], v19 offset:1568
    ds_read_b64_tr_b16 v[144:145], v20 offset:0
    ds_read_b64_tr_b16 v[146:147], v20 offset:1536
    ds_read_b64_tr_b16 v[176:177], v21 offset:0
    ds_read_b64_tr_b16 v[178:179], v21 offset:1536
    ds_read_b64_tr_b16 v[88:89], v21 offset:32
    ds_read_b64_tr_b16 v[90:91], v21 offset:1568
    ds_read_b64_tr_b16 v[184:185], v22 offset:0
    ds_read_b64_tr_b16 v[186:187], v22 offset:1536
    ds_read_b64_tr_b16 v[96:97], v23 offset:0
    ds_read_b64_tr_b16 v[98:99], v23 offset:1536
    ds_read_b64_tr_b16 v[216:217], v23 offset:32
    ds_read_b64_tr_b16 v[218:219], v23 offset:1568
    ds_read_b64_tr_b16 v[224:225], v24 offset:0
    ds_read_b64_tr_b16 v[226:227], v24 offset:1536
    ds_read_b64_tr_b16 v[248:249], v25 offset:0
    ds_read_b64_tr_b16 v[250:251], v25 offset:1536
    ds_read_b64_tr_b16 a[0:1], v25 offset:32
    ds_read_b64_tr_b16 a[2:3], v25 offset:1568
    ds_read_b64_tr_b16 a[8:9], v26 offset:0
    ds_read_b64_tr_b16 a[10:11], v26 offset:1536
    s_waitcnt lgkmcnt(0)
    s_waitcnt vmcnt(12)
    s_barrier
    s_mul_i32 s72, s53, 1572864
    s_add_u32 s72, s72, 1179648
    s_add_u32 m0, s70, 98304
    s_nop 0
    buffer_load_dwordx4 v16, s[12:15], s72 offen lds
    s_add_u32 m0, s70, 99328
    s_nop 0
    buffer_load_dwordx4 v17, s[12:15], s72 offen lds
    s_add_u32 m0, s70, 100352
    s_nop 0
    buffer_load_dwordx4 v18, s[12:15], s72 offen lds
    s_add_u32 s72, s72, 98304
    s_add_u32 m0, s70, 101376
    s_nop 0
    buffer_load_dwordx4 v16, s[12:15], s72 offen lds
    s_add_u32 m0, s70, 102400
    s_nop 0
    buffer_load_dwordx4 v17, s[12:15], s72 offen lds
    s_add_u32 m0, s70, 103424
    s_nop 0
    buffer_load_dwordx4 v18, s[12:15], s72 offen lds
    s_add_u32 s72, s72, 98304
    s_add_u32 m0, s70, 104448
    s_nop 0
    buffer_load_dwordx4 v16, s[12:15], s72 offen lds
    s_add_u32 m0, s70, 105472
    s_nop 0
    buffer_load_dwordx4 v17, s[12:15], s72 offen lds
    s_add_u32 m0, s70, 106496
    s_nop 0
    buffer_load_dwordx4 v18, s[12:15], s72 offen lds
    s_add_u32 s72, s72, 98304
    s_add_u32 m0, s70, 107520
    s_nop 0
    buffer_load_dwordx4 v16, s[12:15], s72 offen lds
    s_add_u32 m0, s70, 108544
    s_nop 0
    buffer_load_dwordx4 v17, s[12:15], s72 offen lds
    s_add_u32 m0, s70, 109568
    s_nop 0
    buffer_load_dwordx4 v18, s[12:15], s72 offen lds
    v_add_u32 v19, -98304, v19
    v_add_u32 v20, -98304, v20
    v_add_u32 v21, -98304, v21
    v_add_u32 v22, -98304, v22
    v_add_u32 v23, -98304, v23
    v_add_u32 v24, -98304, v24
    v_add_u32 v25, -98304, v25
    v_add_u32 v26, -98304, v26
    v_add_u32 v27, -98304, v27
    v_add_u32 v28, -98304, v28
    ds_read_b64_tr_b16 v[132:133], v19 offset:0
    ds_read_b64_tr_b16 v[134:135], v19 offset:1536
    ds_read_b64_tr_b16 v[140:141], v19 offset:32
    ds_read_b64_tr_b16 v[142:143], v19 offset:1568
    ds_read_b64_tr_b16 v[148:149], v20 offset:0
    ds_read_b64_tr_b16 v[150:151], v20 offset:1536
    ds_read_b64_tr_b16 v[180:181], v21 offset:0
    ds_read_b64_tr_b16 v[182:183], v21 offset:1536
    ds_read_b64_tr_b16 v[92:93], v21 offset:32
    ds_read_b64_tr_b16 v[94:95], v21 offset:1568
    ds_read_b64_tr_b16 v[188:189], v22 offset:0
    ds_read_b64_tr_b16 v[190:191], v22 offset:1536
    ds_read_b64_tr_b16 v[100:101], v23 offset:0
    ds_read_b64_tr_b16 v[102:103], v23 offset:1536
    ds_read_b64_tr_b16 v[220:221], v23 offset:32
    ds_read_b64_tr_b16 v[222:223], v23 offset:1568
    ds_read_b64_tr_b16 v[228:229], v24 offset:0
    ds_read_b64_tr_b16 v[230:231], v24 offset:1536
    ds_read_b64_tr_b16 v[252:253], v25 offset:0
    ds_read_b64_tr_b16 v[254:255], v25 offset:1536
    ds_read_b64_tr_b16 a[4:5], v25 offset:32
    ds_read_b64_tr_b16 a[6:7], v25 offset:1568
    ds_read_b64_tr_b16 a[12:13], v26 offset:0
    ds_read_b64_tr_b16 a[14:15], v26 offset:1536
    s_waitcnt lgkmcnt(0)
    s_waitcnt vmcnt(12)
    s_barrier
    s_mul_i32 s72, s53, 393216
    s_add_u32 s72, s72, 6291456
    s_add_u32 m0, s70, 0
    s_nop 0
    buffer_load_dwordx4 v16, s[12:15], s72 offen lds
    s_add_u32 m0, s70, 1024
    s_nop 0
    buffer_load_dwordx4 v17, s[12:15], s72 offen lds
    s_add_u32 m0, s70, 2048
    s_nop 0
    buffer_load_dwordx4 v18, s[12:15], s72 offen lds
    s_add_u32 s72, s72, 98304
    s_add_u32 m0, s70, 3072
    s_nop 0
    buffer_load_dwordx4 v16, s[12:15], s72 offen lds
    s_add_u32 m0, s70, 4096
    s_nop 0
    buffer_load_dwordx4 v17, s[12:15], s72 offen lds
    s_add_u32 m0, s70, 5120
    s_nop 0
    buffer_load_dwordx4 v18, s[12:15], s72 offen lds
    s_add_u32 s72, s72, 98304
    s_add_u32 m0, s70, 6144
    s_nop 0
    buffer_load_dwordx4 v16, s[12:15], s72 offen lds
    s_add_u32 m0, s70, 7168
    s_nop 0
    buffer_load_dwordx4 v17, s[12:15], s72 offen lds
    s_add_u32 m0, s70, 8192
    s_nop 0
    buffer_load_dwordx4 v18, s[12:15], s72 offen lds
    s_add_u32 s72, s72, 98304
    s_add_u32 m0, s70, 9216
    s_nop 0
    buffer_load_dwordx4 v16, s[12:15], s72 offen lds
    s_add_u32 m0, s70, 10240
    s_nop 0
    buffer_load_dwordx4 v17, s[12:15], s72 offen lds
    s_add_u32 m0, s70, 11264
    s_nop 0
    buffer_load_dwordx4 v18, s[12:15], s72 offen lds
    v_add_u32 v19, 49152, v19
    v_add_u32 v20, 49152, v20
    v_add_u32 v21, 49152, v21
    v_add_u32 v22, 49152, v22
    v_add_u32 v23, 49152, v23
    v_add_u32 v24, 49152, v24
    v_add_u32 v25, 49152, v25
    v_add_u32 v26, 49152, v26
    v_add_u32 v27, 49152, v27
    v_add_u32 v28, 49152, v28
    ds_read_b64_tr_b16 v[152:153], v19 offset:0
    ds_read_b64_tr_b16 v[154:155], v19 offset:1536
    ds_read_b64_tr_b16 v[160:161], v19 offset:32
    ds_read_b64_tr_b16 v[162:163], v19 offset:1568
    ds_read_b64_tr_b16 v[168:169], v20 offset:0
    ds_read_b64_tr_b16 v[170:171], v20 offset:1536
    ds_read_b64_tr_b16 v[192:193], v21 offset:0
    ds_read_b64_tr_b16 v[194:195], v21 offset:1536
    ds_read_b64_tr_b16 v[200:201], v21 offset:32
    ds_read_b64_tr_b16 v[202:203], v21 offset:1568
    ds_read_b64_tr_b16 v[208:209], v22 offset:0
    ds_read_b64_tr_b16 v[210:211], v22 offset:1536
    ds_read_b64_tr_b16 v[232:233], v23 offset:0
    ds_read_b64_tr_b16 v[234:235], v23 offset:1536
    ds_read_b64_tr_b16 v[104:105], v23 offset:32
    ds_read_b64_tr_b16 v[106:107], v23 offset:1568
    ds_read_b64_tr_b16 v[240:241], v24 offset:0
    ds_read_b64_tr_b16 v[242:243], v24 offset:1536
    ds_read_b64_tr_b16 v[112:113], v25 offset:0
    ds_read_b64_tr_b16 v[114:115], v25 offset:1536
    ds_read_b64_tr_b16 a[16:17], v25 offset:32
    ds_read_b64_tr_b16 a[18:19], v25 offset:1568
    ds_read_b64_tr_b16 a[24:25], v26 offset:0
    ds_read_b64_tr_b16 a[26:27], v26 offset:1536
    s_waitcnt lgkmcnt(0)
    s_waitcnt vmcnt(12)
    s_barrier
    v_add_u32 v19, 49152, v19
    v_add_u32 v20, 49152, v20
    v_add_u32 v21, 49152, v21
    v_add_u32 v22, 49152, v22
    v_add_u32 v23, 49152, v23
    v_add_u32 v24, 49152, v24
    v_add_u32 v25, 49152, v25
    v_add_u32 v26, 49152, v26
    v_add_u32 v27, 49152, v27
    v_add_u32 v28, 49152, v28
    ds_read_b64_tr_b16 v[156:157], v19 offset:0
    ds_read_b64_tr_b16 v[158:159], v19 offset:1536
    ds_read_b64_tr_b16 v[164:165], v19 offset:32
    ds_read_b64_tr_b16 v[166:167], v19 offset:1568
    ds_read_b64_tr_b16 v[172:173], v20 offset:0
    ds_read_b64_tr_b16 v[174:175], v20 offset:1536
    ds_read_b64_tr_b16 v[196:197], v21 offset:0
    ds_read_b64_tr_b16 v[198:199], v21 offset:1536
    ds_read_b64_tr_b16 v[204:205], v21 offset:32
    ds_read_b64_tr_b16 v[206:207], v21 offset:1568
    ds_read_b64_tr_b16 v[212:213], v22 offset:0
    ds_read_b64_tr_b16 v[214:215], v22 offset:1536
    ds_read_b64_tr_b16 v[236:237], v23 offset:0
    ds_read_b64_tr_b16 v[238:239], v23 offset:1536
    ds_read_b64_tr_b16 v[108:109], v23 offset:32
    ds_read_b64_tr_b16 v[110:111], v23 offset:1568
    ds_read_b64_tr_b16 v[244:245], v24 offset:0
    ds_read_b64_tr_b16 v[246:247], v24 offset:1536
    ds_read_b64_tr_b16 v[116:117], v25 offset:0
    ds_read_b64_tr_b16 v[118:119], v25 offset:1536
    ds_read_b64_tr_b16 a[20:21], v25 offset:32
    ds_read_b64_tr_b16 a[22:23], v25 offset:1568
    ds_read_b64_tr_b16 a[28:29], v26 offset:0
    ds_read_b64_tr_b16 a[30:31], v26 offset:1536
    s_waitcnt lgkmcnt(0)
    s_waitcnt vmcnt(0)
    s_barrier
    v_add_u32 v19, -98304, v19
    v_add_u32 v20, -98304, v20
    v_add_u32 v21, -98304, v21
    v_add_u32 v22, -98304, v22
    v_add_u32 v23, -98304, v23
    v_add_u32 v24, -98304, v24
    v_add_u32 v25, -98304, v25
    v_add_u32 v26, -98304, v26
    v_add_u32 v27, -98304, v27
    v_add_u32 v28, -98304, v28
    ds_read_b64_tr_b16 a[32:33], v27 offset:0
    ds_read_b64_tr_b16 a[34:35], v27 offset:1536
    ds_read_b64_tr_b16 a[40:41], v27 offset:32
    ds_read_b64_tr_b16 a[42:43], v27 offset:1568
    ds_read_b64_tr_b16 a[48:49], v28 offset:0
    ds_read_b64_tr_b16 a[50:51], v28 offset:1536
    ds_read_b64_tr_b16 a[36:37], v27 offset:12288
    ds_read_b64_tr_b16 a[38:39], v27 offset:13824
    ds_read_b64_tr_b16 a[44:45], v27 offset:12320
    ds_read_b64_tr_b16 a[46:47], v27 offset:13856
    ds_read_b64_tr_b16 a[52:53], v28 offset:12288
    ds_read_b64_tr_b16 a[54:55], v28 offset:13824
    ds_read_b64_tr_b16 v[120:121], v27 offset:24576
    ds_read_b64_tr_b16 v[122:123], v27 offset:26112
    ds_read_b64_tr_b16 a[56:57], v27 offset:24608
    ds_read_b64_tr_b16 a[58:59], v27 offset:26144
    ds_read_b64_tr_b16 a[64:65], v28 offset:24576
    ds_read_b64_tr_b16 a[66:67], v28 offset:26112
    ds_read_b64_tr_b16 v[124:125], v27 offset:36864
    ds_read_b64_tr_b16 v[126:127], v27 offset:38400
    ds_read_b64_tr_b16 a[60:61], v27 offset:36896
    ds_read_b64_tr_b16 a[62:63], v27 offset:38432
    ds_read_b64_tr_b16 a[68:69], v28 offset:36864
    ds_read_b64_tr_b16 a[70:71], v28 offset:38400
    s_waitcnt lgkmcnt(0)
    s_barrier
    ds_write_b128 v15, v[32:35] offset:0
    ds_write_b128 v15, v[36:39] offset:1024
    ds_write_b128 v15, v[40:43] offset:18432
    ds_write_b128 v15, v[44:47] offset:19456
    ds_write_b128 v15, v[48:51] offset:20480
    ds_write_b128 v15, v[52:55] offset:21504
    ds_write_b128 v15, v[56:59] offset:22528
    ds_write_b128 v15, v[60:63] offset:23552
    ds_write_b128 v15, v[64:67] offset:12288
    ds_write_b128 v15, v[68:71] offset:13312
    ds_write_b128 v15, v[72:75] offset:14336
    ds_write_b128 v15, v[76:79] offset:15360
    ds_write_b128 v15, v[80:83] offset:16384
    ds_write_b128 v15, v[84:87] offset:17408
    ds_write_b128 v15, v[88:91] offset:2048
    ds_write_b128 v15, v[92:95] offset:3072
    ds_write_b128 v15, v[96:99] offset:4096
    ds_write_b128 v15, v[100:103] offset:5120
    ds_write_b128 v15, v[104:107] offset:6144
    ds_write_b128 v15, v[108:111] offset:7168
    ds_write_b128 v15, v[112:115] offset:8192
    ds_write_b128 v15, v[116:119] offset:9216
    ds_write_b128 v15, v[120:123] offset:10240
    ds_write_b128 v15, v[124:127] offset:11264
    s_waitcnt lgkmcnt(0)
L_s_post:
    v_mov_b32 v19, v0
    s_mov_b32 s96, 2000000
    v_mov_b32 v5, 252
L_aw_3:
    buffer_load_dword v4, v5, s[8:11], 0 offen sc1
    s_sub_u32 s96, s96, 1
    s_cbranch_scc1 L_fail
    s_waitcnt vmcnt(0)
    v_cmp_eq_u32 vcc, 0, v4
    s_cbranch_vccz L_aw_3_d
    s_sleep 16
    s_branch L_aw_3
L_aw_3_d:
    v_readfirstlane_b32 s61, v4
    s_nop 3
    s_and_b32 s60, s61, 8192
    s_and_b32 s3, s61, 2
    s_barrier
    v_mov_b32 v4, 0x4444
    v_mov_b32 v5, 0xeeee
    v_cmp_gt_u32 vcc, 8, v3
    s_nop 1
    v_cndmask_b32 v9, v5, v4, vcc
    s_lshl_b32 s56, s53, 11
    v_lshl_add_u32 v10, v1, 4, s56
    v_add_u32 v12, 98304, v10
    s_lshl_b32 s56, s53, 9
    v_lshl_add_u32 v13, v1, 3, s56
    v_add_u32 v11, 8192, v13
    v_add_u32 v13, 106496, v13
    v_xor_b32 v28, 2048, v12
    v_xor_b32 v29, 4096, v12
    v_xor_b32 v30, 6144, v12
    v_add_u32 v14, 98304, v19
    v_and_b32 v4, 1, v2
    v_lshlrev_b32 v4, 2, v4
    v_and_b32 v5, 7, v3
    v_sub_u32 v5, v5, v4
    v_lshrrev_b32 v6, 2, v3
    v_and_b32 v7, 3, v3
    v_lshl_add_u32 v6, v6, 1, v7
    v_lshrrev_b32 v7, 1, v7
    v_lshl_add_u32 v6, v7, 4, v6
    v_sub_u32 v6, v6, v4
    v_mov_b32 v4, 0x3f80
    v_mov_b32 v7, 0x3f800000
    v_cmp_eq_u32 vcc, 0, v5
    v_cmp_eq_u32 s[56:57], 1, v5
    s_nop 1
    v_cndmask_b32 v16, 0, v4, vcc
    v_cndmask_b32 v16, v16, v7, s[56:57]
    v_cmp_eq_u32 vcc, 2, v5
    v_cmp_eq_u32 s[56:57], 3, v5
    s_nop 1
    v_cndmask_b32 v17, 0, v4, vcc
    v_cndmask_b32 v17, v17, v7, s[56:57]
    v_cmp_eq_u32 vcc, 0, v6
    v_cmp_eq_u32 s[56:57], 1, v6
    s_nop 1
    v_cndmask_b32 v124, 0, v4, vcc
    v_cndmask_b32 v124, v124, v7, s[56:57]
    v_cmp_eq_u32 vcc, 2, v6
    v_cmp_eq_u32 s[56:57], 3, v6
    s_nop 1
    v_cndmask_b32 v125, 0, v4, vcc
    v_cndmask_b32 v125, v125, v7, s[56:57]
    v_cmp_gt_u32 s[74:75], 8, v3
    s_mul_i32 s56, s53, 1152
    s_add_u32 s56, s56, 120832
    v_lshl_add_u32 v4, v2, 5, v19
    v_add_u32 v18, s56, v4
    s_mul_i32 s56, s53, 576
    s_add_u32 s56, s56, 125440
    v_mul_u32_u24 v4, 144, v2
    v_lshl_add_u32 v4, v3, 3, v4
    v_add_u32 v20, s56, v4
    s_and_b32 s56, s53, 1
    s_lshl_b32 s56, s56, 2
    v_add_u32 v0, s56, v2
    v_bfe_u32 v5, v1, 2, 2
    v_bfe_u32 v6, v1, 1, 1
    v_and_b32 v7, 1, v1
    v_mul_u32_u24 v4, 288, v5
    v_lshl_add_u32 v4, v6, 7, v4
    v_lshl_add_u32 v4, v0, 4, v4
    v_lshl_add_u32 v4, v7, 3, v4
    v_add_u32 v31, 120832, v4
    s_lshl_b32 s57, s56, 6
    v_lshl_add_u32 v4, v5, 6, s57
    v_lshl_add_u32 v4, v2, 4, v4
    v_lshl_add_u32 v4, v6, 3, v4
    v_lshl_add_u32 v22, v7, 2, v4
    v_and_b32 v4, 3, v1
    v_mul_u32_u24 v4, 144, v4
    v_lshl_add_u32 v4, v0, 3, v4
    v_bfe_u32 v26, v1, 2, 1
    v_lshl_add_u32 v4, v26, 6, v4
    v_bfe_u32 v5, v1, 3, 1
    v_mul_u32_u24 v27, 1152, v5
    v_add_u32 v4, v4, v27
    v_add_u32 v21, 125440, v4
    s_lshl_b32 s57, s56, 5
    v_lshl_add_u32 v4, v7, 6, s57
    v_lshl_add_u32 v4, v2, 4, v4
    v_lshl_add_u32 v4, v5, 29, v4
    s_and_b32 s57, s54, 1
    s_bfe_u32 s58, s54, 0x10001
    s_lshl_b32 s56, s58, 8
    s_lshl_b32 s59, s57, 3
    s_add_u32 s56, s56, s59
    v_lshl_add_u32 v23, v6, 2, s56
    s_lshl_b32 s56, s57, 8
    s_lshl_b32 s59, s58, 2
    s_add_u32 s56, s56, s59
    s_add_u32 s56, s56, 512
    v_lshl_add_u32 v27, v6, 3, s56
    v_cmp_eq_u32 vcc, 1, v26
    s_nop 1
    v_cndmask_b32 v23, v23, v27, vcc
    v_add_u32 v23, v23, v4
    v_lshlrev_b32 v5, 2, v6
    v_lshl_add_u32 v5, v7, 1, v5
    v_cmp_eq_u32 s[76:77], 1, v26
    v_cmp_eq_u32 vcc, v0, v5
    s_nop 1
    v_cndmask_b32 v26, 0, 1.0, vcc
    v_add_u32 v5, 1, v5
    v_cmp_eq_u32 vcc, v0, v5
    s_nop 1
    v_cndmask_b32 v27, 0, 1.0, vcc
    s_cmp_lt_u32 s53, 2
    s_cselect_b32 s56, 0, 0x40000000
    v_add_u32 v22, s56, v22
    v_add_u32 v23, s56, v23
    v_min_u32 v4, 2, v1
    s_mul_i32 s56, s54, 3
    s_add_u32 s56, s56, 147552
    v_add_lshl_u32 v24, v4, s56, 7
    s_lshr_b32 s56, s53, 1
    s_lshl_b32 s57, s56, 1
    s_add_u32 s57, s57, s53
    s_add_u32 s56, s56, 2
    s_and_b32 s58, s53, 1
    s_lshl_b32 s58, s58, 3
    v_add_u32 v25, s58, v19
    s_mul_i32 s58, s54, 12288
    s_add_u32 s58, s58, 113246208
    s_lshl_b32 s67, s57, 11
    s_add_u32 s67, s67, s58
    s_lshl_b32 s68, s56, 11
    s_add_u32 s68, s68, s58
    s_mul_i32 s58, s54, 6144
    s_add_u32 s58, s58, 41943040
    s_lshl_b32 s69, s57, 10
    s_add_u32 s69, s69, s58
    s_lshl_b32 s70, s56, 10
    s_add_u32 s70, s70, s58
    s_lshr_b32 s56, s54, 3
    s_lshl_b32 s79, s56, 7
    s_add_u32 s79, s79, 21069824
    s_lshl_b32 s71, s56, 14
    s_add_u32 s71, s71, 20971520
    s_mov_b32 s78, 0x3dd53b95
    s_mov_b32 s62, 0x42700000
    s_mov_b32 s55, 0
    s_mov_b32 s73, 1
    s_mov_b32 s96, 2000000
L_wf_4:
    buffer_load_dword v4, v24, s[4:7], 0 offen sc1
    s_sub_u32 s96, s96, 1
    s_cbranch_scc1 L_fail
    s_waitcnt vmcnt(0)
    v_cmp_gt_u32 vcc, s73, v4
    s_cbranch_vccz L_wf_4_d
    s_sleep 4
    s_branch L_wf_4
L_wf_4_d:
    buffer_load_dwordx4 v[68:71], v19, s[4:7], s67 offen sc1
    buffer_load_dwordx4 v[72:75], v19, s[4:7], s67 offen offset:1024 sc1
    s_add_u32 s67, s67, 393216
    buffer_load_dwordx2 v[76:77], v25, s[4:7], s68 offen sc1
    buffer_load_dwordx2 v[78:79], v25, s[4:7], s68 offen offset:1024 sc1
    s_add_u32 s68, s68, 393216
    v_mov_b32 v3, -1
    s_cmp_eq_u32 s3, 0
    s_cbranch_scc0 L_s_slow
    ds_read_b128 v[108:111], v15 offset:0
    ds_read_b128 v[112:115], v15 offset:1024
    ds_read_b128 v[116:119], v15 offset:2048
    ds_read_b128 v[120:123], v15 offset:3072
    v_mov_b32 v44, 0
    v_mov_b32 v45, 0
    v_mov_b32 v46, 0
    v_mov_b32 v47, 0
    v_mov_b32 v48, 0
    v_mov_b32 v49, 0
    v_mov_b32 v50, 0
    v_mov_b32 v51, 0
    v_mov_b32 v52, 0
    v_mov_b32 v53, 0
    v_mov_b32 v54, 0
    v_mov_b32 v55, 0
    v_mov_b32 v56, 0
    v_mov_b32 v57, 0
    v_mov_b32 v58, 0
    v_mov_b32 v59, 0
    v_mov_b32 v60, 0
    v_mov_b32 v61, 0
    v_mov_b32 v62, 0
    v_mov_b32 v63, 0
    v_mov_b32 v64, 0
    v_mov_b32 v65, 0
    v_mov_b32 v66, 0
    v_mov_b32 v67, 0
    s_waitcnt lgkmcnt(0)
L_s_loop:
    s_lshl_b32 s59, s55, 1
    buffer_load_dword v4, v8, s[4:7], s79 offen sc1
    s_waitcnt vmcnt(0)
    v_mov_b32 v5, s55
    buffer_store_dword v5, v8, s[4:7], s66 offen
    v_cmp_gt_u32 vcc, s59, v4
    s_cbranch_vccz L_wf_5_d
    s_mov_b32 s96, 2000000
L_wf_5:
    buffer_load_dword v4, v8, s[4:7], s79 offen sc1
    s_sub_u32 s96, s96, 1
    s_cbranch_scc1 L_fail
    s_waitcnt vmcnt(0)
    v_cmp_gt_u32 vcc, s59, v4
    s_cbranch_vccnz L_wf_5
L_wf_5_d:
    s_mov_b32 s96, 2000000
    buffer_load_dwordx4 v[98:101], v10, s[4:7], s71 offen sc1
    buffer_load_dwordx4 v[102:105], v10, s[4:7], s71 offen offset:1024 sc1
    buffer_load_dwordx2 v[106:107], v11, s[4:7], s71 offen sc1
    s_branch L_s_poll
L_s_pollB_z:
    s_nop 7
    v_mov_b32 v44, 0
    v_mov_b32 v45, 0
    v_mov_b32 v46, 0
    v_mov_b32 v47, 0
    v_mov_b32 v48, 0
    v_mov_b32 v49, 0
    v_mov_b32 v50, 0
    v_mov_b32 v51, 0
    v_mov_b32 v52, 0
    v_mov_b32 v53, 0
    v_mov_b32 v54, 0
    v_mov_b32 v55, 0
L_s_pollB:
    buffer_load_dwordx4 v[98:101], v10, s[4:7], s71 offen sc1
    buffer_load_dwordx4 v[102:105], v10, s[4:7], s71 offen offset:1024 sc1
    buffer_load_dwordx2 v[106:107], v11, s[4:7], s71 offen sc1
    s_sub_u32 s96, s96, 1
    s_cbranch_scc1 L_fail
    s_waitcnt vmcnt(3)
    v_max3_u32 v7, v83, v87, v89
    v_cmp_eq_u32 vcc, -1, v7
    s_cbranch_vccnz L_s_poll
    v_smfmac_f32_16x16x64_bf16 v[44:47], v[80:83], v[128:135], v9
    ds_write_b128 v12, v[80:83]
    v_max3_u32 v7, v80, v81, v82
    v_smfmac_f32_16x16x64_bf16 v[48:51], v[80:83], v[136:143], v9
    ds_write_b128 v12, v[84:87] offset:1024
    v_max3_u32 v7, v7, v84, v85
    v_smfmac_f32_16x16x64_bf16 v[52:55], v[80:83], v[144:151], v9
    ds_write_b64 v13, v[88:89]
    v_max3_u32 v7, v7, v86, v88
    v_smfmac_f32_16x16x64_bf16 v[44:47], v[84:87], v[152:159], v9
    v_cmp_eq_u32 vcc, -1, v7
    v_smfmac_f32_16x16x64_bf16 v[48:51], v[84:87], v[160:167], v9
    s_cbranch_vccnz L_s_poll_z
    v_smfmac_f32_16x16x64_bf16 v[52:55], v[84:87], v[168:175], v9
    s_waitcnt lgkmcnt(0)
    s_barrier
    ds_read_b128 v[32:35], v28 offset:0
    ds_read_b128 v[36:39], v28 offset:1024
    ds_read_b128 v[40:43], v29 offset:0
    v_smfmac_f32_16x16x64_bf16 v[56:59], v[80:83], v[108:115], v9
    ds_read_b128 v[108:111], v15 offset:4096
    ds_read_b128 v[112:115], v15 offset:5120
    v_smfmac_f32_16x16x64_bf16 v[60:63], v[80:83], a[72:79], v9
    v_smfmac_f32_16x16x64_bf16 v[64:67], v[80:83], a[80:87], v9
    s_branch L_s_main
L_s_poll_z:
    s_nop 7
    v_mov_b32 v44, 0
    v_mov_b32 v45, 0
    v_mov_b32 v46, 0
    v_mov_b32 v47, 0
    v_mov_b32 v48, 0
    v_mov_b32 v49, 0
    v_mov_b32 v50, 0
    v_mov_b32 v51, 0
    v_mov_b32 v52, 0
    v_mov_b32 v53, 0
    v_mov_b32 v54, 0
    v_mov_b32 v55, 0
L_s_poll:
    buffer_load_dwordx4 v[80:83], v10, s[4:7], s71 offen sc1
    buffer_load_dwordx4 v[84:87], v10, s[4:7], s71 offen offset:1024 sc1
    buffer_load_dwordx2 v[88:89], v11, s[4:7], s71 offen sc1
    s_waitcnt vmcnt(3)
    v_max3_u32 v7, v101, v105, v107
    v_cmp_eq_u32 vcc, -1, v7
    s_cbranch_vccnz L_s_pollB
    v_smfmac_f32_16x16x64_bf16 v[44:47], v[98:101], v[128:135], v9
    ds_write_b128 v12, v[98:101]
    v_max3_u32 v7, v98, v99, v100
    v_smfmac_f32_16x16x64_bf16 v[48:51], v[98:101], v[136:143], v9
    ds_write_b128 v12, v[102:105] offset:1024
    v_max3_u32 v7, v7, v102, v103
    v_smfmac_f32_16x16x64_bf16 v[52:55], v[98:101], v[144:151], v9
    ds_write_b64 v13, v[106:107]
    v_max3_u32 v7, v7, v104, v106
    v_smfmac_f32_16x16x64_bf16 v[44:47], v[102:105], v[152:159], v9
    v_cmp_eq_u32 vcc, -1, v7
    v_smfmac_f32_16x16x64_bf16 v[48:51], v[102:105], v[160:167], v9
    s_cbranch_vccnz L_s_pollB_z
    v_smfmac_f32_16x16x64_bf16 v[52:55], v[102:105], v[168:175], v9
    s_waitcnt lgkmcnt(0)
    s_barrier
    ds_read_b128 v[32:35], v28 offset:0
    ds_read_b128 v[36:39], v28 offset:1024
    ds_read_b128 v[40:43], v29 offset:0
    v_smfmac_f32_16x16x64_bf16 v[56:59], v[98:101], v[108:115], v9
    ds_read_b128 v[108:111], v15 offset:4096
    ds_read_b128 v[112:115], v15 offset:5120
    v_smfmac_f32_16x16x64_bf16 v[60:63], v[98:101], a[72:79], v9
    v_smfmac_f32_16x16x64_bf16 v[64:67], v[98:101], a[80:87], v9
L_s_main:
    s_waitcnt lgkmcnt(4)
    v_smfmac_f32_16x16x64_bf16 v[44:47], v[32:35], v[176:183], v9
    v_smfmac_f32_16x16x64_bf16 v[48:51], v[32:35], v[116:123], v9
    ds_read_b128 v[116:119], v15 offset:6144
    ds_read_b128 v[120:123], v15 offset:7168
    v_smfmac_f32_16x16x64_bf16 v[52:55], v[32:35], v[184:191], v9
    ds_read_b128 v[32:35], v29 offset:1024
    s_waitcnt lgkmcnt(6)
    v_smfmac_f32_16x16x64_bf16 v[44:47], v[36:39], v[192:199], v9
    buffer_load_dword v2, v24, s[4:7], 0 offen sc1
    v_smfmac_f32_16x16x64_bf16 v[48:51], v[36:39], v[200:207], v9
    v_smfmac_f32_16x16x64_bf16 v[52:55], v[36:39], v[208:215], v9
    ds_read_b128 v[36:39], v30 offset:0
    s_waitcnt lgkmcnt(4)
    v_smfmac_f32_16x16x64_bf16 v[44:47], v[40:43], v[108:115], v9
    ds_read_b128 v[108:111], v15 offset:8192
    ds_read_b128 v[112:115], v15 offset:9216
    v_smfmac_f32_16x16x64_bf16 v[48:51], v[40:43], v[216:223], v9
    v_smfmac_f32_16x16x64_bf16 v[52:55], v[40:43], v[224:231], v9
    ds_read_b128 v[40:43], v30 offset:1024
    s_waitcnt lgkmcnt(4)
    v_smfmac_f32_16x16x64_bf16 v[44:47], v[32:35], v[232:239], v9
    v_smfmac_f32_16x16x64_bf16 v[48:51], v[32:35], v[116:123], v9
    ds_read_b128 v[116:119], v15 offset:10240
    ds_read_b128 v[120:123], v15 offset:11264
    v_smfmac_f32_16x16x64_bf16 v[52:55], v[32:35], v[240:247], v9
    ds_read_b128 v[32:35], v14 offset:8192
    s_waitcnt lgkmcnt(6)
    v_smfmac_f32_16x16x64_bf16 v[44:47], v[36:39], v[248:255], v9
    v_smfmac_f32_16x16x64_bf16 v[48:51], v[36:39], a[0:7], v9
    v_smfmac_f32_16x16x64_bf16 v[52:55], v[36:39], a[8:15], v9
    ds_read_b128 v[36:39], v14 offset:9216
    s_waitcnt lgkmcnt(5)
    s_waitcnt lgkmcnt(4)
    v_smfmac_f32_16x16x64_bf16 v[44:47], v[40:43], v[108:115], v9
    ds_read_b128 v[108:111], v15 offset:12288
    ds_read_b128 v[112:115], v15 offset:13312
    s_waitcnt vmcnt(1)
    v_smfmac_f32_16x16x64_bf16 v[48:51], v[40:43], a[16:23], v9
    s_waitcnt lgkmcnt(3)
    v_smfmac_f32_16x16x64_bf16 v[44:47], v[32:35], a[32:39], v9
    v_smfmac_f32_16x16x64_bf16 v[48:51], v[32:35], a[40:47], v9
    s_waitcnt lgkmcnt(2)
    v_smfmac_f32_16x16x64_bf16 v[44:47], v[36:39], v[116:123], v9
    ds_read_b128 v[116:119], v15 offset:14336
    ds_read_b128 v[120:123], v15 offset:15360
    v_smfmac_f32_16x16x64_bf16 v[48:51], v[36:39], a[56:63], v9
    v_smfmac_f32_16x16x64_bf16 v[52:55], v[40:43], a[24:31], v9
    v_smfmac_f32_16x16x64_bf16 v[52:55], v[32:35], a[48:55], v9
    v_cvt_pk_bf16_f32 v92, v44, v45
    v_cvt_pk_bf16_f32 v93, v46, v47
    v_smfmac_f32_16x16x64_bf16 v[52:55], v[36:39], a[64:71], v9
    s_nop 0
    v_mfma_f32_16x16x16_bf16 v[44:47], v[92:93], v[16:17], 0
    v_cvt_pk_bf16_f32 v94, v48, v49
    v_cvt_pk_bf16_f32 v95, v50, v51
    s_waitcnt lgkmcnt(2)
    v_smfmac_f32_16x16x64_bf16 v[56:59], v[102:105], v[108:115], v9
    ds_read_b128 v[108:111], v15 offset:16384
    ds_read_b128 v[112:115], v15 offset:17408
    s_nop 0
    v_mfma_f32_16x16x16_bf16 v[48:51], v[94:95], v[16:17], 0
    v_cvt_pk_bf16_f32 v96, v52, v53
    v_cvt_pk_bf16_f32 v97, v54, v55
    v_smfmac_f32_16x16x64_bf16 v[60:63], v[102:105], a[88:95], v9
    s_nop 0
    v_mfma_f32_16x16x16_bf16 v[52:55], v[96:97], v[16:17], 0
    v_cvt_pk_bf16_f32 v86, v44, v45
    v_cvt_pk_bf16_f32 v87, v46, v47
    v_smfmac_f32_16x16x64_bf16 v[64:67], v[102:105], a[96:103], v9
    v_cvt_pk_bf16_f32 v88, v48, v49
    v_cvt_pk_bf16_f32 v89, v50, v51
    v_smfmac_f32_16x16x64_bf16 v[56:59], v[40:43], a[200:207], v9
    s_nop 0
    v_mfma_f32_16x16x32_bf16 v[44:47], v[68:71], v[86:89], 0
    v_mfma_f32_16x16x32_bf16 v[48:51], v[72:75], v[86:89], 0
    v_cvt_pk_bf16_f32 v90, v52, v53
    v_cvt_pk_bf16_f32 v91, v54, v55
    s_waitcnt lgkmcnt(2)
    v_smfmac_f32_16x16x64_bf16 v[60:63], v[40:43], v[116:123], v9
    ds_read_b128 v[116:119], v15 offset:18432
    ds_read_b128 v[120:123], v15 offset:19456
    v_smfmac_f32_16x16x64_bf16 v[64:67], v[40:43], a[208:215], v9
    ds_read_b128 v[40:43], v28 offset:0
    v_mfma_f32_16x16x16_bf16 v[44:47], v[76:77], v[90:91], v[44:47]
    v_mfma_f32_16x16x16_bf16 v[48:51], v[78:79], v[90:91], v[48:51]
    v_smfmac_f32_16x16x64_bf16 v[56:59], v[32:35], a[216:223], v9
    v_smfmac_f32_16x16x64_bf16 v[60:63], v[32:35], a[224:231], v9
    v_smfmac_f32_16x16x64_bf16 v[64:67], v[32:35], a[232:239], v9
    ds_read_b128 v[32:35], v28 offset:1024
    v_cndmask_b32 v92, v48, v44, s[74:75]
    v_cndmask_b32 v93, v49, v45, s[74:75]
    v_cndmask_b32 v94, v50, v46, s[74:75]
    v_cndmask_b32 v95, v51, v47, s[74:75]
    ds_write_b128 v18, v[92:95]
    s_waitcnt lgkmcnt(5)
    v_smfmac_f32_16x16x64_bf16 v[56:59], v[36:39], v[108:115], v9
    ds_read_b128 v[108:111], v15 offset:20480
    ds_read_b128 v[112:115], v15 offset:21504
    v_smfmac_f32_16x16x64_bf16 v[60:63], v[36:39], a[240:247], v9
    v_smfmac_f32_16x16x64_bf16 v[64:67], v[36:39], a[248:255], v9
    ds_read_b128 v[36:39], v29 offset:0
    s_waitcnt lgkmcnt(5)
    v_smfmac_f32_16x16x64_bf16 v[56:59], v[40:43], a[104:111], v9
    v_smfmac_f32_16x16x64_bf16 v[60:63], v[40:43], v[116:123], v9
    ds_read_b128 v[116:119], v15 offset:22528
    ds_read_b128 v[120:123], v15 offset:23552
    v_smfmac_f32_16x16x64_bf16 v[64:67], v[40:43], a[112:119], v9
    ds_read_b128 v[40:43], v29 offset:1024
    s_waitcnt lgkmcnt(7)
    v_smfmac_f32_16x16x64_bf16 v[56:59], v[32:35], a[120:127], v9
    s_waitcnt lgkmcnt(6)
    s_barrier
    ds_read_b64 v[92:93], v31 offset:0
    ds_read_b64 v[94:95], v31 offset:1152
    ds_read_b64 v[96:97], v31 offset:2304
    ds_read_b64 v[98:99], v31 offset:3456
    v_smfmac_f32_16x16x64_bf16 v[60:63], v[32:35], a[128:135], v9
    v_smfmac_f32_16x16x64_bf16 v[64:67], v[32:35], a[136:143], v9
    ds_read_b128 v[32:35], v30 offset:0
    s_waitcnt lgkmcnt(9)
    s_waitcnt lgkmcnt(8)
    v_smfmac_f32_16x16x64_bf16 v[56:59], v[36:39], v[108:115], v9
    v_smfmac_f32_16x16x64_bf16 v[60:63], v[36:39], a[144:151], v9
    s_waitcnt lgkmcnt(5)
    v_smfmac_f32_16x16x64_bf16 v[56:59], v[40:43], a[160:167], v9
    s_waitcnt lgkmcnt(3)
    v_add_f32 v92, v92, v94
    v_add_f32 v93, v93, v95
    v_smfmac_f32_16x16x64_bf16 v[60:63], v[40:43], a[168:175], v9
    s_waitcnt lgkmcnt(1)
    v_add_f32 v96, v96, v98
    v_add_f32 v97, v97, v99
    s_waitcnt lgkmcnt(0)
    v_smfmac_f32_16x16x64_bf16 v[56:59], v[32:35], v[116:123], v9
    v_add_f32 v92, v92, v96
    v_add_f32 v93, v93, v97
    v_max_f32 v5, v92, v93
    v_smfmac_f32_16x16x64_bf16 v[60:63], v[32:35], a[184:191], v9
    s_nop 0
    v_max_f32_dpp v5, v5, v5 quad_perm:[1,0,3,2] row_mask:0xf bank_mask:0xf
    v_smfmac_f32_16x16x64_bf16 v[64:67], v[36:39], a[152:159], v9
    s_nop 0
    v_max_f32_dpp v5, v5, v5 quad_perm:[2,3,0,1] row_mask:0xf bank_mask:0xf
    v_smfmac_f32_16x16x64_bf16 v[64:67], v[40:43], a[176:183], v9
    s_nop 0
    v_max_f32_dpp v5, v5, v5 row_half_mirror row_mask:0xf bank_mask:0xf
    v_cvt_pk_bf16_f32 v100, v56, v57
    v_cvt_pk_bf16_f32 v101, v58, v59
    v_smfmac_f32_16x16x64_bf16 v[64:67], v[32:35], a[192:199], v9
    s_nop 0
    v_max_f32_dpp v5, v5, v5 row_mirror row_mask:0xf bank_mask:0xf
    v_cvt_pk_bf16_f32 v102, v60, v61
    v_cvt_pk_bf16_f32 v103, v62, v63
    v_mfma_f32_16x16x16_bf16 v[56:59], v[100:101], v[124:125], 0
    v_mul_f32 v5, s78, v5
    v_mfma_f32_16x16x16_bf16 v[60:63], v[102:103], v[124:125], 0
    v_fma_f32 v92, v92, s78, -v5
    v_fma_f32 v93, v93, s78, -v5
    v_exp_f32 v92, v92
    v_cvt_pk_bf16_f32 v126, v64, v65
    v_cvt_pk_bf16_f32 v127, v66, v67
    v_exp_f32 v93, v93
    s_cmp_lt_u32 s53, 2
    v_mfma_f32_16x16x16_bf16 v[64:67], v[126:127], v[124:125], 0
    v_cvt_pk_bf16_f32 v96, v92, v93
    buffer_store_dword v96, v22, s[4:7], s64 offen
    v_cvt_pk_bf16_f32 v80, v56, v57
    v_cvt_pk_bf16_f32 v81, v58, v59
    v_cvt_pk_bf16_f32 v82, v60, v61
    v_cvt_pk_bf16_f32 v83, v62, v63
    v_add_f32 v6, v92, v93
    s_nop 0
    v_mfma_f32_16x16x32_bf16 v[52:55], v[80:83], v[86:89], 0
    v_cvt_pk_bf16_f32 v84, v64, v65
    v_cvt_pk_bf16_f32 v85, v66, v67
    v_add_f32_dpp v6, v6, v6 quad_perm:[1,0,3,2] row_mask:0xf bank_mask:0xf
    s_nop 1
    v_add_f32_dpp v6, v6, v6 quad_perm:[2,3,0,1] row_mask:0xf bank_mask:0xf
    v_mfma_f32_16x16x16_bf16 v[52:55], v[84:85], v[90:91], v[52:55]
    s_nop 0
    v_add_f32_dpp v6, v6, v6 row_half_mirror row_mask:0xf bank_mask:0xf
    s_nop 1
    v_add_f32_dpp v6, v6, v6 row_mirror row_mask:0xf bank_mask:0xf
    s_nop 2
    ds_write_b64 v20, v[52:53]
    s_waitcnt lgkmcnt(0)
    s_barrier
    s_cbranch_scc0 L_s_nolate
    ds_read2_b64 v[100:103], v21 offset0:0 offset1:72
    s_waitcnt lgkmcnt(0)
    v_add_f32 v100, v100, v102
    v_add_f32 v101, v101, v103
    s_nop 0
    v_add_f32_dpp v100, v100, v100 row_ror:8 row_mask:0xf bank_mask:0xf
    v_add_f32_dpp v101, v101, v101 row_ror:8 row_mask:0xf bank_mask:0xf
    v_fma_f32 v102, v100, s78, -v5
    v_fma_f32 v103, v101, s78, -v5
    v_exp_f32 v104, v102
    v_exp_f32 v105, v103
    v_max_f32 v102, v102, v103
    v_add_f32 v106, v104, v105
    v_cmp_nge_f32 vcc, s62, v102
    v_cndmask_b32 v104, v104, v26, s[76:77]
    v_add_f32_dpp v106, v106, v106 quad_perm:[1,0,3,2] row_mask:0xf bank_mask:0xf
    v_cndmask_b32 v105, v105, v27, s[76:77]
    s_cbranch_vccnz L_s_exact
    v_add_f32_dpp v106, v106, v106 quad_perm:[2,3,0,1] row_mask:0xf bank_mask:0xf
    v_add_f32 v106, v106, v6
L_s_norm:
    v_rcp_f32 v106, v106
    s_nop 0
    v_mul_f32 v104, v104, v106
    v_mul_f32 v105, v105, v106
    v_cvt_pk_bf16_f32 v100, v104, v105
    v_min_u32 v100, -2, v100
    buffer_store_dword v100, v23, s[4:7], s65 offen
L_s_nolate:
    s_barrier
    ds_read_b128 v[108:111], v15 offset:0
    ds_read_b128 v[112:115], v15 offset:1024
    ds_read_b128 v[116:119], v15 offset:2048
    ds_read_b128 v[120:123], v15 offset:3072
    v_mov_b32 v44, 0
    v_mov_b32 v45, 0
    v_mov_b32 v46, 0
    v_mov_b32 v47, 0
    v_mov_b32 v48, 0
    v_mov_b32 v49, 0
    v_mov_b32 v50, 0
    v_mov_b32 v51, 0
    v_mov_b32 v52, 0
    v_mov_b32 v53, 0
    v_mov_b32 v54, 0
    v_mov_b32 v55, 0
    v_mov_b32 v56, 0
    v_mov_b32 v57, 0
    v_mov_b32 v58, 0
    v_mov_b32 v59, 0
    v_mov_b32 v60, 0
    v_mov_b32 v61, 0
    v_mov_b32 v62, 0
    v_mov_b32 v63, 0
    v_mov_b32 v64, 0
    v_mov_b32 v65, 0
    v_mov_b32 v66, 0
    v_mov_b32 v67, 0
    s_waitcnt lgkmcnt(0)
    v_mov_b32 v92, -1
    v_mov_b32 v93, -1
    s_add_u32 s56, s64, 1048576
    s_bitset0_b32 s56, 21
    s_add_u32 s57, s65, 1048576
    s_bitset0_b32 s57, 21
    buffer_store_dword v92, v22, s[4:7], s56 offen
    buffer_store_dword v92, v23, s[4:7], s57 offen
    buffer_store_dwordx4 v[80:83], v19, s[4:7], s69 offen
    buffer_store_dwordx2 v[84:85], v25, s[4:7], s70 offen
    s_add_u32 s73, s55, 2
    s_min_u32 s73, s73, 64
    s_waitcnt vmcnt(5)
    v_cmp_gt_u32 vcc, s73, v2
    s_cbranch_vccnz L_s_kwait
L_s_kok:
    buffer_load_dwordx4 v[68:71], v19, s[4:7], s67 offen sc1
    buffer_load_dwordx4 v[72:75], v19, s[4:7], s67 offen offset:1024 sc1
    s_add_u32 s67, s67, 393216
    buffer_load_dwordx2 v[76:77], v25, s[4:7], s68 offen sc1
    buffer_load_dwordx2 v[78:79], v25, s[4:7], s68 offen offset:1024 sc1
    s_add_u32 s68, s68, 393216
    s_add_u32 s69, s69, 262144
    s_bitset0_b32 s69, 20
    s_add_u32 s70, s70, 262144
    s_bitset0_b32 s70, 20
    s_add_u32 s64, s64, 524288
    s_bitset0_b32 s64, 21
    s_add_u32 s65, s65, 524288
    s_bitset0_b32 s65, 21
    s_add_u32 s71, s71, 524288
    s_bitset0_b32 s71, 21
    s_add_u32 s55, s55, 1
    s_cmp_lt_u32 s55, 64
    s_cbranch_scc1 L_s_loop
    s_waitcnt vmcnt(0)
    v_mov_b32 v4, s55
    buffer_store_dword v4, v8, s[4:7], s66 offen
    s_branch L_end
L_s_kwait:
    s_mov_b32 s96, 2000000
L_wf_6:
    buffer_load_dword v2, v24, s[4:7], 0 offen sc1
    s_sub_u32 s96, s96, 1
    s_cbranch_scc1 L_fail
    s_waitcnt vmcnt(0)
    v_cmp_gt_u32 vcc, s73, v2
    s_cbranch_vccz L_wf_6_d
    s_sleep 4
    s_branch L_wf_6
L_wf_6_d:
    s_branch L_s_kok
L_s_exact:
    v_max_f32 v102, v100, v101
    s_nop 1
    v_max_f32_dpp v102, v102, v102 quad_perm:[1,0,3,2] row_mask:0xf bank_mask:0xf
    s_nop 1
    v_max_f32_dpp v102, v102, v102 quad_perm:[2,3,0,1] row_mask:0xf bank_mask:0xf
    v_mul_f32 v102, s78, v102
    v_max_f32 v102, v102, v5
    v_fma_f32 v104, v100, s78, -v102
    v_fma_f32 v105, v101, s78, -v102
    v_sub_f32 v103, v5, v102
    v_exp_f32 v104, v104
    v_exp_f32 v105, v105
    v_exp_f32 v103, v103
    v_add_f32 v106, v104, v105
    v_mul_f32 v100, v26, v103
    v_mul_f32 v101, v27, v103
    v_add_f32_dpp v106, v106, v106 quad_perm:[1,0,3,2] row_mask:0xf bank_mask:0xf
    v_cndmask_b32 v104, v104, v100, s[76:77]
    v_cndmask_b32 v105, v105, v101, s[76:77]
    v_add_f32_dpp v106, v106, v106 quad_perm:[2,3,0,1] row_mask:0xf bank_mask:0xf
    v_fmac_f32 v106, v6, v103
    s_branch L_s_norm
L_roleC:
    s_mov_b32 s12, s26
    s_mov_b32 s13, s27
    s_mov_b32 s14, 10240
    s_mov_b32 s15, 0x20000
    s_sub_u32 s54, s52, 32
    s_mul_i32 s74, s54, 205
    s_lshr_b32 s74, s74, 11
    s_mul_i32 s56, s74, 10
    s_sub_u32 s76, s54, s56
    s_lshl_b32 s75, s76, 2
    s_add_u32 s75, s75, s53
    v_mov_b32 v8, 0
    v_lshlrev_b32 v10, 4, v1
    v_lshlrev_b32 v11, 3, v1
    v_lshlrev_b32 v12, 2, v1
    s_lshl_b32 s72, s54, 7
    s_add_u32 s72, s72, 212992
    s_lshl_b32 s79, s74, 7
    s_add_u32 s79, s79, 21069824
    s_cmp_eq_u32 s75, 0
    s_cselect_b32 s56, 0, 0x40000000
    v_mov_b32 v17, s56
    buffer_store_dword v8, v17, s[4:7], s79 offen sc1
    buffer_store_dword v8, v8, s[4:7], s72 offen sc1
    s_add_u32 s56, s72, 8192
    buffer_store_dword v8, v8, s[4:7], s56 offen sc1
    s_lshl_b32 s64, s74, 14
    s_lshl_b32 s56, s75, 8
    s_add_u32 s64, s64, s56
    s_add_u32 s64, s64, 20971520
    v_bfe_u32 v4, v1, 2, 3
    v_mul_u32_u24 v4, 1280, v4
    v_and_b32 v5, 3, v1
    v_lshl_add_u32 v4, v5, 3, v4
    v_lshrrev_b32 v5, 5, v1
    v_lshl_add_u32 v4, v5, 2, v4
    s_lshl_b32 s56, s75, 5
    buffer_load_dword v5, v4, s[12:15], s56 offen
    v_mov_b32 v26, -1
    v_mov_b32 v27, -1
    s_add_u32 s56, s64, 524288
    s_add_u32 s57, s64, 1048576
    buffer_store_dword v26, v12, s[4:7], s56 offen sc1
    buffer_store_dword v26, v12, s[4:7], s57 offen sc1
    s_lshl_b32 s70, s76, 14
    s_lshl_b32 s56, s53, 11
    s_add_u32 s70, s70, s56
    s_add_u32 s70, s70, 0
    s_lshl_b32 s77, s74, 8
    s_add_u32 s58, s70, s77
    s_add_u32 s56, s58, 0
    buffer_store_dword v26, v12, s[4:7], s56 offen sc1
    s_add_u32 s56, s58, 8192
    buffer_store_dword v26, v12, s[4:7], s56 offen sc1
    s_add_u32 s56, s58, 262144
    buffer_store_dword v26, v12, s[4:7], s56 offen sc1
    s_add_u32 s56, s58, 270336
    buffer_store_dword v26, v12, s[4:7], s56 offen sc1
    s_lshl_b32 s56, s75, 12
    s_lshl_b32 s57, s74, 10
    s_add_u32 s56, s56, s57
    s_add_u32 s56, s56, 66945024
    buffer_store_dwordx2 v[26:27], v11, s[4:7], s56 offen sc1
    buffer_store_dwordx2 v[26:27], v11, s[4:7], s56 offen offset:512 sc1
    s_waitcnt vmcnt(8)
    v_min_u32 v5, -2, v5
    buffer_store_dword v5, v12, s[4:7], s64 offen sc1
    s_waitcnt vmcnt(0)
    s_barrier
    s_cmp_eq_u32 s53, 3
    s_cbranch_scc0 L_arr_7
    s_mov_b64 exec, 1
    v_mov_b32 v4, 1
    v_mov_b32 v5, 8
    buffer_atomic_add v4, v5, s[8:11], 0 offen sc0
    s_mov_b64 exec, -1
L_arr_7:
    s_waitcnt vmcnt(0)
    s_cmp_eq_u32 s53, 3
    s_cbranch_scc0 L_arr_8
    s_mov_b64 exec, 1
    v_cmp_eq_u32 vcc, 255, v4
    s_cbranch_vccz L_arr_8_x
    v_mov_b32 v5, 8
    buffer_load_dwordx3 v[4:6], v5, s[8:11], 0 offen offset:8 sc1
    s_waitcnt vmcnt(0)
    v_cmp_lt_u32 vcc, v4, v5
    v_mov_b32 v4, 0x2001
    v_lshlrev_b32 v6, 1, v6
    v_cndmask_b32 v4, 1, v4, vcc
    v_or_b32 v4, v4, v6
    v_mov_b32 v5, 252
    buffer_store_dword v4, v5, s[8:11], 0 offen sc1
L_arr_8_x:
    s_mov_b64 exec, -1
L_arr_8:
    s_mov_b32 s96, 2000000
    v_mov_b32 v5, 252
L_aw_9:
    buffer_load_dword v4, v5, s[8:11], 0 offen sc1
    s_sub_u32 s96, s96, 1
    s_cbranch_scc1 L_fail
    s_waitcnt vmcnt(0)
    v_cmp_eq_u32 vcc, 0, v4
    s_cbranch_vccz L_aw_9_d
    s_sleep 16
    s_branch L_aw_9
L_aw_9_d:
    v_readfirstlane_b32 s61, v4
    s_nop 3
    s_and_b32 s60, s61, 8192
    s_and_b32 s3, s61, 2
    s_add_u32 s72, s72, s60
    v_mov_b32 v4, 0x4444
    v_mov_b32 v5, 0xeeee
    v_cmp_gt_u32 vcc, 8, v3
    s_nop 1
    v_cndmask_b32 v9, v5, v4, vcc
    v_lshrrev_b32 v4, 2, v3
    v_lshlrev_b32 v4, 8, v4
    v_lshl_add_u32 v4, v2, 6, v4
    v_and_b32 v5, 3, v3
    v_lshl_add_u32 v13, v5, 4, v4
    v_lshlrev_b32 v4, 4, v5
    v_lshl_add_u32 v4, v2, 8, v4
    v_bfe_u32 v5, v3, 2, 1
    v_lshl_add_u32 v4, v5, 7, v4
    v_lshrrev_b32 v5, 3, v3
    v_lshl_add_u32 v66, v5, 6, v4
    s_lshl_b32 s65, s74, 12
    s_add_u32 s65, s65, 21037056
    s_lshl_b32 s56, s74, 11
    s_add_u32 s66, s56, 21053440
    s_lshl_b32 s67, s75, 13
    s_add_u32 s67, s67, s56
    s_add_u32 s67, s67, 21102592
    s_mul_i32 s68, s74, 327680
    s_lshl_b32 s57, s75, 13
    s_add_u32 s68, s68, s57
    s_add_u32 s68, s68, 164626432
    s_lshl_b32 s57, s75, 13
    s_add_u32 s36, s57, s56
    s_lshr_b32 s36, s36, 1
    s_add_u32 s36, s36, 56623104
    s_lshl_b32 s41, s74, 14
    s_lshl_b32 s56, s53, 12
    s_add_u32 s41, s41, s56
    s_add_u32 s41, s41, 21430272
    s_mov_b32 s45, s56
    s_mul_i32 s56, s75, 205
    s_lshr_b32 s56, s56, 11
    s_lshl_b32 s56, s56, 5
    s_lshl_b32 s57, s74, 3
    s_add_u32 s56, s56, s57
    s_add_u32 s56, s56, 147840
    v_and_b32 v4, 7, v1
    v_add_lshl_u32 v60, v4, s56, 7
    s_lshl_b32 s56, s74, 4
    s_add_u32 s56, s56, 148032
    v_add_lshl_u32 v25, v3, s56, 7
    v_mov_b32 v16, 0
    v_bfe_u32 v4, v1, 3, 1
    v_lshlrev_b32 v4, 2, v4
    v_bfe_u32 v5, v1, 4, 1
    v_lshl_add_u32 v4, v5, 1, v4
    v_lshrrev_b32 v6, 5, v1
    v_add_u32 v4, v4, v6
    v_and_b32 v5, 1, v1
    v_lshl_add_u32 v4, v5, 3, v4
    v_lshlrev_b32 v4, 4, v4
    v_bfe_u32 v5, v1, 1, 2
    v_lshl_add_u32 v20, v5, 2, v4
    v_lshrrev_b32 v4, 3, v3
    v_lshlrev_b32 v4, 9, v4
    v_lshl_add_u32 v4, v2, 7, v4
    v_and_b32 v5, 7, v1
    v_lshl_add_u32 v21, v5, 4, v4
    s_lshl_b32 s39, s53, 10
    s_add_u32 s56, s39, 32768
    v_add_u32 v62, s56, v10
    v_mov_b32 v240, -1
    v_mov_b32 v241, -1
    v_mov_b32 v242, -1
    v_mov_b32 v243, -1
    s_mov_b32 s46, -1
    s_mov_b32 s47, 0
    s_mov_b32 s55, 0
    v_lshrrev_b32 v4, 3, v3
    v_lshlrev_b32 v4, 1, v4
    v_and_b32 v5, 3, v3
    v_add_u32 v4, v4, v5
    v_lshrrev_b32 v5, 1, v5
    v_lshl_add_u32 v4, v5, 3, v4
    v_bfe_u32 v5, v3, 2, 1
    v_lshlrev_b32 v5, 4, v5
    v_mov_b32 v6, 0x3f80
    v_lshlrev_b32 v6, v5, v6
    v_cmp_eq_u32 vcc, 0, v4
    s_nop 1
    v_cndmask_b32 v244, 0, v6, vcc
    v_cmp_eq_u32 vcc, 1, v4
    s_nop 1
    v_cndmask_b32 v245, 0, v6, vcc
    v_cmp_eq_u32 vcc, 2, v4
    s_nop 1
    v_cndmask_b32 v246, 0, v6, vcc
    v_cmp_eq_u32 vcc, 3, v4
    s_nop 1
    v_cndmask_b32 v247, 0, v6, vcc
    buffer_load_dwordx4 v[28:31], v13, s[4:7], s65 offen offset:0 sc1
    buffer_load_dwordx4 v[32:35], v13, s[4:7], s65 offen offset:1024 sc1
    buffer_load_dwordx4 v[36:39], v13, s[4:7], s65 offen offset:2048 sc1
    buffer_load_dwordx4 v[40:43], v13, s[4:7], s65 offen offset:3072 sc1
    buffer_load_dwordx4 v[116:119], v66, s[4:7], s66 offen sc1
    buffer_load_dwordx4 v[120:123], v66, s[4:7], s66 offen offset:1024 sc1
    buffer_load_dwordx4 v[68:71], v10, s[4:7], s67 offen offset:0 sc1
    buffer_load_dwordx4 v[76:79], v10, s[4:7], s67 offen offset:1024 sc1
    buffer_load_dwordx4 v[160:163], v10, s[4:7], s41 offen offset:0 sc1
    buffer_load_dwordx4 v[160:163], v10, s[4:7], s41 offen offset:1024 sc1
    buffer_load_dwordx4 v[160:163], v10, s[4:7], s41 offen offset:2048 sc1
    buffer_load_dwordx4 v[160:163], v10, s[4:7], s41 offen offset:3072 sc1
    buffer_load_dword v160, v12, s[4:7], s64 offen sc1
    s_add_u32 s65, s65, 524288
    s_bitset0_b32 s65, 21
    s_add_u32 s66, s66, 524288
    s_bitset0_b32 s66, 21
    s_add_u32 s67, s67, 524288
    s_bitset0_b32 s67, 21
    s_add_u32 s41, s41, 524288
    s_bitset0_b32 s41, 21
    s_add_u32 s64, s64, 524288
    s_bitset0_b32 s64, 21
    buffer_load_dwordx4 v[28:31], v13, s[4:7], s65 offen offset:0 sc1
    buffer_load_dwordx4 v[32:35], v13, s[4:7], s65 offen offset:1024 sc1
    buffer_load_dwordx4 v[36:39], v13, s[4:7], s65 offen offset:2048 sc1
    buffer_load_dwordx4 v[40:43], v13, s[4:7], s65 offen offset:3072 sc1
    buffer_load_dwordx4 v[116:119], v66, s[4:7], s66 offen sc1
    buffer_load_dwordx4 v[120:123], v66, s[4:7], s66 offen offset:1024 sc1
    buffer_load_dwordx4 v[68:71], v10, s[4:7], s67 offen offset:0 sc1
    buffer_load_dwordx4 v[76:79], v10, s[4:7], s67 offen offset:1024 sc1
    buffer_load_dwordx4 v[160:163], v10, s[4:7], s41 offen offset:0 sc1
    buffer_load_dwordx4 v[160:163], v10, s[4:7], s41 offen offset:1024 sc1
    buffer_load_dwordx4 v[160:163], v10, s[4:7], s41 offen offset:2048 sc1
    buffer_load_dwordx4 v[160:163], v10, s[4:7], s41 offen offset:3072 sc1
    buffer_load_dword v160, v12, s[4:7], s64 offen sc1
    s_add_u32 s65, s65, 524288
    s_bitset0_b32 s65, 21
    s_add_u32 s66, s66, 524288
    s_bitset0_b32 s66, 21
    s_add_u32 s67, s67, 524288
    s_bitset0_b32 s67, 21
    s_add_u32 s41, s41, 524288
    s_bitset0_b32 s41, 21
    s_add_u32 s64, s64, 524288
    s_bitset0_b32 s64, 21
    buffer_load_dwordx4 v[28:31], v13, s[4:7], s65 offen offset:0 sc1
    buffer_load_dwordx4 v[32:35], v13, s[4:7], s65 offen offset:1024 sc1
    buffer_load_dwordx4 v[36:39], v13, s[4:7], s65 offen offset:2048 sc1
    buffer_load_dwordx4 v[40:43], v13, s[4:7], s65 offen offset:3072 sc1
    buffer_load_dwordx4 v[116:119], v66, s[4:7], s66 offen sc1
    buffer_load_dwordx4 v[120:123], v66, s[4:7], s66 offen offset:1024 sc1
    buffer_load_dwordx4 v[68:71], v10, s[4:7], s67 offen offset:0 sc1
    buffer_load_dwordx4 v[76:79], v10, s[4:7], s67 offen offset:1024 sc1
    buffer_load_dwordx4 v[160:163], v10, s[4:7], s41 offen offset:0 sc1
    buffer_load_dwordx4 v[160:163], v10, s[4:7], s41 offen offset:1024 sc1
    buffer_load_dwordx4 v[160:163], v10, s[4:7], s41 offen offset:2048 sc1
    buffer_load_dwordx4 v[160:163], v10, s[4:7], s41 offen offset:3072 sc1
    buffer_load_dword v160, v12, s[4:7], s64 offen sc1
    s_add_u32 s65, s65, 524288
    s_bitset0_b32 s65, 21
    s_add_u32 s66, s66, 524288
    s_bitset0_b32 s66, 21
    s_add_u32 s67, s67, 524288
    s_bitset0_b32 s67, 21
    s_add_u32 s41, s41, 524288
    s_bitset0_b32 s41, 21
    s_add_u32 s64, s64, 524288
    s_bitset0_b32 s64, 21
    buffer_load_dwordx4 v[28:31], v13, s[4:7], s65 offen offset:0 sc1
    buffer_load_dwordx4 v[32:35], v13, s[4:7], s65 offen offset:1024 sc1
    buffer_load_dwordx4 v[36:39], v13, s[4:7], s65 offen offset:2048 sc1
    buffer_load_dwordx4 v[40:43], v13, s[4:7], s65 offen offset:3072 sc1
    buffer_load_dwordx4 v[116:119], v66, s[4:7], s66 offen sc1
    buffer_load_dwordx4 v[120:123], v66, s[4:7], s66 offen offset:1024 sc1
    buffer_load_dwordx4 v[68:71], v10, s[4:7], s67 offen offset:0 sc1
    buffer_load_dwordx4 v[76:79], v10, s[4:7], s67 offen offset:1024 sc1
    buffer_load_dwordx4 v[160:163], v10, s[4:7], s41 offen offset:0 sc1
    buffer_load_dwordx4 v[160:163], v10, s[4:7], s41 offen offset:1024 sc1
    buffer_load_dwordx4 v[160:163], v10, s[4:7], s41 offen offset:2048 sc1
    buffer_load_dwordx4 v[160:163], v10, s[4:7], s41 offen offset:3072 sc1
    buffer_load_dword v160, v12, s[4:7], s64 offen sc1
    s_add_u32 s65, s65, 524288
    s_bitset0_b32 s65, 21
    s_add_u32 s66, s66, 524288
    s_bitset0_b32 s66, 21
    s_add_u32 s67, s67, 524288
    s_bitset0_b32 s67, 21
    s_add_u32 s41, s41, 524288
    s_bitset0_b32 s41, 21
    s_add_u32 s64, s64, 524288
    s_bitset0_b32 s64, 21
    s_sub_u32 s58, s55, 1
    s_add_u32 s59, s55, 1
    s_min_u32 s40, s59, 64
    s_mov_b32 s96, 2000000
L_wf_10:
    buffer_load_dword v16, v60, s[4:7], 0 offen sc1
    s_sub_u32 s96, s96, 1
    s_cbranch_scc1 L_fail
    s_waitcnt vmcnt(0)
    v_cmp_gt_u32 vcc, s40, v16
    s_cbranch_vccz L_wf_10_d
    s_sleep 2
    s_branch L_wf_10
L_wf_10_d:
    s_add_u32 s59, s68, 4096
    buffer_load_dwordx4 a[0:3], v10, s[4:7], s68 offen offset:0 sc1
    buffer_load_dwordx4 a[4:7], v10, s[4:7], s68 offen offset:1024 sc1
    buffer_load_dwordx4 a[8:11], v10, s[4:7], s68 offen offset:2048 sc1
    buffer_load_dwordx4 a[12:15], v10, s[4:7], s68 offen offset:3072 sc1
    buffer_load_dwordx4 a[16:19], v10, s[4:7], s59 offen offset:0 sc1
    buffer_load_dwordx4 a[20:23], v10, s[4:7], s59 offen offset:1024 sc1
    buffer_load_dwordx4 a[24:27], v10, s[4:7], s59 offen offset:2048 sc1
    buffer_load_dwordx4 a[28:31], v10, s[4:7], s59 offen offset:3072 sc1
    s_add_u32 s68, s68, 1310720
    s_cmp_eq_u32 s3, 0
    s_cbranch_scc0 L_c_slow
L_c_loop:
    s_add_u32 s69, s70, 0
    s_lshr_b32 s97, s69, 8
    s_xor_b32 s97, s97, s60
    s_and_b32 s97, s97, 8192
    s_add_u32 s69, s69, s97
    s_add_u32 s71, s69, s77
    s_add_u32 s48, s69, 1048576
    s_add_u32 s49, s71, 1048576
    v_mov_b32 v132, 0
    v_mov_b32 v133, 0
    v_mov_b32 v134, 0
    v_mov_b32 v135, 0
    s_add_u32 s64, s64, 524288
    s_bitset0_b32 s64, 21
    s_add_u32 s62, s55, 1
    s_lshl_b32 s62, s62, 1
    v_mov_b32 v18, s62
    v_add_u32 v63, -1, v18
    s_waitcnt vmcnt(0) lgkmcnt(0)
    s_barrier
L_c_re0:
    s_mov_b32 s96, 2000000
L_poll_11:
    buffer_load_dwordx4 v[28:31], v13, s[4:7], s65 offen offset:0 sc1
    buffer_load_dwordx4 v[32:35], v13, s[4:7], s65 offen offset:1024 sc1
    buffer_load_dwordx4 v[36:39], v13, s[4:7], s65 offen offset:2048 sc1
    buffer_load_dwordx4 v[40:43], v13, s[4:7], s65 offen offset:3072 sc1
    s_sub_u32 s96, s96, 1
    s_cbranch_scc1 L_fail
    s_waitcnt vmcnt(0)
    v_max3_u32 v7, v31, v35, v39
    v_max_u32 v7, v7, v43
    v_cmp_eq_u32 vcc, -1, v7
    s_cbranch_vccnz L_poll_11
    v_mfma_f32_16x16x32_bf16 v[84:87], v[28:31], a[0:3], 0
    v_max3_u32 v7, v7, v28, v29
    v_max_u32 v7, v7, v30
    v_mfma_f32_16x16x32_bf16 v[88:91], v[28:31], a[4:7], 0
    v_max3_u32 v7, v7, v32, v33
    v_max_u32 v7, v7, v34
    buffer_load_dwordx4 v[68:71], v10, s[4:7], s67 offen offset:0 sc1
    buffer_load_dwordx4 v[76:79], v10, s[4:7], s67 offen offset:1024 sc1
    v_mfma_f32_16x16x32_bf16 v[92:95], v[32:35], a[8:11], 0
    v_max3_u32 v7, v7, v36, v37
    v_max_u32 v7, v7, v38
    v_mfma_f32_16x16x32_bf16 v[96:99], v[32:35], a[12:15], 0
    v_max3_u32 v7, v7, v40, v41
    v_max_u32 v7, v7, v42
    v_cmp_eq_u32 vcc, -1, v7
    s_cbranch_vccnz L_c_re0
    buffer_load_dwordx4 v[116:119], v66, s[4:7], s66 offen sc1
    buffer_load_dwordx4 v[120:123], v66, s[4:7], s66 offen offset:1024 sc1
    v_mfma_f32_16x16x32_bf16 v[100:103], v[36:39], a[16:19], 0
    v_cndmask_b32 v84, v88, v84, s[46:47]
    v_cndmask_b32 v85, v89, v85, s[46:47]
    v_mfma_f32_16x16x32_bf16 v[104:107], v[36:39], a[20:23], 0
    v_cndmask_b32 v86, v90, v86, s[46:47]
    v_cndmask_b32 v87, v91, v87, s[46:47]
    v_mfma_f32_16x16x32_bf16 v[108:111], v[40:43], a[24:27], 0
    v_cvt_pk_bf16_f32 v72, v84, v85
    v_cvt_pk_bf16_f32 v73, v86, v87
    v_mfma_f32_16x16x32_bf16 v[112:115], v[40:43], a[28:31], 0
    v_cndmask_b32 v92, v96, v92, s[46:47]
    v_cndmask_b32 v93, v97, v93, s[46:47]
    v_cndmask_b32 v94, v98, v94, s[46:47]
    v_cndmask_b32 v95, v99, v95, s[46:47]
    v_cvt_pk_bf16_f32 v74, v92, v93
    v_cvt_pk_bf16_f32 v75, v94, v95
    v_cndmask_b32 v100, v104, v100, s[46:47]
    v_cndmask_b32 v101, v105, v101, s[46:47]
    v_cndmask_b32 v102, v106, v102, s[46:47]
    v_cndmask_b32 v103, v107, v103, s[46:47]
    v_cvt_pk_bf16_f32 v80, v100, v101
    v_cvt_pk_bf16_f32 v81, v102, v103
    v_cndmask_b32 v108, v112, v108, s[46:47]
    v_cndmask_b32 v109, v113, v109, s[46:47]
    v_cndmask_b32 v110, v114, v110, s[46:47]
    v_cndmask_b32 v111, v115, v111, s[46:47]
    v_cvt_pk_bf16_f32 v82, v108, v109
    v_cvt_pk_bf16_f32 v83, v110, v111
    s_waitcnt vmcnt(2)
    v_max3_u32 v7, v68, v69, v70
    v_max3_u32 v7, v7, v71, v76
    v_max3_u32 v7, v7, v77, v78
    v_max_u32 v7, v7, v79
    v_cmp_eq_u32 vcc, -1, v7
    s_cbranch_vccz L_c_zok0
    s_mov_b32 s96, 2000000
L_poll_12:
    buffer_load_dwordx4 v[68:71], v10, s[4:7], s67 offen offset:0 sc1
    buffer_load_dwordx4 v[76:79], v10, s[4:7], s67 offen offset:1024 sc1
    buffer_load_dwordx4 v[116:119], v66, s[4:7], s66 offen sc1
    buffer_load_dwordx4 v[120:123], v66, s[4:7], s66 offen offset:1024 sc1
    s_sub_u32 s96, s96, 1
    s_cbranch_scc1 L_fail
    s_waitcnt vmcnt(0)
    v_max3_u32 v7, v68, v69, v70
    v_max3_u32 v7, v7, v71, v76
    v_max3_u32 v7, v7, v77, v78
    v_max_u32 v7, v7, v79
    v_cmp_eq_u32 vcc, -1, v7
    s_cbranch_vccnz L_poll_12
L_c_zok0:
    s_mov_b32 s96, 2000000
L_c_lp0:
    s_waitcnt vmcnt(0)
    v_smfmac_f32_16x16x64_bf16 v[132:135], v[116:119], v[68:75], v9
    v_smfmac_f32_16x16x64_bf16 v[132:135], v[120:123], v[76:83], v9
    v_max3_u32 v7, v116, v117, v118
    v_max3_u32 v7, v7, v119, v120
    v_max3_u32 v7, v7, v121, v122
    v_max_u32 v7, v7, v123
    v_cmp_eq_u32 vcc, -1, v7
    s_cbranch_vccz L_c_red0
    buffer_load_dwordx4 v[116:119], v66, s[4:7], s66 offen sc1
    buffer_load_dwordx4 v[120:123], v66, s[4:7], s66 offen offset:1024 sc1
    s_nop 1
    v_mov_b32 v132, 0
    v_mov_b32 v133, 0
    v_mov_b32 v134, 0
    v_mov_b32 v135, 0
    s_sub_u32 s96, s96, 1
    s_cbranch_scc1 L_fail
    s_branch L_c_lp0
L_c_red0:
    s_nop 1
    v_permlane32_swap_b32 v132, v134
    v_permlane32_swap_b32 v133, v135
    v_add_f32 v132, v132, v134
    v_add_f32 v133, v133, v135
    v_cvt_pk_bf16_f32 v132, v132, v133
    buffer_store_dword v132, v12, s[4:7], s71 offen sc1
    ds_read_b128 v[160:163], v10 offset:0
    ds_read_b128 v[164:167], v10 offset:1024
    ds_read_b128 v[168:171], v10 offset:2048
    ds_read_b128 v[172:175], v10 offset:3072
    ds_read_b128 v[176:179], v10 offset:4096
    ds_read_b128 v[180:183], v10 offset:5120
    ds_read_b128 v[184:187], v10 offset:6144
    ds_read_b128 v[188:191], v10 offset:7168
    ds_read_b128 v[192:195], v10 offset:8192
    ds_read_b128 v[196:199], v10 offset:9216
    ds_read_b128 v[200:203], v10 offset:10240
    ds_read_b128 v[204:207], v10 offset:11264
    ds_read_b128 v[208:211], v10 offset:12288
    ds_read_b128 v[212:215], v10 offset:13312
    ds_read_b128 v[216:219], v10 offset:14336
    ds_read_b128 v[220:223], v10 offset:15360
    s_waitcnt lgkmcnt(15)
    v_mfma_f32_16x16x32_bf16 v[152:155], a[80:83], v[160:163], 0
    s_waitcnt lgkmcnt(14)
    v_mfma_f32_16x16x32_bf16 v[152:155], a[84:87], v[164:167], v[152:155]
    s_waitcnt lgkmcnt(13)
    v_mfma_f32_16x16x32_bf16 v[152:155], a[88:91], v[168:171], v[152:155]
    s_waitcnt lgkmcnt(12)
    v_mfma_f32_16x16x32_bf16 v[152:155], a[92:95], v[172:175], v[152:155]
    s_waitcnt lgkmcnt(11)
    v_mfma_f32_16x16x32_bf16 v[152:155], a[96:99], v[176:179], v[152:155]
    s_waitcnt lgkmcnt(10)
    v_mfma_f32_16x16x32_bf16 v[152:155], a[100:103], v[180:183], v[152:155]
    s_waitcnt lgkmcnt(9)
    v_mfma_f32_16x16x32_bf16 v[152:155], a[104:107], v[184:187], v[152:155]
    s_waitcnt lgkmcnt(8)
    v_mfma_f32_16x16x32_bf16 v[152:155], a[108:111], v[188:191], v[152:155]
    s_waitcnt lgkmcnt(7)
    v_mfma_f32_16x16x16_bf16 v[148:151], a[80:81], v[192:193], 0
    v_mfma_f32_16x16x16_bf16 v[148:151], a[84:85], v[194:195], v[148:151]
    s_waitcnt lgkmcnt(6)
    v_mfma_f32_16x16x16_bf16 v[148:151], a[88:89], v[196:197], v[148:151]
    v_mfma_f32_16x16x16_bf16 v[148:151], a[92:93], v[198:199], v[148:151]
    s_waitcnt lgkmcnt(5)
    v_mfma_f32_16x16x16_bf16 v[148:151], a[96:97], v[200:201], v[148:151]
    v_mfma_f32_16x16x16_bf16 v[148:151], a[100:101], v[202:203], v[148:151]
    s_waitcnt lgkmcnt(4)
    v_mfma_f32_16x16x16_bf16 v[148:151], a[104:105], v[204:205], v[148:151]
    v_mfma_f32_16x16x16_bf16 v[148:151], a[108:109], v[206:207], v[148:151]
    s_waitcnt lgkmcnt(0)
    v_mfma_f32_16x16x32_bf16 v[152:155], a[112:115], v[216:219], v[152:155]
    v_mfma_f32_16x16x32_bf16 v[152:155], a[116:119], v[220:223], v[152:155]
    v_accvgpr_write_b32 a32, v68
    v_accvgpr_write_b32 a33, v69
    v_accvgpr_write_b32 a34, v70
    v_accvgpr_write_b32 a35, v71
    v_accvgpr_write_b32 a36, v76
    v_accvgpr_write_b32 a37, v77
    v_accvgpr_write_b32 a38, v78
    v_accvgpr_write_b32 a39, v79
    s_add_u32 s65, s65, 524288
    s_bitset0_b32 s65, 21
    s_add_u32 s66, s66, 524288
    s_bitset0_b32 s66, 21
    s_add_u32 s67, s67, 524288
    s_bitset0_b32 s67, 21
    s_add_u32 s57, s64, 1048576
    s_bitset0_b32 s57, 21
    s_add_u32 s55, s55, 1
    buffer_load_dwordx4 v[136:139], v10, s[4:7], s69 offen sc1
    s_cmp_eq_u32 s75, 0
    s_cbranch_scc0 L_c_nh_14
    buffer_store_dword v18, v8, s[4:7], s79 offen
L_c_nh_14:
    s_nop 3
    v_mfma_f32_16x16x32_bf16 v[148:151], a[112:115], v[208:211], v[148:151]
    v_mfma_f32_16x16x32_bf16 v[148:151], a[116:119], v[212:215], v[148:151]
    s_mov_b32 s96, 2000000
    s_branch L_c_x_13_q
L_c_x_13:
    buffer_load_dwordx4 v[136:139], v10, s[4:7], s69 offen sc1
    s_sub_u32 s96, s96, 1
    s_cbranch_scc1 L_fail
L_c_x_13_q:
    s_waitcnt vmcnt(0)
    v_mfma_f32_16x16x32_bf16 v[232:235], v[244:247], v[136:139], 0
    v_max3_u32 v7, v136, v137, v138
    v_max_u32 v7, v7, v139
    v_cmp_eq_u32 vcc, -1, v7
    s_cbranch_vccnz L_c_x_13
    s_nop 3
    v_cvt_pk_bf16_f32 v232, v232, v233
    v_min_u32 v232, -2, v232
    buffer_store_dword v232, v12, s[4:7], s64 offen
    s_barrier
    s_sub_u32 s58, s55, 1
    s_add_u32 s59, s55, 1
    s_min_u32 s40, s59, 64
    s_cmp_lt_u32 s55, 3
    s_cbranch_scc1 L_c_early0
    s_sub_u32 s42, s55, 3
    v_cmp_gt_u32 vcc, s40, v16
    s_cbranch_vccnz L_c_rw0
L_c_rok0:
    buffer_load_dword v61, v25, s[4:7], 0 offen sc1
    buffer_load_dword v16, v60, s[4:7], 0 offen sc1
    s_cmp_eq_u32 s53, 0
    s_cbranch_scc0 L_c_pg_15
    v_mov_b32 v4, s42
    buffer_store_dword v4, v8, s[4:7], s72 offen sc1
L_c_pg_15:
    s_add_u32 s59, s68, 4096
    buffer_load_dwordx4 a[40:43], v10, s[4:7], s68 offen offset:0 sc1
    buffer_load_dwordx4 a[44:47], v10, s[4:7], s68 offen offset:1024 sc1
    buffer_load_dwordx4 a[48:51], v10, s[4:7], s68 offen offset:2048 sc1
    buffer_load_dwordx4 a[52:55], v10, s[4:7], s68 offen offset:3072 sc1
    buffer_load_dwordx4 a[56:59], v10, s[4:7], s59 offen offset:0 sc1
    buffer_load_dwordx4 a[60:63], v10, s[4:7], s59 offen offset:1024 sc1
    buffer_load_dwordx4 a[64:67], v10, s[4:7], s59 offen offset:2048 sc1
    buffer_load_dwordx4 a[68:71], v10, s[4:7], s59 offen offset:3072 sc1
    s_add_u32 s68, s68, 1310720
    v_cvt_pk_bf16_f32 v156, v148, v149
    v_cvt_pk_bf16_f32 v157, v150, v151
    v_cvt_pk_bf16_f32 v158, v152, v153
    v_cvt_pk_bf16_f32 v159, v154, v155
    buffer_store_dwordx4 v[156:159], v10, s[4:7], s36 offen sc1
    s_add_u32 s36, s36, 163840
    buffer_store_dword v26, v12, s[4:7], s57 offen
    s_add_u32 s56, s70, 524288
    s_bitset0_b32 s56, 20
    s_add_u32 s56, s56, 0
    s_lshr_b32 s97, s56, 8
    s_xor_b32 s97, s97, s60
    s_and_b32 s97, s97, 8192
    s_add_u32 s56, s56, s97
    s_add_u32 s56, s56, s77
    buffer_store_dword v26, v12, s[4:7], s56 offen sc1
    s_add_u32 s70, s70, 262144
    s_bitset0_b32 s70, 20
    s_waitcnt vmcnt(12)
    v_cmp_gt_u32 vcc, s58, v61
    s_cbranch_vccnz L_c_tw0
L_c_tok0:
    s_add_u32 m0, s45, 16384
    s_nop 0
    buffer_load_dwordx4 v10, s[4:7], s41 offen offset:0 sc1 lds
    buffer_load_dwordx4 v10, s[4:7], s41 offen offset:1024 sc1 lds
    buffer_load_dwordx4 v10, s[4:7], s41 offen offset:2048 sc1 lds
    buffer_load_dwordx4 v10, s[4:7], s41 offen offset:3072 sc1 lds
    s_add_u32 s41, s41, 524288
    s_bitset0_b32 s41, 21
L_c_next0:
    s_add_u32 s69, s70, 0
    s_lshr_b32 s97, s69, 8
    s_xor_b32 s97, s97, s60
    s_and_b32 s97, s97, 8192
    s_add_u32 s69, s69, s97
    s_add_u32 s71, s69, s77
    s_add_u32 s48, s69, 1048576
    s_add_u32 s49, s71, 1048576
    v_mov_b32 v132, 0
    v_mov_b32 v133, 0
    v_mov_b32 v134, 0
    v_mov_b32 v135, 0
    s_add_u32 s64, s64, 524288
    s_bitset0_b32 s64, 21
    s_add_u32 s62, s55, 1
    s_lshl_b32 s62, s62, 1
    v_mov_b32 v18, s62
    v_add_u32 v63, -1, v18
    s_waitcnt vmcnt(0) lgkmcnt(0)
    s_barrier
L_c_re1:
    s_mov_b32 s96, 2000000
L_poll_16:
    buffer_load_dwordx4 v[28:31], v13, s[4:7], s65 offen offset:0 sc1
    buffer_load_dwordx4 v[32:35], v13, s[4:7], s65 offen offset:1024 sc1
    buffer_load_dwordx4 v[36:39], v13, s[4:7], s65 offen offset:2048 sc1
    buffer_load_dwordx4 v[40:43], v13, s[4:7], s65 offen offset:3072 sc1
    s_sub_u32 s96, s96, 1
    s_cbranch_scc1 L_fail
    s_waitcnt vmcnt(0)
    v_max3_u32 v7, v31, v35, v39
    v_max_u32 v7, v7, v43
    v_cmp_eq_u32 vcc, -1, v7
    s_cbranch_vccnz L_poll_16
    v_mfma_f32_16x16x32_bf16 v[84:87], v[28:31], a[40:43], 0
    v_max3_u32 v7, v7, v28, v29
    v_max_u32 v7, v7, v30
    v_mfma_f32_16x16x32_bf16 v[88:91], v[28:31], a[44:47], 0
    v_max3_u32 v7, v7, v32, v33
    v_max_u32 v7, v7, v34
    buffer_load_dwordx4 v[68:71], v10, s[4:7], s67 offen offset:0 sc1
    buffer_load_dwordx4 v[76:79], v10, s[4:7], s67 offen offset:1024 sc1
    v_mfma_f32_16x16x32_bf16 v[92:95], v[32:35], a[48:51], 0
    v_max3_u32 v7, v7, v36, v37
    v_max_u32 v7, v7, v38
    v_mfma_f32_16x16x32_bf16 v[96:99], v[32:35], a[52:55], 0
    v_max3_u32 v7, v7, v40, v41
    v_max_u32 v7, v7, v42
    v_cmp_eq_u32 vcc, -1, v7
    s_cbranch_vccnz L_c_re1
    buffer_load_dwordx4 v[116:119], v66, s[4:7], s66 offen sc1
    buffer_load_dwordx4 v[120:123], v66, s[4:7], s66 offen offset:1024 sc1
    v_mfma_f32_16x16x32_bf16 v[100:103], v[36:39], a[56:59], 0
    v_cndmask_b32 v84, v88, v84, s[46:47]
    v_cndmask_b32 v85, v89, v85, s[46:47]
    v_mfma_f32_16x16x32_bf16 v[104:107], v[36:39], a[60:63], 0
    v_cndmask_b32 v86, v90, v86, s[46:47]
    v_cndmask_b32 v87, v91, v87, s[46:47]
    v_mfma_f32_16x16x32_bf16 v[108:111], v[40:43], a[64:67], 0
    v_cvt_pk_bf16_f32 v72, v84, v85
    v_cvt_pk_bf16_f32 v73, v86, v87
    v_mfma_f32_16x16x32_bf16 v[112:115], v[40:43], a[68:71], 0
    v_cndmask_b32 v92, v96, v92, s[46:47]
    v_cndmask_b32 v93, v97, v93, s[46:47]
    v_cndmask_b32 v94, v98, v94, s[46:47]
    v_cndmask_b32 v95, v99, v95, s[46:47]
    v_cvt_pk_bf16_f32 v74, v92, v93
    v_cvt_pk_bf16_f32 v75, v94, v95
    v_cndmask_b32 v100, v104, v100, s[46:47]
    v_cndmask_b32 v101, v105, v101, s[46:47]
    v_cndmask_b32 v102, v106, v102, s[46:47]
    v_cndmask_b32 v103, v107, v103, s[46:47]
    v_cvt_pk_bf16_f32 v80, v100, v101
    v_cvt_pk_bf16_f32 v81, v102, v103
    v_cndmask_b32 v108, v112, v108, s[46:47]
    v_cndmask_b32 v109, v113, v109, s[46:47]
    v_cndmask_b32 v110, v114, v110, s[46:47]
    v_cndmask_b32 v111, v115, v111, s[46:47]
    v_cvt_pk_bf16_f32 v82, v108, v109
    v_cvt_pk_bf16_f32 v83, v110, v111
    s_waitcnt vmcnt(2)
    v_max3_u32 v7, v68, v69, v70
    v_max3_u32 v7, v7, v71, v76
    v_max3_u32 v7, v7, v77, v78
    v_max_u32 v7, v7, v79
    v_cmp_eq_u32 vcc, -1, v7
    s_cbranch_vccz L_c_zok1
    s_mov_b32 s96, 2000000
L_poll_17:
    buffer_load_dwordx4 v[68:71], v10, s[4:7], s67 offen offset:0 sc1
    buffer_load_dwordx4 v[76:79], v10, s[4:7], s67 offen offset:1024 sc1
    buffer_load_dwordx4 v[116:119], v66, s[4:7], s66 offen sc1
    buffer_load_dwordx4 v[120:123], v66, s[4:7], s66 offen offset:1024 sc1
    s_sub_u32 s96, s96, 1
    s_cbranch_scc1 L_fail
    s_waitcnt vmcnt(0)
    v_max3_u32 v7, v68, v69, v70
    v_max3_u32 v7, v7, v71, v76
    v_max3_u32 v7, v7, v77, v78
    v_max_u32 v7, v7, v79
    v_cmp_eq_u32 vcc, -1, v7
    s_cbranch_vccnz L_poll_17
L_c_zok1:
    s_mov_b32 s96, 2000000
L_c_lp1:
    s_waitcnt vmcnt(0)
    v_smfmac_f32_16x16x64_bf16 v[132:135], v[116:119], v[68:75], v9
    v_smfmac_f32_16x16x64_bf16 v[132:135], v[120:123], v[76:83], v9
    v_max3_u32 v7, v116, v117, v118
    v_max3_u32 v7, v7, v119, v120
    v_max3_u32 v7, v7, v121, v122
    v_max_u32 v7, v7, v123
    v_cmp_eq_u32 vcc, -1, v7
    s_cbranch_vccz L_c_red1
    buffer_load_dwordx4 v[116:119], v66, s[4:7], s66 offen sc1
    buffer_load_dwordx4 v[120:123], v66, s[4:7], s66 offen offset:1024 sc1
    s_nop 1
    v_mov_b32 v132, 0
    v_mov_b32 v133, 0
    v_mov_b32 v134, 0
    v_mov_b32 v135, 0
    s_sub_u32 s96, s96, 1
    s_cbranch_scc1 L_fail
    s_branch L_c_lp1
L_c_red1:
    s_nop 1
    v_permlane32_swap_b32 v132, v134
    v_permlane32_swap_b32 v133, v135
    v_add_f32 v132, v132, v134
    v_add_f32 v133, v133, v135
    v_cvt_pk_bf16_f32 v132, v132, v133
    buffer_store_dword v132, v12, s[4:7], s71 offen sc1
    ds_read_b128 v[160:163], v10 offset:16384
    ds_read_b128 v[164:167], v10 offset:17408
    ds_read_b128 v[168:171], v10 offset:18432
    ds_read_b128 v[172:175], v10 offset:19456
    ds_read_b128 v[176:179], v10 offset:20480
    ds_read_b128 v[180:183], v10 offset:21504
    ds_read_b128 v[184:187], v10 offset:22528
    ds_read_b128 v[188:191], v10 offset:23552
    ds_read_b128 v[192:195], v10 offset:24576
    ds_read_b128 v[196:199], v10 offset:25600
    ds_read_b128 v[200:203], v10 offset:26624
    ds_read_b128 v[204:207], v10 offset:27648
    ds_read_b128 v[208:211], v10 offset:28672
    ds_read_b128 v[212:215], v10 offset:29696
    ds_read_b128 v[216:219], v10 offset:30720
    ds_read_b128 v[220:223], v10 offset:31744
    s_waitcnt lgkmcnt(15)
    v_mfma_f32_16x16x32_bf16 v[152:155], a[120:123], v[160:163], 0
    s_waitcnt lgkmcnt(14)
    v_mfma_f32_16x16x32_bf16 v[152:155], a[124:127], v[164:167], v[152:155]
    s_waitcnt lgkmcnt(13)
    v_mfma_f32_16x16x32_bf16 v[152:155], a[128:131], v[168:171], v[152:155]
    s_waitcnt lgkmcnt(12)
    v_mfma_f32_16x16x32_bf16 v[152:155], a[132:135], v[172:175], v[152:155]
    s_waitcnt lgkmcnt(11)
    v_mfma_f32_16x16x32_bf16 v[152:155], a[136:139], v[176:179], v[152:155]
    s_waitcnt lgkmcnt(10)
    v_mfma_f32_16x16x32_bf16 v[152:155], a[140:143], v[180:183], v[152:155]
    s_waitcnt lgkmcnt(9)
    v_mfma_f32_16x16x32_bf16 v[152:155], a[144:147], v[184:187], v[152:155]
    s_waitcnt lgkmcnt(8)
    v_mfma_f32_16x16x32_bf16 v[152:155], a[148:151], v[188:191], v[152:155]
    s_waitcnt lgkmcnt(7)
    v_mfma_f32_16x16x16_bf16 v[148:151], a[120:121], v[192:193], 0
    v_mfma_f32_16x16x16_bf16 v[148:151], a[124:125], v[194:195], v[148:151]
    s_waitcnt lgkmcnt(6)
    v_mfma_f32_16x16x16_bf16 v[148:151], a[128:129], v[196:197], v[148:151]
    v_mfma_f32_16x16x16_bf16 v[148:151], a[132:133], v[198:199], v[148:151]
    s_waitcnt lgkmcnt(5)
    v_mfma_f32_16x16x16_bf16 v[148:151], a[136:137], v[200:201], v[148:151]
    v_mfma_f32_16x16x16_bf16 v[148:151], a[140:141], v[202:203], v[148:151]
    s_waitcnt lgkmcnt(4)
    v_mfma_f32_16x16x16_bf16 v[148:151], a[144:145], v[204:205], v[148:151]
    v_mfma_f32_16x16x16_bf16 v[148:151], a[148:149], v[206:207], v[148:151]
    s_waitcnt lgkmcnt(0)
    v_mfma_f32_16x16x32_bf16 v[152:155], a[152:155], v[216:219], v[152:155]
    v_mfma_f32_16x16x32_bf16 v[152:155], a[156:159], v[220:223], v[152:155]
    v_accvgpr_write_b32 a72, v68
    v_accvgpr_write_b32 a73, v69
    v_accvgpr_write_b32 a74, v70
    v_accvgpr_write_b32 a75, v71
    v_accvgpr_write_b32 a76, v76
    v_accvgpr_write_b32 a77, v77
    v_accvgpr_write_b32 a78, v78
    v_accvgpr_write_b32 a79, v79
    s_add_u32 s65, s65, 524288
    s_bitset0_b32 s65, 21
    s_add_u32 s66, s66, 524288
    s_bitset0_b32 s66, 21
    s_add_u32 s67, s67, 524288
    s_bitset0_b32 s67, 21
    s_add_u32 s57, s64, 1048576
    s_bitset0_b32 s57, 21
    s_add_u32 s55, s55, 1
    buffer_load_dwordx4 v[136:139], v10, s[4:7], s69 offen sc1
    s_cmp_eq_u32 s75, 0
    s_cbranch_scc0 L_c_nh_19
    buffer_store_dword v18, v8, s[4:7], s79 offen
L_c_nh_19:
    s_nop 3
    v_mfma_f32_16x16x32_bf16 v[148:151], a[152:155], v[208:211], v[148:151]
    v_mfma_f32_16x16x32_bf16 v[148:151], a[156:159], v[212:215], v[148:151]
    s_mov_b32 s96, 2000000
    s_branch L_c_x_18_q
L_c_x_18:
    buffer_load_dwordx4 v[136:139], v10, s[4:7], s69 offen sc1
    s_sub_u32 s96, s96, 1
    s_cbranch_scc1 L_fail
L_c_x_18_q:
    s_waitcnt vmcnt(0)
    v_mfma_f32_16x16x32_bf16 v[232:235], v[244:247], v[136:139], 0
    v_max3_u32 v7, v136, v137, v138
    v_max_u32 v7, v7, v139
    v_cmp_eq_u32 vcc, -1, v7
    s_cbranch_vccnz L_c_x_18
    s_nop 3
    v_cvt_pk_bf16_f32 v232, v232, v233
    v_min_u32 v232, -2, v232
    buffer_store_dword v232, v12, s[4:7], s64 offen
    s_barrier
    s_sub_u32 s58, s55, 1
    s_add_u32 s59, s55, 1
    s_min_u32 s40, s59, 64
    s_cmp_lt_u32 s55, 3
    s_cbranch_scc1 L_c_early1
    s_sub_u32 s42, s55, 3
    v_cmp_gt_u32 vcc, s40, v16
    s_cbranch_vccnz L_c_rw1
L_c_rok1:
    buffer_load_dword v61, v25, s[4:7], 0 offen sc1
    buffer_load_dword v16, v60, s[4:7], 0 offen sc1
    s_cmp_eq_u32 s53, 0
    s_cbranch_scc0 L_c_pg_20
    v_mov_b32 v4, s42
    buffer_store_dword v4, v8, s[4:7], s72 offen sc1
L_c_pg_20:
    s_add_u32 s59, s68, 4096
    buffer_load_dwordx4 a[80:83], v10, s[4:7], s68 offen offset:0 sc1
    buffer_load_dwordx4 a[84:87], v10, s[4:7], s68 offen offset:1024 sc1
    buffer_load_dwordx4 a[88:91], v10, s[4:7], s68 offen offset:2048 sc1
    buffer_load_dwordx4 a[92:95], v10, s[4:7], s68 offen offset:3072 sc1
    buffer_load_dwordx4 a[96:99], v10, s[4:7], s59 offen offset:0 sc1
    buffer_load_dwordx4 a[100:103], v10, s[4:7], s59 offen offset:1024 sc1
    buffer_load_dwordx4 a[104:107], v10, s[4:7], s59 offen offset:2048 sc1
    buffer_load_dwordx4 a[108:111], v10, s[4:7], s59 offen offset:3072 sc1
    s_add_u32 s68, s68, 1310720
    v_cvt_pk_bf16_f32 v156, v148, v149
    v_cvt_pk_bf16_f32 v157, v150, v151
    v_cvt_pk_bf16_f32 v158, v152, v153
    v_cvt_pk_bf16_f32 v159, v154, v155
    buffer_store_dwordx4 v[156:159], v10, s[4:7], s36 offen sc1
    s_add_u32 s36, s36, 163840
    buffer_store_dword v26, v12, s[4:7], s57 offen
    s_add_u32 s56, s70, 524288
    s_bitset0_b32 s56, 20
    s_add_u32 s56, s56, 0
    s_lshr_b32 s97, s56, 8
    s_xor_b32 s97, s97, s60
    s_and_b32 s97, s97, 8192
    s_add_u32 s56, s56, s97
    s_add_u32 s56, s56, s77
    buffer_store_dword v26, v12, s[4:7], s56 offen sc1
    s_add_u32 s70, s70, 262144
    s_bitset0_b32 s70, 20
    s_waitcnt vmcnt(12)
    v_cmp_gt_u32 vcc, s58, v61
    s_cbranch_vccnz L_c_tw1
L_c_tok1:
    s_add_u32 m0, s45, 0
    s_nop 0
    buffer_load_dwordx4 v10, s[4:7], s41 offen offset:0 sc1 lds
    buffer_load_dwordx4 v10, s[4:7], s41 offen offset:1024 sc1 lds
    buffer_load_dwordx4 v10, s[4:7], s41 offen offset:2048 sc1 lds
    buffer_load_dwordx4 v10, s[4:7], s41 offen offset:3072 sc1 lds
    s_add_u32 s41, s41, 524288
    s_bitset0_b32 s41, 21
L_c_next1:
    s_add_u32 s69, s70, 0
    s_lshr_b32 s97, s69, 8
    s_xor_b32 s97, s97, s60
    s_and_b32 s97, s97, 8192
    s_add_u32 s69, s69, s97
    s_add_u32 s71, s69, s77
    s_add_u32 s48, s69, 1048576
    s_add_u32 s49, s71, 1048576
    v_mov_b32 v132, 0
    v_mov_b32 v133, 0
    v_mov_b32 v134, 0
    v_mov_b32 v135, 0
    s_add_u32 s64, s64, 524288
    s_bitset0_b32 s64, 21
    s_add_u32 s62, s55, 1
    s_lshl_b32 s62, s62, 1
    v_mov_b32 v18, s62
    v_add_u32 v63, -1, v18
    s_waitcnt vmcnt(0) lgkmcnt(0)
    s_barrier
L_c_re2:
    s_mov_b32 s96, 2000000
L_poll_21:
    buffer_load_dwordx4 v[28:31], v13, s[4:7], s65 offen offset:0 sc1
    buffer_load_dwordx4 v[32:35], v13, s[4:7], s65 offen offset:1024 sc1
    buffer_load_dwordx4 v[36:39], v13, s[4:7], s65 offen offset:2048 sc1
    buffer_load_dwordx4 v[40:43], v13, s[4:7], s65 offen offset:3072 sc1
    s_sub_u32 s96, s96, 1
    s_cbranch_scc1 L_fail
    s_waitcnt vmcnt(0)
    v_max3_u32 v7, v31, v35, v39
    v_max_u32 v7, v7, v43
    v_cmp_eq_u32 vcc, -1, v7
    s_cbranch_vccnz L_poll_21
    v_mfma_f32_16x16x32_bf16 v[84:87], v[28:31], a[80:83], 0
    v_max3_u32 v7, v7, v28, v29
    v_max_u32 v7, v7, v30
    v_mfma_f32_16x16x32_bf16 v[88:91], v[28:31], a[84:87], 0
    v_max3_u32 v7, v7, v32, v33
    v_max_u32 v7, v7, v34
    buffer_load_dwordx4 v[68:71], v10, s[4:7], s67 offen offset:0 sc1
    buffer_load_dwordx4 v[76:79], v10, s[4:7], s67 offen offset:1024 sc1
    v_mfma_f32_16x16x32_bf16 v[92:95], v[32:35], a[88:91], 0
    v_max3_u32 v7, v7, v36, v37
    v_max_u32 v7, v7, v38
    v_mfma_f32_16x16x32_bf16 v[96:99], v[32:35], a[92:95], 0
    v_max3_u32 v7, v7, v40, v41
    v_max_u32 v7, v7, v42
    v_cmp_eq_u32 vcc, -1, v7
    s_cbranch_vccnz L_c_re2
    buffer_load_dwordx4 v[116:119], v66, s[4:7], s66 offen sc1
    buffer_load_dwordx4 v[120:123], v66, s[4:7], s66 offen offset:1024 sc1
    v_mfma_f32_16x16x32_bf16 v[100:103], v[36:39], a[96:99], 0
    v_cndmask_b32 v84, v88, v84, s[46:47]
    v_cndmask_b32 v85, v89, v85, s[46:47]
    v_mfma_f32_16x16x32_bf16 v[104:107], v[36:39], a[100:103], 0
    v_cndmask_b32 v86, v90, v86, s[46:47]
    v_cndmask_b32 v87, v91, v87, s[46:47]
    v_mfma_f32_16x16x32_bf16 v[108:111], v[40:43], a[104:107], 0
    v_cvt_pk_bf16_f32 v72, v84, v85
    v_cvt_pk_bf16_f32 v73, v86, v87
    v_mfma_f32_16x16x32_bf16 v[112:115], v[40:43], a[108:111], 0
    v_cndmask_b32 v92, v96, v92, s[46:47]
    v_cndmask_b32 v93, v97, v93, s[46:47]
    v_cndmask_b32 v94, v98, v94, s[46:47]
    v_cndmask_b32 v95, v99, v95, s[46:47]
    v_cvt_pk_bf16_f32 v74, v92, v93
    v_cvt_pk_bf16_f32 v75, v94, v95
    v_cndmask_b32 v100, v104, v100, s[46:47]
    v_cndmask_b32 v101, v105, v101, s[46:47]
    v_cndmask_b32 v102, v106, v102, s[46:47]
    v_cndmask_b32 v103, v107, v103, s[46:47]
    v_cvt_pk_bf16_f32 v80, v100, v101
    v_cvt_pk_bf16_f32 v81, v102, v103
    v_cndmask_b32 v108, v112, v108, s[46:47]
    v_cndmask_b32 v109, v113, v109, s[46:47]
    v_cndmask_b32 v110, v114, v110, s[46:47]
    v_cndmask_b32 v111, v115, v111, s[46:47]
    v_cvt_pk_bf16_f32 v82, v108, v109
    v_cvt_pk_bf16_f32 v83, v110, v111
    s_waitcnt vmcnt(2)
    v_max3_u32 v7, v68, v69, v70
    v_max3_u32 v7, v7, v71, v76
    v_max3_u32 v7, v7, v77, v78
    v_max_u32 v7, v7, v79
    v_cmp_eq_u32 vcc, -1, v7
    s_cbranch_vccz L_c_zok2
    s_mov_b32 s96, 2000000
L_poll_22:
    buffer_load_dwordx4 v[68:71], v10, s[4:7], s67 offen offset:0 sc1
    buffer_load_dwordx4 v[76:79], v10, s[4:7], s67 offen offset:1024 sc1
    buffer_load_dwordx4 v[116:119], v66, s[4:7], s66 offen sc1
    buffer_load_dwordx4 v[120:123], v66, s[4:7], s66 offen offset:1024 sc1
    s_sub_u32 s96, s96, 1
    s_cbranch_scc1 L_fail
    s_waitcnt vmcnt(0)
    v_max3_u32 v7, v68, v69, v70
    v_max3_u32 v7, v7, v71, v76
    v_max3_u32 v7, v7, v77, v78
    v_max_u32 v7, v7, v79
    v_cmp_eq_u32 vcc, -1, v7
    s_cbranch_vccnz L_poll_22
L_c_zok2:
    s_mov_b32 s96, 2000000
L_c_lp2:
    s_waitcnt vmcnt(0)
    v_smfmac_f32_16x16x64_bf16 v[132:135], v[116:119], v[68:75], v9
    v_smfmac_f32_16x16x64_bf16 v[132:135], v[120:123], v[76:83], v9
    v_max3_u32 v7, v116, v117, v118
    v_max3_u32 v7, v7, v119, v120
    v_max3_u32 v7, v7, v121, v122
    v_max_u32 v7, v7, v123
    v_cmp_eq_u32 vcc, -1, v7
    s_cbranch_vccz L_c_red2
    buffer_load_dwordx4 v[116:119], v66, s[4:7], s66 offen sc1
    buffer_load_dwordx4 v[120:123], v66, s[4:7], s66 offen offset:1024 sc1
    s_nop 1
    v_mov_b32 v132, 0
    v_mov_b32 v133, 0
    v_mov_b32 v134, 0
    v_mov_b32 v135, 0
    s_sub_u32 s96, s96, 1
    s_cbranch_scc1 L_fail
    s_branch L_c_lp2
L_c_red2:
    s_nop 1
    v_permlane32_swap_b32 v132, v134
    v_permlane32_swap_b32 v133, v135
    v_add_f32 v132, v132, v134
    v_add_f32 v133, v133, v135
    v_cvt_pk_bf16_f32 v132, v132, v133
    buffer_store_dword v132, v12, s[4:7], s71 offen sc1
    ds_read_b128 v[160:163], v10 offset:0
    ds_read_b128 v[164:167], v10 offset:1024
    ds_read_b128 v[168:171], v10 offset:2048
    ds_read_b128 v[172:175], v10 offset:3072
    ds_read_b128 v[176:179], v10 offset:4096
    ds_read_b128 v[180:183], v10 offset:5120
    ds_read_b128 v[184:187], v10 offset:6144
    ds_read_b128 v[188:191], v10 offset:7168
    ds_read_b128 v[192:195], v10 offset:8192
    ds_read_b128 v[196:199], v10 offset:9216
    ds_read_b128 v[200:203], v10 offset:10240
    ds_read_b128 v[204:207], v10 offset:11264
    ds_read_b128 v[208:211], v10 offset:12288
    ds_read_b128 v[212:215], v10 offset:13312
    ds_read_b128 v[216:219], v10 offset:14336
    ds_read_b128 v[220:223], v10 offset:15360
    s_waitcnt lgkmcnt(15)
    v_mfma_f32_16x16x32_bf16 v[152:155], a[0:3], v[160:163], 0
    s_waitcnt lgkmcnt(14)
    v_mfma_f32_16x16x32_bf16 v[152:155], a[4:7], v[164:167], v[152:155]
    s_waitcnt lgkmcnt(13)
    v_mfma_f32_16x16x32_bf16 v[152:155], a[8:11], v[168:171], v[152:155]
    s_waitcnt lgkmcnt(12)
    v_mfma_f32_16x16x32_bf16 v[152:155], a[12:15], v[172:175], v[152:155]
    s_waitcnt lgkmcnt(11)
    v_mfma_f32_16x16x32_bf16 v[152:155], a[16:19], v[176:179], v[152:155]
    s_waitcnt lgkmcnt(10)
    v_mfma_f32_16x16x32_bf16 v[152:155], a[20:23], v[180:183], v[152:155]
    s_waitcnt lgkmcnt(9)
    v_mfma_f32_16x16x32_bf16 v[152:155], a[24:27], v[184:187], v[152:155]
    s_waitcnt lgkmcnt(8)
    v_mfma_f32_16x16x32_bf16 v[152:155], a[28:31], v[188:191], v[152:155]
    s_waitcnt lgkmcnt(7)
    v_mfma_f32_16x16x16_bf16 v[148:151], a[0:1], v[192:193], 0
    v_mfma_f32_16x16x16_bf16 v[148:151], a[4:5], v[194:195], v[148:151]
    s_waitcnt lgkmcnt(6)
    v_mfma_f32_16x16x16_bf16 v[148:151], a[8:9], v[196:197], v[148:151]
    v_mfma_f32_16x16x16_bf16 v[148:151], a[12:13], v[198:199], v[148:151]
    s_waitcnt lgkmcnt(5)
    v_mfma_f32_16x16x16_bf16 v[148:151], a[16:17], v[200:201], v[148:151]
    v_mfma_f32_16x16x16_bf16 v[148:151], a[20:21], v[202:203], v[148:151]
    s_waitcnt lgkmcnt(4)
    v_mfma_f32_16x16x16_bf16 v[148:151], a[24:25], v[204:205], v[148:151]
    v_mfma_f32_16x16x16_bf16 v[148:151], a[28:29], v[206:207], v[148:151]
    s_waitcnt lgkmcnt(0)
    v_mfma_f32_16x16x32_bf16 v[152:155], a[32:35], v[216:219], v[152:155]
    v_mfma_f32_16x16x32_bf16 v[152:155], a[36:39], v[220:223], v[152:155]
    v_accvgpr_write_b32 a112, v68
    v_accvgpr_write_b32 a113, v69
    v_accvgpr_write_b32 a114, v70
    v_accvgpr_write_b32 a115, v71
    v_accvgpr_write_b32 a116, v76
    v_accvgpr_write_b32 a117, v77
    v_accvgpr_write_b32 a118, v78
    v_accvgpr_write_b32 a119, v79
    s_add_u32 s65, s65, 524288
    s_bitset0_b32 s65, 21
    s_add_u32 s66, s66, 524288
    s_bitset0_b32 s66, 21
    s_add_u32 s67, s67, 524288
    s_bitset0_b32 s67, 21
    s_add_u32 s57, s64, 1048576
    s_bitset0_b32 s57, 21
    s_add_u32 s55, s55, 1
    buffer_load_dwordx4 v[136:139], v10, s[4:7], s69 offen sc1
    s_cmp_eq_u32 s75, 0
    s_cbranch_scc0 L_c_nh_24
    buffer_store_dword v18, v8, s[4:7], s79 offen
L_c_nh_24:
    s_nop 3
    v_mfma_f32_16x16x32_bf16 v[148:151], a[32:35], v[208:211], v[148:151]
    v_mfma_f32_16x16x32_bf16 v[148:151], a[36:39], v[212:215], v[148:151]
    s_mov_b32 s96, 2000000
    s_branch L_c_x_23_q
L_c_x_23:
    buffer_load_dwordx4 v[136:139], v10, s[4:7], s69 offen sc1
    s_sub_u32 s96, s96, 1
    s_cbranch_scc1 L_fail
L_c_x_23_q:
    s_waitcnt vmcnt(0)
    v_mfma_f32_16x16x32_bf16 v[232:235], v[244:247], v[136:139], 0
    v_max3_u32 v7, v136, v137, v138
    v_max_u32 v7, v7, v139
    v_cmp_eq_u32 vcc, -1, v7
    s_cbranch_vccnz L_c_x_23
    s_nop 3
    v_cvt_pk_bf16_f32 v232, v232, v233
    v_min_u32 v232, -2, v232
    buffer_store_dword v232, v12, s[4:7], s64 offen
    s_barrier
    s_sub_u32 s58, s55, 1
    s_add_u32 s59, s55, 1
    s_min_u32 s40, s59, 64
    s_cmp_lt_u32 s55, 3
    s_cbranch_scc1 L_c_early2
    s_sub_u32 s42, s55, 3
    v_cmp_gt_u32 vcc, s40, v16
    s_cbranch_vccnz L_c_rw2
L_c_rok2:
    buffer_load_dword v61, v25, s[4:7], 0 offen sc1
    buffer_load_dword v16, v60, s[4:7], 0 offen sc1
    s_cmp_eq_u32 s53, 0
    s_cbranch_scc0 L_c_pg_25
    v_mov_b32 v4, s42
    buffer_store_dword v4, v8, s[4:7], s72 offen sc1
L_c_pg_25:
    s_add_u32 s59, s68, 4096
    buffer_load_dwordx4 a[120:123], v10, s[4:7], s68 offen offset:0 sc1
    buffer_load_dwordx4 a[124:127], v10, s[4:7], s68 offen offset:1024 sc1
    buffer_load_dwordx4 a[128:131], v10, s[4:7], s68 offen offset:2048 sc1
    buffer_load_dwordx4 a[132:135], v10, s[4:7], s68 offen offset:3072 sc1
    buffer_load_dwordx4 a[136:139], v10, s[4:7], s59 offen offset:0 sc1
    buffer_load_dwordx4 a[140:143], v10, s[4:7], s59 offen offset:1024 sc1
    buffer_load_dwordx4 a[144:147], v10, s[4:7], s59 offen offset:2048 sc1
    buffer_load_dwordx4 a[148:151], v10, s[4:7], s59 offen offset:3072 sc1
    s_add_u32 s68, s68, 1310720
    v_cvt_pk_bf16_f32 v156, v148, v149
    v_cvt_pk_bf16_f32 v157, v150, v151
    v_cvt_pk_bf16_f32 v158, v152, v153
    v_cvt_pk_bf16_f32 v159, v154, v155
    buffer_store_dwordx4 v[156:159], v10, s[4:7], s36 offen sc1
    s_add_u32 s36, s36, 163840
    buffer_store_dword v26, v12, s[4:7], s57 offen
    s_add_u32 s56, s70, 524288
    s_bitset0_b32 s56, 20
    s_add_u32 s56, s56, 0
    s_lshr_b32 s97, s56, 8
    s_xor_b32 s97, s97, s60
    s_and_b32 s97, s97, 8192
    s_add_u32 s56, s56, s97
    s_add_u32 s56, s56, s77
    buffer_store_dword v26, v12, s[4:7], s56 offen sc1
    s_add_u32 s70, s70, 262144
    s_bitset0_b32 s70, 20
    s_waitcnt vmcnt(12)
    v_cmp_gt_u32 vcc, s58, v61
    s_cbranch_vccnz L_c_tw2
L_c_tok2:
    s_add_u32 m0, s45, 16384
    s_nop 0
    buffer_load_dwordx4 v10, s[4:7], s41 offen offset:0 sc1 lds
    buffer_load_dwordx4 v10, s[4:7], s41 offen offset:1024 sc1 lds
    buffer_load_dwordx4 v10, s[4:7], s41 offen offset:2048 sc1 lds
    buffer_load_dwordx4 v10, s[4:7], s41 offen offset:3072 sc1 lds
    s_add_u32 s41, s41, 524288
    s_bitset0_b32 s41, 21
L_c_next2:
    s_cmp_lt_u32 s55, 63
    s_cbranch_scc0 L_c_drain
    s_add_u32 s69, s70, 0
    s_lshr_b32 s97, s69, 8
    s_xor_b32 s97, s97, s60
    s_and_b32 s97, s97, 8192
    s_add_u32 s69, s69, s97
    s_add_u32 s71, s69, s77
    s_add_u32 s48, s69, 1048576
    s_add_u32 s49, s71, 1048576
    v_mov_b32 v132, 0
    v_mov_b32 v133, 0
    v_mov_b32 v134, 0
    v_mov_b32 v135, 0
    s_add_u32 s64, s64, 524288
    s_bitset0_b32 s64, 21
    s_add_u32 s62, s55, 1
    s_lshl_b32 s62, s62, 1
    v_mov_b32 v18, s62
    v_add_u32 v63, -1, v18
    s_waitcnt vmcnt(0) lgkmcnt(0)
    s_barrier
L_c_re3:
    s_mov_b32 s96, 2000000
L_poll_26:
    buffer_load_dwordx4 v[28:31], v13, s[4:7], s65 offen offset:0 sc1
    buffer_load_dwordx4 v[32:35], v13, s[4:7], s65 offen offset:1024 sc1
    buffer_load_dwordx4 v[36:39], v13, s[4:7], s65 offen offset:2048 sc1
    buffer_load_dwordx4 v[40:43], v13, s[4:7], s65 offen offset:3072 sc1
    s_sub_u32 s96, s96, 1
    s_cbranch_scc1 L_fail
    s_waitcnt vmcnt(0)
    v_max3_u32 v7, v31, v35, v39
    v_max_u32 v7, v7, v43
    v_cmp_eq_u32 vcc, -1, v7
    s_cbranch_vccnz L_poll_26
    v_mfma_f32_16x16x32_bf16 v[84:87], v[28:31], a[120:123], 0
    v_max3_u32 v7, v7, v28, v29
    v_max_u32 v7, v7, v30
    v_mfma_f32_16x16x32_bf16 v[88:91], v[28:31], a[124:127], 0
    v_max3_u32 v7, v7, v32, v33
    v_max_u32 v7, v7, v34
    buffer_load_dwordx4 v[68:71], v10, s[4:7], s67 offen offset:0 sc1
    buffer_load_dwordx4 v[76:79], v10, s[4:7], s67 offen offset:1024 sc1
    v_mfma_f32_16x16x32_bf16 v[92:95], v[32:35], a[128:131], 0
    v_max3_u32 v7, v7, v36, v37
    v_max_u32 v7, v7, v38
    v_mfma_f32_16x16x32_bf16 v[96:99], v[32:35], a[132:135], 0
    v_max3_u32 v7, v7, v40, v41
    v_max_u32 v7, v7, v42
    v_cmp_eq_u32 vcc, -1, v7
    s_cbranch_vccnz L_c_re3
    buffer_load_dwordx4 v[116:119], v66, s[4:7], s66 offen sc1
    buffer_load_dwordx4 v[120:123], v66, s[4:7], s66 offen offset:1024 sc1
    v_mfma_f32_16x16x32_bf16 v[100:103], v[36:39], a[136:139], 0
    v_cndmask_b32 v84, v88, v84, s[46:47]
    v_cndmask_b32 v85, v89, v85, s[46:47]
    v_mfma_f32_16x16x32_bf16 v[104:107], v[36:39], a[140:143], 0
    v_cndmask_b32 v86, v90, v86, s[46:47]
    v_cndmask_b32 v87, v91, v87, s[46:47]
    v_mfma_f32_16x16x32_bf16 v[108:111], v[40:43], a[144:147], 0
    v_cvt_pk_bf16_f32 v72, v84, v85
    v_cvt_pk_bf16_f32 v73, v86, v87
    v_mfma_f32_16x16x32_bf16 v[112:115], v[40:43], a[148:151], 0
    v_cndmask_b32 v92, v96, v92, s[46:47]
    v_cndmask_b32 v93, v97, v93, s[46:47]
    v_cndmask_b32 v94, v98, v94, s[46:47]
    v_cndmask_b32 v95, v99, v95, s[46:47]
    v_cvt_pk_bf16_f32 v74, v92, v93
    v_cvt_pk_bf16_f32 v75, v94, v95
    v_cndmask_b32 v100, v104, v100, s[46:47]
    v_cndmask_b32 v101, v105, v101, s[46:47]
    v_cndmask_b32 v102, v106, v102, s[46:47]
    v_cndmask_b32 v103, v107, v103, s[46:47]
    v_cvt_pk_bf16_f32 v80, v100, v101
    v_cvt_pk_bf16_f32 v81, v102, v103
    v_cndmask_b32 v108, v112, v108, s[46:47]
    v_cndmask_b32 v109, v113, v109, s[46:47]
    v_cndmask_b32 v110, v114, v110, s[46:47]
    v_cndmask_b32 v111, v115, v111, s[46:47]
    v_cvt_pk_bf16_f32 v82, v108, v109
    v_cvt_pk_bf16_f32 v83, v110, v111
    s_waitcnt vmcnt(2)
    v_max3_u32 v7, v68, v69, v70
    v_max3_u32 v7, v7, v71, v76
    v_max3_u32 v7, v7, v77, v78
    v_max_u32 v7, v7, v79
    v_cmp_eq_u32 vcc, -1, v7
    s_cbranch_vccz L_c_zok3
    s_mov_b32 s96, 2000000
L_poll_27:
    buffer_load_dwordx4 v[68:71], v10, s[4:7], s67 offen offset:0 sc1
    buffer_load_dwordx4 v[76:79], v10, s[4:7], s67 offen offset:1024 sc1
    buffer_load_dwordx4 v[116:119], v66, s[4:7], s66 offen sc1
    buffer_load_dwordx4 v[120:123], v66, s[4:7], s66 offen offset:1024 sc1
    s_sub_u32 s96, s96, 1
    s_cbranch_scc1 L_fail
    s_waitcnt vmcnt(0)
    v_max3_u32 v7, v68, v69, v70
    v_max3_u32 v7, v7, v71, v76
    v_max3_u32 v7, v7, v77, v78
    v_max_u32 v7, v7, v79
    v_cmp_eq_u32 vcc, -1, v7
    s_cbranch_vccnz L_poll_27
L_c_zok3:
    s_mov_b32 s96, 2000000
L_c_lp3:
    s_waitcnt vmcnt(0)
    v_smfmac_f32_16x16x64_bf16 v[132:135], v[116:119], v[68:75], v9
    v_smfmac_f32_16x16x64_bf16 v[132:135], v[120:123], v[76:83], v9
    v_max3_u32 v7, v116, v117, v118
    v_max3_u32 v7, v7, v119, v120
    v_max3_u32 v7, v7, v121, v122
    v_max_u32 v7, v7, v123
    v_cmp_eq_u32 vcc, -1, v7
    s_cbranch_vccz L_c_red3
    buffer_load_dwordx4 v[116:119], v66, s[4:7], s66 offen sc1
    buffer_load_dwordx4 v[120:123], v66, s[4:7], s66 offen offset:1024 sc1
    s_nop 1
    v_mov_b32 v132, 0
    v_mov_b32 v133, 0
    v_mov_b32 v134, 0
    v_mov_b32 v135, 0
    s_sub_u32 s96, s96, 1
    s_cbranch_scc1 L_fail
    s_branch L_c_lp3
L_c_red3:
    s_nop 1
    v_permlane32_swap_b32 v132, v134
    v_permlane32_swap_b32 v133, v135
    v_add_f32 v132, v132, v134
    v_add_f32 v133, v133, v135
    v_cvt_pk_bf16_f32 v132, v132, v133
    buffer_store_dword v132, v12, s[4:7], s71 offen sc1
    ds_read_b128 v[160:163], v10 offset:16384
    ds_read_b128 v[164:167], v10 offset:17408
    ds_read_b128 v[168:171], v10 offset:18432
    ds_read_b128 v[172:175], v10 offset:19456
    ds_read_b128 v[176:179], v10 offset:20480
    ds_read_b128 v[180:183], v10 offset:21504
    ds_read_b128 v[184:187], v10 offset:22528
    ds_read_b128 v[188:191], v10 offset:23552
    ds_read_b128 v[192:195], v10 offset:24576
    ds_read_b128 v[196:199], v10 offset:25600
    ds_read_b128 v[200:203], v10 offset:26624
    ds_read_b128 v[204:207], v10 offset:27648
    ds_read_b128 v[208:211], v10 offset:28672
    ds_read_b128 v[212:215], v10 offset:29696
    ds_read_b128 v[216:219], v10 offset:30720
    ds_read_b128 v[220:223], v10 offset:31744
    s_waitcnt lgkmcnt(15)
    v_mfma_f32_16x16x32_bf16 v[152:155], a[40:43], v[160:163], 0
    s_waitcnt lgkmcnt(14)
    v_mfma_f32_16x16x32_bf16 v[152:155], a[44:47], v[164:167], v[152:155]
    s_waitcnt lgkmcnt(13)
    v_mfma_f32_16x16x32_bf16 v[152:155], a[48:51], v[168:171], v[152:155]
    s_waitcnt lgkmcnt(12)
    v_mfma_f32_16x16x32_bf16 v[152:155], a[52:55], v[172:175], v[152:155]
    s_waitcnt lgkmcnt(11)
    v_mfma_f32_16x16x32_bf16 v[152:155], a[56:59], v[176:179], v[152:155]
    s_waitcnt lgkmcnt(10)
    v_mfma_f32_16x16x32_bf16 v[152:155], a[60:63], v[180:183], v[152:155]
    s_waitcnt lgkmcnt(9)
    v_mfma_f32_16x16x32_bf16 v[152:155], a[64:67], v[184:187], v[152:155]
    s_waitcnt lgkmcnt(8)
    v_mfma_f32_16x16x32_bf16 v[152:155], a[68:71], v[188:191], v[152:155]
    s_waitcnt lgkmcnt(7)
    v_mfma_f32_16x16x16_bf16 v[148:151], a[40:41], v[192:193], 0
    v_mfma_f32_16x16x16_bf16 v[148:151], a[44:45], v[194:195], v[148:151]
    s_waitcnt lgkmcnt(6)
    v_mfma_f32_16x16x16_bf16 v[148:151], a[48:49], v[196:197], v[148:151]
    v_mfma_f32_16x16x16_bf16 v[148:151], a[52:53], v[198:199], v[148:151]
    s_waitcnt lgkmcnt(5)
    v_mfma_f32_16x16x16_bf16 v[148:151], a[56:57], v[200:201], v[148:151]
    v_mfma_f32_16x16x16_bf16 v[148:151], a[60:61], v[202:203], v[148:151]
    s_waitcnt lgkmcnt(4)
    v_mfma_f32_16x16x16_bf16 v[148:151], a[64:65], v[204:205], v[148:151]
    v_mfma_f32_16x16x16_bf16 v[148:151], a[68:69], v[206:207], v[148:151]
    s_waitcnt lgkmcnt(0)
    v_mfma_f32_16x16x32_bf16 v[152:155], a[72:75], v[216:219], v[152:155]
    v_mfma_f32_16x16x32_bf16 v[152:155], a[76:79], v[220:223], v[152:155]
    v_accvgpr_write_b32 a152, v68
    v_accvgpr_write_b32 a153, v69
    v_accvgpr_write_b32 a154, v70
    v_accvgpr_write_b32 a155, v71
    v_accvgpr_write_b32 a156, v76
    v_accvgpr_write_b32 a157, v77
    v_accvgpr_write_b32 a158, v78
    v_accvgpr_write_b32 a159, v79
    s_add_u32 s65, s65, 524288
    s_bitset0_b32 s65, 21
    s_add_u32 s66, s66, 524288
    s_bitset0_b32 s66, 21
    s_add_u32 s67, s67, 524288
    s_bitset0_b32 s67, 21
    s_add_u32 s57, s64, 1048576
    s_bitset0_b32 s57, 21
    s_add_u32 s55, s55, 1
    buffer_load_dwordx4 v[136:139], v10, s[4:7], s69 offen sc1
    s_cmp_eq_u32 s75, 0
    s_cbranch_scc0 L_c_nh_29
    buffer_store_dword v18, v8, s[4:7], s79 offen
L_c_nh_29:
    s_nop 3
    v_mfma_f32_16x16x32_bf16 v[148:151], a[72:75], v[208:211], v[148:151]
    v_mfma_f32_16x16x32_bf16 v[148:151], a[76:79], v[212:215], v[148:151]
    s_mov_b32 s96, 2000000
    s_branch L_c_x_28_q
L_c_x_28:
    buffer_load_dwordx4 v[136:139], v10, s[4:7], s69 offen sc1
    s_sub_u32 s96, s96, 1
    s_cbranch_scc1 L_fail
L_c_x_28_q:
    s_waitcnt vmcnt(0)
    v_mfma_f32_16x16x32_bf16 v[232:235], v[244:247], v[136:139], 0
    v_max3_u32 v7, v136, v137, v138
    v_max_u32 v7, v7, v139
    v_cmp_eq_u32 vcc, -1, v7
    s_cbranch_vccnz L_c_x_28
    s_nop 3
    v_cvt_pk_bf16_f32 v232, v232, v233
    v_min_u32 v232, -2, v232
    buffer_store_dword v232, v12, s[4:7], s64 offen
    s_barrier
    s_sub_u32 s58, s55, 1
    s_add_u32 s59, s55, 1
    s_min_u32 s40, s59, 64
    s_cmp_lt_u32 s55, 3
    s_cbranch_scc1 L_c_early3
    s_sub_u32 s42, s55, 3
    v_cmp_gt_u32 vcc, s40, v16
    s_cbranch_vccnz L_c_rw3
L_c_rok3:
    buffer_load_dword v61, v25, s[4:7], 0 offen sc1
    buffer_load_dword v16, v60, s[4:7], 0 offen sc1
    s_cmp_eq_u32 s53, 0
    s_cbranch_scc0 L_c_pg_30
    v_mov_b32 v4, s42
    buffer_store_dword v4, v8, s[4:7], s72 offen sc1
L_c_pg_30:
    s_add_u32 s59, s68, 4096
    buffer_load_dwordx4 a[0:3], v10, s[4:7], s68 offen offset:0 sc1
    buffer_load_dwordx4 a[4:7], v10, s[4:7], s68 offen offset:1024 sc1
    buffer_load_dwordx4 a[8:11], v10, s[4:7], s68 offen offset:2048 sc1
    buffer_load_dwordx4 a[12:15], v10, s[4:7], s68 offen offset:3072 sc1
    buffer_load_dwordx4 a[16:19], v10, s[4:7], s59 offen offset:0 sc1
    buffer_load_dwordx4 a[20:23], v10, s[4:7], s59 offen offset:1024 sc1
    buffer_load_dwordx4 a[24:27], v10, s[4:7], s59 offen offset:2048 sc1
    buffer_load_dwordx4 a[28:31], v10, s[4:7], s59 offen offset:3072 sc1
    s_add_u32 s68, s68, 1310720
    v_cvt_pk_bf16_f32 v156, v148, v149
    v_cvt_pk_bf16_f32 v157, v150, v151
    v_cvt_pk_bf16_f32 v158, v152, v153
    v_cvt_pk_bf16_f32 v159, v154, v155
    buffer_store_dwordx4 v[156:159], v10, s[4:7], s36 offen sc1
    s_add_u32 s36, s36, 163840
    buffer_store_dword v26, v12, s[4:7], s57 offen
    s_add_u32 s56, s70, 524288
    s_bitset0_b32 s56, 20
    s_add_u32 s56, s56, 0
    s_lshr_b32 s97, s56, 8
    s_xor_b32 s97, s97, s60
    s_and_b32 s97, s97, 8192
    s_add_u32 s56, s56, s97
    s_add_u32 s56, s56, s77
    buffer_store_dword v26, v12, s[4:7], s56 offen sc1
    s_add_u32 s70, s70, 262144
    s_bitset0_b32 s70, 20
    s_waitcnt vmcnt(12)
    v_cmp_gt_u32 vcc, s58, v61
    s_cbranch_vccnz L_c_tw3
L_c_tok3:
    s_add_u32 m0, s45, 0
    s_nop 0
    buffer_load_dwordx4 v10, s[4:7], s41 offen offset:0 sc1 lds
    buffer_load_dwordx4 v10, s[4:7], s41 offen offset:1024 sc1 lds
    buffer_load_dwordx4 v10, s[4:7], s41 offen offset:2048 sc1 lds
    buffer_load_dwordx4 v10, s[4:7], s41 offen offset:3072 sc1 lds
    s_add_u32 s41, s41, 524288
    s_bitset0_b32 s41, 21
L_c_next3:
    s_branch L_c_loop
L_c_early0:
    buffer_store_dword v26, v12, s[4:7], s57 offen
    s_add_u32 s56, s70, 524288
    s_bitset0_b32 s56, 20
    s_add_u32 s56, s56, 0
    s_lshr_b32 s97, s56, 8
    s_xor_b32 s97, s97, s60
    s_and_b32 s97, s97, 8192
    s_add_u32 s56, s56, s97
    s_add_u32 s56, s56, s77
    buffer_store_dword v26, v12, s[4:7], s56 offen sc1
    s_add_u32 s70, s70, 262144
    s_bitset0_b32 s70, 20
    s_mov_b32 s96, 2000000
L_wf_31:
    buffer_load_dword v16, v60, s[4:7], 0 offen sc1
    s_sub_u32 s96, s96, 1
    s_cbranch_scc1 L_fail
    s_waitcnt vmcnt(0)
    v_cmp_gt_u32 vcc, s40, v16
    s_cbranch_vccz L_wf_31_d
    s_sleep 2
    s_branch L_wf_31
L_wf_31_d:
    s_add_u32 s59, s68, 4096
    buffer_load_dwordx4 a[40:43], v10, s[4:7], s68 offen offset:0 sc1
    buffer_load_dwordx4 a[44:47], v10, s[4:7], s68 offen offset:1024 sc1
    buffer_load_dwordx4 a[48:51], v10, s[4:7], s68 offen offset:2048 sc1
    buffer_load_dwordx4 a[52:55], v10, s[4:7], s68 offen offset:3072 sc1
    buffer_load_dwordx4 a[56:59], v10, s[4:7], s59 offen offset:0 sc1
    buffer_load_dwordx4 a[60:63], v10, s[4:7], s59 offen offset:1024 sc1
    buffer_load_dwordx4 a[64:67], v10, s[4:7], s59 offen offset:2048 sc1
    buffer_load_dwordx4 a[68:71], v10, s[4:7], s59 offen offset:3072 sc1
    s_add_u32 s68, s68, 1310720
    s_branch L_c_next0
L_c_rw0:
    s_mov_b32 s96, 2000000
L_wf_32:
    buffer_load_dword v16, v60, s[4:7], 0 offen sc1
    s_sub_u32 s96, s96, 1
    s_cbranch_scc1 L_fail
    s_waitcnt vmcnt(0)
    v_cmp_gt_u32 vcc, s40, v16
    s_cbranch_vccz L_wf_32_d
    s_sleep 2
    s_branch L_wf_32
L_wf_32_d:
    s_branch L_c_rok0
L_c_tw0:
    s_mov_b32 s96, 2000000
L_wf_33:
    buffer_load_dword v61, v25, s[4:7], 0 offen sc1
    s_sub_u32 s96, s96, 1
    s_cbranch_scc1 L_fail
    s_waitcnt vmcnt(0)
    v_cmp_gt_u32 vcc, s58, v61
    s_cbranch_vccz L_wf_33_d
    s_sleep 2
    s_branch L_wf_33
L_wf_33_d:
    s_branch L_c_tok0
L_c_early1:
    buffer_store_dword v26, v12, s[4:7], s57 offen
    s_add_u32 s56, s70, 524288
    s_bitset0_b32 s56, 20
    s_add_u32 s56, s56, 0
    s_lshr_b32 s97, s56, 8
    s_xor_b32 s97, s97, s60
    s_and_b32 s97, s97, 8192
    s_add_u32 s56, s56, s97
    s_add_u32 s56, s56, s77
    buffer_store_dword v26, v12, s[4:7], s56 offen sc1
    s_add_u32 s70, s70, 262144
    s_bitset0_b32 s70, 20
    s_mov_b32 s96, 2000000
L_wf_34:
    buffer_load_dword v16, v60, s[4:7], 0 offen sc1
    s_sub_u32 s96, s96, 1
    s_cbranch_scc1 L_fail
    s_waitcnt vmcnt(0)
    v_cmp_gt_u32 vcc, s40, v16
    s_cbranch_vccz L_wf_34_d
    s_sleep 2
    s_branch L_wf_34
L_wf_34_d:
    s_add_u32 s59, s68, 4096
    buffer_load_dwordx4 a[80:83], v10, s[4:7], s68 offen offset:0 sc1
    buffer_load_dwordx4 a[84:87], v10, s[4:7], s68 offen offset:1024 sc1
    buffer_load_dwordx4 a[88:91], v10, s[4:7], s68 offen offset:2048 sc1
    buffer_load_dwordx4 a[92:95], v10, s[4:7], s68 offen offset:3072 sc1
    buffer_load_dwordx4 a[96:99], v10, s[4:7], s59 offen offset:0 sc1
    buffer_load_dwordx4 a[100:103], v10, s[4:7], s59 offen offset:1024 sc1
    buffer_load_dwordx4 a[104:107], v10, s[4:7], s59 offen offset:2048 sc1
    buffer_load_dwordx4 a[108:111], v10, s[4:7], s59 offen offset:3072 sc1
    s_add_u32 s68, s68, 1310720
    s_mov_b32 s96, 2000000
L_wf_35:
    buffer_load_dword v61, v25, s[4:7], 0 offen sc1
    s_sub_u32 s96, s96, 1
    s_cbranch_scc1 L_fail
    s_waitcnt vmcnt(0)
    v_cmp_gt_u32 vcc, s58, v61
    s_cbranch_vccz L_wf_35_d
    s_sleep 2
    s_branch L_wf_35
L_wf_35_d:
    s_add_u32 m0, s45, 0
    s_nop 0
    buffer_load_dwordx4 v10, s[4:7], s41 offen offset:0 sc1 lds
    buffer_load_dwordx4 v10, s[4:7], s41 offen offset:1024 sc1 lds
    buffer_load_dwordx4 v10, s[4:7], s41 offen offset:2048 sc1 lds
    buffer_load_dwordx4 v10, s[4:7], s41 offen offset:3072 sc1 lds
    s_add_u32 s41, s41, 524288
    s_bitset0_b32 s41, 21
    s_branch L_c_next1
L_c_rw1:
    s_mov_b32 s96, 2000000
L_wf_36:
    buffer_load_dword v16, v60, s[4:7], 0 offen sc1
    s_sub_u32 s96, s96, 1
    s_cbranch_scc1 L_fail
    s_waitcnt vmcnt(0)
    v_cmp_gt_u32 vcc, s40, v16
    s_cbranch_vccz L_wf_36_d
    s_sleep 2
    s_branch L_wf_36
L_wf_36_d:
    s_branch L_c_rok1
L_c_tw1:
    s_mov_b32 s96, 2000000
L_wf_37:
    buffer_load_dword v61, v25, s[4:7], 0 offen sc1
    s_sub_u32 s96, s96, 1
    s_cbranch_scc1 L_fail
    s_waitcnt vmcnt(0)
    v_cmp_gt_u32 vcc, s58, v61
    s_cbranch_vccz L_wf_37_d
    s_sleep 2
    s_branch L_wf_37
L_wf_37_d:
    s_branch L_c_tok1
L_c_early2:
    buffer_store_dword v26, v12, s[4:7], s57 offen
    s_add_u32 s56, s70, 524288
    s_bitset0_b32 s56, 20
    s_add_u32 s56, s56, 0
    s_lshr_b32 s97, s56, 8
    s_xor_b32 s97, s97, s60
    s_and_b32 s97, s97, 8192
    s_add_u32 s56, s56, s97
    s_add_u32 s56, s56, s77
    buffer_store_dword v26, v12, s[4:7], s56 offen sc1
    s_add_u32 s70, s70, 262144
    s_bitset0_b32 s70, 20
    s_mov_b32 s96, 2000000
L_wf_38:
    buffer_load_dword v16, v60, s[4:7], 0 offen sc1
    s_sub_u32 s96, s96, 1
    s_cbranch_scc1 L_fail
    s_waitcnt vmcnt(0)
    v_cmp_gt_u32 vcc, s40, v16
    s_cbranch_vccz L_wf_38_d
    s_sleep 2
    s_branch L_wf_38
L_wf_38_d:
    s_add_u32 s59, s68, 4096
    buffer_load_dwordx4 a[120:123], v10, s[4:7], s68 offen offset:0 sc1
    buffer_load_dwordx4 a[124:127], v10, s[4:7], s68 offen offset:1024 sc1
    buffer_load_dwordx4 a[128:131], v10, s[4:7], s68 offen offset:2048 sc1
    buffer_load_dwordx4 a[132:135], v10, s[4:7], s68 offen offset:3072 sc1
    buffer_load_dwordx4 a[136:139], v10, s[4:7], s59 offen offset:0 sc1
    buffer_load_dwordx4 a[140:143], v10, s[4:7], s59 offen offset:1024 sc1
    buffer_load_dwordx4 a[144:147], v10, s[4:7], s59 offen offset:2048 sc1
    buffer_load_dwordx4 a[148:151], v10, s[4:7], s59 offen offset:3072 sc1
    s_add_u32 s68, s68, 1310720
    s_branch L_c_next2
L_c_rw2:
    s_mov_b32 s96, 2000000
L_wf_39:
    buffer_load_dword v16, v60, s[4:7], 0 offen sc1
    s_sub_u32 s96, s96, 1
    s_cbranch_scc1 L_fail
    s_waitcnt vmcnt(0)
    v_cmp_gt_u32 vcc, s40, v16
    s_cbranch_vccz L_wf_39_d
    s_sleep 2
    s_branch L_wf_39
L_wf_39_d:
    s_branch L_c_rok2
L_c_tw2:
    s_mov_b32 s96, 2000000
L_wf_40:
    buffer_load_dword v61, v25, s[4:7], 0 offen sc1
    s_sub_u32 s96, s96, 1
    s_cbranch_scc1 L_fail
    s_waitcnt vmcnt(0)
    v_cmp_gt_u32 vcc, s58, v61
    s_cbranch_vccz L_wf_40_d
    s_sleep 2
    s_branch L_wf_40
L_wf_40_d:
    s_branch L_c_tok2
L_c_early3:
    buffer_store_dword v26, v12, s[4:7], s57 offen
    s_add_u32 s56, s70, 524288
    s_bitset0_b32 s56, 20
    s_add_u32 s56, s56, 0
    s_lshr_b32 s97, s56, 8
    s_xor_b32 s97, s97, s60
    s_and_b32 s97, s97, 8192
    s_add_u32 s56, s56, s97
    s_add_u32 s56, s56, s77
    buffer_store_dword v26, v12, s[4:7], s56 offen sc1
    s_add_u32 s70, s70, 262144
    s_bitset0_b32 s70, 20
    s_mov_b32 s96, 2000000
L_wf_41:
    buffer_load_dword v16, v60, s[4:7], 0 offen sc1
    s_sub_u32 s96, s96, 1
    s_cbranch_scc1 L_fail
    s_waitcnt vmcnt(0)
    v_cmp_gt_u32 vcc, s40, v16
    s_cbranch_vccz L_wf_41_d
    s_sleep 2
    s_branch L_wf_41
L_wf_41_d:
    s_add_u32 s59, s68, 4096
    buffer_load_dwordx4 a[0:3], v10, s[4:7], s68 offen offset:0 sc1
    buffer_load_dwordx4 a[4:7], v10, s[4:7], s68 offen offset:1024 sc1
    buffer_load_dwordx4 a[8:11], v10, s[4:7], s68 offen offset:2048 sc1
    buffer_load_dwordx4 a[12:15], v10, s[4:7], s68 offen offset:3072 sc1
    buffer_load_dwordx4 a[16:19], v10, s[4:7], s59 offen offset:0 sc1
    buffer_load_dwordx4 a[20:23], v10, s[4:7], s59 offen offset:1024 sc1
    buffer_load_dwordx4 a[24:27], v10, s[4:7], s59 offen offset:2048 sc1
    buffer_load_dwordx4 a[28:31], v10, s[4:7], s59 offen offset:3072 sc1
    s_add_u32 s68, s68, 1310720
    s_branch L_c_next3
L_c_rw3:
    s_mov_b32 s96, 2000000
L_wf_42:
    buffer_load_dword v16, v60, s[4:7], 0 offen sc1
    s_sub_u32 s96, s96, 1
    s_cbranch_scc1 L_fail
    s_waitcnt vmcnt(0)
    v_cmp_gt_u32 vcc, s40, v16
    s_cbranch_vccz L_wf_42_d
    s_sleep 2
    s_branch L_wf_42
L_wf_42_d:
    s_branch L_c_rok3
L_c_tw3:
    s_mov_b32 s96, 2000000
L_wf_43:
    buffer_load_dword v61, v25, s[4:7], 0 offen sc1
    s_sub_u32 s96, s96, 1
    s_cbranch_scc1 L_fail
    s_waitcnt vmcnt(0)
    v_cmp_gt_u32 vcc, s58, v61
    s_cbranch_vccz L_wf_43_d
    s_sleep 2
    s_branch L_wf_43
L_wf_43_d:
    s_branch L_c_tok3
L_c_drain:
    s_waitcnt vmcnt(0)
    s_barrier
    s_cmp_eq_u32 s53, 0
    s_cbranch_scc0 L_c_pg_44
    v_mov_b32 v4, 61
    buffer_store_dword v4, v8, s[4:7], s72 offen sc1
L_c_pg_44:
    ds_read_b128 v[160:163], v10 offset:16384
    ds_read_b128 v[164:167], v10 offset:17408
    ds_read_b128 v[168:171], v10 offset:18432
    ds_read_b128 v[172:175], v10 offset:19456
    ds_read_b128 v[176:179], v10 offset:20480
    ds_read_b128 v[180:183], v10 offset:21504
    ds_read_b128 v[184:187], v10 offset:22528
    ds_read_b128 v[188:191], v10 offset:23552
    ds_read_b128 v[192:195], v10 offset:24576
    ds_read_b128 v[196:199], v10 offset:25600
    ds_read_b128 v[200:203], v10 offset:26624
    ds_read_b128 v[204:207], v10 offset:27648
    ds_read_b128 v[208:211], v10 offset:28672
    ds_read_b128 v[212:215], v10 offset:29696
    ds_read_b128 v[216:219], v10 offset:30720
    ds_read_b128 v[220:223], v10 offset:31744
    s_waitcnt lgkmcnt(15)
    v_mfma_f32_16x16x32_bf16 v[152:155], a[40:43], v[160:163], 0
    s_waitcnt lgkmcnt(14)
    v_mfma_f32_16x16x32_bf16 v[152:155], a[44:47], v[164:167], v[152:155]
    s_waitcnt lgkmcnt(13)
    v_mfma_f32_16x16x32_bf16 v[152:155], a[48:51], v[168:171], v[152:155]
    s_waitcnt lgkmcnt(12)
    v_mfma_f32_16x16x32_bf16 v[152:155], a[52:55], v[172:175], v[152:155]
    s_waitcnt lgkmcnt(11)
    v_mfma_f32_16x16x32_bf16 v[152:155], a[56:59], v[176:179], v[152:155]
    s_waitcnt lgkmcnt(10)
    v_mfma_f32_16x16x32_bf16 v[152:155], a[60:63], v[180:183], v[152:155]
    s_waitcnt lgkmcnt(9)
    v_mfma_f32_16x16x32_bf16 v[152:155], a[64:67], v[184:187], v[152:155]
    s_waitcnt lgkmcnt(8)
    v_mfma_f32_16x16x32_bf16 v[152:155], a[68:71], v[188:191], v[152:155]
    s_waitcnt lgkmcnt(7)
    v_mfma_f32_16x16x16_bf16 v[148:151], a[40:41], v[192:193], 0
    v_mfma_f32_16x16x16_bf16 v[148:151], a[44:45], v[194:195], v[148:151]
    s_waitcnt lgkmcnt(6)
    v_mfma_f32_16x16x16_bf16 v[148:151], a[48:49], v[196:197], v[148:151]
    v_mfma_f32_16x16x16_bf16 v[148:151], a[52:53], v[198:199], v[148:151]
    s_waitcnt lgkmcnt(5)
    v_mfma_f32_16x16x16_bf16 v[148:151], a[56:57], v[200:201], v[148:151]
    v_mfma_f32_16x16x16_bf16 v[148:151], a[60:61], v[202:203], v[148:151]
    s_waitcnt lgkmcnt(4)
    v_mfma_f32_16x16x16_bf16 v[148:151], a[64:65], v[204:205], v[148:151]
    v_mfma_f32_16x16x16_bf16 v[148:151], a[68:69], v[206:207], v[148:151]
    s_waitcnt lgkmcnt(0)
    v_mfma_f32_16x16x32_bf16 v[152:155], a[72:75], v[216:219], v[152:155]
    v_mfma_f32_16x16x32_bf16 v[152:155], a[76:79], v[220:223], v[152:155]
    s_nop 3
    v_mfma_f32_16x16x32_bf16 v[148:151], a[72:75], v[208:211], v[148:151]
    v_mfma_f32_16x16x32_bf16 v[148:151], a[76:79], v[212:215], v[148:151]
    s_nop 7
    v_cvt_pk_bf16_f32 v156, v148, v149
    v_cvt_pk_bf16_f32 v157, v150, v151
    v_cvt_pk_bf16_f32 v158, v152, v153
    v_cvt_pk_bf16_f32 v159, v154, v155
    buffer_store_dwordx4 v[156:159], v10, s[4:7], s36 offen sc1
    s_add_u32 s36, s36, 163840
    s_mov_b32 s58, 63
    s_mov_b32 s96, 2000000
L_wf_45:
    buffer_load_dword v61, v25, s[4:7], 0 offen sc1
    s_sub_u32 s96, s96, 1
    s_cbranch_scc1 L_fail
    s_waitcnt vmcnt(0)
    v_cmp_gt_u32 vcc, s58, v61
    s_cbranch_vccz L_wf_45_d
    s_sleep 2
    s_branch L_wf_45
L_wf_45_d:
    s_add_u32 m0, s45, 0
    s_nop 0
    buffer_load_dwordx4 v10, s[4:7], s41 offen offset:0 sc1 lds
    buffer_load_dwordx4 v10, s[4:7], s41 offen offset:1024 sc1 lds
    buffer_load_dwordx4 v10, s[4:7], s41 offen offset:2048 sc1 lds
    buffer_load_dwordx4 v10, s[4:7], s41 offen offset:3072 sc1 lds
    s_add_u32 s41, s41, 524288
    s_bitset0_b32 s41, 21
    s_waitcnt vmcnt(0)
    s_barrier
    s_cmp_eq_u32 s53, 0
    s_cbranch_scc0 L_c_pg_46
    v_mov_b32 v4, 62
    buffer_store_dword v4, v8, s[4:7], s72 offen sc1
L_c_pg_46:
    ds_read_b128 v[160:163], v10 offset:0
    ds_read_b128 v[164:167], v10 offset:1024
    ds_read_b128 v[168:171], v10 offset:2048
    ds_read_b128 v[172:175], v10 offset:3072
    ds_read_b128 v[176:179], v10 offset:4096
    ds_read_b128 v[180:183], v10 offset:5120
    ds_read_b128 v[184:187], v10 offset:6144
    ds_read_b128 v[188:191], v10 offset:7168
    ds_read_b128 v[192:195], v10 offset:8192
    ds_read_b128 v[196:199], v10 offset:9216
    ds_read_b128 v[200:203], v10 offset:10240
    ds_read_b128 v[204:207], v10 offset:11264
    ds_read_b128 v[208:211], v10 offset:12288
    ds_read_b128 v[212:215], v10 offset:13312
    ds_read_b128 v[216:219], v10 offset:14336
    ds_read_b128 v[220:223], v10 offset:15360
    s_waitcnt lgkmcnt(15)
    v_mfma_f32_16x16x32_bf16 v[152:155], a[80:83], v[160:163], 0
    s_waitcnt lgkmcnt(14)
    v_mfma_f32_16x16x32_bf16 v[152:155], a[84:87], v[164:167], v[152:155]
    s_waitcnt lgkmcnt(13)
    v_mfma_f32_16x16x32_bf16 v[152:155], a[88:91], v[168:171], v[152:155]
    s_waitcnt lgkmcnt(12)
    v_mfma_f32_16x16x32_bf16 v[152:155], a[92:95], v[172:175], v[152:155]
    s_waitcnt lgkmcnt(11)
    v_mfma_f32_16x16x32_bf16 v[152:155], a[96:99], v[176:179], v[152:155]
    s_waitcnt lgkmcnt(10)
    v_mfma_f32_16x16x32_bf16 v[152:155], a[100:103], v[180:183], v[152:155]
    s_waitcnt lgkmcnt(9)
    v_mfma_f32_16x16x32_bf16 v[152:155], a[104:107], v[184:187], v[152:155]
    s_waitcnt lgkmcnt(8)
    v_mfma_f32_16x16x32_bf16 v[152:155], a[108:111], v[188:191], v[152:155]
    s_waitcnt lgkmcnt(7)
    v_mfma_f32_16x16x16_bf16 v[148:151], a[80:81], v[192:193], 0
    v_mfma_f32_16x16x16_bf16 v[148:151], a[84:85], v[194:195], v[148:151]
    s_waitcnt lgkmcnt(6)
    v_mfma_f32_16x16x16_bf16 v[148:151], a[88:89], v[196:197], v[148:151]
    v_mfma_f32_16x16x16_bf16 v[148:151], a[92:93], v[198:199], v[148:151]
    s_waitcnt lgkmcnt(5)
    v_mfma_f32_16x16x16_bf16 v[148:151], a[96:97], v[200:201], v[148:151]
    v_mfma_f32_16x16x16_bf16 v[148:151], a[100:101], v[202:203], v[148:151]
    s_waitcnt lgkmcnt(4)
    v_mfma_f32_16x16x16_bf16 v[148:151], a[104:105], v[204:205], v[148:151]
    v_mfma_f32_16x16x16_bf16 v[148:151], a[108:109], v[206:207], v[148:151]
    s_waitcnt lgkmcnt(0)
    v_mfma_f32_16x16x32_bf16 v[152:155], a[112:115], v[216:219], v[152:155]
    v_mfma_f32_16x16x32_bf16 v[152:155], a[116:119], v[220:223], v[152:155]
    s_nop 3
    v_mfma_f32_16x16x32_bf16 v[148:151], a[112:115], v[208:211], v[148:151]
    v_mfma_f32_16x16x32_bf16 v[148:151], a[116:119], v[212:215], v[148:151]
    s_nop 7
    v_cvt_pk_bf16_f32 v156, v148, v149
    v_cvt_pk_bf16_f32 v157, v150, v151
    v_cvt_pk_bf16_f32 v158, v152, v153
    v_cvt_pk_bf16_f32 v159, v154, v155
    buffer_store_dwordx4 v[156:159], v10, s[4:7], s36 offen sc1
    s_add_u32 s36, s36, 163840
    s_waitcnt vmcnt(0)
    s_barrier
    s_cmp_eq_u32 s53, 0
    s_cbranch_scc0 L_c_pg_47
    v_mov_b32 v4, 63
    buffer_store_dword v4, v8, s[4:7], s72 offen sc1
L_c_pg_47:
    s_mov_b32 s96, 2000000
L_poll_48:
    buffer_load_dwordx4 v[68:71], v10, s[4:7], s67 offen offset:0 sc1
    buffer_load_dwordx4 v[76:79], v10, s[4:7], s67 offen offset:1024 sc1
    s_sub_u32 s96, s96, 1
    s_cbranch_scc1 L_fail
    s_waitcnt vmcnt(0)
    v_max3_u32 v7, v68, v69, v70
    v_max3_u32 v7, v7, v71, v76
    v_max3_u32 v7, v7, v77, v78
    v_max_u32 v7, v7, v79
    v_cmp_eq_u32 vcc, -1, v7
    s_cbranch_vccz L_poll_48_d
    s_sleep 1
    s_branch L_poll_48
L_poll_48_d:
    v_accvgpr_write_b32 a152, v68
    v_accvgpr_write_b32 a153, v69
    v_accvgpr_write_b32 a154, v70
    v_accvgpr_write_b32 a155, v71
    v_accvgpr_write_b32 a156, v76
    v_accvgpr_write_b32 a157, v77
    v_accvgpr_write_b32 a158, v78
    v_accvgpr_write_b32 a159, v79
    s_mov_b32 s58, 64
    s_mov_b32 s96, 2000000
L_wf_49:
    buffer_load_dword v61, v25, s[4:7], 0 offen sc1
    s_sub_u32 s96, s96, 1
    s_cbranch_scc1 L_fail
    s_waitcnt vmcnt(0)
    v_cmp_gt_u32 vcc, s58, v61
    s_cbranch_vccz L_wf_49_d
    s_sleep 2
    s_branch L_wf_49
L_wf_49_d:
    s_add_u32 m0, s45, 16384
    s_nop 0
    buffer_load_dwordx4 v10, s[4:7], s41 offen offset:0 sc1 lds
    buffer_load_dwordx4 v10, s[4:7], s41 offen offset:1024 sc1 lds
    buffer_load_dwordx4 v10, s[4:7], s41 offen offset:2048 sc1 lds
    buffer_load_dwordx4 v10, s[4:7], s41 offen offset:3072 sc1 lds
    s_add_u32 s41, s41, 524288
    s_bitset0_b32 s41, 21
    s_waitcnt vmcnt(0)
    s_barrier
    s_cmp_eq_u32 s53, 0
    s_cbranch_scc0 L_c_pg_50
    v_mov_b32 v4, 64
    buffer_store_dword v4, v8, s[4:7], s72 offen sc1
L_c_pg_50:
    ds_read_b128 v[160:163], v10 offset:16384
    ds_read_b128 v[164:167], v10 offset:17408
    ds_read_b128 v[168:171], v10 offset:18432
    ds_read_b128 v[172:175], v10 offset:19456
    ds_read_b128 v[176:179], v10 offset:20480
    ds_read_b128 v[180:183], v10 offset:21504
    ds_read_b128 v[184:187], v10 offset:22528
    ds_read_b128 v[188:191], v10 offset:23552
    ds_read_b128 v[192:195], v10 offset:24576
    ds_read_b128 v[196:199], v10 offset:25600
    ds_read_b128 v[200:203], v10 offset:26624
    ds_read_b128 v[204:207], v10 offset:27648
    ds_read_b128 v[208:211], v10 offset:28672
    ds_read_b128 v[212:215], v10 offset:29696
    ds_read_b128 v[216:219], v10 offset:30720
    ds_read_b128 v[220:223], v10 offset:31744
    s_waitcnt lgkmcnt(15)
    v_mfma_f32_16x16x32_bf16 v[152:155], a[120:123], v[160:163], 0
    s_waitcnt lgkmcnt(14)
    v_mfma_f32_16x16x32_bf16 v[152:155], a[124:127], v[164:167], v[152:155]
    s_waitcnt lgkmcnt(13)
    v_mfma_f32_16x16x32_bf16 v[152:155], a[128:131], v[168:171], v[152:155]
    s_waitcnt lgkmcnt(12)
    v_mfma_f32_16x16x32_bf16 v[152:155], a[132:135], v[172:175], v[152:155]
    s_waitcnt lgkmcnt(11)
    v_mfma_f32_16x16x32_bf16 v[152:155], a[136:139], v[176:179], v[152:155]
    s_waitcnt lgkmcnt(10)
    v_mfma_f32_16x16x32_bf16 v[152:155], a[140:143], v[180:183], v[152:155]
    s_waitcnt lgkmcnt(9)
    v_mfma_f32_16x16x32_bf16 v[152:155], a[144:147], v[184:187], v[152:155]
    s_waitcnt lgkmcnt(8)
    v_mfma_f32_16x16x32_bf16 v[152:155], a[148:151], v[188:191], v[152:155]
    s_waitcnt lgkmcnt(7)
    v_mfma_f32_16x16x16_bf16 v[148:151], a[120:121], v[192:193], 0
    v_mfma_f32_16x16x16_bf16 v[148:151], a[124:125], v[194:195], v[148:151]
    s_waitcnt lgkmcnt(6)
    v_mfma_f32_16x16x16_bf16 v[148:151], a[128:129], v[196:197], v[148:151]
    v_mfma_f32_16x16x16_bf16 v[148:151], a[132:133], v[198:199], v[148:151]
    s_waitcnt lgkmcnt(5)
    v_mfma_f32_16x16x16_bf16 v[148:151], a[136:137], v[200:201], v[148:151]
    v_mfma_f32_16x16x16_bf16 v[148:151], a[140:141], v[202:203], v[148:151]
    s_waitcnt lgkmcnt(4)
    v_mfma_f32_16x16x16_bf16 v[148:151], a[144:145], v[204:205], v[148:151]
    v_mfma_f32_16x16x16_bf16 v[148:151], a[148:149], v[206:207], v[148:151]
    s_waitcnt lgkmcnt(0)
    v_mfma_f32_16x16x32_bf16 v[152:155], a[152:155], v[216:219], v[152:155]
    v_mfma_f32_16x16x32_bf16 v[152:155], a[156:159], v[220:223], v[152:155]
    s_nop 3
    v_mfma_f32_16x16x32_bf16 v[148:151], a[152:155], v[208:211], v[148:151]
    v_mfma_f32_16x16x32_bf16 v[148:151], a[156:159], v[212:215], v[148:151]
    s_nop 7
    v_cvt_pk_bf16_f32 v156, v148, v149
    v_cvt_pk_bf16_f32 v157, v150, v151
    v_cvt_pk_bf16_f32 v158, v152, v153
    v_cvt_pk_bf16_f32 v159, v154, v155
    v_min_u32 v156, -2, v156
    v_min_u32 v157, -2, v157
    v_min_u32 v158, -2, v158
    v_min_u32 v159, -2, v159
    buffer_store_dwordx4 v[156:159], v10, s[4:7], s36 offen sc1
    s_add_u32 s36, s36, 163840
    s_branch L_end
L_roleV:
    s_sub_u32 s54, s52, 72
    v_lshlrev_b32 v18, 4, v1
    v_and_b32 v4, 1, v2
    v_lshlrev_b32 v4, 3, v4
    v_lshl_add_u32 v4, v3, 4, v4
    v_lshrrev_b32 v5, 5, v1
    v_lshl_add_u32 v19, v5, 13, v4
    s_mul_i32 s64, s53, 81920
    s_lshl_b32 s56, s54, 8
    s_add_u32 s64, s64, s56
    s_add_u32 s64, s64, 21102592
    v_mov_b32 v4, -1
    v_mov_b32 v5, -1
    s_add_u32 s56, s64, 0
    buffer_store_dwordx2 v[4:5], v19, s[4:7], s56 offen sc1
    s_add_u32 s56, s64, 16384
    buffer_store_dwordx2 v[4:5], v19, s[4:7], s56 offen sc1
    s_add_u32 s56, s64, 32768
    buffer_store_dwordx2 v[4:5], v19, s[4:7], s56 offen sc1
    s_add_u32 s56, s64, 49152
    buffer_store_dwordx2 v[4:5], v19, s[4:7], s56 offen sc1
    s_add_u32 s56, s64, 65536
    buffer_store_dwordx2 v[4:5], v19, s[4:7], s56 offen sc1
    s_add_u32 s56, s64, 524288
    buffer_store_dwordx2 v[4:5], v19, s[4:7], s56 offen sc1
    s_add_u32 s56, s64, 540672
    buffer_store_dwordx2 v[4:5], v19, s[4:7], s56 offen sc1
    s_add_u32 s56, s64, 557056
    buffer_store_dwordx2 v[4:5], v19, s[4:7], s56 offen sc1
    s_add_u32 s56, s64, 573440
    buffer_store_dwordx2 v[4:5], v19, s[4:7], s56 offen sc1
    s_add_u32 s56, s64, 589824
    buffer_store_dwordx2 v[4:5], v19, s[4:7], s56 offen sc1
    s_mov_b32 s12, s34
    s_mov_b32 s13, s35
    s_mov_b32 s14, 7864320
    s_mov_b32 s15, 0x20000
    s_mov_b32 s16, s32
    s_mov_b32 s17, s33
    s_mov_b32 s18, 7864320
    s_mov_b32 s19, 0x20000
    s_mul_i32 s57, s53, 320
    v_and_b32 v4, 1, v2
    v_lshlrev_b32 v4, 1, v4
    v_lshrrev_b32 v5, 3, v3
    v_add_u32 v4, v4, v5
    v_mul_u32_u24 v4, 12352, v4
    v_lshrrev_b32 v5, 1, v2
    v_lshlrev_b32 v5, 2, v5
    v_bfe_u32 v6, v3, 2, 1
    v_add_u32 v5, v5, v6
    v_mul_u32_u24 v5, 1280, v5
    v_add_u32 v4, v4, v5
    v_and_b32 v5, 3, v3
    v_lshl_add_u32 v4, v5, 3, v4
    v_add_u32 v14, s57, v4
    s_mul_i32 s74, s54, 245760
    s_mul_i32 s56, s53, 20480
    s_add_u32 s74, s74, s56
    s_mul_i32 s75, s53, 12352
    s_mul_i32 s71, s53, 18432
    v_add_u32 v15, s71, v18
    v_mov_b32 v0, v19
    s_mul_i32 s58, s54, 384
    v_add_u32 v4, 0, v1
    v_mul_u32_u24 v5, 171, v4
    v_lshrrev_b32 v5, 12, v5
    v_mul_u32_u24 v6, 24, v5
    v_sub_u32 v4, v4, v6
    v_mul_u32_u24 v5, 12288, v5
    v_lshl_add_u32 v5, v4, 4, v5
    v_add_u32 v19, s58, v5
    v_add_u32 v4, 64, v1
    v_mul_u32_u24 v5, 171, v4
    v_lshrrev_b32 v5, 12, v5
    v_mul_u32_u24 v6, 24, v5
    v_sub_u32 v4, v4, v6
    v_mul_u32_u24 v5, 12288, v5
    v_lshl_add_u32 v5, v4, 4, v5
    v_add_u32 v20, s58, v5
    v_add_u32 v4, 128, v1
    v_mul_u32_u24 v5, 171, v4
    v_lshrrev_b32 v5, 12, v5
    v_mul_u32_u24 v6, 24, v5
    v_sub_u32 v4, v4, v6
    v_mul_u32_u24 v5, 12288, v5
    v_lshl_add_u32 v5, v4, 4, v5
    v_add_u32 v21, s58, v5
    v_lshrrev_b32 v4, 2, v3
    v_lshl_add_u32 v4, v2, 3, v4
    v_mul_u32_u24 v4, 384, v4
    v_and_b32 v5, 3, v3
    v_lshl_add_u32 v4, v5, 3, v4
    s_lshr_b32 s56, s53, 1
    s_lshl_b32 s56, s56, 1
    s_add_u32 s56, s56, s53
    s_lshl_b32 s56, s56, 6
    s_lshl_b32 s57, s53, 5
    s_add_u32 s57, s57, 128
    v_add_u32 v30, s56, v4
    v_add_u32 v31, s57, v4
    s_mul_i32 s70, s53, 12288
    s_xor_b32 s56, s53, 0
    s_mul_i32 s56, s56, 12288
    v_add_u32 v22, s56, v30
    v_add_u32 v23, s56, v31
    s_xor_b32 s56, s53, 1
    s_mul_i32 s56, s56, 12288
    v_add_u32 v24, s56, v30
    v_add_u32 v25, s56, v31
    s_xor_b32 s56, s53, 2
    s_mul_i32 s56, s56, 12288
    v_add_u32 v26, s56, v30
    v_add_u32 v27, s56, v31
    s_xor_b32 s56, s53, 3
    s_mul_i32 s56, s56, 12288
    v_add_u32 v28, s56, v30
    v_add_u32 v29, s56, v31
    s_mul_i32 s72, s53, 1572864
    s_add_u32 s72, s72, 0
    s_add_u32 m0, s70, 0
    s_nop 0
    buffer_load_dwordx4 v19, s[16:19], s72 offen lds
    s_add_u32 m0, s70, 1024
    s_nop 0
    buffer_load_dwordx4 v20, s[16:19], s72 offen lds
    s_add_u32 m0, s70, 2048
    s_nop 0
    buffer_load_dwordx4 v21, s[16:19], s72 offen lds
    s_add_u32 s72, s72, 98304
    s_add_u32 m0, s70, 3072
    s_nop 0
    buffer_load_dwordx4 v19, s[16:19], s72 offen lds
    s_add_u32 m0, s70, 4096
    s_nop 0
    buffer_load_dwordx4 v20, s[16:19], s72 offen lds
    s_add_u32 m0, s70, 5120
    s_nop 0
    buffer_load_dwordx4 v21, s[16:19], s72 offen lds
    s_add_u32 s72, s72, 98304
    s_add_u32 m0, s70, 6144
    s_nop 0
    buffer_load_dwordx4 v19, s[16:19], s72 offen lds
    s_add_u32 m0, s70, 7168
    s_nop 0
    buffer_load_dwordx4 v20, s[16:19], s72 offen lds
    s_add_u32 m0, s70, 8192
    s_nop 0
    buffer_load_dwordx4 v21, s[16:19], s72 offen lds
    s_add_u32 s72, s72, 98304
    s_add_u32 m0, s70, 9216
    s_nop 0
    buffer_load_dwordx4 v19, s[16:19], s72 offen lds
    s_add_u32 m0, s70, 10240
    s_nop 0
    buffer_load_dwordx4 v20, s[16:19], s72 offen lds
    s_add_u32 m0, s70, 11264
    s_nop 0
    buffer_load_dwordx4 v21, s[16:19], s72 offen lds
    s_mul_i32 s72, s53, 1572864
    s_add_u32 s72, s72, 393216
    s_add_u32 m0, s70, 49152
    s_nop 0
    buffer_load_dwordx4 v19, s[16:19], s72 offen lds
    s_add_u32 m0, s70, 50176
    s_nop 0
    buffer_load_dwordx4 v20, s[16:19], s72 offen lds
    s_add_u32 m0, s70, 51200
    s_nop 0
    buffer_load_dwordx4 v21, s[16:19], s72 offen lds
    s_add_u32 s72, s72, 98304
    s_add_u32 m0, s70, 52224
    s_nop 0
    buffer_load_dwordx4 v19, s[16:19], s72 offen lds
    s_add_u32 m0, s70, 53248
    s_nop 0
    buffer_load_dwordx4 v20, s[16:19], s72 offen lds
    s_add_u32 m0, s70, 54272
    s_nop 0
    buffer_load_dwordx4 v21, s[16:19], s72 offen lds
    s_add_u32 s72, s72, 98304
    s_add_u32 m0, s70, 55296
    s_nop 0
    buffer_load_dwordx4 v19, s[16:19], s72 offen lds
    s_add_u32 m0, s70, 56320
    s_nop 0
    buffer_load_dwordx4 v20, s[16:19], s72 offen lds
    s_add_u32 m0, s70, 57344
    s_nop 0
    buffer_load_dwordx4 v21, s[16:19], s72 offen lds
    s_add_u32 s72, s72, 98304
    s_add_u32 m0, s70, 58368
    s_nop 0
    buffer_load_dwordx4 v19, s[16:19], s72 offen lds
    s_add_u32 m0, s70, 59392
    s_nop 0
    buffer_load_dwordx4 v20, s[16:19], s72 offen lds
    s_add_u32 m0, s70, 60416
    s_nop 0
    buffer_load_dwordx4 v21, s[16:19], s72 offen lds
    s_waitcnt vmcnt(24)
    s_barrier
    s_cmp_eq_u32 s53, 3
    s_cbranch_scc0 L_arr_51
    s_mov_b64 exec, 1
    v_mov_b32 v7, 1
    v_mov_b32 v5, 8
    buffer_atomic_add v7, v5, s[8:11], 0 offen sc0
    s_mov_b64 exec, -1
L_arr_51:
    s_waitcnt vmcnt(12)
    s_barrier
    s_mul_i32 s72, s53, 1572864
    s_add_u32 s72, s72, 786432
    s_add_u32 m0, s70, 98304
    s_nop 0
    buffer_load_dwordx4 v19, s[16:19], s72 offen lds
    s_add_u32 m0, s70, 99328
    s_nop 0
    buffer_load_dwordx4 v20, s[16:19], s72 offen lds
    s_add_u32 m0, s70, 100352
    s_nop 0
    buffer_load_dwordx4 v21, s[16:19], s72 offen lds
    s_add_u32 s72, s72, 98304
    s_add_u32 m0, s70, 101376
    s_nop 0
    buffer_load_dwordx4 v19, s[16:19], s72 offen lds
    s_add_u32 m0, s70, 102400
    s_nop 0
    buffer_load_dwordx4 v20, s[16:19], s72 offen lds
    s_add_u32 m0, s70, 103424
    s_nop 0
    buffer_load_dwordx4 v21, s[16:19], s72 offen lds
    s_add_u32 s72, s72, 98304
    s_add_u32 m0, s70, 104448
    s_nop 0
    buffer_load_dwordx4 v19, s[16:19], s72 offen lds
    s_add_u32 m0, s70, 105472
    s_nop 0
    buffer_load_dwordx4 v20, s[16:19], s72 offen lds
    s_add_u32 m0, s70, 106496
    s_nop 0
    buffer_load_dwordx4 v21, s[16:19], s72 offen lds
    s_add_u32 s72, s72, 98304
    s_add_u32 m0, s70, 107520
    s_nop 0
    buffer_load_dwordx4 v19, s[16:19], s72 offen lds
    s_add_u32 m0, s70, 108544
    s_nop 0
    buffer_load_dwordx4 v20, s[16:19], s72 offen lds
    s_add_u32 m0, s70, 109568
    s_nop 0
    buffer_load_dwordx4 v21, s[16:19], s72 offen lds
    ds_read_b64_tr_b16 a[88:89], v22 offset:0
    ds_read_b64_tr_b16 a[90:91], v22 offset:1536
    ds_read_b64_tr_b16 a[96:97], v22 offset:32
    ds_read_b64_tr_b16 a[98:99], v22 offset:1568
    ds_read_b64_tr_b16 a[104:105], v23 offset:0
    ds_read_b64_tr_b16 a[106:107], v23 offset:1536
    ds_read_b64_tr_b16 a[128:129], v24 offset:0
    ds_read_b64_tr_b16 a[130:131], v24 offset:1536
    ds_read_b64_tr_b16 a[136:137], v24 offset:32
    ds_read_b64_tr_b16 a[138:139], v24 offset:1568
    ds_read_b64_tr_b16 a[216:217], v25 offset:0
    ds_read_b64_tr_b16 a[218:219], v25 offset:1536
    ds_read_b64_tr_b16 a[152:153], v26 offset:0
    ds_read_b64_tr_b16 a[154:155], v26 offset:1536
    ds_read_b64_tr_b16 v[32:33], v26 offset:32
    ds_read_b64_tr_b16 v[34:35], v26 offset:1568
    ds_read_b64_tr_b16 a[224:225], v27 offset:0
    ds_read_b64_tr_b16 a[226:227], v27 offset:1536
    ds_read_b64_tr_b16 v[40:41], v28 offset:0
    ds_read_b64_tr_b16 v[42:43], v28 offset:1536
    ds_read_b64_tr_b16 a[176:177], v28 offset:32
    ds_read_b64_tr_b16 a[178:179], v28 offset:1568
    ds_read_b64_tr_b16 v[48:49], v29 offset:0
    ds_read_b64_tr_b16 v[50:51], v29 offset:1536
    s_waitcnt lgkmcnt(0)
    s_waitcnt vmcnt(12)
    s_barrier
    s_mul_i32 s72, s53, 1572864
    s_add_u32 s72, s72, 1179648
    s_add_u32 m0, s70, 0
    s_nop 0
    buffer_load_dwordx4 v19, s[16:19], s72 offen lds
    s_add_u32 m0, s70, 1024
    s_nop 0
    buffer_load_dwordx4 v20, s[16:19], s72 offen lds
    s_add_u32 m0, s70, 2048
    s_nop 0
    buffer_load_dwordx4 v21, s[16:19], s72 offen lds
    s_add_u32 s72, s72, 98304
    s_add_u32 m0, s70, 3072
    s_nop 0
    buffer_load_dwordx4 v19, s[16:19], s72 offen lds
    s_add_u32 m0, s70, 4096
    s_nop 0
    buffer_load_dwordx4 v20, s[16:19], s72 offen lds
    s_add_u32 m0, s70, 5120
    s_nop 0
    buffer_load_dwordx4 v21, s[16:19], s72 offen lds
    s_add_u32 s72, s72, 98304
    s_add_u32 m0, s70, 6144
    s_nop 0
    buffer_load_dwordx4 v19, s[16:19], s72 offen lds
    s_add_u32 m0, s70, 7168
    s_nop 0
    buffer_load_dwordx4 v20, s[16:19], s72 offen lds
    s_add_u32 m0, s70, 8192
    s_nop 0
    buffer_load_dwordx4 v21, s[16:19], s72 offen lds
    s_add_u32 s72, s72, 98304
    s_add_u32 m0, s70, 9216
    s_nop 0
    buffer_load_dwordx4 v19, s[16:19], s72 offen lds
    s_add_u32 m0, s70, 10240
    s_nop 0
    buffer_load_dwordx4 v20, s[16:19], s72 offen lds
    s_add_u32 m0, s70, 11264
    s_nop 0
    buffer_load_dwordx4 v21, s[16:19], s72 offen lds
    v_add_u32 v22, 49152, v22
    v_add_u32 v23, 49152, v23
    v_add_u32 v24, 49152, v24
    v_add_u32 v25, 49152, v25
    v_add_u32 v26, 49152, v26
    v_add_u32 v27, 49152, v27
    v_add_u32 v28, 49152, v28
    v_add_u32 v29, 49152, v29
    v_add_u32 v30, 49152, v30
    v_add_u32 v31, 49152, v31
    ds_read_b64_tr_b16 a[92:93], v22 offset:0
    ds_read_b64_tr_b16 a[94:95], v22 offset:1536
    ds_read_b64_tr_b16 a[100:101], v22 offset:32
    ds_read_b64_tr_b16 a[102:103], v22 offset:1568
    ds_read_b64_tr_b16 a[108:109], v23 offset:0
    ds_read_b64_tr_b16 a[110:111], v23 offset:1536
    ds_read_b64_tr_b16 a[132:133], v24 offset:0
    ds_read_b64_tr_b16 a[134:135], v24 offset:1536
    ds_read_b64_tr_b16 a[140:141], v24 offset:32
    ds_read_b64_tr_b16 a[142:143], v24 offset:1568
    ds_read_b64_tr_b16 a[220:221], v25 offset:0
    ds_read_b64_tr_b16 a[222:223], v25 offset:1536
    ds_read_b64_tr_b16 a[156:157], v26 offset:0
    ds_read_b64_tr_b16 a[158:159], v26 offset:1536
    ds_read_b64_tr_b16 v[36:37], v26 offset:32
    ds_read_b64_tr_b16 v[38:39], v26 offset:1568
    ds_read_b64_tr_b16 a[228:229], v27 offset:0
    ds_read_b64_tr_b16 a[230:231], v27 offset:1536
    ds_read_b64_tr_b16 v[44:45], v28 offset:0
    ds_read_b64_tr_b16 v[46:47], v28 offset:1536
    ds_read_b64_tr_b16 a[180:181], v28 offset:32
    ds_read_b64_tr_b16 a[182:183], v28 offset:1568
    ds_read_b64_tr_b16 v[52:53], v29 offset:0
    ds_read_b64_tr_b16 v[54:55], v29 offset:1536
    s_waitcnt lgkmcnt(0)
    s_waitcnt vmcnt(12)
    s_cmp_eq_u32 s53, 3
    s_cbranch_scc0 L_arr_52
    s_mov_b64 exec, 1
    v_cmp_eq_u32 vcc, 255, v7
    s_cbranch_vccz L_arr_52_x
    v_mov_b32 v5, 8
    buffer_load_dwordx3 v[4:6], v5, s[8:11], 0 offen offset:8 sc1
    s_waitcnt vmcnt(0)
    v_cmp_lt_u32 vcc, v4, v5
    v_mov_b32 v4, 0x2001
    v_lshlrev_b32 v6, 1, v6
    v_cndmask_b32 v4, 1, v4, vcc
    v_or_b32 v4, v4, v6
    v_mov_b32 v5, 252
    buffer_store_dword v4, v5, s[8:11], 0 offen sc1
L_arr_52_x:
    s_mov_b64 exec, -1
L_arr_52:
    s_barrier
    s_mul_i32 s72, s53, 393216
    s_add_u32 s72, s72, 6291456
    s_add_u32 m0, s70, 49152
    s_nop 0
    buffer_load_dwordx4 v19, s[16:19], s72 offen lds
    s_add_u32 m0, s70, 50176
    s_nop 0
    buffer_load_dwordx4 v20, s[16:19], s72 offen lds
    s_add_u32 m0, s70, 51200
    s_nop 0
    buffer_load_dwordx4 v21, s[16:19], s72 offen lds
    s_add_u32 s72, s72, 98304
    s_add_u32 m0, s70, 52224
    s_nop 0
    buffer_load_dwordx4 v19, s[16:19], s72 offen lds
    s_add_u32 m0, s70, 53248
    s_nop 0
    buffer_load_dwordx4 v20, s[16:19], s72 offen lds
    s_add_u32 m0, s70, 54272
    s_nop 0
    buffer_load_dwordx4 v21, s[16:19], s72 offen lds
    s_add_u32 s72, s72, 98304
    s_add_u32 m0, s70, 55296
    s_nop 0
    buffer_load_dwordx4 v19, s[16:19], s72 offen lds
    s_add_u32 m0, s70, 56320
    s_nop 0
    buffer_load_dwordx4 v20, s[16:19], s72 offen lds
    s_add_u32 m0, s70, 57344
    s_nop 0
    buffer_load_dwordx4 v21, s[16:19], s72 offen lds
    s_add_u32 s72, s72, 98304
    s_add_u32 m0, s70, 58368
    s_nop 0
    buffer_load_dwordx4 v19, s[16:19], s72 offen lds
    s_add_u32 m0, s70, 59392
    s_nop 0
    buffer_load_dwordx4 v20, s[16:19], s72 offen lds
    s_add_u32 m0, s70, 60416
    s_nop 0
    buffer_load_dwordx4 v21, s[16:19], s72 offen lds
    v_add_u32 v22, 49152, v22
    v_add_u32 v23, 49152, v23
    v_add_u32 v24, 49152, v24
    v_add_u32 v25, 49152, v25
    v_add_u32 v26, 49152, v26
    v_add_u32 v27, 49152, v27
    v_add_u32 v28, 49152, v28
    v_add_u32 v29, 49152, v29
    v_add_u32 v30, 49152, v30
    v_add_u32 v31, 49152, v31
    ds_read_b64_tr_b16 a[112:113], v22 offset:0
    ds_read_b64_tr_b16 a[114:115], v22 offset:1536
    ds_read_b64_tr_b16 a[120:121], v22 offset:32
    ds_read_b64_tr_b16 a[122:123], v22 offset:1568
    ds_read_b64_tr_b16 v[56:57], v23 offset:0
    ds_read_b64_tr_b16 v[58:59], v23 offset:1536
    ds_read_b64_tr_b16 v[64:65], v24 offset:0
    ds_read_b64_tr_b16 v[66:67], v24 offset:1536
    ds_read_b64_tr_b16 a[144:145], v24 offset:32
    ds_read_b64_tr_b16 a[146:147], v24 offset:1568
    ds_read_b64_tr_b16 v[72:73], v25 offset:0
    ds_read_b64_tr_b16 v[74:75], v25 offset:1536
    ds_read_b64_tr_b16 a[160:161], v26 offset:0
    ds_read_b64_tr_b16 a[162:163], v26 offset:1536
    ds_read_b64_tr_b16 a[168:169], v26 offset:32
    ds_read_b64_tr_b16 a[170:171], v26 offset:1568
    ds_read_b64_tr_b16 a[232:233], v27 offset:0
    ds_read_b64_tr_b16 a[234:235], v27 offset:1536
    ds_read_b64_tr_b16 a[184:185], v28 offset:0
    ds_read_b64_tr_b16 a[186:187], v28 offset:1536
    ds_read_b64_tr_b16 v[80:81], v28 offset:32
    ds_read_b64_tr_b16 v[82:83], v28 offset:1568
    ds_read_b64_tr_b16 a[240:241], v29 offset:0
    ds_read_b64_tr_b16 a[242:243], v29 offset:1536
    s_waitcnt lgkmcnt(0)
    s_waitcnt vmcnt(12)
    s_barrier
    s_add_u32 m0, s75, 98304
    s_add_u32 s73, s74, 0
    buffer_load_dwordx4 v18, s[12:15], s73 offen offset:0 lds
    buffer_load_dwordx4 v18, s[12:15], s73 offen offset:1024 lds
    buffer_load_dwordx4 v18, s[12:15], s73 offen offset:2048 lds
    buffer_load_dwordx4 v18, s[12:15], s73 offen offset:3072 lds
    s_add_u32 m0, s75, 102400
    s_add_u32 s73, s74, 4096
    buffer_load_dwordx4 v18, s[12:15], s73 offen offset:0 lds
    buffer_load_dwordx4 v18, s[12:15], s73 offen offset:1024 lds
    buffer_load_dwordx4 v18, s[12:15], s73 offen offset:2048 lds
    buffer_load_dwordx4 v18, s[12:15], s73 offen offset:3072 lds
    s_add_u32 m0, s75, 106496
    s_add_u32 s73, s74, 8192
    buffer_load_dwordx4 v18, s[12:15], s73 offen offset:0 lds
    buffer_load_dwordx4 v18, s[12:15], s73 offen offset:1024 lds
    v_add_u32 v22, -98304, v22
    v_add_u32 v23, -98304, v23
    v_add_u32 v24, -98304, v24
    v_add_u32 v25, -98304, v25
    v_add_u32 v26, -98304, v26
    v_add_u32 v27, -98304, v27
    v_add_u32 v28, -98304, v28
    v_add_u32 v29, -98304, v29
    v_add_u32 v30, -98304, v30
    v_add_u32 v31, -98304, v31
    ds_read_b64_tr_b16 a[116:117], v22 offset:0
    ds_read_b64_tr_b16 a[118:119], v22 offset:1536
    ds_read_b64_tr_b16 a[124:125], v22 offset:32
    ds_read_b64_tr_b16 a[126:127], v22 offset:1568
    ds_read_b64_tr_b16 v[60:61], v23 offset:0
    ds_read_b64_tr_b16 v[62:63], v23 offset:1536
    ds_read_b64_tr_b16 v[68:69], v24 offset:0
    ds_read_b64_tr_b16 v[70:71], v24 offset:1536
    ds_read_b64_tr_b16 a[148:149], v24 offset:32
    ds_read_b64_tr_b16 a[150:151], v24 offset:1568
    ds_read_b64_tr_b16 v[76:77], v25 offset:0
    ds_read_b64_tr_b16 v[78:79], v25 offset:1536
    ds_read_b64_tr_b16 a[164:165], v26 offset:0
    ds_read_b64_tr_b16 a[166:167], v26 offset:1536
    ds_read_b64_tr_b16 a[172:173], v26 offset:32
    ds_read_b64_tr_b16 a[174:175], v26 offset:1568
    ds_read_b64_tr_b16 a[236:237], v27 offset:0
    ds_read_b64_tr_b16 a[238:239], v27 offset:1536
    ds_read_b64_tr_b16 a[188:189], v28 offset:0
    ds_read_b64_tr_b16 a[190:191], v28 offset:1536
    ds_read_b64_tr_b16 v[84:85], v28 offset:32
    ds_read_b64_tr_b16 v[86:87], v28 offset:1568
    ds_read_b64_tr_b16 a[244:245], v29 offset:0
    ds_read_b64_tr_b16 a[246:247], v29 offset:1536
    s_waitcnt lgkmcnt(0)
    s_waitcnt vmcnt(10)
    s_barrier
    s_add_u32 m0, s75, 0
    s_add_u32 s73, s74, 10240
    buffer_load_dwordx4 v18, s[12:15], s73 offen offset:0 lds
    buffer_load_dwordx4 v18, s[12:15], s73 offen offset:1024 lds
    buffer_load_dwordx4 v18, s[12:15], s73 offen offset:2048 lds
    buffer_load_dwordx4 v18, s[12:15], s73 offen offset:3072 lds
    s_add_u32 m0, s75, 4096
    s_add_u32 s73, s74, 14336
    buffer_load_dwordx4 v18, s[12:15], s73 offen offset:0 lds
    buffer_load_dwordx4 v18, s[12:15], s73 offen offset:1024 lds
    buffer_load_dwordx4 v18, s[12:15], s73 offen offset:2048 lds
    buffer_load_dwordx4 v18, s[12:15], s73 offen offset:3072 lds
    s_add_u32 m0, s75, 8192
    s_add_u32 s73, s74, 18432
    buffer_load_dwordx4 v18, s[12:15], s73 offen offset:0 lds
    buffer_load_dwordx4 v18, s[12:15], s73 offen offset:1024 lds
    v_add_u32 v22, 49152, v22
    v_add_u32 v23, 49152, v23
    v_add_u32 v24, 49152, v24
    v_add_u32 v25, 49152, v25
    v_add_u32 v26, 49152, v26
    v_add_u32 v27, 49152, v27
    v_add_u32 v28, 49152, v28
    v_add_u32 v29, 49152, v29
    v_add_u32 v30, 49152, v30
    v_add_u32 v31, 49152, v31
    ds_read_b64_tr_b16 a[192:193], v30 offset:0
    ds_read_b64_tr_b16 a[194:195], v30 offset:1536
    ds_read_b64_tr_b16 a[200:201], v30 offset:32
    ds_read_b64_tr_b16 a[202:203], v30 offset:1568
    ds_read_b64_tr_b16 a[248:249], v31 offset:0
    ds_read_b64_tr_b16 a[250:251], v31 offset:1536
    ds_read_b64_tr_b16 a[196:197], v30 offset:12288
    ds_read_b64_tr_b16 a[198:199], v30 offset:13824
    ds_read_b64_tr_b16 a[204:205], v30 offset:12320
    ds_read_b64_tr_b16 a[206:207], v30 offset:13856
    ds_read_b64_tr_b16 a[252:253], v31 offset:12288
    ds_read_b64_tr_b16 a[254:255], v31 offset:13824
    ds_read_b64_tr_b16 v[88:89], v30 offset:24576
    ds_read_b64_tr_b16 v[90:91], v30 offset:26112
    ds_read_b64_tr_b16 a[208:209], v30 offset:24608
    ds_read_b64_tr_b16 a[210:211], v30 offset:26144
    ds_read_b64_tr_b16 v[96:97], v31 offset:24576
    ds_read_b64_tr_b16 v[98:99], v31 offset:26112
    ds_read_b64_tr_b16 v[92:93], v30 offset:36864
    ds_read_b64_tr_b16 v[94:95], v30 offset:38400
    ds_read_b64_tr_b16 a[212:213], v30 offset:36896
    ds_read_b64_tr_b16 a[214:215], v30 offset:38432
    ds_read_b64_tr_b16 v[100:101], v31 offset:36864
    ds_read_b64_tr_b16 v[102:103], v31 offset:38400
    s_waitcnt lgkmcnt(0)
    s_waitcnt vmcnt(10)
    s_barrier
    s_add_u32 m0, s75, 49152
    s_add_u32 s73, s74, 81920
    buffer_load_dwordx4 v18, s[12:15], s73 offen offset:0 lds
    buffer_load_dwordx4 v18, s[12:15], s73 offen offset:1024 lds
    buffer_load_dwordx4 v18, s[12:15], s73 offen offset:2048 lds
    buffer_load_dwordx4 v18, s[12:15], s73 offen offset:3072 lds
    s_add_u32 m0, s75, 53248
    s_add_u32 s73, s74, 86016
    buffer_load_dwordx4 v18, s[12:15], s73 offen offset:0 lds
    buffer_load_dwordx4 v18, s[12:15], s73 offen offset:1024 lds
    buffer_load_dwordx4 v18, s[12:15], s73 offen offset:2048 lds
    buffer_load_dwordx4 v18, s[12:15], s73 offen offset:3072 lds
    s_add_u32 m0, s75, 57344
    s_add_u32 s73, s74, 90112
    buffer_load_dwordx4 v18, s[12:15], s73 offen offset:0 lds
    buffer_load_dwordx4 v18, s[12:15], s73 offen offset:1024 lds
    v_add_u32 v14, 98304, v14
    ds_read_b64_tr_b16 v[104:105], v14 offset:0
    ds_read_b64_tr_b16 v[106:107], v14 offset:2560
    ds_read_b64_tr_b16 v[112:113], v14 offset:32
    ds_read_b64_tr_b16 v[114:115], v14 offset:2592
    ds_read_b64_tr_b16 v[120:121], v14 offset:64
    ds_read_b64_tr_b16 v[122:123], v14 offset:2624
    ds_read_b64_tr_b16 v[128:129], v14 offset:96
    ds_read_b64_tr_b16 v[130:131], v14 offset:2656
    ds_read_b64_tr_b16 v[136:137], v14 offset:128
    ds_read_b64_tr_b16 v[138:139], v14 offset:2688
    ds_read_b64_tr_b16 v[144:145], v14 offset:160
    ds_read_b64_tr_b16 v[146:147], v14 offset:2720
    ds_read_b64_tr_b16 v[152:153], v14 offset:192
    ds_read_b64_tr_b16 v[154:155], v14 offset:2752
    ds_read_b64_tr_b16 v[160:161], v14 offset:224
    ds_read_b64_tr_b16 v[162:163], v14 offset:2784
    ds_read_b64_tr_b16 v[168:169], v14 offset:256
    ds_read_b64_tr_b16 v[170:171], v14 offset:2816
    ds_read_b64_tr_b16 v[176:177], v14 offset:288
    ds_read_b64_tr_b16 v[178:179], v14 offset:2848
    s_waitcnt lgkmcnt(0)
    s_waitcnt vmcnt(10)
    s_barrier
    s_add_u32 m0, s75, 98304
    s_add_u32 s73, s74, 92160
    buffer_load_dwordx4 v18, s[12:15], s73 offen offset:0 lds
    buffer_load_dwordx4 v18, s[12:15], s73 offen offset:1024 lds
    buffer_load_dwordx4 v18, s[12:15], s73 offen offset:2048 lds
    buffer_load_dwordx4 v18, s[12:15], s73 offen offset:3072 lds
    s_add_u32 m0, s75, 102400
    s_add_u32 s73, s74, 96256
    buffer_load_dwordx4 v18, s[12:15], s73 offen offset:0 lds
    buffer_load_dwordx4 v18, s[12:15], s73 offen offset:1024 lds
    buffer_load_dwordx4 v18, s[12:15], s73 offen offset:2048 lds
    buffer_load_dwordx4 v18, s[12:15], s73 offen offset:3072 lds
    s_add_u32 m0, s75, 106496
    s_add_u32 s73, s74, 100352
    buffer_load_dwordx4 v18, s[12:15], s73 offen offset:0 lds
    buffer_load_dwordx4 v18, s[12:15], s73 offen offset:1024 lds
    v_add_u32 v14, -98304, v14
    ds_read_b64_tr_b16 v[108:109], v14 offset:0
    ds_read_b64_tr_b16 v[110:111], v14 offset:2560
    ds_read_b64_tr_b16 v[116:117], v14 offset:32
    ds_read_b64_tr_b16 v[118:119], v14 offset:2592
    ds_read_b64_tr_b16 v[124:125], v14 offset:64
    ds_read_b64_tr_b16 v[126:127], v14 offset:2624
    ds_read_b64_tr_b16 v[132:133], v14 offset:96
    ds_read_b64_tr_b16 v[134:135], v14 offset:2656
    ds_read_b64_tr_b16 v[140:141], v14 offset:128
    ds_read_b64_tr_b16 v[142:143], v14 offset:2688
    ds_read_b64_tr_b16 v[148:149], v14 offset:160
    ds_read_b64_tr_b16 v[150:151], v14 offset:2720
    ds_read_b64_tr_b16 v[156:157], v14 offset:192
    ds_read_b64_tr_b16 v[158:159], v14 offset:2752
    ds_read_b64_tr_b16 v[164:165], v14 offset:224
    ds_read_b64_tr_b16 v[166:167], v14 offset:2784
    ds_read_b64_tr_b16 v[172:173], v14 offset:256
    ds_read_b64_tr_b16 v[174:175], v14 offset:2816
    ds_read_b64_tr_b16 v[180:181], v14 offset:288
    ds_read_b64_tr_b16 v[182:183], v14 offset:2848
    s_waitcnt lgkmcnt(0)
    s_waitcnt vmcnt(10)
    s_barrier
    s_add_u32 m0, s75, 0
    s_add_u32 s73, s74, 163840
    buffer_load_dwordx4 v18, s[12:15], s73 offen offset:0 lds
    buffer_load_dwordx4 v18, s[12:15], s73 offen offset:1024 lds
    buffer_load_dwordx4 v18, s[12:15], s73 offen offset:2048 lds
    buffer_load_dwordx4 v18, s[12:15], s73 offen offset:3072 lds
    s_add_u32 m0, s75, 4096
    s_add_u32 s73, s74, 167936
    buffer_load_dwordx4 v18, s[12:15], s73 offen offset:0 lds
    buffer_load_dwordx4 v18, s[12:15], s73 offen offset:1024 lds
    buffer_load_dwordx4 v18, s[12:15], s73 offen offset:2048 lds
    buffer_load_dwordx4 v18, s[12:15], s73 offen offset:3072 lds
    s_add_u32 m0, s75, 8192
    s_add_u32 s73, s74, 172032
    buffer_load_dwordx4 v18, s[12:15], s73 offen offset:0 lds
    buffer_load_dwordx4 v18, s[12:15], s73 offen offset:1024 lds
    v_add_u32 v14, 49152, v14
    ds_read_b64_tr_b16 v[184:185], v14 offset:0
    ds_read_b64_tr_b16 v[186:187], v14 offset:2560
    ds_read_b64_tr_b16 v[192:193], v14 offset:32
    ds_read_b64_tr_b16 v[194:195], v14 offset:2592
    ds_read_b64_tr_b16 v[200:201], v14 offset:64
    ds_read_b64_tr_b16 v[202:203], v14 offset:2624
    ds_read_b64_tr_b16 v[208:209], v14 offset:96
    ds_read_b64_tr_b16 v[210:211], v14 offset:2656
    ds_read_b64_tr_b16 v[216:217], v14 offset:128
    ds_read_b64_tr_b16 v[218:219], v14 offset:2688
    ds_read_b64_tr_b16 v[224:225], v14 offset:160
    ds_read_b64_tr_b16 v[226:227], v14 offset:2720
    ds_read_b64_tr_b16 v[232:233], v14 offset:192
    ds_read_b64_tr_b16 v[234:235], v14 offset:2752
    ds_read_b64_tr_b16 v[240:241], v14 offset:224
    ds_read_b64_tr_b16 v[242:243], v14 offset:2784
    ds_read_b64_tr_b16 v[248:249], v14 offset:256
    ds_read_b64_tr_b16 v[250:251], v14 offset:2816
    ds_read_b64_tr_b16 a[0:1], v14 offset:288
    ds_read_b64_tr_b16 a[2:3], v14 offset:2848
    s_waitcnt lgkmcnt(0)
    s_waitcnt vmcnt(10)
    s_barrier
    s_add_u32 m0, s75, 49152
    s_add_u32 s73, s74, 174080
    buffer_load_dwordx4 v18, s[12:15], s73 offen offset:0 lds
    buffer_load_dwordx4 v18, s[12:15], s73 offen offset:1024 lds
    buffer_load_dwordx4 v18, s[12:15], s73 offen offset:2048 lds
    buffer_load_dwordx4 v18, s[12:15], s73 offen offset:3072 lds
    s_add_u32 m0, s75, 53248
    s_add_u32 s73, s74, 178176
    buffer_load_dwordx4 v18, s[12:15], s73 offen offset:0 lds
    buffer_load_dwordx4 v18, s[12:15], s73 offen offset:1024 lds
    buffer_load_dwordx4 v18, s[12:15], s73 offen offset:2048 lds
    buffer_load_dwordx4 v18, s[12:15], s73 offen offset:3072 lds
    s_add_u32 m0, s75, 57344
    s_add_u32 s73, s74, 182272
    buffer_load_dwordx4 v18, s[12:15], s73 offen offset:0 lds
    buffer_load_dwordx4 v18, s[12:15], s73 offen offset:1024 lds
    v_add_u32 v14, 49152, v14
    ds_read_b64_tr_b16 v[188:189], v14 offset:0
    ds_read_b64_tr_b16 v[190:191], v14 offset:2560
    ds_read_b64_tr_b16 v[196:197], v14 offset:32
    ds_read_b64_tr_b16 v[198:199], v14 offset:2592
    ds_read_b64_tr_b16 v[204:205], v14 offset:64
    ds_read_b64_tr_b16 v[206:207], v14 offset:2624
    ds_read_b64_tr_b16 v[212:213], v14 offset:96
    ds_read_b64_tr_b16 v[214:215], v14 offset:2656
    ds_read_b64_tr_b16 v[220:221], v14 offset:128
    ds_read_b64_tr_b16 v[222:223], v14 offset:2688
    ds_read_b64_tr_b16 v[228:229], v14 offset:160
    ds_read_b64_tr_b16 v[230:231], v14 offset:2720
    ds_read_b64_tr_b16 v[236:237], v14 offset:192
    ds_read_b64_tr_b16 v[238:239], v14 offset:2752
    ds_read_b64_tr_b16 v[244:245], v14 offset:224
    ds_read_b64_tr_b16 v[246:247], v14 offset:2784
    ds_read_b64_tr_b16 v[252:253], v14 offset:256
    ds_read_b64_tr_b16 v[254:255], v14 offset:2816
    ds_read_b64_tr_b16 a[4:5], v14 offset:288
    ds_read_b64_tr_b16 a[6:7], v14 offset:2848
    s_waitcnt lgkmcnt(0)
    s_waitcnt vmcnt(10)
    s_barrier
    v_add_u32 v14, -98304, v14
    ds_read_b64_tr_b16 a[8:9], v14 offset:0
    ds_read_b64_tr_b16 a[10:11], v14 offset:2560
    ds_read_b64_tr_b16 a[16:17], v14 offset:32
    ds_read_b64_tr_b16 a[18:19], v14 offset:2592
    ds_read_b64_tr_b16 a[24:25], v14 offset:64
    ds_read_b64_tr_b16 a[26:27], v14 offset:2624
    ds_read_b64_tr_b16 a[32:33], v14 offset:96
    ds_read_b64_tr_b16 a[34:35], v14 offset:2656
    ds_read_b64_tr_b16 a[40:41], v14 offset:128
    ds_read_b64_tr_b16 a[42:43], v14 offset:2688
    ds_read_b64_tr_b16 a[48:49], v14 offset:160
    ds_read_b64_tr_b16 a[50:51], v14 offset:2720
    ds_read_b64_tr_b16 a[56:57], v14 offset:192
    ds_read_b64_tr_b16 a[58:59], v14 offset:2752
    ds_read_b64_tr_b16 a[64:65], v14 offset:224
    ds_read_b64_tr_b16 a[66:67], v14 offset:2784
    ds_read_b64_tr_b16 a[72:73], v14 offset:256
    ds_read_b64_tr_b16 a[74:75], v14 offset:2816
    ds_read_b64_tr_b16 a[80:81], v14 offset:288
    ds_read_b64_tr_b16 a[82:83], v14 offset:2848
    s_waitcnt lgkmcnt(0)
    s_waitcnt vmcnt(0)
    s_barrier
    v_add_u32 v14, 49152, v14
    ds_read_b64_tr_b16 a[12:13], v14 offset:0
    ds_read_b64_tr_b16 a[14:15], v14 offset:2560
    ds_read_b64_tr_b16 a[20:21], v14 offset:32
    ds_read_b64_tr_b16 a[22:23], v14 offset:2592
    ds_read_b64_tr_b16 a[28:29], v14 offset:64
    ds_read_b64_tr_b16 a[30:31], v14 offset:2624
    ds_read_b64_tr_b16 a[36:37], v14 offset:96
    ds_read_b64_tr_b16 a[38:39], v14 offset:2656
    ds_read_b64_tr_b16 a[44:45], v14 offset:128
    ds_read_b64_tr_b16 a[46:47], v14 offset:2688
    ds_read_b64_tr_b16 a[52:53], v14 offset:160
    ds_read_b64_tr_b16 a[54:55], v14 offset:2720
    ds_read_b64_tr_b16 a[60:61], v14 offset:192
    ds_read_b64_tr_b16 a[62:63], v14 offset:2752
    ds_read_b64_tr_b16 a[68:69], v14 offset:224
    ds_read_b64_tr_b16 a[70:71], v14 offset:2784
    ds_read_b64_tr_b16 a[76:77], v14 offset:256
    ds_read_b64_tr_b16 a[78:79], v14 offset:2816
    ds_read_b64_tr_b16 a[84:85], v14 offset:288
    ds_read_b64_tr_b16 a[86:87], v14 offset:2848
    s_waitcnt lgkmcnt(0)
    s_barrier
    ds_write_b128 v15, v[32:35] offset:4096
    ds_write_b128 v15, v[36:39] offset:5120
    ds_write_b128 v15, v[40:43] offset:6144
    ds_write_b128 v15, v[44:47] offset:7168
    ds_write_b128 v15, v[48:51] offset:14336
    ds_write_b128 v15, v[52:55] offset:15360
    ds_write_b128 v15, v[56:59] offset:0
    ds_write_b128 v15, v[60:63] offset:1024
    ds_write_b128 v15, v[64:67] offset:2048
    ds_write_b128 v15, v[68:71] offset:3072
    ds_write_b128 v15, v[72:75] offset:12288
    ds_write_b128 v15, v[76:79] offset:13312
    ds_write_b128 v15, v[80:83] offset:8192
    ds_write_b128 v15, v[84:87] offset:9216
    ds_write_b128 v15, v[88:91] offset:10240
    ds_write_b128 v15, v[92:95] offset:11264
    ds_write_b128 v15, v[96:99] offset:16384
    ds_write_b128 v15, v[100:103] offset:17408
    s_waitcnt lgkmcnt(0)
L_v_post:
    v_mov_b32 v19, v0
    s_mov_b32 s96, 2000000
    v_mov_b32 v5, 252
L_aw_53:
    buffer_load_dword v4, v5, s[8:11], 0 offen sc1
    s_sub_u32 s96, s96, 1
    s_cbranch_scc1 L_fail
    s_waitcnt vmcnt(0)
    v_cmp_eq_u32 vcc, 0, v4
    s_cbranch_vccz L_aw_53_d
    s_sleep 16
    s_branch L_aw_53
L_aw_53_d:
    v_readfirstlane_b32 s61, v4
    s_nop 3
    s_and_b32 s60, s61, 8192
    s_and_b32 s3, s61, 2
    s_barrier
    v_mov_b32 v4, 0x4444
    v_mov_b32 v5, 0xeeee
    v_cmp_gt_u32 vcc, 8, v3
    s_nop 1
    v_cndmask_b32 v9, v5, v4, vcc
    s_lshl_b32 s56, s53, 11
    v_lshl_add_u32 v10, v1, 4, s56
    v_add_u32 v12, 73728, v10
    s_lshl_b32 s56, s53, 9
    v_lshl_add_u32 v13, v1, 3, s56
    v_add_u32 v11, 8192, v13
    v_add_u32 v13, 81920, v13
    v_add_u32 v14, 73728, v18
    s_lshr_b32 s56, s53, 1
    s_lshl_b32 s57, s56, 11
    s_and_b32 s58, s53, 1
    s_lshl_b32 s59, s58, 3
    s_add_u32 s57, s57, s59
    s_add_u32 s57, s57, 83968
    v_add_u32 v16, s57, v18
    s_lshl_b32 s56, s56, 3
    s_add_u32 s56, s56, 84992
    v_add_u32 v17, s56, v18
    v_lshrrev_b32 v4, 3, v3
    v_cmp_eq_u32 s[76:77], s58, v4
    s_lshr_b32 s56, s54, 3
    s_lshl_b32 s79, s56, 7
    s_add_u32 s79, s79, 21069824
    s_lshl_b32 s71, s56, 14
    s_add_u32 s71, s71, 20971520
    v_mov_b32 v23, 0
    s_mov_b32 s55, 0
    v_and_b32 v4, 1, v2
    v_lshlrev_b32 v78, 14, v4
    v_lshrrev_b32 v5, 1, v2
    v_lshl_add_u32 v78, v5, 13, v78
    v_lshl_add_u32 v78, v3, 4, v78
    v_lshlrev_b32 v4, 2, v4
    v_sub_u32 v5, v3, v4
    v_mov_b32 v6, 0x3f80
    v_mov_b32 v7, 0x3f800000
    v_cmp_eq_u32 vcc, 0, v5
    v_cmp_eq_u32 s[56:57], 1, v5
    s_nop 1
    v_cndmask_b32 v0, 0, v6, vcc
    v_cndmask_b32 v0, v0, v7, s[56:57]
    v_cmp_eq_u32 vcc, 2, v5
    v_cmp_eq_u32 s[56:57], 3, v5
    s_nop 1
    v_cndmask_b32 v1, 0, v6, vcc
    v_cndmask_b32 v1, v1, v7, s[56:57]
    v_cmp_eq_u32 vcc, 8, v5
    v_cmp_eq_u32 s[56:57], 9, v5
    s_nop 1
    v_cndmask_b32 v2, 0, v6, vcc
    v_cndmask_b32 v2, v2, v7, s[56:57]
    v_cmp_eq_u32 vcc, 10, v5
    v_cmp_eq_u32 s[56:57], 11, v5
    s_nop 1
    v_cndmask_b32 v3, 0, v6, vcc
    v_cndmask_b32 v3, v3, v7, s[56:57]
    s_lshl_b32 s56, s54, 2
    s_add_u32 s56, s56, s53
    s_mul_i32 s65, s56, 10240
    s_add_u32 s65, s65, 167247872
    s_mul_i32 s66, s56, 3072
    s_add_u32 s66, s66, 113639424
    v_xor_b32 v20, 2048, v12
    v_xor_b32 v21, 4096, v12
    v_xor_b32 v22, 6144, v12
    s_cmp_eq_u32 s3, 0
    s_cbranch_scc0 L_v_slow
    ds_read_b128 v[88:91], v15 offset:0
    ds_read_b128 v[92:95], v15 offset:1024
    ds_read_b128 v[96:99], v15 offset:2048
    ds_read_b128 v[100:103], v15 offset:3072
    v_mov_b32 v56, 0
    v_mov_b32 v57, 0
    v_mov_b32 v58, 0
    v_mov_b32 v59, 0
    v_mov_b32 v60, 0
    v_mov_b32 v61, 0
    v_mov_b32 v62, 0
    v_mov_b32 v63, 0
    v_mov_b32 v64, 0
    v_mov_b32 v65, 0
    v_mov_b32 v66, 0
    v_mov_b32 v67, 0
    s_waitcnt lgkmcnt(0)
L_v_loop:
    s_lshl_b32 s59, s55, 1
    s_mov_b32 s96, 2000000
L_wf_54:
    buffer_load_dword v4, v23, s[4:7], s79 offen sc1
    s_sub_u32 s96, s96, 1
    s_cbranch_scc1 L_fail
    s_waitcnt vmcnt(0)
    v_cmp_gt_u32 vcc, s59, v4
    s_cbranch_vccnz L_wf_54
L_wf_54_d:
    s_mov_b32 s96, 2000000
    s_branch L_v_poll
L_v_poll_z:
    s_nop 7
    v_mov_b32 v56, 0
    v_mov_b32 v57, 0
    v_mov_b32 v58, 0
    v_mov_b32 v59, 0
    v_mov_b32 v60, 0
    v_mov_b32 v61, 0
    v_mov_b32 v62, 0
    v_mov_b32 v63, 0
    v_mov_b32 v64, 0
    v_mov_b32 v65, 0
    v_mov_b32 v66, 0
    v_mov_b32 v67, 0
L_v_poll:
    buffer_load_dwordx4 v[68:71], v10, s[4:7], s71 offen sc1
    buffer_load_dwordx4 v[72:75], v10, s[4:7], s71 offen offset:1024 sc1
    buffer_load_dwordx2 v[76:77], v11, s[4:7], s71 offen sc1
    s_sub_u32 s96, s96, 1
    s_cbranch_scc1 L_fail
    s_waitcnt vmcnt(0)
    v_max3_u32 v8, v71, v75, v77
    v_cmp_eq_u32 vcc, -1, v8
    s_cbranch_vccnz L_v_poll
    v_smfmac_f32_16x16x64_bf16 v[56:59], v[68:71], a[88:95], v9
    ds_write_b128 v12, v[68:71]
    v_max3_u32 v8, v68, v69, v70
    v_smfmac_f32_16x16x64_bf16 v[60:63], v[68:71], a[96:103], v9
    ds_write_b128 v12, v[72:75] offset:1024
    v_max3_u32 v8, v8, v72, v73
    v_smfmac_f32_16x16x64_bf16 v[64:67], v[68:71], a[104:111], v9
    ds_write_b64 v13, v[76:77]
    v_max3_u32 v8, v8, v74, v76
    v_smfmac_f32_16x16x64_bf16 v[56:59], v[72:75], a[112:119], v9
    v_cmp_eq_u32 vcc, -1, v8
    v_smfmac_f32_16x16x64_bf16 v[60:63], v[72:75], a[120:127], v9
    s_cbranch_vccnz L_v_poll_z
    s_waitcnt lgkmcnt(0)
    s_barrier
    ds_read_b128 v[24:27], v20 offset:0
    ds_read_b128 v[28:31], v20 offset:1024
    ds_read_b128 v[32:35], v21 offset:0
    v_smfmac_f32_16x16x64_bf16 v[64:67], v[72:75], v[88:95], v9
    ds_read_b128 v[88:91], v15 offset:4096
    ds_read_b128 v[92:95], v15 offset:5120
    s_waitcnt lgkmcnt(4)
    v_smfmac_f32_16x16x64_bf16 v[56:59], v[24:27], a[128:135], v9
    ds_read_b128 v[36:39], v21 offset:1024
    v_smfmac_f32_16x16x64_bf16 v[60:63], v[24:27], a[136:143], v9
    s_waitcnt lgkmcnt(4)
    v_smfmac_f32_16x16x64_bf16 v[56:59], v[28:31], v[96:103], v9
    ds_read_b128 v[96:99], v15 offset:6144
    ds_read_b128 v[100:103], v15 offset:7168
    ds_read_b128 v[40:43], v22 offset:0
    v_smfmac_f32_16x16x64_bf16 v[60:63], v[28:31], a[144:151], v9
    v_mov_b32 v68, 0
    s_waitcnt lgkmcnt(6)
    v_smfmac_f32_16x16x64_bf16 v[56:59], v[32:35], a[152:159], v9
    ds_read_b128 v[44:47], v22 offset:1024
    v_mov_b32 v69, 0
    s_waitcnt lgkmcnt(5)
    v_smfmac_f32_16x16x64_bf16 v[60:63], v[32:35], v[88:95], v9
    ds_read_b128 v[88:91], v15 offset:8192
    ds_read_b128 v[92:95], v15 offset:9216
    v_mov_b32 v70, 0
    s_waitcnt lgkmcnt(6)
    v_smfmac_f32_16x16x64_bf16 v[56:59], v[36:39], a[160:167], v9
    ds_read_b128 v[48:51], v14 offset:8192
    v_mov_b32 v71, 0
    v_smfmac_f32_16x16x64_bf16 v[60:63], v[36:39], a[168:175], v9
    v_mov_b32 v72, 0
    s_waitcnt lgkmcnt(5)
    s_waitcnt lgkmcnt(4)
    v_smfmac_f32_16x16x64_bf16 v[56:59], v[40:43], v[96:103], v9
    ds_read_b128 v[96:99], v15 offset:10240
    ds_read_b128 v[100:103], v15 offset:11264
    ds_read_b128 v[52:55], v14 offset:9216
    v_mov_b32 v73, 0
    v_smfmac_f32_16x16x64_bf16 v[60:63], v[40:43], a[176:183], v9
    v_mov_b32 v74, 0
    s_waitcnt lgkmcnt(6)
    v_smfmac_f32_16x16x64_bf16 v[56:59], v[44:47], a[184:191], v9
    v_mov_b32 v75, 0
    s_waitcnt lgkmcnt(4)
    v_smfmac_f32_16x16x64_bf16 v[60:63], v[44:47], v[88:95], v9
    ds_read_b128 v[88:91], v15 offset:12288
    ds_read_b128 v[92:95], v15 offset:13312
    s_waitcnt lgkmcnt(5)
    v_smfmac_f32_16x16x64_bf16 v[56:59], v[48:51], a[192:199], v9
    v_smfmac_f32_16x16x64_bf16 v[60:63], v[48:51], a[200:207], v9
    s_waitcnt lgkmcnt(3)
    s_waitcnt lgkmcnt(2)
    v_smfmac_f32_16x16x64_bf16 v[56:59], v[52:55], v[96:103], v9
    ds_read_b128 v[96:99], v15 offset:14336
    ds_read_b128 v[100:103], v15 offset:15360
    v_smfmac_f32_16x16x64_bf16 v[60:63], v[52:55], a[208:215], v9
    v_smfmac_f32_16x16x64_bf16 v[64:67], v[24:27], a[216:223], v9
    s_waitcnt lgkmcnt(2)
    v_smfmac_f32_16x16x64_bf16 v[64:67], v[28:31], v[88:95], v9
    ds_read_b128 v[88:91], v15 offset:16384
    ds_read_b128 v[92:95], v15 offset:17408
    v_smfmac_f32_16x16x64_bf16 v[64:67], v[32:35], a[224:231], v9
    v_cvt_pk_bf16_f32 v80, v56, v57
    v_cvt_pk_bf16_f32 v81, v58, v59
    v_cvt_pk_bf16_f32 v82, v60, v61
    v_cvt_pk_bf16_f32 v83, v62, v63
    v_smfmac_f32_16x16x64_bf16 v[64:67], v[36:39], a[232:239], v9
    s_nop 0
    v_mfma_f32_16x16x32_bf16 v[84:87], v[80:83], v[0:3], 0
    v_mov_b32 v56, 0
    s_waitcnt lgkmcnt(2)
    v_smfmac_f32_16x16x64_bf16 v[64:67], v[40:43], v[96:103], v9
    v_mov_b32 v57, 0
    v_smfmac_f32_16x16x64_bf16 v[64:67], v[44:47], a[240:247], v9
    v_mov_b32 v58, 0
    v_smfmac_f32_16x16x64_bf16 v[64:67], v[48:51], a[248:255], v9
    v_cvt_pk_bf16_f32 v80, v84, v85
    v_cvt_pk_bf16_f32 v81, v86, v87
    ds_write_b64 v16, v[80:81]
    s_waitcnt lgkmcnt(1)
    v_smfmac_f32_16x16x64_bf16 v[64:67], v[52:55], v[88:95], v9
    v_mov_b32 v59, 0
    v_mov_b32 v60, 0
    v_mov_b32 v61, 0
    v_mov_b32 v62, 0
    v_mov_b32 v63, 0
    v_mov_b32 v40, 0
    v_mov_b32 v41, 0
    v_mov_b32 v42, 0
    v_cvt_pk_bf16_f32 v4, v64, v65
    v_cvt_pk_bf16_f32 v5, v66, v67
    v_cvt_pk_bf16_f32 v6, v64, v65
    v_cvt_pk_bf16_f32 v7, v66, v67
    s_waitcnt lgkmcnt(0)
    s_barrier
    v_mfma_f32_16x16x32_bf16 v[84:87], v[4:7], v[0:3], 0
    ds_read_b128 v[24:27], v14 offset:10240
    ds_read_b128 v[28:31], v14 offset:12288
    v_mov_b32 v43, 0
    v_mov_b32 v44, 0
    v_mov_b32 v45, 0
    v_mov_b32 v46, 0
    v_mov_b32 v47, 0
    s_nop 0
    v_cvt_pk_bf16_f32 v82, v84, v85
    v_cvt_pk_bf16_f32 v83, v86, v87
    s_mov_b64 exec, s[76:77]
    ds_write_b64 v17, v[82:83]
    s_mov_b64 exec, -1
    s_waitcnt lgkmcnt(2)
    v_smfmac_f32_16x16x64_bf16 v[68:71], v[24:27], v[104:111], v9
    v_mov_b32 v48, 0
    v_smfmac_f32_16x16x64_bf16 v[72:75], v[24:27], v[112:119], v9
    v_mov_b32 v49, 0
    s_waitcnt lgkmcnt(1)
    v_smfmac_f32_16x16x64_bf16 v[68:71], v[28:31], a[8:15], v9
    v_mov_b32 v50, 0
    v_smfmac_f32_16x16x64_bf16 v[72:75], v[28:31], a[16:23], v9
    v_mov_b32 v51, 0
    v_smfmac_f32_16x16x64_bf16 v[56:59], v[24:27], v[120:127], v9
    v_mov_b32 v52, 0
    v_smfmac_f32_16x16x64_bf16 v[60:63], v[24:27], v[128:135], v9
    s_waitcnt lgkmcnt(0)
    s_barrier
    ds_read_b128 v[32:35], v14 offset:11264
    v_mov_b32 v53, 0
    v_smfmac_f32_16x16x64_bf16 v[56:59], v[28:31], a[24:31], v9
    v_mov_b32 v54, 0
    v_smfmac_f32_16x16x64_bf16 v[60:63], v[28:31], a[32:39], v9
    v_mov_b32 v55, 0
    v_smfmac_f32_16x16x64_bf16 v[40:43], v[24:27], v[136:143], v9
    v_mov_b32 v64, 0
    v_smfmac_f32_16x16x64_bf16 v[44:47], v[24:27], v[144:151], v9
    v_mov_b32 v65, 0
    v_smfmac_f32_16x16x64_bf16 v[40:43], v[28:31], a[40:47], v9
    v_mov_b32 v66, 0
    v_smfmac_f32_16x16x64_bf16 v[44:47], v[28:31], a[48:55], v9
    v_mov_b32 v67, 0
    s_waitcnt lgkmcnt(0)
    v_smfmac_f32_16x16x64_bf16 v[68:71], v[32:35], v[184:191], v9
    v_mov_b32 v36, 0
    v_smfmac_f32_16x16x64_bf16 v[72:75], v[32:35], v[192:199], v9
    v_mov_b32 v37, 0
    v_smfmac_f32_16x16x64_bf16 v[56:59], v[32:35], v[200:207], v9
    v_mov_b32 v38, 0
    v_smfmac_f32_16x16x64_bf16 v[60:63], v[32:35], v[208:215], v9
    v_mov_b32 v39, 0
    v_smfmac_f32_16x16x64_bf16 v[40:43], v[32:35], v[216:223], v9
    v_cvt_pk_bf16_f32 v80, v68, v69
    v_cvt_pk_bf16_f32 v81, v70, v71
    v_smfmac_f32_16x16x64_bf16 v[44:47], v[32:35], v[224:231], v9
    v_cvt_pk_bf16_f32 v82, v72, v73
    v_cvt_pk_bf16_f32 v83, v74, v75
    v_smfmac_f32_16x16x64_bf16 v[48:51], v[24:27], v[152:159], v9
    s_nop 0
    v_mfma_f32_16x16x32_bf16 v[92:95], v[0:3], v[80:83], 0
    v_smfmac_f32_16x16x64_bf16 v[52:55], v[24:27], v[160:167], v9
    v_cvt_pk_bf16_f32 v88, v56, v57
    v_cvt_pk_bf16_f32 v89, v58, v59
    v_smfmac_f32_16x16x64_bf16 v[48:51], v[32:35], v[232:239], v9
    v_cvt_pk_bf16_f32 v90, v60, v61
    v_cvt_pk_bf16_f32 v91, v62, v63
    v_smfmac_f32_16x16x64_bf16 v[52:55], v[32:35], v[240:247], v9
    v_cvt_pk_bf16_f32 v100, v92, v93
    v_cvt_pk_bf16_f32 v101, v94, v95
    s_add_u32 s56, s64, 0
    buffer_store_dwordx2 v[100:101], v19, s[4:7], s56 offen
    s_nop 0
    v_mfma_f32_16x16x32_bf16 v[96:99], v[0:3], v[88:91], 0
    v_smfmac_f32_16x16x64_bf16 v[48:51], v[28:31], a[56:63], v9
    v_cvt_pk_bf16_f32 v80, v40, v41
    v_cvt_pk_bf16_f32 v81, v42, v43
    v_smfmac_f32_16x16x64_bf16 v[52:55], v[28:31], a[64:71], v9
    v_cvt_pk_bf16_f32 v82, v44, v45
    v_cvt_pk_bf16_f32 v83, v46, v47
    v_smfmac_f32_16x16x64_bf16 v[64:67], v[24:27], v[168:175], v9
    v_cvt_pk_bf16_f32 v102, v96, v97
    v_cvt_pk_bf16_f32 v103, v98, v99
    s_add_u32 s56, s64, 16384
    buffer_store_dwordx2 v[102:103], v19, s[4:7], s56 offen
    s_nop 0
    v_mfma_f32_16x16x32_bf16 v[92:95], v[0:3], v[80:83], 0
    v_smfmac_f32_16x16x64_bf16 v[36:39], v[24:27], v[176:183], v9
    v_smfmac_f32_16x16x64_bf16 v[64:67], v[32:35], v[248:255], v9
    v_cvt_pk_bf16_f32 v88, v48, v49
    v_cvt_pk_bf16_f32 v89, v50, v51
    v_smfmac_f32_16x16x64_bf16 v[36:39], v[32:35], a[0:7], v9
    v_cvt_pk_bf16_f32 v100, v92, v93
    v_cvt_pk_bf16_f32 v101, v94, v95
    s_add_u32 s56, s64, 32768
    buffer_store_dwordx2 v[100:101], v19, s[4:7], s56 offen
    v_cvt_pk_bf16_f32 v90, v52, v53
    v_cvt_pk_bf16_f32 v91, v54, v55
    v_smfmac_f32_16x16x64_bf16 v[64:67], v[28:31], a[72:79], v9
    s_nop 0
    v_mfma_f32_16x16x32_bf16 v[96:99], v[0:3], v[88:91], 0
    v_smfmac_f32_16x16x64_bf16 v[36:39], v[28:31], a[80:87], v9
    s_nop 5
    v_cvt_pk_bf16_f32 v80, v64, v65
    v_cvt_pk_bf16_f32 v81, v66, v67
    v_cvt_pk_bf16_f32 v82, v36, v37
    v_cvt_pk_bf16_f32 v83, v38, v39
    v_cvt_pk_bf16_f32 v102, v96, v97
    v_cvt_pk_bf16_f32 v103, v98, v99
    s_nop 0
    v_mfma_f32_16x16x32_bf16 v[92:95], v[0:3], v[80:83], 0
    s_add_u32 s56, s64, 49152
    buffer_store_dwordx2 v[102:103], v19, s[4:7], s56 offen
    s_nop 5
    v_cvt_pk_bf16_f32 v100, v92, v93
    v_cvt_pk_bf16_f32 v101, v94, v95
    s_add_u32 s56, s64, 65536
    buffer_store_dwordx2 v[100:101], v19, s[4:7], s56 offen
    ds_read_b128 v[88:91], v15 offset:0
    ds_read_b128 v[92:95], v15 offset:1024
    ds_read_b128 v[96:99], v15 offset:2048
    ds_read_b128 v[100:103], v15 offset:3072
    v_mov_b32 v56, 0
    v_mov_b32 v57, 0
    v_mov_b32 v58, 0
    v_mov_b32 v59, 0
    v_mov_b32 v60, 0
    v_mov_b32 v61, 0
    v_mov_b32 v62, 0
    v_mov_b32 v63, 0
    v_mov_b32 v64, 0
    v_mov_b32 v65, 0
    v_mov_b32 v66, 0
    v_mov_b32 v67, 0
    s_waitcnt lgkmcnt(0)
    v_mov_b32 v4, -1
    v_mov_b32 v5, -1
    v_mov_b32 v6, -1
    v_mov_b32 v7, -1
    s_add_u32 s57, s64, 1048576
    s_bitset0_b32 s57, 21
    s_add_u32 s56, s57, 0
    buffer_store_dwordx2 v[4:5], v19, s[4:7], s56 offen
    s_add_u32 s56, s57, 16384
    buffer_store_dwordx2 v[4:5], v19, s[4:7], s56 offen
    s_add_u32 s56, s57, 32768
    buffer_store_dwordx2 v[4:5], v19, s[4:7], s56 offen
    s_add_u32 s56, s57, 49152
    buffer_store_dwordx2 v[4:5], v19, s[4:7], s56 offen
    s_add_u32 s56, s57, 65536
    buffer_store_dwordx2 v[4:5], v19, s[4:7], s56 offen
    s_add_u32 s64, s64, 524288
    s_bitset0_b32 s64, 21
    s_add_u32 s71, s71, 524288
    s_bitset0_b32 s71, 21
    s_add_u32 s55, s55, 1
    s_cmp_lt_u32 s55, 64
    s_cbranch_scc1 L_v_loop
    s_branch L_end
L_roleT:
    s_sub_u32 s54, s52, 104
    s_lshl_b32 s66, s54, 2
    s_add_u32 s66, s66, s53
    s_lshr_b32 s64, s66, 1
    s_and_b32 s65, s53, 1
    s_lshl_b32 s66, s66, 7
    s_add_u32 s66, s66, 18948096
    v_mov_b32 v8, 0
    v_mov_b32 v4, 0
    buffer_store_dword v4, v8, s[4:7], s66 offen sc1
    s_and_b32 s57, s53, 1
    s_lshl_b32 s56, s57, 13
    s_lshl_b32 s58, s64, 8
    s_add_u32 s56, s56, s58
    s_add_u32 s56, s56, 196608
    s_getreg_b32 s58, hwreg(HW_REG_XCC_ID)
    s_bfe_u32 s58, s58, 0x10002
    s_xor_b32 s57, s57, s58
    s_lshl_b32 s57, s57, 2
    s_mov_b32 s58, 65535
    s_mov_b32 s59, 0
    s_waitcnt vmcnt(0)
L_t_probe:
    s_memtime s[68:69]
    s_waitcnt lgkmcnt(0)
    buffer_store_dword v8, v8, s[4:7], s56 offen sc1
    s_waitcnt vmcnt(0)
    s_memtime s[70:71]
    s_waitcnt lgkmcnt(0)
    s_sub_u32 s67, s70, s68
    s_min_u32 s58, s58, s67
    s_add_u32 s59, s59, 1
    s_cmp_lt_u32 s59, 5
    s_cbranch_scc1 L_t_probe
    s_sub_u32 s58, 65535, s58
    v_mov_b32 v4, s58
    s_mov_b64 exec, 1
    buffer_atomic_umax v4, v8, s[8:11], s57 offen offset:16
    s_mov_b64 exec, -1
    s_waitcnt vmcnt(0)
    s_barrier
    s_cmp_eq_u32 s53, 3
    s_cbranch_scc0 L_arr_55
    s_mov_b64 exec, 1
    v_mov_b32 v4, 1
    v_mov_b32 v5, 8
    buffer_atomic_add v4, v5, s[8:11], 0 offen sc0
    s_mov_b64 exec, -1
L_arr_55:
    s_waitcnt vmcnt(0)
    s_cmp_eq_u32 s53, 3
    s_cbranch_scc0 L_arr_56
    s_mov_b64 exec, 1
    v_cmp_eq_u32 vcc, 255, v4
    s_cbranch_vccz L_arr_56_x
    v_mov_b32 v5, 8
    buffer_load_dwordx3 v[4:6], v5, s[8:11], 0 offen offset:8 sc1
    s_waitcnt vmcnt(0)
    v_cmp_lt_u32 vcc, v4, v5
    v_mov_b32 v4, 0x2001
    v_lshlrev_b32 v6, 1, v6
    v_cndmask_b32 v4, 1, v4, vcc
    v_or_b32 v4, v4, v6
    v_mov_b32 v5, 252
    buffer_store_dword v4, v5, s[8:11], 0 offen sc1
L_arr_56_x:
    s_mov_b64 exec, -1
L_arr_56:
    s_mov_b32 s96, 2000000
    v_mov_b32 v5, 252
L_aw_57:
    buffer_load_dword v4, v5, s[8:11], 0 offen sc1
    s_sub_u32 s96, s96, 1
    s_cbranch_scc1 L_fail
    s_waitcnt vmcnt(0)
    v_cmp_eq_u32 vcc, 0, v4
    s_cbranch_vccz L_aw_57_d
    s_sleep 16
    s_branch L_aw_57
L_aw_57_d:
    v_readfirstlane_b32 s61, v4
    s_nop 3
    s_and_b32 s60, s61, 8192
    s_and_b32 s3, s61, 2
    v_lshlrev_b32 v9, 4, v1
    v_min_u32 v4, 5, v1
    v_add_u32 v5, 93, v4
    v_cmp_gt_u32 vcc, 3, v4
    s_mul_i32 s56, s64, 3
    s_add_u32 s56, s56, 147456
    v_cndmask_b32 v4, v5, v4, vcc
    v_add_lshl_u32 v10, v4, s56, 7
    v_and_b32 v4, 3, v1
    s_lshl_b32 s56, s64, 2
    s_add_u32 s56, s56, 148096
    v_add_lshl_u32 v11, v4, s56, 7
    v_lshlrev_b32 v4, 4, v3
    v_lshl_add_u32 v12, v2, 2, v4
    v_mov_b32 v13, 0xff800000
    s_mul_i32 s67, s64, 12288
    s_add_u32 s67, s67, 88080384
    s_lshl_b32 s74, s65, 10
    s_mul_i32 s68, s64, 6144
    s_add_u32 s68, s68, 41943040
    s_and_b32 s59, s64, 7
    s_lshl_b32 s69, s59, 10
    s_lshr_b32 s56, s59, 1
    s_lshl_b32 s56, s56, 10
    s_and_b32 s57, s59, 1
    s_lshl_b32 s58, s57, 3
    s_add_u32 s56, s56, s58
    s_add_u32 s56, s56, 8192
    s_cmp_eq_u32 s65, 0
    s_cselect_b32 s69, s56, s69
    s_lshl_b32 s70, s65, 11
    s_lshl_b32 s56, s59, 8
    s_add_u32 s70, s70, s56
    s_add_u32 s70, s70, 12288
    s_lshr_b32 s56, s64, 3
    s_lshl_b32 s56, s56, 14
    s_add_u32 s56, s56, 21430272
    s_add_u32 s69, s69, s56
    s_add_u32 s70, s70, s56
    s_mov_b32 s78, 0x3dd53b95
    v_lshlrev_b32 v4, 2, v2
    s_lshl_b32 s56, s65, 4
    v_add_u32 v6, s56, v3
    v_add_u32 v5, 0, v4
    v_cmp_le_u32 s[24:25], v5, v6
    v_add_u32 v5, 16, v4
    v_cmp_le_u32 s[32:33], v5, v6
    v_add_u32 v5, 1, v4
    v_cmp_le_u32 s[26:27], v5, v6
    v_add_u32 v5, 17, v4
    v_cmp_le_u32 s[34:35], v5, v6
    v_add_u32 v5, 2, v4
    v_cmp_le_u32 s[28:29], v5, v6
    v_add_u32 v5, 18, v4
    v_cmp_le_u32 s[36:37], v5, v6
    v_add_u32 v5, 3, v4
    v_cmp_le_u32 s[30:31], v5, v6
    v_add_u32 v5, 19, v4
    v_cmp_le_u32 s[38:39], v5, v6
    s_mov_b32 s55, 0
    s_mov_b32 s73, 1
    s_add_u32 s56, s68, 4096
    buffer_load_dwordx4 v[64:67], v9, s[4:7], s68 offen offset:0 sc1
    buffer_load_dwordx4 v[64:67], v9, s[4:7], s68 offen offset:1024 sc1
    buffer_load_dwordx4 v[64:67], v9, s[4:7], s68 offen offset:2048 sc1
    buffer_load_dwordx4 v[64:67], v9, s[4:7], s68 offen offset:3072 sc1
    buffer_load_dwordx4 v[64:67], v9, s[4:7], s56 offen offset:0 sc1
    buffer_load_dwordx4 v[64:67], v9, s[4:7], s56 offen offset:1024 sc1
    s_add_u32 s68, s68, 262144
    s_bitset0_b32 s68, 20
    s_add_u32 s56, s68, 4096
    buffer_load_dwordx4 v[64:67], v9, s[4:7], s68 offen offset:0 sc1
    buffer_load_dwordx4 v[64:67], v9, s[4:7], s68 offen offset:1024 sc1
    buffer_load_dwordx4 v[64:67], v9, s[4:7], s68 offen offset:2048 sc1
    buffer_load_dwordx4 v[64:67], v9, s[4:7], s68 offen offset:3072 sc1
    buffer_load_dwordx4 v[64:67], v9, s[4:7], s56 offen offset:0 sc1
    buffer_load_dwordx4 v[64:67], v9, s[4:7], s56 offen offset:1024 sc1
    s_add_u32 s68, s68, 262144
    s_bitset0_b32 s68, 20
    s_add_u32 s56, s68, 4096
    buffer_load_dwordx4 v[64:67], v9, s[4:7], s68 offen offset:0 sc1
    buffer_load_dwordx4 v[64:67], v9, s[4:7], s68 offen offset:1024 sc1
    buffer_load_dwordx4 v[64:67], v9, s[4:7], s68 offen offset:2048 sc1
    buffer_load_dwordx4 v[64:67], v9, s[4:7], s68 offen offset:3072 sc1
    buffer_load_dwordx4 v[64:67], v9, s[4:7], s56 offen offset:0 sc1
    buffer_load_dwordx4 v[64:67], v9, s[4:7], s56 offen offset:1024 sc1
    s_add_u32 s68, s68, 262144
    s_bitset0_b32 s68, 20
    s_add_u32 s56, s68, 4096
    buffer_load_dwordx4 v[64:67], v9, s[4:7], s68 offen offset:0 sc1
    buffer_load_dwordx4 v[64:67], v9, s[4:7], s68 offen offset:1024 sc1
    buffer_load_dwordx4 v[64:67], v9, s[4:7], s68 offen offset:2048 sc1
    buffer_load_dwordx4 v[64:67], v9, s[4:7], s68 offen offset:3072 sc1
    buffer_load_dwordx4 v[64:67], v9, s[4:7], s56 offen offset:0 sc1
    buffer_load_dwordx4 v[64:67], v9, s[4:7], s56 offen offset:1024 sc1
    s_add_u32 s68, s68, 262144
    s_bitset0_b32 s68, 20
    s_mov_b32 s96, 2000000
L_wf_58:
    buffer_load_dword v4, v10, s[4:7], 0 offen sc1
    s_sub_u32 s96, s96, 1
    s_cbranch_scc1 L_fail
    s_waitcnt vmcnt(0)
    v_cmp_gt_u32 vcc, s73, v4
    s_cbranch_vccz L_wf_58_d
    s_sleep 4
    s_branch L_wf_58
L_wf_58_d:
    s_add_u32 s56, s67, s74
    s_add_u32 s56, s56, 0
    buffer_load_dwordx4 a[0:3], v9, s[4:7], s56 offen offset:0 sc1
    buffer_load_dwordx4 a[4:7], v9, s[4:7], s56 offen offset:2048 sc1
    s_add_u32 s56, s67, s74
    s_add_u32 s56, s56, 4096
    buffer_load_dwordx4 a[8:11], v9, s[4:7], s56 offen offset:0 sc1
    buffer_load_dwordx4 a[12:15], v9, s[4:7], s56 offen offset:2048 sc1
    s_add_u32 s56, s67, s74
    s_add_u32 s56, s56, 8192
    buffer_load_dwordx4 a[16:19], v9, s[4:7], s56 offen offset:0 sc1
    buffer_load_dwordx4 a[20:23], v9, s[4:7], s56 offen offset:2048 sc1
    s_add_u32 s56, s67, 25165824
    buffer_load_dwordx4 a[24:27], v9, s[4:7], s56 offen offset:0 sc1
    buffer_load_dwordx4 a[28:31], v9, s[4:7], s56 offen offset:2048 sc1
    s_add_u32 s56, s67, 25169920
    buffer_load_dwordx4 a[32:35], v9, s[4:7], s56 offen offset:0 sc1
    buffer_load_dwordx4 a[36:39], v9, s[4:7], s56 offen offset:2048 sc1
    s_add_u32 s56, s67, 25174016
    buffer_load_dwordx4 a[40:43], v9, s[4:7], s56 offen offset:0 sc1
    buffer_load_dwordx4 a[44:47], v9, s[4:7], s56 offen offset:2048 sc1
    s_cmp_eq_u32 s65, 0
    s_cbranch_scc1 L_t_skip_59
    s_add_u32 s56, s67, 25166848
    buffer_load_dwordx4 a[48:51], v9, s[4:7], s56 offen offset:0 sc1
    buffer_load_dwordx4 a[52:55], v9, s[4:7], s56 offen offset:2048 sc1
    s_add_u32 s56, s67, 25170944
    buffer_load_dwordx4 a[56:59], v9, s[4:7], s56 offen offset:0 sc1
    buffer_load_dwordx4 a[60:63], v9, s[4:7], s56 offen offset:2048 sc1
    s_add_u32 s56, s67, 25175040
    buffer_load_dwordx4 a[64:67], v9, s[4:7], s56 offen offset:0 sc1
    buffer_load_dwordx4 a[68:71], v9, s[4:7], s56 offen offset:2048 sc1
L_t_skip_59:
    s_add_u32 s67, s67, 393216
    s_cmp_eq_u32 s3, 0
    s_cbranch_scc0 L_t_slow
L_t_loop:
    s_add_u32 s73, s55, 2
    s_min_u32 s73, s73, 64
    s_waitcnt vmcnt(0)
    v_mov_b32 v4, s55
    buffer_store_dword v4, v8, s[4:7], s66 offen
    buffer_load_dword v4, v10, s[4:7], 0 offen sc1
    s_mov_b32 s75, s73
    s_waitcnt vmcnt(0)
    v_cmp_gt_u32 vcc, s73, v4
    s_mov_b32 s76, 1
    s_cbranch_vccnz L_t_la_60
    s_mov_b32 s76, 0
    s_add_u32 s56, s67, s74
    s_add_u32 s56, s56, 0
    buffer_load_dwordx4 a[72:75], v9, s[4:7], s56 offen offset:0 sc1
    buffer_load_dwordx4 a[76:79], v9, s[4:7], s56 offen offset:2048 sc1
    s_add_u32 s56, s67, s74
    s_add_u32 s56, s56, 4096
    buffer_load_dwordx4 a[80:83], v9, s[4:7], s56 offen offset:0 sc1
    buffer_load_dwordx4 a[84:87], v9, s[4:7], s56 offen offset:2048 sc1
    s_add_u32 s56, s67, s74
    s_add_u32 s56, s56, 8192
    buffer_load_dwordx4 a[88:91], v9, s[4:7], s56 offen offset:0 sc1
    buffer_load_dwordx4 a[92:95], v9, s[4:7], s56 offen offset:2048 sc1
    s_add_u32 s56, s67, 25165824
    buffer_load_dwordx4 a[96:99], v9, s[4:7], s56 offen offset:0 sc1
    buffer_load_dwordx4 a[100:103], v9, s[4:7], s56 offen offset:2048 sc1
    s_add_u32 s56, s67, 25169920
    buffer_load_dwordx4 a[104:107], v9, s[4:7], s56 offen offset:0 sc1
    buffer_load_dwordx4 a[108:111], v9, s[4:7], s56 offen offset:2048 sc1
    s_add_u32 s56, s67, 25174016
    buffer_load_dwordx4 a[112:115], v9, s[4:7], s56 offen offset:0 sc1
    buffer_load_dwordx4 a[116:119], v9, s[4:7], s56 offen offset:2048 sc1
    s_cmp_eq_u32 s65, 0
    s_cbranch_scc1 L_t_skip_61
    s_add_u32 s56, s67, 25166848
    buffer_load_dwordx4 a[120:123], v9, s[4:7], s56 offen offset:0 sc1
    buffer_load_dwordx4 a[124:127], v9, s[4:7], s56 offen offset:2048 sc1
    s_add_u32 s56, s67, 25170944
    buffer_load_dwordx4 a[128:131], v9, s[4:7], s56 offen offset:0 sc1
    buffer_load_dwordx4 a[132:135], v9, s[4:7], s56 offen offset:2048 sc1
    s_add_u32 s56, s67, 25175040
    buffer_load_dwordx4 a[136:139], v9, s[4:7], s56 offen offset:0 sc1
    buffer_load_dwordx4 a[140:143], v9, s[4:7], s56 offen offset:2048 sc1
L_t_skip_61:
    s_add_u32 s67, s67, 393216
L_t_la_60:
    s_add_u32 s73, s55, 1
    v_mfma_f32_16x16x32_bf16 v[16:19], a[24:27], a[0:3], 0
    v_mfma_f32_16x16x32_bf16 v[20:23], a[48:51], a[0:3], 0
    v_mfma_f32_16x16x32_bf16 v[16:19], a[28:31], a[4:7], v[16:19]
    v_mfma_f32_16x16x32_bf16 v[20:23], a[52:55], a[4:7], v[20:23]
    v_mfma_f32_16x16x32_bf16 v[16:19], a[32:35], a[8:11], v[16:19]
    v_mfma_f32_16x16x32_bf16 v[20:23], a[56:59], a[8:11], v[20:23]
    v_mfma_f32_16x16x32_bf16 v[16:19], a[36:39], a[12:15], v[16:19]
    v_mfma_f32_16x16x32_bf16 v[20:23], a[60:63], a[12:15], v[20:23]
    v_mfma_f32_16x16x32_bf16 v[16:19], a[40:43], a[16:19], v[16:19]
    v_mfma_f32_16x16x32_bf16 v[20:23], a[64:67], a[16:19], v[20:23]
    v_mfma_f32_16x16x32_bf16 v[16:19], a[44:47], a[20:23], v[16:19]
    v_mfma_f32_16x16x32_bf16 v[20:23], a[68:71], a[20:23], v[20:23]
    s_mov_b32 s96, 2000000
L_wf_62:
    buffer_load_dword v4, v11, s[4:7], 0 offen sc1
    s_sub_u32 s96, s96, 1
    s_cbranch_scc1 L_fail
    s_waitcnt vmcnt(0)
    v_cmp_gt_u32 vcc, s73, v4
    s_cbranch_vccz L_wf_62_d
    s_sleep 2
    s_branch L_wf_62
L_wf_62_d:
    s_add_u32 s56, s68, 4096
    buffer_load_dwordx4 v[64:67], v9, s[4:7], s68 offen offset:0 sc1
    buffer_load_dwordx4 v[68:71], v9, s[4:7], s68 offen offset:1024 sc1
    buffer_load_dwordx4 v[72:75], v9, s[4:7], s68 offen offset:2048 sc1
    buffer_load_dwordx4 v[76:79], v9, s[4:7], s68 offen offset:3072 sc1
    buffer_load_dwordx4 v[80:83], v9, s[4:7], s56 offen offset:0 sc1
    buffer_load_dwordx4 v[84:87], v9, s[4:7], s56 offen offset:1024 sc1
    v_cndmask_b32 v16, v13, v16, s[24:25]
    v_cndmask_b32 v20, v13, v20, s[32:33]
    v_cndmask_b32 v17, v13, v17, s[26:27]
    v_cndmask_b32 v21, v13, v21, s[34:35]
    v_cndmask_b32 v18, v13, v18, s[28:29]
    v_cndmask_b32 v22, v13, v22, s[36:37]
    v_cndmask_b32 v19, v13, v19, s[30:31]
    v_cndmask_b32 v23, v13, v23, s[38:39]
    v_max3_f32 v28, v16, v17, v18
    v_max3_f32 v28, v28, v19, v20
    v_max3_f32 v28, v28, v21, v22
    v_max_f32 v28, v28, v23
    s_waitcnt vmcnt(5)
    v_mfma_f32_16x16x32_bf16 v[24:27], v[64:67], a[0:3], 0
    s_waitcnt vmcnt(4)
    v_mfma_f32_16x16x32_bf16 v[24:27], v[68:71], a[4:7], v[24:27]
    s_waitcnt vmcnt(3)
    v_mfma_f32_16x16x32_bf16 v[24:27], v[72:75], a[8:11], v[24:27]
    s_waitcnt vmcnt(2)
    v_mfma_f32_16x16x32_bf16 v[24:27], v[76:79], a[12:15], v[24:27]
    s_waitcnt vmcnt(1)
    v_mfma_f32_16x16x32_bf16 v[24:27], v[80:83], a[16:19], v[24:27]
    s_waitcnt vmcnt(0)
    v_mfma_f32_16x16x32_bf16 v[24:27], v[84:87], a[20:23], v[24:27]
    s_nop 7
    v_max3_f32 v28, v28, v24, v25
    v_mov_b32 v30, v28
    s_nop 1
    v_permlane16_swap_b32 v28, v30
    v_max_f32 v28, v28, v30
    v_mov_b32 v30, v28
    s_nop 1
    v_permlane32_swap_b32 v28, v30
    v_max_f32 v28, v28, v30
    v_mul_f32 v28, s78, v28
    v_fma_f32 v16, v16, s78, -v28
    v_fma_f32 v17, v17, s78, -v28
    v_fma_f32 v18, v18, s78, -v28
    v_fma_f32 v19, v19, s78, -v28
    v_fma_f32 v20, v20, s78, -v28
    v_fma_f32 v21, v21, s78, -v28
    v_fma_f32 v22, v22, s78, -v28
    v_fma_f32 v23, v23, s78, -v28
    v_fma_f32 v24, v24, s78, -v28
    v_fma_f32 v25, v25, s78, -v28
    v_exp_f32 v16, v16
    v_exp_f32 v17, v17
    v_exp_f32 v18, v18
    v_exp_f32 v19, v19
    v_exp_f32 v20, v20
    v_exp_f32 v21, v21
    v_exp_f32 v22, v22
    v_exp_f32 v23, v23
    v_exp_f32 v24, v24
    v_exp_f32 v25, v25
    v_add_f32 v29, v16, v17
    v_add_f32 v29, v29, v18
    v_add_f32 v29, v29, v19
    v_add_f32 v29, v29, v20
    v_add_f32 v29, v29, v21
    v_add_f32 v29, v29, v22
    v_add_f32 v29, v29, v23
    v_add_f32 v29, v29, v24
    v_add_f32 v29, v29, v25
    v_mov_b32 v30, v29
    s_nop 1
    v_permlane16_swap_b32 v29, v30
    v_add_f32 v29, v29, v30
    v_mov_b32 v30, v29
    s_nop 1
    v_permlane32_swap_b32 v29, v30
    v_add_f32 v29, v29, v30
    v_rcp_f32 v29, v29
    s_cmp_eq_u32 s65, 0
    v_mul_f32 v16, v16, v29
    v_mul_f32 v17, v17, v29
    v_mul_f32 v18, v18, v29
    v_mul_f32 v19, v19, v29
    v_mul_f32 v20, v20, v29
    v_mul_f32 v21, v21, v29
    v_mul_f32 v22, v22, v29
    v_mul_f32 v23, v23, v29
    v_mul_f32 v24, v24, v29
    v_mul_f32 v25, v25, v29
    v_cvt_pk_bf16_f32 v32, v16, v17
    v_cvt_pk_bf16_f32 v33, v18, v19
    v_cvt_pk_bf16_f32 v34, v20, v21
    v_cvt_pk_bf16_f32 v35, v22, v23
    v_cvt_pk_bf16_f32 v36, v24, v25
    buffer_store_dword v36, v12, s[4:7], s70 offen
    s_cbranch_scc1 L_t_st_63
    buffer_store_dwordx4 v[32:35], v9, s[4:7], s69 offen
    s_branch L_t_st_63_e
L_t_st_63:
    buffer_store_dwordx2 v[32:33], v9, s[4:7], s69 offen
L_t_st_63_e:
    s_add_u32 s68, s68, 262144
    s_bitset0_b32 s68, 20
    s_add_u32 s69, s69, 524288
    s_bitset0_b32 s69, 21
    s_add_u32 s70, s70, 524288
    s_bitset0_b32 s70, 21
    s_add_u32 s55, s55, 1
    s_cmp_eq_u32 s76, 0
    s_cbranch_scc1 L_t_la_60_e
    buffer_load_dword v4, v10, s[4:7], 0 offen sc1
    s_waitcnt vmcnt(0)
    v_mov_b32 v5, s55
    buffer_store_dword v5, v8, s[4:7], s66 offen
    v_cmp_gt_u32 vcc, s75, v4
    s_cbranch_vccz L_wf_64_d
    s_mov_b32 s96, 2000000
L_wf_64:
    buffer_load_dword v4, v10, s[4:7], 0 offen sc1
    s_sub_u32 s96, s96, 1
    s_cbranch_scc1 L_fail
    s_waitcnt vmcnt(0)
    v_cmp_gt_u32 vcc, s75, v4
    s_cbranch_vccz L_wf_64_d
    s_sleep 4
    s_branch L_wf_64
L_wf_64_d:
    s_add_u32 s56, s67, s74
    s_add_u32 s56, s56, 0
    buffer_load_dwordx4 a[72:75], v9, s[4:7], s56 offen offset:0 sc1
    buffer_load_dwordx4 a[76:79], v9, s[4:7], s56 offen offset:2048 sc1
    s_add_u32 s56, s67, s74
    s_add_u32 s56, s56, 4096
    buffer_load_dwordx4 a[80:83], v9, s[4:7], s56 offen offset:0 sc1
    buffer_load_dwordx4 a[84:87], v9, s[4:7], s56 offen offset:2048 sc1
    s_add_u32 s56, s67, s74
    s_add_u32 s56, s56, 8192
    buffer_load_dwordx4 a[88:91], v9, s[4:7], s56 offen offset:0 sc1
    buffer_load_dwordx4 a[92:95], v9, s[4:7], s56 offen offset:2048 sc1
    s_add_u32 s56, s67, 25165824
    buffer_load_dwordx4 a[96:99], v9, s[4:7], s56 offen offset:0 sc1
    buffer_load_dwordx4 a[100:103], v9, s[4:7], s56 offen offset:2048 sc1
    s_add_u32 s56, s67, 25169920
    buffer_load_dwordx4 a[104:107], v9, s[4:7], s56 offen offset:0 sc1
    buffer_load_dwordx4 a[108:111], v9, s[4:7], s56 offen offset:2048 sc1
    s_add_u32 s56, s67, 25174016
    buffer_load_dwordx4 a[112:115], v9, s[4:7], s56 offen offset:0 sc1
    buffer_load_dwordx4 a[116:119], v9, s[4:7], s56 offen offset:2048 sc1
    s_cmp_eq_u32 s65, 0
    s_cbranch_scc1 L_t_skip_65
    s_add_u32 s56, s67, 25166848
    buffer_load_dwordx4 a[120:123], v9, s[4:7], s56 offen offset:0 sc1
    buffer_load_dwordx4 a[124:127], v9, s[4:7], s56 offen offset:2048 sc1
    s_add_u32 s56, s67, 25170944
    buffer_load_dwordx4 a[128:131], v9, s[4:7], s56 offen offset:0 sc1
    buffer_load_dwordx4 a[132:135], v9, s[4:7], s56 offen offset:2048 sc1
    s_add_u32 s56, s67, 25175040
    buffer_load_dwordx4 a[136:139], v9, s[4:7], s56 offen offset:0 sc1
    buffer_load_dwordx4 a[140:143], v9, s[4:7], s56 offen offset:2048 sc1
L_t_skip_65:
    s_add_u32 s67, s67, 393216
L_t_la_60_e:
    s_add_u32 s73, s55, 2
    s_min_u32 s73, s73, 64
    s_waitcnt vmcnt(0)
    v_mov_b32 v4, s55
    buffer_store_dword v4, v8, s[4:7], s66 offen
    buffer_load_dword v4, v10, s[4:7], 0 offen sc1
    s_mov_b32 s75, s73
    s_waitcnt vmcnt(0)
    v_cmp_gt_u32 vcc, s73, v4
    s_mov_b32 s76, 1
    s_cbranch_vccnz L_t_la_66
    s_mov_b32 s76, 0
    s_add_u32 s56, s67, s74
    s_add_u32 s56, s56, 0
    buffer_load_dwordx4 a[0:3], v9, s[4:7], s56 offen offset:0 sc1
    buffer_load_dwordx4 a[4:7], v9, s[4:7], s56 offen offset:2048 sc1
    s_add_u32 s56, s67, s74
    s_add_u32 s56, s56, 4096
    buffer_load_dwordx4 a[8:11], v9, s[4:7], s56 offen offset:0 sc1
    buffer_load_dwordx4 a[12:15], v9, s[4:7], s56 offen offset:2048 sc1
    s_add_u32 s56, s67, s74
    s_add_u32 s56, s56, 8192
    buffer_load_dwordx4 a[16:19], v9, s[4:7], s56 offen offset:0 sc1
    buffer_load_dwordx4 a[20:23], v9, s[4:7], s56 offen offset:2048 sc1
    s_add_u32 s56, s67, 25165824
    buffer_load_dwordx4 a[24:27], v9, s[4:7], s56 offen offset:0 sc1
    buffer_load_dwordx4 a[28:31], v9, s[4:7], s56 offen offset:2048 sc1
    s_add_u32 s56, s67, 25169920
    buffer_load_dwordx4 a[32:35], v9, s[4:7], s56 offen offset:0 sc1
    buffer_load_dwordx4 a[36:39], v9, s[4:7], s56 offen offset:2048 sc1
    s_add_u32 s56, s67, 25174016
    buffer_load_dwordx4 a[40:43], v9, s[4:7], s56 offen offset:0 sc1
    buffer_load_dwordx4 a[44:47], v9, s[4:7], s56 offen offset:2048 sc1
    s_cmp_eq_u32 s65, 0
    s_cbranch_scc1 L_t_skip_67
    s_add_u32 s56, s67, 25166848
    buffer_load_dwordx4 a[48:51], v9, s[4:7], s56 offen offset:0 sc1
    buffer_load_dwordx4 a[52:55], v9, s[4:7], s56 offen offset:2048 sc1
    s_add_u32 s56, s67, 25170944
    buffer_load_dwordx4 a[56:59], v9, s[4:7], s56 offen offset:0 sc1
    buffer_load_dwordx4 a[60:63], v9, s[4:7], s56 offen offset:2048 sc1
    s_add_u32 s56, s67, 25175040
    buffer_load_dwordx4 a[64:67], v9, s[4:7], s56 offen offset:0 sc1
    buffer_load_dwordx4 a[68:71], v9, s[4:7], s56 offen offset:2048 sc1
L_t_skip_67:
    s_add_u32 s67, s67, 393216
L_t_la_66:
    s_add_u32 s73, s55, 1
    v_mfma_f32_16x16x32_bf16 v[16:19], a[96:99], a[72:75], 0
    v_mfma_f32_16x16x32_bf16 v[20:23], a[120:123], a[72:75], 0
    v_mfma_f32_16x16x32_bf16 v[16:19], a[100:103], a[76:79], v[16:19]
    v_mfma_f32_16x16x32_bf16 v[20:23], a[124:127], a[76:79], v[20:23]
    v_mfma_f32_16x16x32_bf16 v[16:19], a[104:107], a[80:83], v[16:19]
    v_mfma_f32_16x16x32_bf16 v[20:23], a[128:131], a[80:83], v[20:23]
    v_mfma_f32_16x16x32_bf16 v[16:19], a[108:111], a[84:87], v[16:19]
    v_mfma_f32_16x16x32_bf16 v[20:23], a[132:135], a[84:87], v[20:23]
    v_mfma_f32_16x16x32_bf16 v[16:19], a[112:115], a[88:91], v[16:19]
    v_mfma_f32_16x16x32_bf16 v[20:23], a[136:139], a[88:91], v[20:23]
    v_mfma_f32_16x16x32_bf16 v[16:19], a[116:119], a[92:95], v[16:19]
    v_mfma_f32_16x16x32_bf16 v[20:23], a[140:143], a[92:95], v[20:23]
    s_mov_b32 s96, 2000000
L_wf_68:
    buffer_load_dword v4, v11, s[4:7], 0 offen sc1
    s_sub_u32 s96, s96, 1
    s_cbranch_scc1 L_fail
    s_waitcnt vmcnt(0)
    v_cmp_gt_u32 vcc, s73, v4
    s_cbranch_vccz L_wf_68_d
    s_sleep 2
    s_branch L_wf_68
L_wf_68_d:
    s_add_u32 s56, s68, 4096
    buffer_load_dwordx4 v[64:67], v9, s[4:7], s68 offen offset:0 sc1
    buffer_load_dwordx4 v[68:71], v9, s[4:7], s68 offen offset:1024 sc1
    buffer_load_dwordx4 v[72:75], v9, s[4:7], s68 offen offset:2048 sc1
    buffer_load_dwordx4 v[76:79], v9, s[4:7], s68 offen offset:3072 sc1
    buffer_load_dwordx4 v[80:83], v9, s[4:7], s56 offen offset:0 sc1
    buffer_load_dwordx4 v[84:87], v9, s[4:7], s56 offen offset:1024 sc1
    v_cndmask_b32 v16, v13, v16, s[24:25]
    v_cndmask_b32 v20, v13, v20, s[32:33]
    v_cndmask_b32 v17, v13, v17, s[26:27]
    v_cndmask_b32 v21, v13, v21, s[34:35]
    v_cndmask_b32 v18, v13, v18, s[28:29]
    v_cndmask_b32 v22, v13, v22, s[36:37]
    v_cndmask_b32 v19, v13, v19, s[30:31]
    v_cndmask_b32 v23, v13, v23, s[38:39]
    v_max3_f32 v28, v16, v17, v18
    v_max3_f32 v28, v28, v19, v20
    v_max3_f32 v28, v28, v21, v22
    v_max_f32 v28, v28, v23
    s_waitcnt vmcnt(5)
    v_mfma_f32_16x16x32_bf16 v[24:27], v[64:67], a[72:75], 0
    s_waitcnt vmcnt(4)
    v_mfma_f32_16x16x32_bf16 v[24:27], v[68:71], a[76:79], v[24:27]
    s_waitcnt vmcnt(3)
    v_mfma_f32_16x16x32_bf16 v[24:27], v[72:75], a[80:83], v[24:27]
    s_waitcnt vmcnt(2)
    v_mfma_f32_16x16x32_bf16 v[24:27], v[76:79], a[84:87], v[24:27]
    s_waitcnt vmcnt(1)
    v_mfma_f32_16x16x32_bf16 v[24:27], v[80:83], a[88:91], v[24:27]
    s_waitcnt vmcnt(0)
    v_mfma_f32_16x16x32_bf16 v[24:27], v[84:87], a[92:95], v[24:27]
    s_nop 7
    v_max3_f32 v28, v28, v24, v25
    v_mov_b32 v30, v28
    s_nop 1
    v_permlane16_swap_b32 v28, v30
    v_max_f32 v28, v28, v30
    v_mov_b32 v30, v28
    s_nop 1
    v_permlane32_swap_b32 v28, v30
    v_max_f32 v28, v28, v30
    v_mul_f32 v28, s78, v28
    v_fma_f32 v16, v16, s78, -v28
    v_fma_f32 v17, v17, s78, -v28
    v_fma_f32 v18, v18, s78, -v28
    v_fma_f32 v19, v19, s78, -v28
    v_fma_f32 v20, v20, s78, -v28
    v_fma_f32 v21, v21, s78, -v28
    v_fma_f32 v22, v22, s78, -v28
    v_fma_f32 v23, v23, s78, -v28
    v_fma_f32 v24, v24, s78, -v28
    v_fma_f32 v25, v25, s78, -v28
    v_exp_f32 v16, v16
    v_exp_f32 v17, v17
    v_exp_f32 v18, v18
    v_exp_f32 v19, v19
    v_exp_f32 v20, v20
    v_exp_f32 v21, v21
    v_exp_f32 v22, v22
    v_exp_f32 v23, v23
    v_exp_f32 v24, v24
    v_exp_f32 v25, v25
    v_add_f32 v29, v16, v17
    v_add_f32 v29, v29, v18
    v_add_f32 v29, v29, v19
    v_add_f32 v29, v29, v20
    v_add_f32 v29, v29, v21
    v_add_f32 v29, v29, v22
    v_add_f32 v29, v29, v23
    v_add_f32 v29, v29, v24
    v_add_f32 v29, v29, v25
    v_mov_b32 v30, v29
    s_nop 1
    v_permlane16_swap_b32 v29, v30
    v_add_f32 v29, v29, v30
    v_mov_b32 v30, v29
    s_nop 1
    v_permlane32_swap_b32 v29, v30
    v_add_f32 v29, v29, v30
    v_rcp_f32 v29, v29
    s_cmp_eq_u32 s65, 0
    v_mul_f32 v16, v16, v29
    v_mul_f32 v17, v17, v29
    v_mul_f32 v18, v18, v29
    v_mul_f32 v19, v19, v29
    v_mul_f32 v20, v20, v29
    v_mul_f32 v21, v21, v29
    v_mul_f32 v22, v22, v29
    v_mul_f32 v23, v23, v29
    v_mul_f32 v24, v24, v29
    v_mul_f32 v25, v25, v29
    v_cvt_pk_bf16_f32 v32, v16, v17
    v_cvt_pk_bf16_f32 v33, v18, v19
    v_cvt_pk_bf16_f32 v34, v20, v21
    v_cvt_pk_bf16_f32 v35, v22, v23
    v_cvt_pk_bf16_f32 v36, v24, v25
    buffer_store_dword v36, v12, s[4:7], s70 offen
    s_cbranch_scc1 L_t_st_69
    buffer_store_dwordx4 v[32:35], v9, s[4:7], s69 offen
    s_branch L_t_st_69_e
L_t_st_69:
    buffer_store_dwordx2 v[32:33], v9, s[4:7], s69 offen
L_t_st_69_e:
    s_add_u32 s68, s68, 262144
    s_bitset0_b32 s68, 20
    s_add_u32 s69, s69, 524288
    s_bitset0_b32 s69, 21
    s_add_u32 s70, s70, 524288
    s_bitset0_b32 s70, 21
    s_add_u32 s55, s55, 1
    s_cmp_eq_u32 s76, 0
    s_cbranch_scc1 L_t_la_66_e
    buffer_load_dword v4, v10, s[4:7], 0 offen sc1
    s_waitcnt vmcnt(0)
    v_mov_b32 v5, s55
    buffer_store_dword v5, v8, s[4:7], s66 offen
    v_cmp_gt_u32 vcc, s75, v4
    s_cbranch_vccz L_wf_70_d
    s_mov_b32 s96, 2000000
L_wf_70:
    buffer_load_dword v4, v10, s[4:7], 0 offen sc1
    s_sub_u32 s96, s96, 1
    s_cbranch_scc1 L_fail
    s_waitcnt vmcnt(0)
    v_cmp_gt_u32 vcc, s75, v4
    s_cbranch_vccz L_wf_70_d
    s_sleep 4
    s_branch L_wf_70
L_wf_70_d:
    s_add_u32 s56, s67, s74
    s_add_u32 s56, s56, 0
    buffer_load_dwordx4 a[0:3], v9, s[4:7], s56 offen offset:0 sc1
    buffer_load_dwordx4 a[4:7], v9, s[4:7], s56 offen offset:2048 sc1
    s_add_u32 s56, s67, s74
    s_add_u32 s56, s56, 4096
    buffer_load_dwordx4 a[8:11], v9, s[4:7], s56 offen offset:0 sc1
    buffer_load_dwordx4 a[12:15], v9, s[4:7], s56 offen offset:2048 sc1
    s_add_u32 s56, s67, s74
    s_add_u32 s56, s56, 8192
    buffer_load_dwordx4 a[16:19], v9, s[4:7], s56 offen offset:0 sc1
    buffer_load_dwordx4 a[20:23], v9, s[4:7], s56 offen offset:2048 sc1
    s_add_u32 s56, s67, 25165824
    buffer_load_dwordx4 a[24:27], v9, s[4:7], s56 offen offset:0 sc1
    buffer_load_dwordx4 a[28:31], v9, s[4:7], s56 offen offset:2048 sc1
    s_add_u32 s56, s67, 25169920
    buffer_load_dwordx4 a[32:35], v9, s[4:7], s56 offen offset:0 sc1
    buffer_load_dwordx4 a[36:39], v9, s[4:7], s56 offen offset:2048 sc1
    s_add_u32 s56, s67, 25174016
    buffer_load_dwordx4 a[40:43], v9, s[4:7], s56 offen offset:0 sc1
    buffer_load_dwordx4 a[44:47], v9, s[4:7], s56 offen offset:2048 sc1
    s_cmp_eq_u32 s65, 0
    s_cbranch_scc1 L_t_skip_71
    s_add_u32 s56, s67, 25166848
    buffer_load_dwordx4 a[48:51], v9, s[4:7], s56 offen offset:0 sc1
    buffer_load_dwordx4 a[52:55], v9, s[4:7], s56 offen offset:2048 sc1
    s_add_u32 s56, s67, 25170944
    buffer_load_dwordx4 a[56:59], v9, s[4:7], s56 offen offset:0 sc1
    buffer_load_dwordx4 a[60:63], v9, s[4:7], s56 offen offset:2048 sc1
    s_add_u32 s56, s67, 25175040
    buffer_load_dwordx4 a[64:67], v9, s[4:7], s56 offen offset:0 sc1
    buffer_load_dwordx4 a[68:71], v9, s[4:7], s56 offen offset:2048 sc1
L_t_skip_71:
    s_add_u32 s67, s67, 393216
L_t_la_66_e:
    s_cmp_lt_u32 s55, 64
    s_cbranch_scc1 L_t_loop
    s_waitcnt vmcnt(0)
    v_mov_b32 v4, s55
    buffer_store_dword v4, v8, s[4:7], s66 offen
    s_branch L_end
L_roleO:
    s_lshl_b32 s56, s52, 2
    s_add_u32 s56, s56, s53
    s_cmp_eq_u32 s56, 480
    s_cselect_b32 s56, 0, 0x40000000
    v_mov_b32 v12, s56
    s_mov_b32 s72, 18972672
    v_mov_b32 v4, 0
    buffer_store_dword v4, v12, s[4:7], s72 offen sc1
    s_waitcnt vmcnt(0)
    s_barrier
    s_cmp_eq_u32 s53, 3
    s_cbranch_scc0 L_arr_72
    s_mov_b64 exec, 1
    v_mov_b32 v4, 1
    v_mov_b32 v5, 8
    buffer_atomic_add v4, v5, s[8:11], 0 offen sc0
    s_mov_b64 exec, -1
L_arr_72:
    s_waitcnt vmcnt(0)
    s_cmp_eq_u32 s53, 3
    s_cbranch_scc0 L_arr_73
    s_mov_b64 exec, 1
    v_cmp_eq_u32 vcc, 255, v4
    s_cbranch_vccz L_arr_73_x
    v_mov_b32 v5, 8
    buffer_load_dwordx3 v[4:6], v5, s[8:11], 0 offen offset:8 sc1
    s_waitcnt vmcnt(0)
    v_cmp_lt_u32 vcc, v4, v5
    v_mov_b32 v4, 0x2001
    v_lshlrev_b32 v6, 1, v6
    v_cndmask_b32 v4, 1, v4, vcc
    v_or_b32 v4, v4, v6
    v_mov_b32 v5, 252
    buffer_store_dword v4, v5, s[8:11], 0 offen sc1
L_arr_73_x:
    s_mov_b64 exec, -1
L_arr_73:
    s_sub_u32 s54, s52, 120
    s_cmp_lt_u32 s54, 10
    s_cbranch_scc0 L_end
    s_mov_b32 s76, s72
    s_mov_b32 s12, s24
    s_mov_b32 s13, s25
    s_mov_b32 s14, 2621440
    s_mov_b32 s15, 0x20000
    s_mov_b32 s20, s46
    s_mov_b32 s21, s47
    s_mov_b32 s22, 2621440
    s_mov_b32 s23, 0x20000
    s_mov_b32 s96, 2000000
    v_mov_b32 v5, 252
L_aw_74:
    buffer_load_dword v4, v5, s[8:11], 0 offen sc1
    s_sub_u32 s96, s96, 1
    s_cbranch_scc1 L_fail
    s_waitcnt vmcnt(0)
    v_cmp_eq_u32 vcc, 0, v4
    s_cbranch_vccz L_aw_74_d
    s_sleep 16
    s_branch L_aw_74
L_aw_74_d:
    v_readfirstlane_b32 s61, v4
    s_nop 3
    s_and_b32 s60, s61, 8192
    s_and_b32 s3, s61, 2
    v_lshlrev_b32 v8, 4, v1
    v_lshlrev_b32 v10, 3, v1
    v_mul_u32_u24 v9, 1280, v3
    v_lshl_add_u32 v9, v2, 3, v9
    s_lshl_b32 s57, s54, 2
    s_add_u32 s57, s57, s53
    s_lshl_b32 s64, s57, 12
    s_add_u32 s64, s64, 56623104
    s_lshl_b32 s65, s57, 10
    s_add_u32 s65, s65, 26214400
    s_lshl_b32 s66, s57, 5
    v_and_b32 v4, 3, v1
    v_mul_u32_u24 v5, 10, v4
    s_add_u32 s56, s54, 1664
    v_add_lshl_u32 v5, v5, s56, 7
    v_add_u32 v5, s60, v5
    s_lshl_b32 s56, s57, 1
    v_and_b32 v4, 1, v1
    v_add_u32 v4, s56, v4
    v_mul_u32_u24 v6, 205, v4
    v_lshrrev_b32 v6, 11, v6
    v_mul_u32_u24 v7, 10, v6
    v_sub_u32 v7, v4, v7
    v_and_b32 v7, 3, v7
    v_lshl_add_u32 v6, v6, 2, v7
    v_add_u32 v6, 147968, v6
    v_lshlrev_b32 v6, 7, v6
    v_cmp_gt_u32 vcc, 4, v1
    s_mov_b32 s55, 1
    s_nop 0
    v_cndmask_b32 v11, v6, v5, vcc
    v_mov_b32 v5, 18972800
    v_cndmask_b32 v13, v6, v5, vcc
L_o_loop:
    s_add_u32 s67, s66, 20480
    buffer_load_dwordx2 v[32:33], v9, s[12:15], s66 offen
    buffer_load_dwordx2 v[34:35], v9, s[12:15], s67 offen
    s_cmp_lt_u32 s55, 62
    s_cbranch_scc1 L_o_w
    s_mov_b32 s96, 2000000
L_wf_75:
    buffer_load_dword v4, v11, s[4:7], 0 offen sc1
    s_sub_u32 s96, s96, 1
    s_cbranch_scc1 L_fail
    s_waitcnt vmcnt(0)
    v_cmp_gt_u32 vcc, s55, v4
    s_cbranch_vccnz L_wf_75
L_wf_75_d:
    s_branch L_o_we
L_o_w:
    s_mov_b32 s96, 2000000
L_wf_76:
    buffer_load_dword v4, v11, s[4:7], 0 offen sc1
    s_sub_u32 s96, s96, 1
    s_cbranch_scc1 L_fail
    s_waitcnt vmcnt(0)
    v_cmp_gt_u32 vcc, s55, v4
    s_cbranch_vccz L_wf_76_d
    s_sleep 16
    s_branch L_wf_76
L_wf_76_d:
L_o_we:
    v_mov_b32 v4, s55
    buffer_store_dword v4, v12, s[4:7], s72 offen sc1
    buffer_load_dwordx2 v[36:37], v10, s[4:7], s65 offen offset:0 sc1
    buffer_load_dwordx2 v[38:39], v10, s[4:7], s65 offen offset:512 sc1
    s_cmp_eq_u32 s55, 64
    s_cbranch_scc0 L_o_x
    s_mov_b32 s96, 2000000
L_poll_77:
    buffer_load_dwordx4 v[16:19], v8, s[4:7], s64 offen offset:0 sc1
    buffer_load_dwordx4 v[20:23], v8, s[4:7], s64 offen offset:1024 sc1
    buffer_load_dwordx4 v[24:27], v8, s[4:7], s64 offen offset:2048 sc1
    buffer_load_dwordx4 v[28:31], v8, s[4:7], s64 offen offset:3072 sc1
    s_sub_u32 s96, s96, 1
    s_cbranch_scc1 L_fail
    s_waitcnt vmcnt(0)
    v_max3_u32 v4, v16, v17, v18
    v_max3_u32 v4, v4, v19, v20
    v_max3_u32 v4, v4, v21, v22
    v_max3_u32 v4, v4, v23, v24
    v_max3_u32 v4, v4, v25, v26
    v_max3_u32 v4, v4, v27, v28
    v_max3_u32 v4, v4, v29, v30
    v_max_u32 v4, v4, v31
    v_cmp_eq_u32 vcc, -1, v4
    s_cbranch_vccnz L_poll_77
    s_branch L_o_y
L_o_x:
    buffer_load_dwordx4 v[16:19], v8, s[4:7], s64 offen offset:0 sc1
    buffer_load_dwordx4 v[20:23], v8, s[4:7], s64 offen offset:1024 sc1
    buffer_load_dwordx4 v[24:27], v8, s[4:7], s64 offen offset:2048 sc1
    buffer_load_dwordx4 v[28:31], v8, s[4:7], s64 offen offset:3072 sc1
L_o_y:
    v_lshlrev_b32 v40, 16, v32
    v_and_b32 v41, 0xffff0000, v32
    v_lshlrev_b32 v42, 16, v33
    v_and_b32 v43, 0xffff0000, v33
    v_lshlrev_b32 v44, 16, v34
    v_and_b32 v45, 0xffff0000, v34
    v_lshlrev_b32 v46, 16, v35
    v_and_b32 v47, 0xffff0000, v35
    s_waitcnt vmcnt(4)
    v_lshlrev_b32 v4, 16, v36
    v_and_b32 v5, 0xffff0000, v36
    v_add_f32 v40, v40, v4
    v_add_f32 v41, v41, v5
    v_lshlrev_b32 v4, 16, v37
    v_and_b32 v5, 0xffff0000, v37
    v_add_f32 v42, v42, v4
    v_add_f32 v43, v43, v5
    v_lshlrev_b32 v4, 16, v38
    v_and_b32 v5, 0xffff0000, v38
    v_add_f32 v44, v44, v4
    v_add_f32 v45, v45, v5
    v_lshlrev_b32 v4, 16, v39
    v_and_b32 v5, 0xffff0000, v39
    v_add_f32 v46, v46, v4
    v_add_f32 v47, v47, v5
    s_waitcnt vmcnt(3)
    v_lshlrev_b32 v4, 16, v16
    v_and_b32 v5, 0xffff0000, v16
    v_add_f32 v40, v40, v4
    v_add_f32 v41, v41, v5
    v_lshlrev_b32 v4, 16, v17
    v_and_b32 v5, 0xffff0000, v17
    v_add_f32 v42, v42, v4
    v_add_f32 v43, v43, v5
    v_lshlrev_b32 v4, 16, v18
    v_and_b32 v5, 0xffff0000, v18
    v_add_f32 v44, v44, v4
    v_add_f32 v45, v45, v5
    v_lshlrev_b32 v4, 16, v19
    v_and_b32 v5, 0xffff0000, v19
    v_add_f32 v46, v46, v4
    v_add_f32 v47, v47, v5
    s_waitcnt vmcnt(2)
    v_lshlrev_b32 v4, 16, v20
    v_and_b32 v5, 0xffff0000, v20
    v_add_f32 v40, v40, v4
    v_add_f32 v41, v41, v5
    v_lshlrev_b32 v4, 16, v21
    v_and_b32 v5, 0xffff0000, v21
    v_add_f32 v42, v42, v4
    v_add_f32 v43, v43, v5
    v_lshlrev_b32 v4, 16, v22
    v_and_b32 v5, 0xffff0000, v22
    v_add_f32 v44, v44, v4
    v_add_f32 v45, v45, v5
    v_lshlrev_b32 v4, 16, v23
    v_and_b32 v5, 0xffff0000, v23
    v_add_f32 v46, v46, v4
    v_add_f32 v47, v47, v5
    s_waitcnt vmcnt(1)
    v_lshlrev_b32 v4, 16, v24
    v_and_b32 v5, 0xffff0000, v24
    v_add_f32 v40, v40, v4
    v_add_f32 v41, v41, v5
    v_lshlrev_b32 v4, 16, v25
    v_and_b32 v5, 0xffff0000, v25
    v_add_f32 v42, v42, v4
    v_add_f32 v43, v43, v5
    v_lshlrev_b32 v4, 16, v26
    v_and_b32 v5, 0xffff0000, v26
    v_add_f32 v44, v44, v4
    v_add_f32 v45, v45, v5
    v_lshlrev_b32 v4, 16, v27
    v_and_b32 v5, 0xffff0000, v27
    v_add_f32 v46, v46, v4
    v_add_f32 v47, v47, v5
    s_waitcnt vmcnt(0)
    v_lshlrev_b32 v4, 16, v28
    v_and_b32 v5, 0xffff0000, v28
    v_add_f32 v40, v40, v4
    v_add_f32 v41, v41, v5
    v_lshlrev_b32 v4, 16, v29
    v_and_b32 v5, 0xffff0000, v29
    v_add_f32 v42, v42, v4
    v_add_f32 v43, v43, v5
    v_lshlrev_b32 v4, 16, v30
    v_and_b32 v5, 0xffff0000, v30
    v_add_f32 v44, v44, v4
    v_add_f32 v45, v45, v5
    v_lshlrev_b32 v4, 16, v31
    v_and_b32 v5, 0xffff0000, v31
    v_add_f32 v46, v46, v4
    v_add_f32 v47, v47, v5
    v_cvt_pk_bf16_f32 v48, v40, v41
    v_cvt_pk_bf16_f32 v49, v42, v43
    v_cvt_pk_bf16_f32 v50, v44, v45
    v_cvt_pk_bf16_f32 v51, v46, v47
    buffer_store_dwordx2 v[48:49], v9, s[20:23], s66 offen
    buffer_store_dwordx2 v[50:51], v9, s[20:23], s67 offen
    s_add_u32 s64, s64, 163840
    s_add_u32 s65, s65, 40960
    s_add_u32 s66, s66, 40960
    s_add_u32 s55, s55, 1
    s_cmp_le_u32 s55, 64
    s_cbranch_scc1 L_o_loop
    s_branch L_end
L_roleFD:
    s_sub_u32 s54, s52, 132
    s_lshl_b32 s66, s54, 2
    s_add_u32 s66, s66, s53
    s_lshl_b32 s66, s66, 7
    s_add_u32 s66, s66, 18939904
    v_mov_b32 v8, 0
    v_mov_b32 v4, 0
    buffer_store_dword v4, v8, s[4:7], s66 offen sc1
    s_waitcnt vmcnt(0)
    s_barrier
    s_cmp_eq_u32 s53, 3
    s_cbranch_scc0 L_arr_78
    s_mov_b64 exec, 1
    v_mov_b32 v4, 1
    v_mov_b32 v5, 8
    buffer_atomic_add v4, v5, s[8:11], 0 offen sc0
    s_mov_b64 exec, -1
L_arr_78:
    s_waitcnt vmcnt(0)
    s_cmp_eq_u32 s53, 3
    s_cbranch_scc0 L_arr_79
    s_mov_b64 exec, 1
    v_cmp_eq_u32 vcc, 255, v4
    s_cbranch_vccz L_arr_79_x
    v_mov_b32 v5, 8
    buffer_load_dwordx3 v[4:6], v5, s[8:11], 0 offen offset:8 sc1
    s_waitcnt vmcnt(0)
    v_cmp_lt_u32 vcc, v4, v5
    v_mov_b32 v4, 0x2001
    v_lshlrev_b32 v6, 1, v6
    v_cndmask_b32 v4, 1, v4, vcc
    v_or_b32 v4, v4, v6
    v_mov_b32 v5, 252
    buffer_store_dword v4, v5, s[8:11], 0 offen sc1
L_arr_79_x:
    s_mov_b64 exec, -1
L_arr_79:
    s_mov_b32 s12, s44
    s_mov_b32 s13, s45
    s_mov_b32 s14, 1966080
    s_mov_b32 s15, 0x20000
    s_mul_i32 s57, s54, 160
    s_mul_i32 s72, s53, 491520
    s_mul_i32 s70, s53, 40960
    v_add_u32 v4, 0, v1
    v_mul_u32_u24 v5, 205, v4
    v_lshrrev_b32 v5, 11, v5
    v_mul_u32_u24 v6, 10, v5
    v_sub_u32 v4, v4, v6
    v_mul_u32_u24 v5, 1280, v5
    v_lshl_add_u32 v4, v4, 4, v5
    v_add_u32 v16, s57, v4
    v_add_u32 v4, 64, v1
    v_mul_u32_u24 v5, 205, v4
    v_lshrrev_b32 v5, 11, v5
    v_mul_u32_u24 v6, 10, v5
    v_sub_u32 v4, v4, v6
    v_mul_u32_u24 v5, 1280, v5
    v_lshl_add_u32 v4, v4, 4, v5
    v_add_u32 v17, s57, v4
    v_add_u32 v4, 128, v1
    v_mul_u32_u24 v5, 205, v4
    v_lshrrev_b32 v5, 11, v5
    v_mul_u32_u24 v6, 10, v5
    v_sub_u32 v4, v4, v6
    v_mul_u32_u24 v5, 1280, v5
    v_lshl_add_u32 v4, v4, 4, v5
    v_add_u32 v18, s57, v4
    v_add_u32 v4, 192, v1
    v_mul_u32_u24 v5, 205, v4
    v_lshrrev_b32 v5, 11, v5
    v_mul_u32_u24 v6, 10, v5
    v_sub_u32 v4, v4, v6
    v_mul_u32_u24 v5, 1280, v5
    v_lshl_add_u32 v4, v4, 4, v5
    v_add_u32 v19, s57, v4
    v_add_u32 v4, 256, v1
    v_mul_u32_u24 v5, 205, v4
    v_lshrrev_b32 v5, 11, v5
    v_mul_u32_u24 v6, 10, v5
    v_sub_u32 v4, v4, v6
    v_mul_u32_u24 v5, 1280, v5
    v_lshl_add_u32 v4, v4, 4, v5
    v_add_u32 v20, s57, v4
    v_lshrrev_b32 v4, 2, v3
    v_lshl_add_u32 v4, v2, 2, v4
    v_mul_u32_u24 v4, 160, v4
    v_and_b32 v5, 3, v3
    v_lshl_add_u32 v4, v5, 3, v4
    v_add_u32 v12, s70, v4
    s_add_u32 m0, s70, 0
    s_nop 0
    buffer_load_dwordx4 v16, s[12:15], s72 offen lds
    s_add_u32 m0, s70, 1024
    s_nop 0
    buffer_load_dwordx4 v17, s[12:15], s72 offen lds
    s_add_u32 m0, s70, 2048
    s_nop 0
    buffer_load_dwordx4 v18, s[12:15], s72 offen lds
    s_add_u32 m0, s70, 3072
    s_nop 0
    buffer_load_dwordx4 v19, s[12:15], s72 offen lds
    s_add_u32 m0, s70, 4096
    s_nop 0
    buffer_load_dwordx4 v20, s[12:15], s72 offen lds
    s_add_u32 s72, s72, 40960
    s_add_u32 m0, s70, 5120
    s_nop 0
    buffer_load_dwordx4 v16, s[12:15], s72 offen lds
    s_add_u32 m0, s70, 6144
    s_nop 0
    buffer_load_dwordx4 v17, s[12:15], s72 offen lds
    s_add_u32 m0, s70, 7168
    s_nop 0
    buffer_load_dwordx4 v18, s[12:15], s72 offen lds
    s_add_u32 m0, s70, 8192
    s_nop 0
    buffer_load_dwordx4 v19, s[12:15], s72 offen lds
    s_add_u32 m0, s70, 9216
    s_nop 0
    buffer_load_dwordx4 v20, s[12:15], s72 offen lds
    s_add_u32 s72, s72, 40960
    s_add_u32 m0, s70, 10240
    s_nop 0
    buffer_load_dwordx4 v16, s[12:15], s72 offen lds
    s_add_u32 m0, s70, 11264
    s_nop 0
    buffer_load_dwordx4 v17, s[12:15], s72 offen lds
    s_add_u32 m0, s70, 12288
    s_nop 0
    buffer_load_dwordx4 v18, s[12:15], s72 offen lds
    s_add_u32 m0, s70, 13312
    s_nop 0
    buffer_load_dwordx4 v19, s[12:15], s72 offen lds
    s_add_u32 m0, s70, 14336
    s_nop 0
    buffer_load_dwordx4 v20, s[12:15], s72 offen lds
    s_add_u32 s72, s72, 40960
    s_add_u32 m0, s70, 15360
    s_nop 0
    buffer_load_dwordx4 v16, s[12:15], s72 offen lds
    s_add_u32 m0, s70, 16384
    s_nop 0
    buffer_load_dwordx4 v17, s[12:15], s72 offen lds
    s_add_u32 m0, s70, 17408
    s_nop 0
    buffer_load_dwordx4 v18, s[12:15], s72 offen lds
    s_add_u32 m0, s70, 18432
    s_nop 0
    buffer_load_dwordx4 v19, s[12:15], s72 offen lds
    s_add_u32 m0, s70, 19456
    s_nop 0
    buffer_load_dwordx4 v20, s[12:15], s72 offen lds
    s_add_u32 s72, s72, 40960
    s_add_u32 m0, s70, 20480
    s_nop 0
    buffer_load_dwordx4 v16, s[12:15], s72 offen lds
    s_add_u32 m0, s70, 21504
    s_nop 0
    buffer_load_dwordx4 v17, s[12:15], s72 offen lds
    s_add_u32 m0, s70, 22528
    s_nop 0
    buffer_load_dwordx4 v18, s[12:15], s72 offen lds
    s_add_u32 m0, s70, 23552
    s_nop 0
    buffer_load_dwordx4 v19, s[12:15], s72 offen lds
    s_add_u32 m0, s70, 24576
    s_nop 0
    buffer_load_dwordx4 v20, s[12:15], s72 offen lds
    s_add_u32 s72, s72, 40960
    s_add_u32 m0, s70, 25600
    s_nop 0
    buffer_load_dwordx4 v16, s[12:15], s72 offen lds
    s_add_u32 m0, s70, 26624
    s_nop 0
    buffer_load_dwordx4 v17, s[12:15], s72 offen lds
    s_add_u32 m0, s70, 27648
    s_nop 0
    buffer_load_dwordx4 v18, s[12:15], s72 offen lds
    s_add_u32 m0, s70, 28672
    s_nop 0
    buffer_load_dwordx4 v19, s[12:15], s72 offen lds
    s_add_u32 m0, s70, 29696
    s_nop 0
    buffer_load_dwordx4 v20, s[12:15], s72 offen lds
    s_add_u32 s72, s72, 40960
    s_add_u32 m0, s70, 30720
    s_nop 0
    buffer_load_dwordx4 v16, s[12:15], s72 offen lds
    s_add_u32 m0, s70, 31744
    s_nop 0
    buffer_load_dwordx4 v17, s[12:15], s72 offen lds
    s_add_u32 m0, s70, 32768
    s_nop 0
    buffer_load_dwordx4 v18, s[12:15], s72 offen lds
    s_add_u32 m0, s70, 33792
    s_nop 0
    buffer_load_dwordx4 v19, s[12:15], s72 offen lds
    s_add_u32 m0, s70, 34816
    s_nop 0
    buffer_load_dwordx4 v20, s[12:15], s72 offen lds
    s_add_u32 s72, s72, 40960
    s_add_u32 m0, s70, 35840
    s_nop 0
    buffer_load_dwordx4 v16, s[12:15], s72 offen lds
    s_add_u32 m0, s70, 36864
    s_nop 0
    buffer_load_dwordx4 v17, s[12:15], s72 offen lds
    s_add_u32 m0, s70, 37888
    s_nop 0
    buffer_load_dwordx4 v18, s[12:15], s72 offen lds
    s_add_u32 m0, s70, 38912
    s_nop 0
    buffer_load_dwordx4 v19, s[12:15], s72 offen lds
    s_add_u32 m0, s70, 39936
    s_nop 0
    buffer_load_dwordx4 v20, s[12:15], s72 offen lds
    s_add_u32 s72, s72, 40960
    s_waitcnt vmcnt(35)
    ds_read_b64_tr_b16 a[0:1], v12 offset:0
    ds_read_b64_tr_b16 a[2:3], v12 offset:2560
    ds_read_b64_tr_b16 a[4:5], v12 offset:32
    ds_read_b64_tr_b16 a[6:7], v12 offset:2592
    ds_read_b64_tr_b16 a[8:9], v12 offset:64
    ds_read_b64_tr_b16 a[10:11], v12 offset:2624
    ds_read_b64_tr_b16 a[12:13], v12 offset:96
    ds_read_b64_tr_b16 a[14:15], v12 offset:2656
    ds_read_b64_tr_b16 a[16:17], v12 offset:128
    ds_read_b64_tr_b16 a[18:19], v12 offset:2688
    s_waitcnt lgkmcnt(0)
    s_add_u32 m0, s70, 0
    s_nop 0
    buffer_load_dwordx4 v16, s[12:15], s72 offen lds
    s_add_u32 m0, s70, 1024
    s_nop 0
    buffer_load_dwordx4 v17, s[12:15], s72 offen lds
    s_add_u32 m0, s70, 2048
    s_nop 0
    buffer_load_dwordx4 v18, s[12:15], s72 offen lds
    s_add_u32 m0, s70, 3072
    s_nop 0
    buffer_load_dwordx4 v19, s[12:15], s72 offen lds
    s_add_u32 m0, s70, 4096
    s_nop 0
    buffer_load_dwordx4 v20, s[12:15], s72 offen lds
    s_add_u32 s72, s72, 40960
    s_waitcnt vmcnt(35)
    ds_read_b64_tr_b16 a[20:21], v12 offset:5120
    ds_read_b64_tr_b16 a[22:23], v12 offset:7680
    ds_read_b64_tr_b16 a[24:25], v12 offset:5152
    ds_read_b64_tr_b16 a[26:27], v12 offset:7712
    ds_read_b64_tr_b16 a[28:29], v12 offset:5184
    ds_read_b64_tr_b16 a[30:31], v12 offset:7744
    ds_read_b64_tr_b16 a[32:33], v12 offset:5216
    ds_read_b64_tr_b16 a[34:35], v12 offset:7776
    ds_read_b64_tr_b16 a[36:37], v12 offset:5248
    ds_read_b64_tr_b16 a[38:39], v12 offset:7808
    s_waitcnt lgkmcnt(0)
    s_add_u32 m0, s70, 5120
    s_nop 0
    buffer_load_dwordx4 v16, s[12:15], s72 offen lds
    s_add_u32 m0, s70, 6144
    s_nop 0
    buffer_load_dwordx4 v17, s[12:15], s72 offen lds
    s_add_u32 m0, s70, 7168
    s_nop 0
    buffer_load_dwordx4 v18, s[12:15], s72 offen lds
    s_add_u32 m0, s70, 8192
    s_nop 0
    buffer_load_dwordx4 v19, s[12:15], s72 offen lds
    s_add_u32 m0, s70, 9216
    s_nop 0
    buffer_load_dwordx4 v20, s[12:15], s72 offen lds
    s_add_u32 s72, s72, 40960
    s_waitcnt vmcnt(35)
    ds_read_b64_tr_b16 a[40:41], v12 offset:10240
    ds_read_b64_tr_b16 a[42:43], v12 offset:12800
    ds_read_b64_tr_b16 a[44:45], v12 offset:10272
    ds_read_b64_tr_b16 a[46:47], v12 offset:12832
    ds_read_b64_tr_b16 a[48:49], v12 offset:10304
    ds_read_b64_tr_b16 a[50:51], v12 offset:12864
    ds_read_b64_tr_b16 a[52:53], v12 offset:10336
    ds_read_b64_tr_b16 a[54:55], v12 offset:12896
    ds_read_b64_tr_b16 a[56:57], v12 offset:10368
    ds_read_b64_tr_b16 a[58:59], v12 offset:12928
    s_waitcnt lgkmcnt(0)
    s_add_u32 m0, s70, 10240
    s_nop 0
    buffer_load_dwordx4 v16, s[12:15], s72 offen lds
    s_add_u32 m0, s70, 11264
    s_nop 0
    buffer_load_dwordx4 v17, s[12:15], s72 offen lds
    s_add_u32 m0, s70, 12288
    s_nop 0
    buffer_load_dwordx4 v18, s[12:15], s72 offen lds
    s_add_u32 m0, s70, 13312
    s_nop 0
    buffer_load_dwordx4 v19, s[12:15], s72 offen lds
    s_add_u32 m0, s70, 14336
    s_nop 0
    buffer_load_dwordx4 v20, s[12:15], s72 offen lds
    s_add_u32 s72, s72, 40960
    s_waitcnt vmcnt(35)
    ds_read_b64_tr_b16 a[60:61], v12 offset:15360
    ds_read_b64_tr_b16 a[62:63], v12 offset:17920
    ds_read_b64_tr_b16 a[64:65], v12 offset:15392
    ds_read_b64_tr_b16 a[66:67], v12 offset:17952
    ds_read_b64_tr_b16 a[68:69], v12 offset:15424
    ds_read_b64_tr_b16 a[70:71], v12 offset:17984
    ds_read_b64_tr_b16 a[72:73], v12 offset:15456
    ds_read_b64_tr_b16 a[74:75], v12 offset:18016
    ds_read_b64_tr_b16 a[76:77], v12 offset:15488
    ds_read_b64_tr_b16 a[78:79], v12 offset:18048
    s_waitcnt lgkmcnt(0)
    s_add_u32 m0, s70, 15360
    s_nop 0
    buffer_load_dwordx4 v16, s[12:15], s72 offen lds
    s_add_u32 m0, s70, 16384
    s_nop 0
    buffer_load_dwordx4 v17, s[12:15], s72 offen lds
    s_add_u32 m0, s70, 17408
    s_nop 0
    buffer_load_dwordx4 v18, s[12:15], s72 offen lds
    s_add_u32 m0, s70, 18432
    s_nop 0
    buffer_load_dwordx4 v19, s[12:15], s72 offen lds
    s_add_u32 m0, s70, 19456
    s_nop 0
    buffer_load_dwordx4 v20, s[12:15], s72 offen lds
    s_add_u32 s72, s72, 40960
    s_waitcnt vmcnt(35)
    ds_read_b64_tr_b16 a[80:81], v12 offset:20480
    ds_read_b64_tr_b16 a[82:83], v12 offset:23040
    ds_read_b64_tr_b16 a[84:85], v12 offset:20512
    ds_read_b64_tr_b16 a[86:87], v12 offset:23072
    ds_read_b64_tr_b16 a[88:89], v12 offset:20544
    ds_read_b64_tr_b16 a[90:91], v12 offset:23104
    ds_read_b64_tr_b16 a[92:93], v12 offset:20576
    ds_read_b64_tr_b16 a[94:95], v12 offset:23136
    ds_read_b64_tr_b16 a[96:97], v12 offset:20608
    ds_read_b64_tr_b16 a[98:99], v12 offset:23168
    s_waitcnt lgkmcnt(0)
    s_waitcnt vmcnt(30)
    ds_read_b64_tr_b16 a[100:101], v12 offset:25600
    ds_read_b64_tr_b16 a[102:103], v12 offset:28160
    ds_read_b64_tr_b16 a[104:105], v12 offset:25632
    ds_read_b64_tr_b16 a[106:107], v12 offset:28192
    ds_read_b64_tr_b16 a[108:109], v12 offset:25664
    ds_read_b64_tr_b16 a[110:111], v12 offset:28224
    ds_read_b64_tr_b16 a[112:113], v12 offset:25696
    ds_read_b64_tr_b16 a[114:115], v12 offset:28256
    ds_read_b64_tr_b16 a[116:117], v12 offset:25728
    ds_read_b64_tr_b16 a[118:119], v12 offset:28288
    s_waitcnt lgkmcnt(0)
    s_waitcnt vmcnt(25)
    ds_read_b64_tr_b16 a[120:121], v12 offset:30720
    ds_read_b64_tr_b16 a[122:123], v12 offset:33280
    ds_read_b64_tr_b16 a[124:125], v12 offset:30752
    ds_read_b64_tr_b16 a[126:127], v12 offset:33312
    ds_read_b64_tr_b16 a[128:129], v12 offset:30784
    ds_read_b64_tr_b16 a[130:131], v12 offset:33344
    ds_read_b64_tr_b16 a[132:133], v12 offset:30816
    ds_read_b64_tr_b16 a[134:135], v12 offset:33376
    ds_read_b64_tr_b16 a[136:137], v12 offset:30848
    ds_read_b64_tr_b16 a[138:139], v12 offset:33408
    s_waitcnt lgkmcnt(0)
    s_waitcnt vmcnt(20)
    ds_read_b64_tr_b16 a[140:141], v12 offset:35840
    ds_read_b64_tr_b16 a[142:143], v12 offset:38400
    ds_read_b64_tr_b16 a[144:145], v12 offset:35872
    ds_read_b64_tr_b16 a[146:147], v12 offset:38432
    ds_read_b64_tr_b16 a[148:149], v12 offset:35904
    ds_read_b64_tr_b16 a[150:151], v12 offset:38464
    ds_read_b64_tr_b16 a[152:153], v12 offset:35936
    ds_read_b64_tr_b16 a[154:155], v12 offset:38496
    ds_read_b64_tr_b16 a[156:157], v12 offset:35968
    ds_read_b64_tr_b16 a[158:159], v12 offset:38528
    s_waitcnt lgkmcnt(0)
    s_waitcnt vmcnt(15)
    ds_read_b64_tr_b16 a[160:161], v12 offset:0
    ds_read_b64_tr_b16 a[162:163], v12 offset:2560
    ds_read_b64_tr_b16 a[164:165], v12 offset:32
    ds_read_b64_tr_b16 a[166:167], v12 offset:2592
    ds_read_b64_tr_b16 a[168:169], v12 offset:64
    ds_read_b64_tr_b16 a[170:171], v12 offset:2624
    ds_read_b64_tr_b16 a[172:173], v12 offset:96
    ds_read_b64_tr_b16 a[174:175], v12 offset:2656
    ds_read_b64_tr_b16 a[176:177], v12 offset:128
    ds_read_b64_tr_b16 a[178:179], v12 offset:2688
    s_waitcnt lgkmcnt(0)
    s_waitcnt vmcnt(10)
    ds_read_b64_tr_b16 a[180:181], v12 offset:5120
    ds_read_b64_tr_b16 a[182:183], v12 offset:7680
    ds_read_b64_tr_b16 a[184:185], v12 offset:5152
    ds_read_b64_tr_b16 a[186:187], v12 offset:7712
    ds_read_b64_tr_b16 a[188:189], v12 offset:5184
    ds_read_b64_tr_b16 a[190:191], v12 offset:7744
    ds_read_b64_tr_b16 a[192:193], v12 offset:5216
    ds_read_b64_tr_b16 a[194:195], v12 offset:7776
    ds_read_b64_tr_b16 a[196:197], v12 offset:5248
    ds_read_b64_tr_b16 a[198:199], v12 offset:7808
    s_waitcnt lgkmcnt(0)
    s_waitcnt vmcnt(5)
    ds_read_b64_tr_b16 a[200:201], v12 offset:10240
    ds_read_b64_tr_b16 a[202:203], v12 offset:12800
    ds_read_b64_tr_b16 a[204:205], v12 offset:10272
    ds_read_b64_tr_b16 a[206:207], v12 offset:12832
    ds_read_b64_tr_b16 a[208:209], v12 offset:10304
    ds_read_b64_tr_b16 a[210:211], v12 offset:12864
    ds_read_b64_tr_b16 a[212:213], v12 offset:10336
    ds_read_b64_tr_b16 a[214:215], v12 offset:12896
    ds_read_b64_tr_b16 a[216:217], v12 offset:10368
    ds_read_b64_tr_b16 a[218:219], v12 offset:12928
    s_waitcnt lgkmcnt(0)
    s_waitcnt vmcnt(0)
    ds_read_b64_tr_b16 a[220:221], v12 offset:15360
    ds_read_b64_tr_b16 a[222:223], v12 offset:17920
    ds_read_b64_tr_b16 a[224:225], v12 offset:15392
    ds_read_b64_tr_b16 a[226:227], v12 offset:17952
    ds_read_b64_tr_b16 a[228:229], v12 offset:15424
    ds_read_b64_tr_b16 a[230:231], v12 offset:17984
    ds_read_b64_tr_b16 a[232:233], v12 offset:15456
    ds_read_b64_tr_b16 a[234:235], v12 offset:18016
    ds_read_b64_tr_b16 a[236:237], v12 offset:15488
    ds_read_b64_tr_b16 a[238:239], v12 offset:18048
    s_waitcnt lgkmcnt(0)
    s_mov_b32 s96, 2000000
    v_mov_b32 v5, 252
L_aw_80:
    buffer_load_dword v4, v5, s[8:11], 0 offen sc1
    s_sub_u32 s96, s96, 1
    s_cbranch_scc1 L_fail
    s_waitcnt vmcnt(0)
    v_cmp_eq_u32 vcc, 0, v4
    s_cbranch_vccz L_aw_80_d
    s_sleep 16
    s_branch L_aw_80
L_aw_80_d:
    v_readfirstlane_b32 s61, v4
    s_nop 3
    s_and_b32 s60, s61, 8192
    s_and_b32 s3, s61, 2
    s_barrier
    v_lshlrev_b32 v13, 4, v1
    v_lshlrev_b32 v10, 3, v1
    s_mul_i32 s70, s53, 10240
    v_add_u32 v14, s70, v13
    s_lshl_b32 s70, s53, 10
    v_add_u32 v9, s70, v13
    v_min_u32 v4, 11, v1
    s_mul_i32 s56, s53, 12
    s_add_u32 s56, s56, 147744
    v_add_lshl_u32 v15, v4, s56, 7
    s_mul_i32 s72, s53, 24576
    s_add_u32 s72, s72, 34603008
    s_mul_i32 s67, s54, 5120
    s_lshl_b32 s56, s53, 9
    s_add_u32 s67, s67, s56
    s_add_u32 s67, s67, 26214400
    s_mov_b32 s55, 0
    s_mov_b32 s73, 1
    s_mov_b32 s96, 2000000
L_wf_81:
    buffer_load_dword v4, v15, s[4:7], 0 offen sc1
    s_sub_u32 s96, s96, 1
    s_cbranch_scc1 L_fail
    s_waitcnt vmcnt(0)
    v_cmp_gt_u32 vcc, s73, v4
    s_cbranch_vccz L_wf_81_d
    s_sleep 4
    s_branch L_wf_81
L_wf_81_d:
    s_add_u32 s75, s72, 0
    buffer_load_dwordx4 v[64:67], v13, s[4:7], s75 offen offset:0 sc1
    s_add_u32 s75, s72, 0
    buffer_load_dwordx4 v[68:71], v13, s[4:7], s75 offen offset:1024 sc1
    s_add_u32 s75, s72, 0
    buffer_load_dwordx4 v[72:75], v13, s[4:7], s75 offen offset:2048 sc1
    s_add_u32 s75, s72, 0
    buffer_load_dwordx4 v[76:79], v13, s[4:7], s75 offen offset:3072 sc1
    s_add_u32 s75, s72, 4096
    buffer_load_dwordx4 v[80:83], v13, s[4:7], s75 offen offset:0 sc1
    s_add_u32 s75, s72, 4096
    buffer_load_dwordx4 v[84:87], v13, s[4:7], s75 offen offset:1024 sc1
    s_add_u32 s75, s72, 4096
    buffer_load_dwordx4 v[88:91], v13, s[4:7], s75 offen offset:2048 sc1
    s_add_u32 s75, s72, 4096
    buffer_load_dwordx4 v[92:95], v13, s[4:7], s75 offen offset:3072 sc1
    s_add_u32 s75, s72, 8192
    buffer_load_dwordx4 v[96:99], v13, s[4:7], s75 offen offset:0 sc1
    s_add_u32 s75, s72, 8192
    buffer_load_dwordx4 v[100:103], v13, s[4:7], s75 offen offset:1024 sc1
    s_add_u32 s75, s72, 8192
    buffer_load_dwordx4 v[104:107], v13, s[4:7], s75 offen offset:2048 sc1
    s_add_u32 s75, s72, 8192
    buffer_load_dwordx4 v[108:111], v13, s[4:7], s75 offen offset:3072 sc1
    s_add_u32 s75, s72, 12288
    buffer_load_dwordx4 v[112:115], v13, s[4:7], s75 offen offset:0 sc1
    s_add_u32 s75, s72, 12288
    buffer_load_dwordx4 v[116:119], v13, s[4:7], s75 offen offset:1024 sc1
    s_add_u32 s75, s72, 12288
    buffer_load_dwordx4 v[120:123], v13, s[4:7], s75 offen offset:2048 sc1
    s_add_u32 s75, s72, 12288
    buffer_load_dwordx4 v[124:127], v13, s[4:7], s75 offen offset:3072 sc1
    s_add_u32 s75, s72, 16384
    buffer_load_dwordx4 v[128:131], v13, s[4:7], s75 offen offset:0 sc1
    s_add_u32 s75, s72, 16384
    buffer_load_dwordx4 v[132:135], v13, s[4:7], s75 offen offset:1024 sc1
    s_add_u32 s75, s72, 16384
    buffer_load_dwordx4 v[136:139], v13, s[4:7], s75 offen offset:2048 sc1
    s_add_u32 s75, s72, 16384
    buffer_load_dwordx4 v[140:143], v13, s[4:7], s75 offen offset:3072 sc1
    s_add_u32 s75, s72, 20480
    buffer_load_dwordx4 v[144:147], v13, s[4:7], s75 offen offset:0 sc1
    s_add_u32 s75, s72, 20480
    buffer_load_dwordx4 v[148:151], v13, s[4:7], s75 offen offset:1024 sc1
    s_add_u32 s75, s72, 20480
    buffer_load_dwordx4 v[152:155], v13, s[4:7], s75 offen offset:2048 sc1
    s_add_u32 s75, s72, 20480
    buffer_load_dwordx4 v[156:159], v13, s[4:7], s75 offen offset:3072 sc1
    s_add_u32 s72, s72, 98304
    v_mov_b32 v22, 0
    s_waitcnt vmcnt(0)
L_fd_loop:
    s_add_u32 s73, s55, 2
    s_min_u32 s73, s73, 64
    s_waitcnt vmcnt(2)
    v_cmp_gt_u32 vcc, s73, v22
    s_cbranch_vccz L_fd_ok_82
    s_mov_b32 s96, 2000000
L_wf_83:
    buffer_load_dword v4, v15, s[4:7], 0 offen sc1
    s_sub_u32 s96, s96, 1
    s_cbranch_scc1 L_fail
    s_waitcnt vmcnt(0)
    v_cmp_gt_u32 vcc, s73, v4
    s_cbranch_vccz L_wf_83_d
    s_sleep 4
    s_branch L_wf_83
L_wf_83_d:
L_fd_ok_82:
    v_mfma_f32_16x16x32_bf16 v[24:27], a[0:3], v[64:67], 0
    v_mfma_f32_16x16x32_bf16 v[28:31], a[0:3], v[68:71], 0
    s_add_u32 s75, s72, 0
    buffer_load_dwordx4 v[160:163], v13, s[4:7], s75 offen offset:0 sc1
    v_mfma_f32_16x16x32_bf16 v[32:35], a[4:7], v[64:67], 0
    v_mfma_f32_16x16x32_bf16 v[36:39], a[4:7], v[68:71], 0
    v_mfma_f32_16x16x32_bf16 v[40:43], a[8:11], v[64:67], 0
    v_mfma_f32_16x16x32_bf16 v[44:47], a[8:11], v[68:71], 0
    s_add_u32 s75, s72, 0
    buffer_load_dwordx4 v[164:167], v13, s[4:7], s75 offen offset:1024 sc1
    v_mfma_f32_16x16x32_bf16 v[48:51], a[12:15], v[64:67], 0
    v_mfma_f32_16x16x32_bf16 v[52:55], a[12:15], v[68:71], 0
    v_mfma_f32_16x16x32_bf16 v[56:59], a[16:19], v[64:67], 0
    v_mfma_f32_16x16x32_bf16 v[60:63], a[16:19], v[68:71], 0
    s_add_u32 s75, s72, 0
    buffer_load_dwordx4 v[168:171], v13, s[4:7], s75 offen offset:2048 sc1
    v_mfma_f32_16x16x32_bf16 v[24:27], a[20:23], v[72:75], v[24:27]
    v_mfma_f32_16x16x32_bf16 v[28:31], a[20:23], v[76:79], v[28:31]
    v_mfma_f32_16x16x32_bf16 v[32:35], a[24:27], v[72:75], v[32:35]
    v_mfma_f32_16x16x32_bf16 v[36:39], a[24:27], v[76:79], v[36:39]
    s_add_u32 s75, s72, 0
    buffer_load_dwordx4 v[172:175], v13, s[4:7], s75 offen offset:3072 sc1
    v_mfma_f32_16x16x32_bf16 v[40:43], a[28:31], v[72:75], v[40:43]
    v_mfma_f32_16x16x32_bf16 v[44:47], a[28:31], v[76:79], v[44:47]
    v_mfma_f32_16x16x32_bf16 v[48:51], a[32:35], v[72:75], v[48:51]
    v_mfma_f32_16x16x32_bf16 v[52:55], a[32:35], v[76:79], v[52:55]
    s_add_u32 s75, s72, 4096
    buffer_load_dwordx4 v[176:179], v13, s[4:7], s75 offen offset:0 sc1
    v_mfma_f32_16x16x32_bf16 v[56:59], a[36:39], v[72:75], v[56:59]
    v_mfma_f32_16x16x32_bf16 v[60:63], a[36:39], v[76:79], v[60:63]
    v_mfma_f32_16x16x32_bf16 v[24:27], a[40:43], v[80:83], v[24:27]
    v_mfma_f32_16x16x32_bf16 v[28:31], a[40:43], v[84:87], v[28:31]
    s_add_u32 s75, s72, 4096
    buffer_load_dwordx4 v[180:183], v13, s[4:7], s75 offen offset:1024 sc1
    v_mfma_f32_16x16x32_bf16 v[32:35], a[44:47], v[80:83], v[32:35]
    v_mfma_f32_16x16x32_bf16 v[36:39], a[44:47], v[84:87], v[36:39]
    v_mfma_f32_16x16x32_bf16 v[40:43], a[48:51], v[80:83], v[40:43]
    v_mfma_f32_16x16x32_bf16 v[44:47], a[48:51], v[84:87], v[44:47]
    s_add_u32 s75, s72, 4096
    buffer_load_dwordx4 v[184:187], v13, s[4:7], s75 offen offset:2048 sc1
    v_mfma_f32_16x16x32_bf16 v[48:51], a[52:55], v[80:83], v[48:51]
    v_mfma_f32_16x16x32_bf16 v[52:55], a[52:55], v[84:87], v[52:55]
    v_mfma_f32_16x16x32_bf16 v[56:59], a[56:59], v[80:83], v[56:59]
    v_mfma_f32_16x16x32_bf16 v[60:63], a[56:59], v[84:87], v[60:63]
    s_add_u32 s75, s72, 4096
    buffer_load_dwordx4 v[188:191], v13, s[4:7], s75 offen offset:3072 sc1
    v_mfma_f32_16x16x32_bf16 v[24:27], a[60:63], v[88:91], v[24:27]
    v_mfma_f32_16x16x32_bf16 v[28:31], a[60:63], v[92:95], v[28:31]
    v_mfma_f32_16x16x32_bf16 v[32:35], a[64:67], v[88:91], v[32:35]
    v_mfma_f32_16x16x32_bf16 v[36:39], a[64:67], v[92:95], v[36:39]
    s_add_u32 s75, s72, 8192
    buffer_load_dwordx4 v[192:195], v13, s[4:7], s75 offen offset:0 sc1
    v_mfma_f32_16x16x32_bf16 v[40:43], a[68:71], v[88:91], v[40:43]
    v_mfma_f32_16x16x32_bf16 v[44:47], a[68:71], v[92:95], v[44:47]
    v_mfma_f32_16x16x32_bf16 v[48:51], a[72:75], v[88:91], v[48:51]
    v_mfma_f32_16x16x32_bf16 v[52:55], a[72:75], v[92:95], v[52:55]
    s_add_u32 s75, s72, 8192
    buffer_load_dwordx4 v[196:199], v13, s[4:7], s75 offen offset:1024 sc1
    v_mfma_f32_16x16x32_bf16 v[56:59], a[76:79], v[88:91], v[56:59]
    v_mfma_f32_16x16x32_bf16 v[60:63], a[76:79], v[92:95], v[60:63]
    v_mfma_f32_16x16x32_bf16 v[24:27], a[80:83], v[96:99], v[24:27]
    v_mfma_f32_16x16x32_bf16 v[28:31], a[80:83], v[100:103], v[28:31]
    s_add_u32 s75, s72, 8192
    buffer_load_dwordx4 v[200:203], v13, s[4:7], s75 offen offset:2048 sc1
    v_mfma_f32_16x16x32_bf16 v[32:35], a[84:87], v[96:99], v[32:35]
    v_mfma_f32_16x16x32_bf16 v[36:39], a[84:87], v[100:103], v[36:39]
    v_mfma_f32_16x16x32_bf16 v[40:43], a[88:91], v[96:99], v[40:43]
    v_mfma_f32_16x16x32_bf16 v[44:47], a[88:91], v[100:103], v[44:47]
    s_add_u32 s75, s72, 8192
    buffer_load_dwordx4 v[204:207], v13, s[4:7], s75 offen offset:3072 sc1
    v_mfma_f32_16x16x32_bf16 v[48:51], a[92:95], v[96:99], v[48:51]
    v_mfma_f32_16x16x32_bf16 v[52:55], a[92:95], v[100:103], v[52:55]
    v_mfma_f32_16x16x32_bf16 v[56:59], a[96:99], v[96:99], v[56:59]
    v_mfma_f32_16x16x32_bf16 v[60:63], a[96:99], v[100:103], v[60:63]
    s_add_u32 s75, s72, 12288
    buffer_load_dwordx4 v[208:211], v13, s[4:7], s75 offen offset:0 sc1
    v_mfma_f32_16x16x32_bf16 v[24:27], a[100:103], v[104:107], v[24:27]
    v_mfma_f32_16x16x32_bf16 v[28:31], a[100:103], v[108:111], v[28:31]
    v_mfma_f32_16x16x32_bf16 v[32:35], a[104:107], v[104:107], v[32:35]
    v_mfma_f32_16x16x32_bf16 v[36:39], a[104:107], v[108:111], v[36:39]
    s_add_u32 s75, s72, 12288
    buffer_load_dwordx4 v[212:215], v13, s[4:7], s75 offen offset:1024 sc1
    v_mfma_f32_16x16x32_bf16 v[40:43], a[108:111], v[104:107], v[40:43]
    v_mfma_f32_16x16x32_bf16 v[44:47], a[108:111], v[108:111], v[44:47]
    v_mfma_f32_16x16x32_bf16 v[48:51], a[112:115], v[104:107], v[48:51]
    v_mfma_f32_16x16x32_bf16 v[52:55], a[112:115], v[108:111], v[52:55]
    s_add_u32 s75, s72, 12288
    buffer_load_dwordx4 v[216:219], v13, s[4:7], s75 offen offset:2048 sc1
    v_mfma_f32_16x16x32_bf16 v[56:59], a[116:119], v[104:107], v[56:59]
    v_mfma_f32_16x16x32_bf16 v[60:63], a[116:119], v[108:111], v[60:63]
    v_mfma_f32_16x16x32_bf16 v[24:27], a[120:123], v[112:115], v[24:27]
    v_mfma_f32_16x16x32_bf16 v[28:31], a[120:123], v[116:119], v[28:31]
    s_add_u32 s75, s72, 12288
    buffer_load_dwordx4 v[220:223], v13, s[4:7], s75 offen offset:3072 sc1
    v_mfma_f32_16x16x32_bf16 v[32:35], a[124:127], v[112:115], v[32:35]
    s_waitcnt vmcnt(16)
    v_mov_b32 v4, s55
    buffer_store_dword v4, v8, s[4:7], s66 offen sc1
    v_mfma_f32_16x16x32_bf16 v[36:39], a[124:127], v[116:119], v[36:39]
    v_mfma_f32_16x16x32_bf16 v[40:43], a[128:131], v[112:115], v[40:43]
    v_mfma_f32_16x16x32_bf16 v[44:47], a[128:131], v[116:119], v[44:47]
    s_add_u32 s75, s72, 16384
    buffer_load_dwordx4 v[224:227], v13, s[4:7], s75 offen offset:0 sc1
    v_mfma_f32_16x16x32_bf16 v[48:51], a[132:135], v[112:115], v[48:51]
    v_mfma_f32_16x16x32_bf16 v[52:55], a[132:135], v[116:119], v[52:55]
    v_mfma_f32_16x16x32_bf16 v[56:59], a[136:139], v[112:115], v[56:59]
    v_mfma_f32_16x16x32_bf16 v[60:63], a[136:139], v[116:119], v[60:63]
    s_add_u32 s75, s72, 16384
    buffer_load_dwordx4 v[228:231], v13, s[4:7], s75 offen offset:1024 sc1
    v_mfma_f32_16x16x32_bf16 v[24:27], a[140:143], v[120:123], v[24:27]
    v_mfma_f32_16x16x32_bf16 v[28:31], a[140:143], v[124:127], v[28:31]
    v_mfma_f32_16x16x32_bf16 v[32:35], a[144:147], v[120:123], v[32:35]
    v_mfma_f32_16x16x32_bf16 v[36:39], a[144:147], v[124:127], v[36:39]
    s_add_u32 s75, s72, 16384
    buffer_load_dwordx4 v[232:235], v13, s[4:7], s75 offen offset:2048 sc1
    v_mfma_f32_16x16x32_bf16 v[40:43], a[148:151], v[120:123], v[40:43]
    v_mfma_f32_16x16x32_bf16 v[44:47], a[148:151], v[124:127], v[44:47]
    v_mfma_f32_16x16x32_bf16 v[48:51], a[152:155], v[120:123], v[48:51]
    v_mfma_f32_16x16x32_bf16 v[52:55], a[152:155], v[124:127], v[52:55]
    s_add_u32 s75, s72, 16384
    buffer_load_dwordx4 v[236:239], v13, s[4:7], s75 offen offset:3072 sc1
    v_mfma_f32_16x16x32_bf16 v[56:59], a[156:159], v[120:123], v[56:59]
    v_mfma_f32_16x16x32_bf16 v[60:63], a[156:159], v[124:127], v[60:63]
    v_mfma_f32_16x16x32_bf16 v[24:27], a[160:163], v[128:131], v[24:27]
    v_mfma_f32_16x16x32_bf16 v[28:31], a[160:163], v[132:135], v[28:31]
    s_add_u32 s75, s72, 20480
    buffer_load_dwordx4 v[240:243], v13, s[4:7], s75 offen offset:0 sc1
    v_mfma_f32_16x16x32_bf16 v[32:35], a[164:167], v[128:131], v[32:35]
    v_mfma_f32_16x16x32_bf16 v[36:39], a[164:167], v[132:135], v[36:39]
    v_mfma_f32_16x16x32_bf16 v[40:43], a[168:171], v[128:131], v[40:43]
    v_mfma_f32_16x16x32_bf16 v[44:47], a[168:171], v[132:135], v[44:47]
    s_add_u32 s75, s72, 20480
    buffer_load_dwordx4 v[244:247], v13, s[4:7], s75 offen offset:1024 sc1
    v_mfma_f32_16x16x32_bf16 v[48:51], a[172:175], v[128:131], v[48:51]
    v_mfma_f32_16x16x32_bf16 v[52:55], a[172:175], v[132:135], v[52:55]
    v_mfma_f32_16x16x32_bf16 v[56:59], a[176:179], v[128:131], v[56:59]
    v_mfma_f32_16x16x32_bf16 v[60:63], a[176:179], v[132:135], v[60:63]
    s_add_u32 s75, s72, 20480
    buffer_load_dwordx4 v[248:251], v13, s[4:7], s75 offen offset:2048 sc1
    v_mfma_f32_16x16x32_bf16 v[24:27], a[180:183], v[136:139], v[24:27]
    v_mfma_f32_16x16x32_bf16 v[28:31], a[180:183], v[140:143], v[28:31]
    v_mfma_f32_16x16x32_bf16 v[32:35], a[184:187], v[136:139], v[32:35]
    v_mfma_f32_16x16x32_bf16 v[36:39], a[184:187], v[140:143], v[36:39]
    s_add_u32 s75, s72, 20480
    buffer_load_dwordx4 v[252:255], v13, s[4:7], s75 offen offset:3072 sc1
    v_mfma_f32_16x16x32_bf16 v[40:43], a[188:191], v[136:139], v[40:43]
    v_mfma_f32_16x16x32_bf16 v[44:47], a[188:191], v[140:143], v[44:47]
    v_mfma_f32_16x16x32_bf16 v[48:51], a[192:195], v[136:139], v[48:51]
    v_mfma_f32_16x16x32_bf16 v[52:55], a[192:195], v[140:143], v[52:55]
    v_mfma_f32_16x16x32_bf16 v[56:59], a[196:199], v[136:139], v[56:59]
    v_mfma_f32_16x16x32_bf16 v[60:63], a[196:199], v[140:143], v[60:63]
    v_mfma_f32_16x16x32_bf16 v[24:27], a[200:203], v[144:147], v[24:27]
    v_mfma_f32_16x16x32_bf16 v[28:31], a[200:203], v[148:151], v[28:31]
    v_mfma_f32_16x16x32_bf16 v[32:35], a[204:207], v[144:147], v[32:35]
    v_mfma_f32_16x16x32_bf16 v[36:39], a[204:207], v[148:151], v[36:39]
    v_mfma_f32_16x16x32_bf16 v[40:43], a[208:211], v[144:147], v[40:43]
    v_mfma_f32_16x16x32_bf16 v[44:47], a[208:211], v[148:151], v[44:47]
    v_mfma_f32_16x16x32_bf16 v[48:51], a[212:215], v[144:147], v[48:51]
    v_mfma_f32_16x16x32_bf16 v[52:55], a[212:215], v[148:151], v[52:55]
    v_mfma_f32_16x16x32_bf16 v[56:59], a[216:219], v[144:147], v[56:59]
    v_mfma_f32_16x16x32_bf16 v[60:63], a[216:219], v[148:151], v[60:63]
    v_mfma_f32_16x16x32_bf16 v[24:27], a[220:223], v[152:155], v[24:27]
    buffer_load_dword v22, v15, s[4:7], 0 offen sc1
    v_mfma_f32_16x16x32_bf16 v[28:31], a[220:223], v[156:159], v[28:31]
    v_mfma_f32_16x16x32_bf16 v[32:35], a[224:227], v[152:155], v[32:35]
    v_mfma_f32_16x16x32_bf16 v[36:39], a[224:227], v[156:159], v[36:39]
    v_mfma_f32_16x16x32_bf16 v[40:43], a[228:231], v[152:155], v[40:43]
    v_mfma_f32_16x16x32_bf16 v[44:47], a[228:231], v[156:159], v[44:47]
    v_mfma_f32_16x16x32_bf16 v[48:51], a[232:235], v[152:155], v[48:51]
    v_mfma_f32_16x16x32_bf16 v[52:55], a[232:235], v[156:159], v[52:55]
    v_mfma_f32_16x16x32_bf16 v[56:59], a[236:239], v[152:155], v[56:59]
    v_mfma_f32_16x16x32_bf16 v[60:63], a[236:239], v[156:159], v[60:63]
    s_add_u32 s72, s72, 98304
    s_nop 7
    ds_write_b128 v14, v[24:27] offset:0
    ds_write_b128 v14, v[28:31] offset:1024
    ds_write_b128 v14, v[32:35] offset:2048
    ds_write_b128 v14, v[36:39] offset:3072
    ds_write_b128 v14, v[40:43] offset:4096
    ds_write_b128 v14, v[44:47] offset:5120
    ds_write_b128 v14, v[48:51] offset:6144
    ds_write_b128 v14, v[52:55] offset:7168
    ds_write_b128 v14, v[56:59] offset:8192
    ds_write_b128 v14, v[60:63] offset:9216
    s_waitcnt lgkmcnt(0)
    s_barrier
    ds_read_b128 v[24:27], v9 offset:0
    ds_read_b128 v[28:31], v9 offset:10240
    ds_read_b128 v[32:35], v9 offset:20480
    ds_read_b128 v[36:39], v9 offset:30720
    s_waitcnt lgkmcnt(0)
    v_add_f32 v24, v24, v28
    v_add_f32 v32, v32, v36
    v_add_f32 v24, v24, v32
    v_add_f32 v25, v25, v29
    v_add_f32 v33, v33, v37
    v_add_f32 v25, v25, v33
    v_add_f32 v26, v26, v30
    v_add_f32 v34, v34, v38
    v_add_f32 v26, v26, v34
    v_add_f32 v27, v27, v31
    v_add_f32 v35, v35, v39
    v_add_f32 v27, v27, v35
    v_cvt_pk_bf16_f32 v16, v24, v25
    v_cvt_pk_bf16_f32 v17, v26, v27
    buffer_store_dwordx2 v[16:17], v10, s[4:7], s67 offen offset:0 sc1
    ds_read_b128 v[24:27], v9 offset:4096
    ds_read_b128 v[28:31], v9 offset:14336
    ds_read_b128 v[32:35], v9 offset:24576
    ds_read_b128 v[36:39], v9 offset:34816
    s_waitcnt lgkmcnt(0)
    v_add_f32 v24, v24, v28
    v_add_f32 v32, v32, v36
    v_add_f32 v24, v24, v32
    v_add_f32 v25, v25, v29
    v_add_f32 v33, v33, v37
    v_add_f32 v25, v25, v33
    v_add_f32 v26, v26, v30
    v_add_f32 v34, v34, v38
    v_add_f32 v26, v26, v34
    v_add_f32 v27, v27, v31
    v_add_f32 v35, v35, v39
    v_add_f32 v27, v27, v35
    v_cvt_pk_bf16_f32 v18, v24, v25
    v_cvt_pk_bf16_f32 v19, v26, v27
    buffer_store_dwordx2 v[18:19], v10, s[4:7], s67 offen offset:2048 sc1
    s_cmp_lt_u32 s53, 2
    s_cbranch_scc0 L_fd_skip_84
    ds_read_b128 v[24:27], v9 offset:8192
    ds_read_b128 v[28:31], v9 offset:18432
    ds_read_b128 v[32:35], v9 offset:28672
    ds_read_b128 v[36:39], v9 offset:38912
    s_waitcnt lgkmcnt(0)
    v_add_f32 v24, v24, v28
    v_add_f32 v32, v32, v36
    v_add_f32 v24, v24, v32
    v_add_f32 v25, v25, v29
    v_add_f32 v33, v33, v37
    v_add_f32 v25, v25, v33
    v_add_f32 v26, v26, v30
    v_add_f32 v34, v34, v38
    v_add_f32 v26, v26, v34
    v_add_f32 v27, v27, v31
    v_add_f32 v35, v35, v39
    v_add_f32 v27, v27, v35
    v_cvt_pk_bf16_f32 v20, v24, v25
    v_cvt_pk_bf16_f32 v21, v26, v27
    s_add_u32 s75, s67, 4096
    buffer_store_dwordx2 v[20:21], v10, s[4:7], s75 offen sc1
L_fd_skip_84:
    s_add_u32 s67, s67, 40960
    s_add_u32 s55, s55, 1
    s_add_u32 s73, s55, 2
    s_min_u32 s73, s73, 64
    s_waitcnt vmcnt(2)
    v_cmp_gt_u32 vcc, s73, v22
    s_cbranch_vccz L_fd_ok_85
    s_mov_b32 s96, 2000000
L_wf_86:
    buffer_load_dword v4, v15, s[4:7], 0 offen sc1
    s_sub_u32 s96, s96, 1
    s_cbranch_scc1 L_fail
    s_waitcnt vmcnt(0)
    v_cmp_gt_u32 vcc, s73, v4
    s_cbranch_vccz L_wf_86_d
    s_sleep 4
    s_branch L_wf_86
L_wf_86_d:
L_fd_ok_85:
    v_mfma_f32_16x16x32_bf16 v[24:27], a[0:3], v[160:163], 0
    v_mfma_f32_16x16x32_bf16 v[28:31], a[0:3], v[164:167], 0
    s_add_u32 s75, s72, 0
    buffer_load_dwordx4 v[64:67], v13, s[4:7], s75 offen offset:0 sc1
    v_mfma_f32_16x16x32_bf16 v[32:35], a[4:7], v[160:163], 0
    v_mfma_f32_16x16x32_bf16 v[36:39], a[4:7], v[164:167], 0
    v_mfma_f32_16x16x32_bf16 v[40:43], a[8:11], v[160:163], 0
    v_mfma_f32_16x16x32_bf16 v[44:47], a[8:11], v[164:167], 0
    s_add_u32 s75, s72, 0
    buffer_load_dwordx4 v[68:71], v13, s[4:7], s75 offen offset:1024 sc1
    v_mfma_f32_16x16x32_bf16 v[48:51], a[12:15], v[160:163], 0
    v_mfma_f32_16x16x32_bf16 v[52:55], a[12:15], v[164:167], 0
    v_mfma_f32_16x16x32_bf16 v[56:59], a[16:19], v[160:163], 0
    v_mfma_f32_16x16x32_bf16 v[60:63], a[16:19], v[164:167], 0
    s_add_u32 s75, s72, 0
    buffer_load_dwordx4 v[72:75], v13, s[4:7], s75 offen offset:2048 sc1
    v_mfma_f32_16x16x32_bf16 v[24:27], a[20:23], v[168:171], v[24:27]
    v_mfma_f32_16x16x32_bf16 v[28:31], a[20:23], v[172:175], v[28:31]
    v_mfma_f32_16x16x32_bf16 v[32:35], a[24:27], v[168:171], v[32:35]
    v_mfma_f32_16x16x32_bf16 v[36:39], a[24:27], v[172:175], v[36:39]
    s_add_u32 s75, s72, 0
    buffer_load_dwordx4 v[76:79], v13, s[4:7], s75 offen offset:3072 sc1
    v_mfma_f32_16x16x32_bf16 v[40:43], a[28:31], v[168:171], v[40:43]
    v_mfma_f32_16x16x32_bf16 v[44:47], a[28:31], v[172:175], v[44:47]
    v_mfma_f32_16x16x32_bf16 v[48:51], a[32:35], v[168:171], v[48:51]
    v_mfma_f32_16x16x32_bf16 v[52:55], a[32:35], v[172:175], v[52:55]
    s_add_u32 s75, s72, 4096
    buffer_load_dwordx4 v[80:83], v13, s[4:7], s75 offen offset:0 sc1
    v_mfma_f32_16x16x32_bf16 v[56:59], a[36:39], v[168:171], v[56:59]
    v_mfma_f32_16x16x32_bf16 v[60:63], a[36:39], v[172:175], v[60:63]
    v_mfma_f32_16x16x32_bf16 v[24:27], a[40:43], v[176:179], v[24:27]
    v_mfma_f32_16x16x32_bf16 v[28:31], a[40:43], v[180:183], v[28:31]
    s_add_u32 s75, s72, 4096
    buffer_load_dwordx4 v[84:87], v13, s[4:7], s75 offen offset:1024 sc1
    v_mfma_f32_16x16x32_bf16 v[32:35], a[44:47], v[176:179], v[32:35]
    v_mfma_f32_16x16x32_bf16 v[36:39], a[44:47], v[180:183], v[36:39]
    v_mfma_f32_16x16x32_bf16 v[40:43], a[48:51], v[176:179], v[40:43]
    v_mfma_f32_16x16x32_bf16 v[44:47], a[48:51], v[180:183], v[44:47]
    s_add_u32 s75, s72, 4096
    buffer_load_dwordx4 v[88:91], v13, s[4:7], s75 offen offset:2048 sc1
    v_mfma_f32_16x16x32_bf16 v[48:51], a[52:55], v[176:179], v[48:51]
    v_mfma_f32_16x16x32_bf16 v[52:55], a[52:55], v[180:183], v[52:55]
    v_mfma_f32_16x16x32_bf16 v[56:59], a[56:59], v[176:179], v[56:59]
    v_mfma_f32_16x16x32_bf16 v[60:63], a[56:59], v[180:183], v[60:63]
    s_add_u32 s75, s72, 4096
    buffer_load_dwordx4 v[92:95], v13, s[4:7], s75 offen offset:3072 sc1
    v_mfma_f32_16x16x32_bf16 v[24:27], a[60:63], v[184:187], v[24:27]
    v_mfma_f32_16x16x32_bf16 v[28:31], a[60:63], v[188:191], v[28:31]
    v_mfma_f32_16x16x32_bf16 v[32:35], a[64:67], v[184:187], v[32:35]
    v_mfma_f32_16x16x32_bf16 v[36:39], a[64:67], v[188:191], v[36:39]
    s_add_u32 s75, s72, 8192
    buffer_load_dwordx4 v[96:99], v13, s[4:7], s75 offen offset:0 sc1
    v_mfma_f32_16x16x32_bf16 v[40:43], a[68:71], v[184:187], v[40:43]
    v_mfma_f32_16x16x32_bf16 v[44:47], a[68:71], v[188:191], v[44:47]
    v_mfma_f32_16x16x32_bf16 v[48:51], a[72:75], v[184:187], v[48:51]
    v_mfma_f32_16x16x32_bf16 v[52:55], a[72:75], v[188:191], v[52:55]
    s_add_u32 s75, s72, 8192
    buffer_load_dwordx4 v[100:103], v13, s[4:7], s75 offen offset:1024 sc1
    v_mfma_f32_16x16x32_bf16 v[56:59], a[76:79], v[184:187], v[56:59]
    v_mfma_f32_16x16x32_bf16 v[60:63], a[76:79], v[188:191], v[60:63]
    v_mfma_f32_16x16x32_bf16 v[24:27], a[80:83], v[192:195], v[24:27]
    v_mfma_f32_16x16x32_bf16 v[28:31], a[80:83], v[196:199], v[28:31]
    s_add_u32 s75, s72, 8192
    buffer_load_dwordx4 v[104:107], v13, s[4:7], s75 offen offset:2048 sc1
    v_mfma_f32_16x16x32_bf16 v[32:35], a[84:87], v[192:195], v[32:35]
    v_mfma_f32_16x16x32_bf16 v[36:39], a[84:87], v[196:199], v[36:39]
    v_mfma_f32_16x16x32_bf16 v[40:43], a[88:91], v[192:195], v[40:43]
    v_mfma_f32_16x16x32_bf16 v[44:47], a[88:91], v[196:199], v[44:47]
    s_add_u32 s75, s72, 8192
    buffer_load_dwordx4 v[108:111], v13, s[4:7], s75 offen offset:3072 sc1
    v_mfma_f32_16x16x32_bf16 v[48:51], a[92:95], v[192:195], v[48:51]
    v_mfma_f32_16x16x32_bf16 v[52:55], a[92:95], v[196:199], v[52:55]
    v_mfma_f32_16x16x32_bf16 v[56:59], a[96:99], v[192:195], v[56:59]
    v_mfma_f32_16x16x32_bf16 v[60:63], a[96:99], v[196:199], v[60:63]
    s_add_u32 s75, s72, 12288
    buffer_load_dwordx4 v[112:115], v13, s[4:7], s75 offen offset:0 sc1
    v_mfma_f32_16x16x32_bf16 v[24:27], a[100:103], v[200:203], v[24:27]
    v_mfma_f32_16x16x32_bf16 v[28:31], a[100:103], v[204:207], v[28:31]
    v_mfma_f32_16x16x32_bf16 v[32:35], a[104:107], v[200:203], v[32:35]
    v_mfma_f32_16x16x32_bf16 v[36:39], a[104:107], v[204:207], v[36:39]
    s_add_u32 s75, s72, 12288
    buffer_load_dwordx4 v[116:119], v13, s[4:7], s75 offen offset:1024 sc1
    v_mfma_f32_16x16x32_bf16 v[40:43], a[108:111], v[200:203], v[40:43]
    v_mfma_f32_16x16x32_bf16 v[44:47], a[108:111], v[204:207], v[44:47]
    v_mfma_f32_16x16x32_bf16 v[48:51], a[112:115], v[200:203], v[48:51]
    v_mfma_f32_16x16x32_bf16 v[52:55], a[112:115], v[204:207], v[52:55]
    s_add_u32 s75, s72, 12288
    buffer_load_dwordx4 v[120:123], v13, s[4:7], s75 offen offset:2048 sc1
    v_mfma_f32_16x16x32_bf16 v[56:59], a[116:119], v[200:203], v[56:59]
    v_mfma_f32_16x16x32_bf16 v[60:63], a[116:119], v[204:207], v[60:63]
    v_mfma_f32_16x16x32_bf16 v[24:27], a[120:123], v[208:211], v[24:27]
    v_mfma_f32_16x16x32_bf16 v[28:31], a[120:123], v[212:215], v[28:31]
    s_add_u32 s75, s72, 12288
    buffer_load_dwordx4 v[124:127], v13, s[4:7], s75 offen offset:3072 sc1
    v_mfma_f32_16x16x32_bf16 v[32:35], a[124:127], v[208:211], v[32:35]
    s_waitcnt vmcnt(16)
    v_mov_b32 v4, s55
    buffer_store_dword v4, v8, s[4:7], s66 offen sc1
    v_mfma_f32_16x16x32_bf16 v[36:39], a[124:127], v[212:215], v[36:39]
    v_mfma_f32_16x16x32_bf16 v[40:43], a[128:131], v[208:211], v[40:43]
    v_mfma_f32_16x16x32_bf16 v[44:47], a[128:131], v[212:215], v[44:47]
    s_add_u32 s75, s72, 16384
    buffer_load_dwordx4 v[128:131], v13, s[4:7], s75 offen offset:0 sc1
    v_mfma_f32_16x16x32_bf16 v[48:51], a[132:135], v[208:211], v[48:51]
    v_mfma_f32_16x16x32_bf16 v[52:55], a[132:135], v[212:215], v[52:55]
    v_mfma_f32_16x16x32_bf16 v[56:59], a[136:139], v[208:211], v[56:59]
    v_mfma_f32_16x16x32_bf16 v[60:63], a[136:139], v[212:215], v[60:63]
    s_add_u32 s75, s72, 16384
    buffer_load_dwordx4 v[132:135], v13, s[4:7], s75 offen offset:1024 sc1
    v_mfma_f32_16x16x32_bf16 v[24:27], a[140:143], v[216:219], v[24:27]
    v_mfma_f32_16x16x32_bf16 v[28:31], a[140:143], v[220:223], v[28:31]
    v_mfma_f32_16x16x32_bf16 v[32:35], a[144:147], v[216:219], v[32:35]
    v_mfma_f32_16x16x32_bf16 v[36:39], a[144:147], v[220:223], v[36:39]
    s_add_u32 s75, s72, 16384
    buffer_load_dwordx4 v[136:139], v13, s[4:7], s75 offen offset:2048 sc1
    v_mfma_f32_16x16x32_bf16 v[40:43], a[148:151], v[216:219], v[40:43]
    v_mfma_f32_16x16x32_bf16 v[44:47], a[148:151], v[220:223], v[44:47]
    v_mfma_f32_16x16x32_bf16 v[48:51], a[152:155], v[216:219], v[48:51]
    v_mfma_f32_16x16x32_bf16 v[52:55], a[152:155], v[220:223], v[52:55]
    s_add_u32 s75, s72, 16384
    buffer_load_dwordx4 v[140:143], v13, s[4:7], s75 offen offset:3072 sc1
    v_mfma_f32_16x16x32_bf16 v[56:59], a[156:159], v[216:219], v[56:59]
    v_mfma_f32_16x16x32_bf16 v[60:63], a[156:159], v[220:223], v[60:63]
    v_mfma_f32_16x16x32_bf16 v[24:27], a[160:163], v[224:227], v[24:27]
    v_mfma_f32_16x16x32_bf16 v[28:31], a[160:163], v[228:231], v[28:31]
    s_add_u32 s75, s72, 20480
    buffer_load_dwordx4 v[144:147], v13, s[4:7], s75 offen offset:0 sc1
    v_mfma_f32_16x16x32_bf16 v[32:35], a[164:167], v[224:227], v[32:35]
    v_mfma_f32_16x16x32_bf16 v[36:39], a[164:167], v[228:231], v[36:39]
    v_mfma_f32_16x16x32_bf16 v[40:43], a[168:171], v[224:227], v[40:43]
    v_mfma_f32_16x16x32_bf16 v[44:47], a[168:171], v[228:231], v[44:47]
    s_add_u32 s75, s72, 20480
    buffer_load_dwordx4 v[148:151], v13, s[4:7], s75 offen offset:1024 sc1
    v_mfma_f32_16x16x32_bf16 v[48:51], a[172:175], v[224:227], v[48:51]
    v_mfma_f32_16x16x32_bf16 v[52:55], a[172:175], v[228:231], v[52:55]
    v_mfma_f32_16x16x32_bf16 v[56:59], a[176:179], v[224:227], v[56:59]
    v_mfma_f32_16x16x32_bf16 v[60:63], a[176:179], v[228:231], v[60:63]
    s_add_u32 s75, s72, 20480
    buffer_load_dwordx4 v[152:155], v13, s[4:7], s75 offen offset:2048 sc1
    v_mfma_f32_16x16x32_bf16 v[24:27], a[180:183], v[232:235], v[24:27]
    v_mfma_f32_16x16x32_bf16 v[28:31], a[180:183], v[236:239], v[28:31]
    v_mfma_f32_16x16x32_bf16 v[32:35], a[184:187], v[232:235], v[32:35]
    v_mfma_f32_16x16x32_bf16 v[36:39], a[184:187], v[236:239], v[36:39]
    s_add_u32 s75, s72, 20480
    buffer_load_dwordx4 v[156:159], v13, s[4:7], s75 offen offset:3072 sc1
    v_mfma_f32_16x16x32_bf16 v[40:43], a[188:191], v[232:235], v[40:43]
    v_mfma_f32_16x16x32_bf16 v[44:47], a[188:191], v[236:239], v[44:47]
    v_mfma_f32_16x16x32_bf16 v[48:51], a[192:195], v[232:235], v[48:51]
    v_mfma_f32_16x16x32_bf16 v[52:55], a[192:195], v[236:239], v[52:55]
    v_mfma_f32_16x16x32_bf16 v[56:59], a[196:199], v[232:235], v[56:59]
    v_mfma_f32_16x16x32_bf16 v[60:63], a[196:199], v[236:239], v[60:63]
    v_mfma_f32_16x16x32_bf16 v[24:27], a[200:203], v[240:243], v[24:27]
    v_mfma_f32_16x16x32_bf16 v[28:31], a[200:203], v[244:247], v[28:31]
    v_mfma_f32_16x16x32_bf16 v[32:35], a[204:207], v[240:243], v[32:35]
    v_mfma_f32_16x16x32_bf16 v[36:39], a[204:207], v[244:247], v[36:39]
    v_mfma_f32_16x16x32_bf16 v[40:43], a[208:211], v[240:243], v[40:43]
    v_mfma_f32_16x16x32_bf16 v[44:47], a[208:211], v[244:247], v[44:47]
    v_mfma_f32_16x16x32_bf16 v[48:51], a[212:215], v[240:243], v[48:51]
    v_mfma_f32_16x16x32_bf16 v[52:55], a[212:215], v[244:247], v[52:55]
    v_mfma_f32_16x16x32_bf16 v[56:59], a[216:219], v[240:243], v[56:59]
    v_mfma_f32_16x16x32_bf16 v[60:63], a[216:219], v[244:247], v[60:63]
    v_mfma_f32_16x16x32_bf16 v[24:27], a[220:223], v[248:251], v[24:27]
    buffer_load_dword v22, v15, s[4:7], 0 offen sc1
    v_mfma_f32_16x16x32_bf16 v[28:31], a[220:223], v[252:255], v[28:31]
    v_mfma_f32_16x16x32_bf16 v[32:35], a[224:227], v[248:251], v[32:35]
    v_mfma_f32_16x16x32_bf16 v[36:39], a[224:227], v[252:255], v[36:39]
    v_mfma_f32_16x16x32_bf16 v[40:43], a[228:231], v[248:251], v[40:43]
    v_mfma_f32_16x16x32_bf16 v[44:47], a[228:231], v[252:255], v[44:47]
    v_mfma_f32_16x16x32_bf16 v[48:51], a[232:235], v[248:251], v[48:51]
    v_mfma_f32_16x16x32_bf16 v[52:55], a[232:235], v[252:255], v[52:55]
    v_mfma_f32_16x16x32_bf16 v[56:59], a[236:239], v[248:251], v[56:59]
    v_mfma_f32_16x16x32_bf16 v[60:63], a[236:239], v[252:255], v[60:63]
    s_add_u32 s72, s72, 98304
    s_nop 7
    ds_write_b128 v14, v[24:27] offset:40960
    ds_write_b128 v14, v[28:31] offset:41984
    ds_write_b128 v14, v[32:35] offset:43008
    ds_write_b128 v14, v[36:39] offset:44032
    ds_write_b128 v14, v[40:43] offset:45056
    ds_write_b128 v14, v[44:47] offset:46080
    ds_write_b128 v14, v[48:51] offset:47104
    ds_write_b128 v14, v[52:55] offset:48128
    ds_write_b128 v14, v[56:59] offset:49152
    ds_write_b128 v14, v[60:63] offset:50176
    s_waitcnt lgkmcnt(0)
    s_barrier
    ds_read_b128 v[24:27], v9 offset:40960
    ds_read_b128 v[28:31], v9 offset:51200
    ds_read_b128 v[32:35], v9 offset:61440
    v_add_u32 v11, 71680, v9
    ds_read_b128 v[36:39], v11
    s_waitcnt lgkmcnt(0)
    v_add_f32 v24, v24, v28
    v_add_f32 v32, v32, v36
    v_add_f32 v24, v24, v32
    v_add_f32 v25, v25, v29
    v_add_f32 v33, v33, v37
    v_add_f32 v25, v25, v33
    v_add_f32 v26, v26, v30
    v_add_f32 v34, v34, v38
    v_add_f32 v26, v26, v34
    v_add_f32 v27, v27, v31
    v_add_f32 v35, v35, v39
    v_add_f32 v27, v27, v35
    v_cvt_pk_bf16_f32 v16, v24, v25
    v_cvt_pk_bf16_f32 v17, v26, v27
    buffer_store_dwordx2 v[16:17], v10, s[4:7], s67 offen offset:0 sc1
    ds_read_b128 v[24:27], v9 offset:45056
    ds_read_b128 v[28:31], v9 offset:55296
    v_add_u32 v11, 65536, v9
    ds_read_b128 v[32:35], v11
    v_add_u32 v11, 75776, v9
    ds_read_b128 v[36:39], v11
    s_waitcnt lgkmcnt(0)
    v_add_f32 v24, v24, v28
    v_add_f32 v32, v32, v36
    v_add_f32 v24, v24, v32
    v_add_f32 v25, v25, v29
    v_add_f32 v33, v33, v37
    v_add_f32 v25, v25, v33
    v_add_f32 v26, v26, v30
    v_add_f32 v34, v34, v38
    v_add_f32 v26, v26, v34
    v_add_f32 v27, v27, v31
    v_add_f32 v35, v35, v39
    v_add_f32 v27, v27, v35
    v_cvt_pk_bf16_f32 v18, v24, v25
    v_cvt_pk_bf16_f32 v19, v26, v27
    buffer_store_dwordx2 v[18:19], v10, s[4:7], s67 offen offset:2048 sc1
    s_cmp_lt_u32 s53, 2
    s_cbranch_scc0 L_fd_skip_87
    ds_read_b128 v[24:27], v9 offset:49152
    ds_read_b128 v[28:31], v9 offset:59392
    v_add_u32 v11, 69632, v9
    ds_read_b128 v[32:35], v11
    v_add_u32 v11, 79872, v9
    ds_read_b128 v[36:39], v11
    s_waitcnt lgkmcnt(0)
    v_add_f32 v24, v24, v28
    v_add_f32 v32, v32, v36
    v_add_f32 v24, v24, v32
    v_add_f32 v25, v25, v29
    v_add_f32 v33, v33, v37
    v_add_f32 v25, v25, v33
    v_add_f32 v26, v26, v30
    v_add_f32 v34, v34, v38
    v_add_f32 v26, v26, v34
    v_add_f32 v27, v27, v31
    v_add_f32 v35, v35, v39
    v_add_f32 v27, v27, v35
    v_cvt_pk_bf16_f32 v20, v24, v25
    v_cvt_pk_bf16_f32 v21, v26, v27
    s_add_u32 s75, s67, 4096
    buffer_store_dwordx2 v[20:21], v10, s[4:7], s75 offen sc1
L_fd_skip_87:
    s_add_u32 s67, s67, 40960
    s_add_u32 s55, s55, 1
    s_cmp_lt_u32 s55, 64
    s_cbranch_scc1 L_fd_loop
    s_waitcnt vmcnt(0)
    v_mov_b32 v4, 64
    buffer_store_dword v4, v8, s[4:7], s66 offen sc1
    s_branch L_end
L_roleOT:
    s_sub_u32 s54, s52, 140
    s_lshl_b32 s66, s53, 5
    s_add_u32 s66, s66, s54
    s_lshl_b32 s66, s66, 7
    s_add_u32 s66, s66, 18923520
    v_mov_b32 v8, 0
    v_mov_b32 v4, 0
    buffer_store_dword v4, v8, s[4:7], s66 offen sc1
    s_mov_b32 s12, s34
    s_mov_b32 s13, s35
    s_mov_b32 s14, 7864320
    s_mov_b32 s15, 0x20000
    v_lshlrev_b32 v13, 4, v1
    s_mul_i32 s57, s53, 320
    v_lshrrev_b32 v4, 2, v3
    v_lshl_add_u32 v4, v2, 2, v4
    v_mul_u32_u24 v4, 1280, v4
    v_and_b32 v5, 3, v3
    v_lshl_add_u32 v4, v5, 3, v4
    v_add_u32 v12, s57, v4
    s_mul_i32 s72, s54, 245760
    s_mul_i32 s70, s53, 10240
    s_add_u32 s72, s72, s70
    s_add_u32 m0, s70, 0
    s_add_u32 s73, s72, 0
    buffer_load_dwordx4 v13, s[12:15], s73 offen offset:0 lds
    buffer_load_dwordx4 v13, s[12:15], s73 offen offset:1024 lds
    buffer_load_dwordx4 v13, s[12:15], s73 offen offset:2048 lds
    buffer_load_dwordx4 v13, s[12:15], s73 offen offset:3072 lds
    s_add_u32 m0, s70, 4096
    s_add_u32 s73, s72, 4096
    buffer_load_dwordx4 v13, s[12:15], s73 offen offset:0 lds
    buffer_load_dwordx4 v13, s[12:15], s73 offen offset:1024 lds
    buffer_load_dwordx4 v13, s[12:15], s73 offen offset:2048 lds
    buffer_load_dwordx4 v13, s[12:15], s73 offen offset:3072 lds
    s_add_u32 m0, s70, 8192
    s_add_u32 s73, s72, 8192
    buffer_load_dwordx4 v13, s[12:15], s73 offen offset:0 lds
    buffer_load_dwordx4 v13, s[12:15], s73 offen offset:1024 lds
    s_add_u32 m0, s70, 40960
    s_add_u32 s73, s72, 40960
    buffer_load_dwordx4 v13, s[12:15], s73 offen offset:0 lds
    buffer_load_dwordx4 v13, s[12:15], s73 offen offset:1024 lds
    buffer_load_dwordx4 v13, s[12:15], s73 offen offset:2048 lds
    buffer_load_dwordx4 v13, s[12:15], s73 offen offset:3072 lds
    s_add_u32 m0, s70, 45056
    s_add_u32 s73, s72, 45056
    buffer_load_dwordx4 v13, s[12:15], s73 offen offset:0 lds
    buffer_load_dwordx4 v13, s[12:15], s73 offen offset:1024 lds
    buffer_load_dwordx4 v13, s[12:15], s73 offen offset:2048 lds
    buffer_load_dwordx4 v13, s[12:15], s73 offen offset:3072 lds
    s_add_u32 m0, s70, 49152
    s_add_u32 s73, s72, 49152
    buffer_load_dwordx4 v13, s[12:15], s73 offen offset:0 lds
    buffer_load_dwordx4 v13, s[12:15], s73 offen offset:1024 lds
    s_add_u32 m0, s70, 81920
    s_add_u32 s73, s72, 81920
    buffer_load_dwordx4 v13, s[12:15], s73 offen offset:0 lds
    buffer_load_dwordx4 v13, s[12:15], s73 offen offset:1024 lds
    buffer_load_dwordx4 v13, s[12:15], s73 offen offset:2048 lds
    buffer_load_dwordx4 v13, s[12:15], s73 offen offset:3072 lds
    s_add_u32 m0, s70, 86016
    s_add_u32 s73, s72, 86016
    buffer_load_dwordx4 v13, s[12:15], s73 offen offset:0 lds
    buffer_load_dwordx4 v13, s[12:15], s73 offen offset:1024 lds
    buffer_load_dwordx4 v13, s[12:15], s73 offen offset:2048 lds
    buffer_load_dwordx4 v13, s[12:15], s73 offen offset:3072 lds
    s_add_u32 m0, s70, 90112
    s_add_u32 s73, s72, 90112
    buffer_load_dwordx4 v13, s[12:15], s73 offen offset:0 lds
    buffer_load_dwordx4 v13, s[12:15], s73 offen offset:1024 lds
    s_waitcnt vmcnt(30)
    s_barrier
    s_cmp_eq_u32 s53, 3
    s_cbranch_scc0 L_arr_88
    s_mov_b64 exec, 1
    v_mov_b32 v7, 1
    v_mov_b32 v5, 8
    buffer_atomic_add v7, v5, s[8:11], 0 offen sc0
    s_mov_b64 exec, -1
L_arr_88:
    s_waitcnt vmcnt(20)
    s_barrier
    s_add_u32 m0, s70, 122880
    s_add_u32 s73, s72, 122880
    buffer_load_dwordx4 v13, s[12:15], s73 offen offset:0 lds
    buffer_load_dwordx4 v13, s[12:15], s73 offen offset:1024 lds
    buffer_load_dwordx4 v13, s[12:15], s73 offen offset:2048 lds
    buffer_load_dwordx4 v13, s[12:15], s73 offen offset:3072 lds
    s_add_u32 m0, s70, 126976
    s_add_u32 s73, s72, 126976
    buffer_load_dwordx4 v13, s[12:15], s73 offen offset:0 lds
    buffer_load_dwordx4 v13, s[12:15], s73 offen offset:1024 lds
    buffer_load_dwordx4 v13, s[12:15], s73 offen offset:2048 lds
    buffer_load_dwordx4 v13, s[12:15], s73 offen offset:3072 lds
    s_add_u32 m0, s70, 131072
    s_add_u32 s73, s72, 131072
    buffer_load_dwordx4 v13, s[12:15], s73 offen offset:0 lds
    buffer_load_dwordx4 v13, s[12:15], s73 offen offset:1024 lds
    ds_read_b64_tr_b16 a[0:1], v12 offset:0
    ds_read_b64_tr_b16 a[2:3], v12 offset:20480
    ds_read_b64_tr_b16 a[24:25], v12 offset:32
    ds_read_b64_tr_b16 a[26:27], v12 offset:20512
    ds_read_b64_tr_b16 a[48:49], v12 offset:64
    ds_read_b64_tr_b16 a[50:51], v12 offset:20544
    ds_read_b64_tr_b16 a[72:73], v12 offset:96
    ds_read_b64_tr_b16 a[74:75], v12 offset:20576
    ds_read_b64_tr_b16 a[96:97], v12 offset:128
    ds_read_b64_tr_b16 a[98:99], v12 offset:20608
    ds_read_b64_tr_b16 a[120:121], v12 offset:160
    ds_read_b64_tr_b16 a[122:123], v12 offset:20640
    ds_read_b64_tr_b16 a[144:145], v12 offset:192
    ds_read_b64_tr_b16 a[146:147], v12 offset:20672
    ds_read_b64_tr_b16 a[168:169], v12 offset:224
    ds_read_b64_tr_b16 a[170:171], v12 offset:20704
    ds_read_b64_tr_b16 a[192:193], v12 offset:256
    ds_read_b64_tr_b16 a[194:195], v12 offset:20736
    ds_read_b64_tr_b16 a[216:217], v12 offset:288
    ds_read_b64_tr_b16 a[218:219], v12 offset:20768
    s_waitcnt lgkmcnt(0)
    s_waitcnt vmcnt(20)
    s_barrier
    s_add_u32 m0, s70, 0
    s_add_u32 s73, s72, 163840
    buffer_load_dwordx4 v13, s[12:15], s73 offen offset:0 lds
    buffer_load_dwordx4 v13, s[12:15], s73 offen offset:1024 lds
    buffer_load_dwordx4 v13, s[12:15], s73 offen offset:2048 lds
    buffer_load_dwordx4 v13, s[12:15], s73 offen offset:3072 lds
    s_add_u32 m0, s70, 4096
    s_add_u32 s73, s72, 167936
    buffer_load_dwordx4 v13, s[12:15], s73 offen offset:0 lds
    buffer_load_dwordx4 v13, s[12:15], s73 offen offset:1024 lds
    buffer_load_dwordx4 v13, s[12:15], s73 offen offset:2048 lds
    buffer_load_dwordx4 v13, s[12:15], s73 offen offset:3072 lds
    s_add_u32 m0, s70, 8192
    s_add_u32 s73, s72, 172032
    buffer_load_dwordx4 v13, s[12:15], s73 offen offset:0 lds
    buffer_load_dwordx4 v13, s[12:15], s73 offen offset:1024 lds
    v_add_u32 v12, 40960, v12
    ds_read_b64_tr_b16 a[4:5], v12 offset:0
    ds_read_b64_tr_b16 a[6:7], v12 offset:20480
    ds_read_b64_tr_b16 a[28:29], v12 offset:32
    ds_read_b64_tr_b16 a[30:31], v12 offset:20512
    ds_read_b64_tr_b16 a[52:53], v12 offset:64
    ds_read_b64_tr_b16 a[54:55], v12 offset:20544
    ds_read_b64_tr_b16 a[76:77], v12 offset:96
    ds_read_b64_tr_b16 a[78:79], v12 offset:20576
    ds_read_b64_tr_b16 a[100:101], v12 offset:128
    ds_read_b64_tr_b16 a[102:103], v12 offset:20608
    ds_read_b64_tr_b16 a[124:125], v12 offset:160
    ds_read_b64_tr_b16 a[126:127], v12 offset:20640
    ds_read_b64_tr_b16 a[148:149], v12 offset:192
    ds_read_b64_tr_b16 a[150:151], v12 offset:20672
    ds_read_b64_tr_b16 a[172:173], v12 offset:224
    ds_read_b64_tr_b16 a[174:175], v12 offset:20704
    ds_read_b64_tr_b16 a[196:197], v12 offset:256
    ds_read_b64_tr_b16 a[198:199], v12 offset:20736
    ds_read_b64_tr_b16 a[220:221], v12 offset:288
    ds_read_b64_tr_b16 a[222:223], v12 offset:20768
    s_waitcnt lgkmcnt(0)
    s_waitcnt vmcnt(20)
    s_barrier
    s_add_u32 m0, s70, 40960
    s_add_u32 s73, s72, 204800
    buffer_load_dwordx4 v13, s[12:15], s73 offen offset:0 lds
    buffer_load_dwordx4 v13, s[12:15], s73 offen offset:1024 lds
    buffer_load_dwordx4 v13, s[12:15], s73 offen offset:2048 lds
    buffer_load_dwordx4 v13, s[12:15], s73 offen offset:3072 lds
    s_add_u32 m0, s70, 45056
    s_add_u32 s73, s72, 208896
    buffer_load_dwordx4 v13, s[12:15], s73 offen offset:0 lds
    buffer_load_dwordx4 v13, s[12:15], s73 offen offset:1024 lds
    buffer_load_dwordx4 v13, s[12:15], s73 offen offset:2048 lds
    buffer_load_dwordx4 v13, s[12:15], s73 offen offset:3072 lds
    s_add_u32 m0, s70, 49152
    s_add_u32 s73, s72, 212992
    buffer_load_dwordx4 v13, s[12:15], s73 offen offset:0 lds
    buffer_load_dwordx4 v13, s[12:15], s73 offen offset:1024 lds
    v_add_u32 v12, 40960, v12
    ds_read_b64_tr_b16 a[8:9], v12 offset:0
    ds_read_b64_tr_b16 a[10:11], v12 offset:20480
    ds_read_b64_tr_b16 a[32:33], v12 offset:32
    ds_read_b64_tr_b16 a[34:35], v12 offset:20512
    ds_read_b64_tr_b16 a[56:57], v12 offset:64
    ds_read_b64_tr_b16 a[58:59], v12 offset:20544
    ds_read_b64_tr_b16 a[80:81], v12 offset:96
    ds_read_b64_tr_b16 a[82:83], v12 offset:20576
    ds_read_b64_tr_b16 a[104:105], v12 offset:128
    ds_read_b64_tr_b16 a[106:107], v12 offset:20608
    ds_read_b64_tr_b16 a[128:129], v12 offset:160
    ds_read_b64_tr_b16 a[130:131], v12 offset:20640
    ds_read_b64_tr_b16 a[152:153], v12 offset:192
    ds_read_b64_tr_b16 a[154:155], v12 offset:20672
    ds_read_b64_tr_b16 a[176:177], v12 offset:224
    ds_read_b64_tr_b16 a[178:179], v12 offset:20704
    ds_read_b64_tr_b16 a[200:201], v12 offset:256
    ds_read_b64_tr_b16 a[202:203], v12 offset:20736
    ds_read_b64_tr_b16 a[224:225], v12 offset:288
    ds_read_b64_tr_b16 a[226:227], v12 offset:20768
    s_waitcnt lgkmcnt(0)
    s_waitcnt vmcnt(20)
    s_cmp_eq_u32 s53, 3
    s_cbranch_scc0 L_arr_89
    s_mov_b64 exec, 1
    v_cmp_eq_u32 vcc, 255, v7
    s_cbranch_vccz L_arr_89_x
    v_mov_b32 v5, 8
    buffer_load_dwordx3 v[4:6], v5, s[8:11], 0 offen offset:8 sc1
    s_waitcnt vmcnt(0)
    v_cmp_lt_u32 vcc, v4, v5
    v_mov_b32 v4, 0x2001
    v_lshlrev_b32 v6, 1, v6
    v_cndmask_b32 v4, 1, v4, vcc
    v_or_b32 v4, v4, v6
    v_mov_b32 v5, 252
    buffer_store_dword v4, v5, s[8:11], 0 offen sc1
L_arr_89_x:
    s_mov_b64 exec, -1
L_arr_89:
    s_barrier
    v_add_u32 v12, 40960, v12
    ds_read_b64_tr_b16 a[12:13], v12 offset:0
    ds_read_b64_tr_b16 a[14:15], v12 offset:20480
    ds_read_b64_tr_b16 a[36:37], v12 offset:32
    ds_read_b64_tr_b16 a[38:39], v12 offset:20512
    ds_read_b64_tr_b16 a[60:61], v12 offset:64
    ds_read_b64_tr_b16 a[62:63], v12 offset:20544
    ds_read_b64_tr_b16 a[84:85], v12 offset:96
    ds_read_b64_tr_b16 a[86:87], v12 offset:20576
    ds_read_b64_tr_b16 a[108:109], v12 offset:128
    ds_read_b64_tr_b16 a[110:111], v12 offset:20608
    ds_read_b64_tr_b16 a[132:133], v12 offset:160
    ds_read_b64_tr_b16 a[134:135], v12 offset:20640
    ds_read_b64_tr_b16 a[156:157], v12 offset:192
    ds_read_b64_tr_b16 a[158:159], v12 offset:20672
    ds_read_b64_tr_b16 a[180:181], v12 offset:224
    ds_read_b64_tr_b16 a[182:183], v12 offset:20704
    ds_read_b64_tr_b16 a[204:205], v12 offset:256
    ds_read_b64_tr_b16 a[206:207], v12 offset:20736
    ds_read_b64_tr_b16 a[228:229], v12 offset:288
    ds_read_b64_tr_b16 a[230:231], v12 offset:20768
    s_waitcnt lgkmcnt(0)
    s_waitcnt vmcnt(10)
    s_barrier
    v_add_u32 v12, -122880, v12
    ds_read_b64_tr_b16 a[16:17], v12 offset:0
    ds_read_b64_tr_b16 a[18:19], v12 offset:20480
    ds_read_b64_tr_b16 a[40:41], v12 offset:32
    ds_read_b64_tr_b16 a[42:43], v12 offset:20512
    ds_read_b64_tr_b16 a[64:65], v12 offset:64
    ds_read_b64_tr_b16 a[66:67], v12 offset:20544
    ds_read_b64_tr_b16 a[88:89], v12 offset:96
    ds_read_b64_tr_b16 a[90:91], v12 offset:20576
    ds_read_b64_tr_b16 a[112:113], v12 offset:128
    ds_read_b64_tr_b16 a[114:115], v12 offset:20608
    ds_read_b64_tr_b16 a[136:137], v12 offset:160
    ds_read_b64_tr_b16 a[138:139], v12 offset:20640
    ds_read_b64_tr_b16 a[160:161], v12 offset:192
    ds_read_b64_tr_b16 a[162:163], v12 offset:20672
    ds_read_b64_tr_b16 a[184:185], v12 offset:224
    ds_read_b64_tr_b16 a[186:187], v12 offset:20704
    ds_read_b64_tr_b16 a[208:209], v12 offset:256
    ds_read_b64_tr_b16 a[210:211], v12 offset:20736
    ds_read_b64_tr_b16 a[232:233], v12 offset:288
    ds_read_b64_tr_b16 a[234:235], v12 offset:20768
    s_waitcnt lgkmcnt(0)
    s_waitcnt vmcnt(0)
    s_barrier
    v_add_u32 v12, 40960, v12
    ds_read_b64_tr_b16 a[20:21], v12 offset:0
    ds_read_b64_tr_b16 a[22:23], v12 offset:20480
    ds_read_b64_tr_b16 a[44:45], v12 offset:32
    ds_read_b64_tr_b16 a[46:47], v12 offset:20512
    ds_read_b64_tr_b16 a[68:69], v12 offset:64
    ds_read_b64_tr_b16 a[70:71], v12 offset:20544
    ds_read_b64_tr_b16 a[92:93], v12 offset:96
    ds_read_b64_tr_b16 a[94:95], v12 offset:20576
    ds_read_b64_tr_b16 a[116:117], v12 offset:128
    ds_read_b64_tr_b16 a[118:119], v12 offset:20608
    ds_read_b64_tr_b16 a[140:141], v12 offset:160
    ds_read_b64_tr_b16 a[142:143], v12 offset:20640
    ds_read_b64_tr_b16 a[164:165], v12 offset:192
    ds_read_b64_tr_b16 a[166:167], v12 offset:20672
    ds_read_b64_tr_b16 a[188:189], v12 offset:224
    ds_read_b64_tr_b16 a[190:191], v12 offset:20704
    ds_read_b64_tr_b16 a[212:213], v12 offset:256
    ds_read_b64_tr_b16 a[214:215], v12 offset:20736
    ds_read_b64_tr_b16 a[236:237], v12 offset:288
    ds_read_b64_tr_b16 a[238:239], v12 offset:20768
    s_waitcnt lgkmcnt(0)
    s_barrier
    s_mov_b32 s96, 2000000
    v_mov_b32 v5, 252
L_aw_90:
    buffer_load_dword v4, v5, s[8:11], 0 offen sc1
    s_sub_u32 s96, s96, 1
    s_cbranch_scc1 L_fail
    s_waitcnt vmcnt(0)
    v_cmp_eq_u32 vcc, 0, v4
    s_cbranch_vccz L_aw_90_d
    s_sleep 16
    s_branch L_aw_90
L_aw_90_d:
    v_readfirstlane_b32 s61, v4
    s_nop 3
    s_and_b32 s60, s61, 8192
    s_and_b32 s3, s61, 2
    v_lshlrev_b32 v13, 4, v1
    v_min_u32 v4, 2, v1
    s_mul_i32 s56, s54, 3
    s_add_u32 s56, s56, 147648
    v_add_lshl_u32 v15, v4, s56, 7
    s_mul_i32 s72, s54, 12288
    s_add_u32 s72, s72, 138412032
    s_mul_i32 s67, s53, 81920
    s_and_b32 s56, s54, 7
    s_lshl_b32 s56, s56, 10
    s_add_u32 s67, s67, s56
    s_lshr_b32 s56, s54, 3
    s_mul_i32 s56, s56, 327680
    s_add_u32 s67, s67, s56
    s_add_u32 s67, s67, 164626432
    s_mov_b32 s55, 0
    s_mov_b32 s73, 1
    s_mov_b32 s96, 2000000
L_wf_91:
    buffer_load_dword v4, v15, s[4:7], 0 offen sc1
    s_sub_u32 s96, s96, 1
    s_cbranch_scc1 L_fail
    s_waitcnt vmcnt(0)
    v_cmp_gt_u32 vcc, s73, v4
    s_cbranch_vccz L_wf_91_d
    s_sleep 4
    s_branch L_wf_91
L_wf_91_d:
    s_add_u32 s75, s72, 0
    buffer_load_dwordx4 v[64:67], v13, s[4:7], s75 offen offset:0 sc1
    s_add_u32 s75, s72, 0
    buffer_load_dwordx4 v[68:71], v13, s[4:7], s75 offen offset:1024 sc1
    s_add_u32 s75, s72, 0
    buffer_load_dwordx4 v[72:75], v13, s[4:7], s75 offen offset:2048 sc1
    s_add_u32 s75, s72, 0
    buffer_load_dwordx4 v[76:79], v13, s[4:7], s75 offen offset:3072 sc1
    s_add_u32 s75, s72, 4096
    buffer_load_dwordx4 v[80:83], v13, s[4:7], s75 offen offset:0 sc1
    s_add_u32 s75, s72, 4096
    buffer_load_dwordx4 v[84:87], v13, s[4:7], s75 offen offset:1024 sc1
    s_add_u32 s75, s72, 4096
    buffer_load_dwordx4 v[88:91], v13, s[4:7], s75 offen offset:2048 sc1
    s_add_u32 s75, s72, 4096
    buffer_load_dwordx4 v[92:95], v13, s[4:7], s75 offen offset:3072 sc1
    s_add_u32 s75, s72, 8192
    buffer_load_dwordx4 v[96:99], v13, s[4:7], s75 offen offset:0 sc1
    s_add_u32 s75, s72, 8192
    buffer_load_dwordx4 v[100:103], v13, s[4:7], s75 offen offset:1024 sc1
    s_add_u32 s75, s72, 8192
    buffer_load_dwordx4 v[104:107], v13, s[4:7], s75 offen offset:2048 sc1
    s_add_u32 s75, s72, 8192
    buffer_load_dwordx4 v[108:111], v13, s[4:7], s75 offen offset:3072 sc1
    s_add_u32 s72, s72, 393216
    s_waitcnt vmcnt(0)
L_ot_loop:
    s_add_u32 s73, s55, 2
    s_min_u32 s73, s73, 64
    s_mov_b32 s74, s67
    s_waitcnt vmcnt(4)
    buffer_load_dword v17, v15, s[4:7], 0 offen sc1
    v_mfma_f32_16x16x32_bf16 v[32:35], v[64:67], a[0:3], 0
    v_mfma_f32_16x16x32_bf16 v[36:39], v[68:71], a[0:3], 0
    v_mfma_f32_16x16x32_bf16 v[32:35], v[72:75], a[4:7], v[32:35]
    v_mfma_f32_16x16x32_bf16 v[36:39], v[76:79], a[4:7], v[36:39]
    v_mfma_f32_16x16x32_bf16 v[32:35], v[80:83], a[8:11], v[32:35]
    v_mfma_f32_16x16x32_bf16 v[36:39], v[84:87], a[8:11], v[36:39]
    v_mfma_f32_16x16x32_bf16 v[32:35], v[88:91], a[12:15], v[32:35]
    v_mfma_f32_16x16x32_bf16 v[36:39], v[92:95], a[12:15], v[36:39]
    v_mfma_f32_16x16x32_bf16 v[32:35], v[96:99], a[16:19], v[32:35]
    v_mfma_f32_16x16x32_bf16 v[36:39], v[100:103], a[16:19], v[36:39]
    v_mfma_f32_16x16x32_bf16 v[32:35], v[104:107], a[20:23], v[32:35]
    v_mfma_f32_16x16x32_bf16 v[36:39], v[108:111], a[20:23], v[36:39]
    v_mfma_f32_16x16x32_bf16 v[40:43], v[64:67], a[24:27], 0
    v_mfma_f32_16x16x32_bf16 v[44:47], v[68:71], a[24:27], 0
    v_mfma_f32_16x16x32_bf16 v[40:43], v[72:75], a[28:31], v[40:43]
    v_cvt_pk_bf16_f32 v48, v32, v33
    v_mfma_f32_16x16x32_bf16 v[44:47], v[76:79], a[28:31], v[44:47]
    v_cvt_pk_bf16_f32 v49, v34, v35
    v_mfma_f32_16x16x32_bf16 v[40:43], v[80:83], a[32:35], v[40:43]
    v_cvt_pk_bf16_f32 v50, v36, v37
    v_mfma_f32_16x16x32_bf16 v[44:47], v[84:87], a[32:35], v[44:47]
    v_cvt_pk_bf16_f32 v51, v38, v39
    v_mfma_f32_16x16x32_bf16 v[40:43], v[88:91], a[36:39], v[40:43]
    buffer_store_dwordx4 v[48:51], v13, s[4:7], s74 offen sc1
    s_add_u32 s74, s74, 8192
    v_mfma_f32_16x16x32_bf16 v[44:47], v[92:95], a[36:39], v[44:47]
    v_mfma_f32_16x16x32_bf16 v[40:43], v[96:99], a[40:43], v[40:43]
    v_mfma_f32_16x16x32_bf16 v[44:47], v[100:103], a[40:43], v[44:47]
    v_mfma_f32_16x16x32_bf16 v[40:43], v[104:107], a[44:47], v[40:43]
    v_mfma_f32_16x16x32_bf16 v[44:47], v[108:111], a[44:47], v[44:47]
    v_mfma_f32_16x16x32_bf16 v[32:35], v[64:67], a[48:51], 0
    v_mfma_f32_16x16x32_bf16 v[36:39], v[68:71], a[48:51], 0
    v_mfma_f32_16x16x32_bf16 v[32:35], v[72:75], a[52:55], v[32:35]
    v_cvt_pk_bf16_f32 v52, v40, v41
    v_mfma_f32_16x16x32_bf16 v[36:39], v[76:79], a[52:55], v[36:39]
    v_cvt_pk_bf16_f32 v53, v42, v43
    v_mfma_f32_16x16x32_bf16 v[32:35], v[80:83], a[56:59], v[32:35]
    v_cvt_pk_bf16_f32 v54, v44, v45
    v_mfma_f32_16x16x32_bf16 v[36:39], v[84:87], a[56:59], v[36:39]
    v_cvt_pk_bf16_f32 v55, v46, v47
    v_mfma_f32_16x16x32_bf16 v[32:35], v[88:91], a[60:63], v[32:35]
    buffer_store_dwordx4 v[52:55], v13, s[4:7], s74 offen sc1
    s_add_u32 s74, s74, 8192
    v_mfma_f32_16x16x32_bf16 v[36:39], v[92:95], a[60:63], v[36:39]
    v_mfma_f32_16x16x32_bf16 v[32:35], v[96:99], a[64:67], v[32:35]
    v_mfma_f32_16x16x32_bf16 v[36:39], v[100:103], a[64:67], v[36:39]
    v_mfma_f32_16x16x32_bf16 v[32:35], v[104:107], a[68:71], v[32:35]
    v_mfma_f32_16x16x32_bf16 v[36:39], v[108:111], a[68:71], v[36:39]
    s_waitcnt vmcnt(2)
    v_cmp_gt_u32 vcc, s73, v17
    v_mov_b32 v4, s55
    s_cmp_eq_u64 vcc, 0
    s_cselect_b32 s76, 0, 0x40000000
    v_add_u32 v16, s76, v13
    buffer_store_dword v4, v8, s[4:7], s66 offen sc1
    v_mfma_f32_16x16x32_bf16 v[40:43], v[64:67], a[72:75], 0
    s_add_u32 s75, s72, 0
    buffer_load_dwordx4 v[112:115], v16, s[4:7], s75 offen offset:0 sc1
    v_mfma_f32_16x16x32_bf16 v[44:47], v[68:71], a[72:75], 0
    v_mfma_f32_16x16x32_bf16 v[40:43], v[72:75], a[76:79], v[40:43]
    v_cvt_pk_bf16_f32 v48, v32, v33
    v_mfma_f32_16x16x32_bf16 v[44:47], v[76:79], a[76:79], v[44:47]
    v_cvt_pk_bf16_f32 v49, v34, v35
    v_mfma_f32_16x16x32_bf16 v[40:43], v[80:83], a[80:83], v[40:43]
    v_cvt_pk_bf16_f32 v50, v36, v37
    s_add_u32 s75, s72, 0
    buffer_load_dwordx4 v[116:119], v16, s[4:7], s75 offen offset:1024 sc1
    v_mfma_f32_16x16x32_bf16 v[44:47], v[84:87], a[80:83], v[44:47]
    v_cvt_pk_bf16_f32 v51, v38, v39
    v_mfma_f32_16x16x32_bf16 v[40:43], v[88:91], a[84:87], v[40:43]
    buffer_store_dwordx4 v[48:51], v13, s[4:7], s74 offen sc1
    s_add_u32 s74, s74, 8192
    v_mfma_f32_16x16x32_bf16 v[44:47], v[92:95], a[84:87], v[44:47]
    v_mfma_f32_16x16x32_bf16 v[40:43], v[96:99], a[88:91], v[40:43]
    v_mfma_f32_16x16x32_bf16 v[44:47], v[100:103], a[88:91], v[44:47]
    s_add_u32 s75, s72, 0
    buffer_load_dwordx4 v[120:123], v16, s[4:7], s75 offen offset:2048 sc1
    v_mfma_f32_16x16x32_bf16 v[40:43], v[104:107], a[92:95], v[40:43]
    v_mfma_f32_16x16x32_bf16 v[44:47], v[108:111], a[92:95], v[44:47]
    v_mfma_f32_16x16x32_bf16 v[32:35], v[64:67], a[96:99], 0
    s_add_u32 s75, s72, 0
    buffer_load_dwordx4 v[124:127], v16, s[4:7], s75 offen offset:3072 sc1
    v_mfma_f32_16x16x32_bf16 v[36:39], v[68:71], a[96:99], 0
    v_mfma_f32_16x16x32_bf16 v[32:35], v[72:75], a[100:103], v[32:35]
    v_cvt_pk_bf16_f32 v52, v40, v41
    v_mfma_f32_16x16x32_bf16 v[36:39], v[76:79], a[100:103], v[36:39]
    v_cvt_pk_bf16_f32 v53, v42, v43
    v_mfma_f32_16x16x32_bf16 v[32:35], v[80:83], a[104:107], v[32:35]
    v_cvt_pk_bf16_f32 v54, v44, v45
    s_add_u32 s75, s72, 4096
    buffer_load_dwordx4 v[128:131], v16, s[4:7], s75 offen offset:0 sc1
    v_mfma_f32_16x16x32_bf16 v[36:39], v[84:87], a[104:107], v[36:39]
    v_cvt_pk_bf16_f32 v55, v46, v47
    v_mfma_f32_16x16x32_bf16 v[32:35], v[88:91], a[108:111], v[32:35]
    buffer_store_dwordx4 v[52:55], v13, s[4:7], s74 offen sc1
    s_add_u32 s74, s74, 8192
    v_mfma_f32_16x16x32_bf16 v[36:39], v[92:95], a[108:111], v[36:39]
    v_mfma_f32_16x16x32_bf16 v[32:35], v[96:99], a[112:115], v[32:35]
    v_mfma_f32_16x16x32_bf16 v[36:39], v[100:103], a[112:115], v[36:39]
    s_add_u32 s75, s72, 4096
    buffer_load_dwordx4 v[132:135], v16, s[4:7], s75 offen offset:1024 sc1
    v_mfma_f32_16x16x32_bf16 v[32:35], v[104:107], a[116:119], v[32:35]
    v_mfma_f32_16x16x32_bf16 v[36:39], v[108:111], a[116:119], v[36:39]
    v_mfma_f32_16x16x32_bf16 v[40:43], v[64:67], a[120:123], 0
    s_add_u32 s75, s72, 4096
    buffer_load_dwordx4 v[136:139], v16, s[4:7], s75 offen offset:2048 sc1
    v_mfma_f32_16x16x32_bf16 v[44:47], v[68:71], a[120:123], 0
    v_mfma_f32_16x16x32_bf16 v[40:43], v[72:75], a[124:127], v[40:43]
    v_cvt_pk_bf16_f32 v48, v32, v33
    v_mfma_f32_16x16x32_bf16 v[44:47], v[76:79], a[124:127], v[44:47]
    v_cvt_pk_bf16_f32 v49, v34, v35
    v_mfma_f32_16x16x32_bf16 v[40:43], v[80:83], a[128:131], v[40:43]
    v_cvt_pk_bf16_f32 v50, v36, v37
    s_add_u32 s75, s72, 4096
    buffer_load_dwordx4 v[140:143], v16, s[4:7], s75 offen offset:3072 sc1
    v_mfma_f32_16x16x32_bf16 v[44:47], v[84:87], a[128:131], v[44:47]
    v_cvt_pk_bf16_f32 v51, v38, v39
    v_mfma_f32_16x16x32_bf16 v[40:43], v[88:91], a[132:135], v[40:43]
    buffer_store_dwordx4 v[48:51], v13, s[4:7], s74 offen sc1
    s_add_u32 s74, s74, 8192
    v_mfma_f32_16x16x32_bf16 v[44:47], v[92:95], a[132:135], v[44:47]
    v_mfma_f32_16x16x32_bf16 v[40:43], v[96:99], a[136:139], v[40:43]
    v_mfma_f32_16x16x32_bf16 v[44:47], v[100:103], a[136:139], v[44:47]
    s_add_u32 s75, s72, 8192
    buffer_load_dwordx4 v[144:147], v16, s[4:7], s75 offen offset:0 sc1
    v_mfma_f32_16x16x32_bf16 v[40:43], v[104:107], a[140:143], v[40:43]
    v_mfma_f32_16x16x32_bf16 v[44:47], v[108:111], a[140:143], v[44:47]
    v_mfma_f32_16x16x32_bf16 v[32:35], v[64:67], a[144:147], 0
    s_add_u32 s75, s72, 8192
    buffer_load_dwordx4 v[148:151], v16, s[4:7], s75 offen offset:1024 sc1
    v_mfma_f32_16x16x32_bf16 v[36:39], v[68:71], a[144:147], 0
    v_mfma_f32_16x16x32_bf16 v[32:35], v[72:75], a[148:151], v[32:35]
    v_cvt_pk_bf16_f32 v52, v40, v41
    v_mfma_f32_16x16x32_bf16 v[36:39], v[76:79], a[148:151], v[36:39]
    v_cvt_pk_bf16_f32 v53, v42, v43
    v_mfma_f32_16x16x32_bf16 v[32:35], v[80:83], a[152:155], v[32:35]
    v_cvt_pk_bf16_f32 v54, v44, v45
    s_add_u32 s75, s72, 8192
    buffer_load_dwordx4 v[152:155], v16, s[4:7], s75 offen offset:2048 sc1
    v_mfma_f32_16x16x32_bf16 v[36:39], v[84:87], a[152:155], v[36:39]
    v_cvt_pk_bf16_f32 v55, v46, v47
    v_mfma_f32_16x16x32_bf16 v[32:35], v[88:91], a[156:159], v[32:35]
    buffer_store_dwordx4 v[52:55], v13, s[4:7], s74 offen sc1
    s_add_u32 s74, s74, 8192
    v_mfma_f32_16x16x32_bf16 v[36:39], v[92:95], a[156:159], v[36:39]
    v_mfma_f32_16x16x32_bf16 v[32:35], v[96:99], a[160:163], v[32:35]
    v_mfma_f32_16x16x32_bf16 v[36:39], v[100:103], a[160:163], v[36:39]
    s_add_u32 s75, s72, 8192
    buffer_load_dwordx4 v[156:159], v16, s[4:7], s75 offen offset:3072 sc1
    v_mfma_f32_16x16x32_bf16 v[32:35], v[104:107], a[164:167], v[32:35]
    v_mfma_f32_16x16x32_bf16 v[36:39], v[108:111], a[164:167], v[36:39]
    v_mfma_f32_16x16x32_bf16 v[40:43], v[64:67], a[168:171], 0
    v_mfma_f32_16x16x32_bf16 v[44:47], v[68:71], a[168:171], 0
    v_mfma_f32_16x16x32_bf16 v[40:43], v[72:75], a[172:175], v[40:43]
    v_cvt_pk_bf16_f32 v48, v32, v33
    v_mfma_f32_16x16x32_bf16 v[44:47], v[76:79], a[172:175], v[44:47]
    v_cvt_pk_bf16_f32 v49, v34, v35
    v_mfma_f32_16x16x32_bf16 v[40:43], v[80:83], a[176:179], v[40:43]
    v_cvt_pk_bf16_f32 v50, v36, v37
    v_mfma_f32_16x16x32_bf16 v[44:47], v[84:87], a[176:179], v[44:47]
    v_cvt_pk_bf16_f32 v51, v38, v39
    v_mfma_f32_16x16x32_bf16 v[40:43], v[88:91], a[180:183], v[40:43]
    buffer_store_dwordx4 v[48:51], v13, s[4:7], s74 offen sc1
    s_add_u32 s74, s74, 8192
    v_mfma_f32_16x16x32_bf16 v[44:47], v[92:95], a[180:183], v[44:47]
    v_mfma_f32_16x16x32_bf16 v[40:43], v[96:99], a[184:187], v[40:43]
    v_mfma_f32_16x16x32_bf16 v[44:47], v[100:103], a[184:187], v[44:47]
    v_mfma_f32_16x16x32_bf16 v[40:43], v[104:107], a[188:191], v[40:43]
    v_mfma_f32_16x16x32_bf16 v[44:47], v[108:111], a[188:191], v[44:47]
    v_mfma_f32_16x16x32_bf16 v[32:35], v[64:67], a[192:195], 0
    v_mfma_f32_16x16x32_bf16 v[36:39], v[68:71], a[192:195], 0
    v_mfma_f32_16x16x32_bf16 v[32:35], v[72:75], a[196:199], v[32:35]
    v_cvt_pk_bf16_f32 v52, v40, v41
    v_mfma_f32_16x16x32_bf16 v[36:39], v[76:79], a[196:199], v[36:39]
    v_cvt_pk_bf16_f32 v53, v42, v43
    v_mfma_f32_16x16x32_bf16 v[32:35], v[80:83], a[200:203], v[32:35]
    v_cvt_pk_bf16_f32 v54, v44, v45
    v_mfma_f32_16x16x32_bf16 v[36:39], v[84:87], a[200:203], v[36:39]
    v_cvt_pk_bf16_f32 v55, v46, v47
    v_mfma_f32_16x16x32_bf16 v[32:35], v[88:91], a[204:207], v[32:35]
    buffer_store_dwordx4 v[52:55], v13, s[4:7], s74 offen sc1
    s_add_u32 s74, s74, 8192
    v_mfma_f32_16x16x32_bf16 v[36:39], v[92:95], a[204:207], v[36:39]
    v_mfma_f32_16x16x32_bf16 v[32:35], v[96:99], a[208:211], v[32:35]
    v_mfma_f32_16x16x32_bf16 v[36:39], v[100:103], a[208:211], v[36:39]
    v_mfma_f32_16x16x32_bf16 v[32:35], v[104:107], a[212:215], v[32:35]
    v_mfma_f32_16x16x32_bf16 v[36:39], v[108:111], a[212:215], v[36:39]
    v_mfma_f32_16x16x32_bf16 v[40:43], v[64:67], a[216:219], 0
    v_mfma_f32_16x16x32_bf16 v[44:47], v[68:71], a[216:219], 0
    v_mfma_f32_16x16x32_bf16 v[40:43], v[72:75], a[220:223], v[40:43]
    v_cvt_pk_bf16_f32 v48, v32, v33
    v_mfma_f32_16x16x32_bf16 v[44:47], v[76:79], a[220:223], v[44:47]
    v_cvt_pk_bf16_f32 v49, v34, v35
    v_mfma_f32_16x16x32_bf16 v[40:43], v[80:83], a[224:227], v[40:43]
    v_cvt_pk_bf16_f32 v50, v36, v37
    v_mfma_f32_16x16x32_bf16 v[44:47], v[84:87], a[224:227], v[44:47]
    v_cvt_pk_bf16_f32 v51, v38, v39
    v_mfma_f32_16x16x32_bf16 v[40:43], v[88:91], a[228:231], v[40:43]
    buffer_store_dwordx4 v[48:51], v13, s[4:7], s74 offen sc1
    s_add_u32 s74, s74, 8192
    v_mfma_f32_16x16x32_bf16 v[44:47], v[92:95], a[228:231], v[44:47]
    v_mfma_f32_16x16x32_bf16 v[40:43], v[96:99], a[232:235], v[40:43]
    v_mfma_f32_16x16x32_bf16 v[44:47], v[100:103], a[232:235], v[44:47]
    v_mfma_f32_16x16x32_bf16 v[40:43], v[104:107], a[236:239], v[40:43]
    v_mfma_f32_16x16x32_bf16 v[44:47], v[108:111], a[236:239], v[44:47]
    s_nop 7
    v_cvt_pk_bf16_f32 v52, v40, v41
    v_cvt_pk_bf16_f32 v53, v42, v43
    v_cvt_pk_bf16_f32 v54, v44, v45
    v_cvt_pk_bf16_f32 v55, v46, v47
    buffer_store_dwordx4 v[52:55], v13, s[4:7], s74 offen sc1
    s_add_u32 s74, s74, 8192
    s_add_u32 s55, s55, 1
    s_cmp_eq_u32 s76, 0
    s_cbranch_scc1 L_ot_96
    buffer_load_dword v4, v15, s[4:7], 0 offen sc1
    s_waitcnt vmcnt(0)
    v_mov_b32 v5, s55
    buffer_store_dword v5, v8, s[4:7], s66 offen sc1
    v_cmp_gt_u32 vcc, s73, v4
    s_cbranch_vccz L_wf_97_d
    s_mov_b32 s96, 2000000
L_wf_97:
    buffer_load_dword v4, v15, s[4:7], 0 offen sc1
    s_sub_u32 s96, s96, 1
    s_cbranch_scc1 L_fail
    s_waitcnt vmcnt(0)
    v_cmp_gt_u32 vcc, s73, v4
    s_cbranch_vccz L_wf_97_d
    s_sleep 2
    s_branch L_wf_97
L_wf_97_d:
    s_add_u32 s75, s72, 0
    buffer_load_dwordx4 v[112:115], v13, s[4:7], s75 offen offset:0 sc1
    s_add_u32 s75, s72, 0
    buffer_load_dwordx4 v[116:119], v13, s[4:7], s75 offen offset:1024 sc1
    s_add_u32 s75, s72, 0
    buffer_load_dwordx4 v[120:123], v13, s[4:7], s75 offen offset:2048 sc1
    s_add_u32 s75, s72, 0
    buffer_load_dwordx4 v[124:127], v13, s[4:7], s75 offen offset:3072 sc1
    s_add_u32 s75, s72, 4096
    buffer_load_dwordx4 v[128:131], v13, s[4:7], s75 offen offset:0 sc1
    s_add_u32 s75, s72, 4096
    buffer_load_dwordx4 v[132:135], v13, s[4:7], s75 offen offset:1024 sc1
    s_add_u32 s75, s72, 4096
    buffer_load_dwordx4 v[136:139], v13, s[4:7], s75 offen offset:2048 sc1
    s_add_u32 s75, s72, 4096
    buffer_load_dwordx4 v[140:143], v13, s[4:7], s75 offen offset:3072 sc1
    s_add_u32 s75, s72, 8192
    buffer_load_dwordx4 v[144:147], v13, s[4:7], s75 offen offset:0 sc1
    s_add_u32 s75, s72, 8192
    buffer_load_dwordx4 v[148:151], v13, s[4:7], s75 offen offset:1024 sc1
    s_add_u32 s75, s72, 8192
    buffer_load_dwordx4 v[152:155], v13, s[4:7], s75 offen offset:2048 sc1
    s_add_u32 s75, s72, 8192
    buffer_load_dwordx4 v[156:159], v13, s[4:7], s75 offen offset:3072 sc1
    s_waitcnt vmcnt(0)
L_ot_96:
    s_add_u32 s72, s72, 393216
    s_add_u32 s67, s67, 1310720
    s_add_u32 s73, s55, 2
    s_min_u32 s73, s73, 64
    s_mov_b32 s74, s67
    s_waitcnt vmcnt(4)
    buffer_load_dword v17, v15, s[4:7], 0 offen sc1
    v_mfma_f32_16x16x32_bf16 v[32:35], v[112:115], a[0:3], 0
    v_mfma_f32_16x16x32_bf16 v[36:39], v[116:119], a[0:3], 0
    v_mfma_f32_16x16x32_bf16 v[32:35], v[120:123], a[4:7], v[32:35]
    v_mfma_f32_16x16x32_bf16 v[36:39], v[124:127], a[4:7], v[36:39]
    v_mfma_f32_16x16x32_bf16 v[32:35], v[128:131], a[8:11], v[32:35]
    v_mfma_f32_16x16x32_bf16 v[36:39], v[132:135], a[8:11], v[36:39]
    v_mfma_f32_16x16x32_bf16 v[32:35], v[136:139], a[12:15], v[32:35]
    v_mfma_f32_16x16x32_bf16 v[36:39], v[140:143], a[12:15], v[36:39]
    v_mfma_f32_16x16x32_bf16 v[32:35], v[144:147], a[16:19], v[32:35]
    v_mfma_f32_16x16x32_bf16 v[36:39], v[148:151], a[16:19], v[36:39]
    v_mfma_f32_16x16x32_bf16 v[32:35], v[152:155], a[20:23], v[32:35]
    v_mfma_f32_16x16x32_bf16 v[36:39], v[156:159], a[20:23], v[36:39]
    v_mfma_f32_16x16x32_bf16 v[40:43], v[112:115], a[24:27], 0
    v_mfma_f32_16x16x32_bf16 v[44:47], v[116:119], a[24:27], 0
    v_mfma_f32_16x16x32_bf16 v[40:43], v[120:123], a[28:31], v[40:43]
    v_cvt_pk_bf16_f32 v48, v32, v33
    v_mfma_f32_16x16x32_bf16 v[44:47], v[124:127], a[28:31], v[44:47]
    v_cvt_pk_bf16_f32 v49, v34, v35
    v_mfma_f32_16x16x32_bf16 v[40:43], v[128:131], a[32:35], v[40:43]
    v_cvt_pk_bf16_f32 v50, v36, v37
    v_mfma_f32_16x16x32_bf16 v[44:47], v[132:135], a[32:35], v[44:47]
    v_cvt_pk_bf16_f32 v51, v38, v39
    v_mfma_f32_16x16x32_bf16 v[40:43], v[136:139], a[36:39], v[40:43]
    buffer_store_dwordx4 v[48:51], v13, s[4:7], s74 offen sc1
    s_add_u32 s74, s74, 8192
    v_mfma_f32_16x16x32_bf16 v[44:47], v[140:143], a[36:39], v[44:47]
    v_mfma_f32_16x16x32_bf16 v[40:43], v[144:147], a[40:43], v[40:43]
    v_mfma_f32_16x16x32_bf16 v[44:47], v[148:151], a[40:43], v[44:47]
    v_mfma_f32_16x16x32_bf16 v[40:43], v[152:155], a[44:47], v[40:43]
    v_mfma_f32_16x16x32_bf16 v[44:47], v[156:159], a[44:47], v[44:47]
    v_mfma_f32_16x16x32_bf16 v[32:35], v[112:115], a[48:51], 0
    v_mfma_f32_16x16x32_bf16 v[36:39], v[116:119], a[48:51], 0
    v_mfma_f32_16x16x32_bf16 v[32:35], v[120:123], a[52:55], v[32:35]
    v_cvt_pk_bf16_f32 v52, v40, v41
    v_mfma_f32_16x16x32_bf16 v[36:39], v[124:127], a[52:55], v[36:39]
    v_cvt_pk_bf16_f32 v53, v42, v43
    v_mfma_f32_16x16x32_bf16 v[32:35], v[128:131], a[56:59], v[32:35]
    v_cvt_pk_bf16_f32 v54, v44, v45
    v_mfma_f32_16x16x32_bf16 v[36:39], v[132:135], a[56:59], v[36:39]
    v_cvt_pk_bf16_f32 v55, v46, v47
    v_mfma_f32_16x16x32_bf16 v[32:35], v[136:139], a[60:63], v[32:35]
    buffer_store_dwordx4 v[52:55], v13, s[4:7], s74 offen sc1
    s_add_u32 s74, s74, 8192
    v_mfma_f32_16x16x32_bf16 v[36:39], v[140:143], a[60:63], v[36:39]
    v_mfma_f32_16x16x32_bf16 v[32:35], v[144:147], a[64:67], v[32:35]
    v_mfma_f32_16x16x32_bf16 v[36:39], v[148:151], a[64:67], v[36:39]
    v_mfma_f32_16x16x32_bf16 v[32:35], v[152:155], a[68:71], v[32:35]
    v_mfma_f32_16x16x32_bf16 v[36:39], v[156:159], a[68:71], v[36:39]
    s_waitcnt vmcnt(2)
    v_cmp_gt_u32 vcc, s73, v17
    v_mov_b32 v4, s55
    s_cmp_eq_u64 vcc, 0
    s_cselect_b32 s76, 0, 0x40000000
    v_add_u32 v16, s76, v13
    buffer_store_dword v4, v8, s[4:7], s66 offen sc1
    v_mfma_f32_16x16x32_bf16 v[40:43], v[112:115], a[72:75], 0
    s_add_u32 s75, s72, 0
    buffer_load_dwordx4 v[64:67], v16, s[4:7], s75 offen offset:0 sc1
    v_mfma_f32_16x16x32_bf16 v[44:47], v[116:119], a[72:75], 0
    v_mfma_f32_16x16x32_bf16 v[40:43], v[120:123], a[76:79], v[40:43]
    v_cvt_pk_bf16_f32 v48, v32, v33
    v_mfma_f32_16x16x32_bf16 v[44:47], v[124:127], a[76:79], v[44:47]
    v_cvt_pk_bf16_f32 v49, v34, v35
    v_mfma_f32_16x16x32_bf16 v[40:43], v[128:131], a[80:83], v[40:43]
    v_cvt_pk_bf16_f32 v50, v36, v37
    s_add_u32 s75, s72, 0
    buffer_load_dwordx4 v[68:71], v16, s[4:7], s75 offen offset:1024 sc1
    v_mfma_f32_16x16x32_bf16 v[44:47], v[132:135], a[80:83], v[44:47]
    v_cvt_pk_bf16_f32 v51, v38, v39
    v_mfma_f32_16x16x32_bf16 v[40:43], v[136:139], a[84:87], v[40:43]
    buffer_store_dwordx4 v[48:51], v13, s[4:7], s74 offen sc1
    s_add_u32 s74, s74, 8192
    v_mfma_f32_16x16x32_bf16 v[44:47], v[140:143], a[84:87], v[44:47]
    v_mfma_f32_16x16x32_bf16 v[40:43], v[144:147], a[88:91], v[40:43]
    v_mfma_f32_16x16x32_bf16 v[44:47], v[148:151], a[88:91], v[44:47]
    s_add_u32 s75, s72, 0
    buffer_load_dwordx4 v[72:75], v16, s[4:7], s75 offen offset:2048 sc1
    v_mfma_f32_16x16x32_bf16 v[40:43], v[152:155], a[92:95], v[40:43]
    v_mfma_f32_16x16x32_bf16 v[44:47], v[156:159], a[92:95], v[44:47]
    v_mfma_f32_16x16x32_bf16 v[32:35], v[112:115], a[96:99], 0
    s_add_u32 s75, s72, 0
    buffer_load_dwordx4 v[76:79], v16, s[4:7], s75 offen offset:3072 sc1
    v_mfma_f32_16x16x32_bf16 v[36:39], v[116:119], a[96:99], 0
    v_mfma_f32_16x16x32_bf16 v[32:35], v[120:123], a[100:103], v[32:35]
    v_cvt_pk_bf16_f32 v52, v40, v41
    v_mfma_f32_16x16x32_bf16 v[36:39], v[124:127], a[100:103], v[36:39]
    v_cvt_pk_bf16_f32 v53, v42, v43
    v_mfma_f32_16x16x32_bf16 v[32:35], v[128:131], a[104:107], v[32:35]
    v_cvt_pk_bf16_f32 v54, v44, v45
    s_add_u32 s75, s72, 4096
    buffer_load_dwordx4 v[80:83], v16, s[4:7], s75 offen offset:0 sc1
    v_mfma_f32_16x16x32_bf16 v[36:39], v[132:135], a[104:107], v[36:39]
    v_cvt_pk_bf16_f32 v55, v46, v47
    v_mfma_f32_16x16x32_bf16 v[32:35], v[136:139], a[108:111], v[32:35]
    buffer_store_dwordx4 v[52:55], v13, s[4:7], s74 offen sc1
    s_add_u32 s74, s74, 8192
    v_mfma_f32_16x16x32_bf16 v[36:39], v[140:143], a[108:111], v[36:39]
    v_mfma_f32_16x16x32_bf16 v[32:35], v[144:147], a[112:115], v[32:35]
    v_mfma_f32_16x16x32_bf16 v[36:39], v[148:151], a[112:115], v[36:39]
    s_add_u32 s75, s72, 4096
    buffer_load_dwordx4 v[84:87], v16, s[4:7], s75 offen offset:1024 sc1
    v_mfma_f32_16x16x32_bf16 v[32:35], v[152:155], a[116:119], v[32:35]
    v_mfma_f32_16x16x32_bf16 v[36:39], v[156:159], a[116:119], v[36:39]
    v_mfma_f32_16x16x32_bf16 v[40:43], v[112:115], a[120:123], 0
    s_add_u32 s75, s72, 4096
    buffer_load_dwordx4 v[88:91], v16, s[4:7], s75 offen offset:2048 sc1
    v_mfma_f32_16x16x32_bf16 v[44:47], v[116:119], a[120:123], 0
    v_mfma_f32_16x16x32_bf16 v[40:43], v[120:123], a[124:127], v[40:43]
    v_cvt_pk_bf16_f32 v48, v32, v33
    v_mfma_f32_16x16x32_bf16 v[44:47], v[124:127], a[124:127], v[44:47]
    v_cvt_pk_bf16_f32 v49, v34, v35
    v_mfma_f32_16x16x32_bf16 v[40:43], v[128:131], a[128:131], v[40:43]
    v_cvt_pk_bf16_f32 v50, v36, v37
    s_add_u32 s75, s72, 4096
    buffer_load_dwordx4 v[92:95], v16, s[4:7], s75 offen offset:3072 sc1
    v_mfma_f32_16x16x32_bf16 v[44:47], v[132:135], a[128:131], v[44:47]
    v_cvt_pk_bf16_f32 v51, v38, v39
    v_mfma_f32_16x16x32_bf16 v[40:43], v[136:139], a[132:135], v[40:43]
    buffer_store_dwordx4 v[48:51], v13, s[4:7], s74 offen sc1
    s_add_u32 s74, s74, 8192
    v_mfma_f32_16x16x32_bf16 v[44:47], v[140:143], a[132:135], v[44:47]
    v_mfma_f32_16x16x32_bf16 v[40:43], v[144:147], a[136:139], v[40:43]
    v_mfma_f32_16x16x32_bf16 v[44:47], v[148:151], a[136:139], v[44:47]
    s_add_u32 s75, s72, 8192
    buffer_load_dwordx4 v[96:99], v16, s[4:7], s75 offen offset:0 sc1
    v_mfma_f32_16x16x32_bf16 v[40:43], v[152:155], a[140:143], v[40:43]
    v_mfma_f32_16x16x32_bf16 v[44:47], v[156:159], a[140:143], v[44:47]
    v_mfma_f32_16x16x32_bf16 v[32:35], v[112:115], a[144:147], 0
    s_add_u32 s75, s72, 8192
    buffer_load_dwordx4 v[100:103], v16, s[4:7], s75 offen offset:1024 sc1
    v_mfma_f32_16x16x32_bf16 v[36:39], v[116:119], a[144:147], 0
    v_mfma_f32_16x16x32_bf16 v[32:35], v[120:123], a[148:151], v[32:35]
    v_cvt_pk_bf16_f32 v52, v40, v41
    v_mfma_f32_16x16x32_bf16 v[36:39], v[124:127], a[148:151], v[36:39]
    v_cvt_pk_bf16_f32 v53, v42, v43
    v_mfma_f32_16x16x32_bf16 v[32:35], v[128:131], a[152:155], v[32:35]
    v_cvt_pk_bf16_f32 v54, v44, v45
    s_add_u32 s75, s72, 8192
    buffer_load_dwordx4 v[104:107], v16, s[4:7], s75 offen offset:2048 sc1
    v_mfma_f32_16x16x32_bf16 v[36:39], v[132:135], a[152:155], v[36:39]
    v_cvt_pk_bf16_f32 v55, v46, v47
    v_mfma_f32_16x16x32_bf16 v[32:35], v[136:139], a[156:159], v[32:35]
    buffer_store_dwordx4 v[52:55], v13, s[4:7], s74 offen sc1
    s_add_u32 s74, s74, 8192
    v_mfma_f32_16x16x32_bf16 v[36:39], v[140:143], a[156:159], v[36:39]
    v_mfma_f32_16x16x32_bf16 v[32:35], v[144:147], a[160:163], v[32:35]
    v_mfma_f32_16x16x32_bf16 v[36:39], v[148:151], a[160:163], v[36:39]
    s_add_u32 s75, s72, 8192
    buffer_load_dwordx4 v[108:111], v16, s[4:7], s75 offen offset:3072 sc1
    v_mfma_f32_16x16x32_bf16 v[32:35], v[152:155], a[164:167], v[32:35]
    v_mfma_f32_16x16x32_bf16 v[36:39], v[156:159], a[164:167], v[36:39]
    v_mfma_f32_16x16x32_bf16 v[40:43], v[112:115], a[168:171], 0
    v_mfma_f32_16x16x32_bf16 v[44:47], v[116:119], a[168:171], 0
    v_mfma_f32_16x16x32_bf16 v[40:43], v[120:123], a[172:175], v[40:43]
    v_cvt_pk_bf16_f32 v48, v32, v33
    v_mfma_f32_16x16x32_bf16 v[44:47], v[124:127], a[172:175], v[44:47]
    v_cvt_pk_bf16_f32 v49, v34, v35
    v_mfma_f32_16x16x32_bf16 v[40:43], v[128:131], a[176:179], v[40:43]
    v_cvt_pk_bf16_f32 v50, v36, v37
    v_mfma_f32_16x16x32_bf16 v[44:47], v[132:135], a[176:179], v[44:47]
    v_cvt_pk_bf16_f32 v51, v38, v39
    v_mfma_f32_16x16x32_bf16 v[40:43], v[136:139], a[180:183], v[40:43]
    buffer_store_dwordx4 v[48:51], v13, s[4:7], s74 offen sc1
    s_add_u32 s74, s74, 8192
    v_mfma_f32_16x16x32_bf16 v[44:47], v[140:143], a[180:183], v[44:47]
    v_mfma_f32_16x16x32_bf16 v[40:43], v[144:147], a[184:187], v[40:43]
    v_mfma_f32_16x16x32_bf16 v[44:47], v[148:151], a[184:187], v[44:47]
    v_mfma_f32_16x16x32_bf16 v[40:43], v[152:155], a[188:191], v[40:43]
    v_mfma_f32_16x16x32_bf16 v[44:47], v[156:159], a[188:191], v[44:47]
    v_mfma_f32_16x16x32_bf16 v[32:35], v[112:115], a[192:195], 0
    v_mfma_f32_16x16x32_bf16 v[36:39], v[116:119], a[192:195], 0
    v_mfma_f32_16x16x32_bf16 v[32:35], v[120:123], a[196:199], v[32:35]
    v_cvt_pk_bf16_f32 v52, v40, v41
    v_mfma_f32_16x16x32_bf16 v[36:39], v[124:127], a[196:199], v[36:39]
    v_cvt_pk_bf16_f32 v53, v42, v43
    v_mfma_f32_16x16x32_bf16 v[32:35], v[128:131], a[200:203], v[32:35]
    v_cvt_pk_bf16_f32 v54, v44, v45
    v_mfma_f32_16x16x32_bf16 v[36:39], v[132:135], a[200:203], v[36:39]
    v_cvt_pk_bf16_f32 v55, v46, v47
    v_mfma_f32_16x16x32_bf16 v[32:35], v[136:139], a[204:207], v[32:35]
    buffer_store_dwordx4 v[52:55], v13, s[4:7], s74 offen sc1
    s_add_u32 s74, s74, 8192
    v_mfma_f32_16x16x32_bf16 v[36:39], v[140:143], a[204:207], v[36:39]
    v_mfma_f32_16x16x32_bf16 v[32:35], v[144:147], a[208:211], v[32:35]
    v_mfma_f32_16x16x32_bf16 v[36:39], v[148:151], a[208:211], v[36:39]
    v_mfma_f32_16x16x32_bf16 v[32:35], v[152:155], a[212:215], v[32:35]
    v_mfma_f32_16x16x32_bf16 v[36:39], v[156:159], a[212:215], v[36:39]
    v_mfma_f32_16x16x32_bf16 v[40:43], v[112:115], a[216:219], 0
    v_mfma_f32_16x16x32_bf16 v[44:47], v[116:119], a[216:219], 0
    v_mfma_f32_16x16x32_bf16 v[40:43], v[120:123], a[220:223], v[40:43]
    v_cvt_pk_bf16_f32 v48, v32, v33
    v_mfma_f32_16x16x32_bf16 v[44:47], v[124:127], a[220:223], v[44:47]
    v_cvt_pk_bf16_f32 v49, v34, v35
    v_mfma_f32_16x16x32_bf16 v[40:43], v[128:131], a[224:227], v[40:43]
    v_cvt_pk_bf16_f32 v50, v36, v37
    v_mfma_f32_16x16x32_bf16 v[44:47], v[132:135], a[224:227], v[44:47]
    v_cvt_pk_bf16_f32 v51, v38, v39
    v_mfma_f32_16x16x32_bf16 v[40:43], v[136:139], a[228:231], v[40:43]
    buffer_store_dwordx4 v[48:51], v13, s[4:7], s74 offen sc1
    s_add_u32 s74, s74, 8192
    v_mfma_f32_16x16x32_bf16 v[44:47], v[140:143], a[228:231], v[44:47]
    v_mfma_f32_16x16x32_bf16 v[40:43], v[144:147], a[232:235], v[40:43]
    v_mfma_f32_16x16x32_bf16 v[44:47], v[148:151], a[232:235], v[44:47]
    v_mfma_f32_16x16x32_bf16 v[40:43], v[152:155], a[236:239], v[40:43]
    v_mfma_f32_16x16x32_bf16 v[44:47], v[156:159], a[236:239], v[44:47]
    s_nop 7
    v_cvt_pk_bf16_f32 v52, v40, v41
    v_cvt_pk_bf16_f32 v53, v42, v43
    v_cvt_pk_bf16_f32 v54, v44, v45
    v_cvt_pk_bf16_f32 v55, v46, v47
    buffer_store_dwordx4 v[52:55], v13, s[4:7], s74 offen sc1
    s_add_u32 s74, s74, 8192
    s_add_u32 s55, s55, 1
    s_cmp_eq_u32 s76, 0
    s_cbranch_scc1 L_ot_98
    buffer_load_dword v4, v15, s[4:7], 0 offen sc1
    s_waitcnt vmcnt(0)
    v_mov_b32 v5, s55
    buffer_store_dword v5, v8, s[4:7], s66 offen sc1
    v_cmp_gt_u32 vcc, s73, v4
    s_cbranch_vccz L_wf_99_d
    s_mov_b32 s96, 2000000
L_wf_99:
    buffer_load_dword v4, v15, s[4:7], 0 offen sc1
    s_sub_u32 s96, s96, 1
    s_cbranch_scc1 L_fail
    s_waitcnt vmcnt(0)
    v_cmp_gt_u32 vcc, s73, v4
    s_cbranch_vccz L_wf_99_d
    s_sleep 2
    s_branch L_wf_99
L_wf_99_d:
    s_add_u32 s75, s72, 0
    buffer_load_dwordx4 v[64:67], v13, s[4:7], s75 offen offset:0 sc1
    s_add_u32 s75, s72, 0
    buffer_load_dwordx4 v[68:71], v13, s[4:7], s75 offen offset:1024 sc1
    s_add_u32 s75, s72, 0
    buffer_load_dwordx4 v[72:75], v13, s[4:7], s75 offen offset:2048 sc1
    s_add_u32 s75, s72, 0
    buffer_load_dwordx4 v[76:79], v13, s[4:7], s75 offen offset:3072 sc1
    s_add_u32 s75, s72, 4096
    buffer_load_dwordx4 v[80:83], v13, s[4:7], s75 offen offset:0 sc1
    s_add_u32 s75, s72, 4096
    buffer_load_dwordx4 v[84:87], v13, s[4:7], s75 offen offset:1024 sc1
    s_add_u32 s75, s72, 4096
    buffer_load_dwordx4 v[88:91], v13, s[4:7], s75 offen offset:2048 sc1
    s_add_u32 s75, s72, 4096
    buffer_load_dwordx4 v[92:95], v13, s[4:7], s75 offen offset:3072 sc1
    s_add_u32 s75, s72, 8192
    buffer_load_dwordx4 v[96:99], v13, s[4:7], s75 offen offset:0 sc1
    s_add_u32 s75, s72, 8192
    buffer_load_dwordx4 v[100:103], v13, s[4:7], s75 offen offset:1024 sc1
    s_add_u32 s75, s72, 8192
    buffer_load_dwordx4 v[104:107], v13, s[4:7], s75 offen offset:2048 sc1
    s_add_u32 s75, s72, 8192
    buffer_load_dwordx4 v[108:111], v13, s[4:7], s75 offen offset:3072 sc1
    s_waitcnt vmcnt(0)
L_ot_98:
    s_add_u32 s72, s72, 393216
    s_add_u32 s67, s67, 1310720
    s_cmp_lt_u32 s55, 64
    s_cbranch_scc1 L_ot_loop
    s_waitcnt vmcnt(0)
    v_mov_b32 v4, 64
    buffer_store_dword v4, v8, s[4:7], s66 offen sc1
    s_branch L_end
L_roleXW:
    s_sub_u32 s54, s52, 172
    s_lshl_b32 s64, s54, 2
    s_add_u32 s64, s64, s53
    s_lshl_b32 s66, s64, 7
    s_add_u32 s66, s66, 18874368
    v_mov_b32 v8, 0
    v_mov_b32 v4, 0
    buffer_store_dword v4, v8, s[4:7], s66 offen sc1
    s_mov_b32 s63, 3
    s_sub_u32 s56, s54, 24
    s_cmp_lt_u32 s56, 48
    s_cbranch_scc1 L_xw_soon
    s_waitcnt vmcnt(0)
    s_barrier
    s_cmp_eq_u32 s53, 3
    s_cbranch_scc0 L_arr_100
    s_mov_b64 exec, 1
    v_mov_b32 v4, 1
    v_mov_b32 v5, 8
    buffer_atomic_add v4, v5, s[8:11], 0 offen sc0
    s_mov_b64 exec, -1
L_arr_100:
    s_waitcnt vmcnt(0)
    s_cmp_eq_u32 s53, 3
    s_cbranch_scc0 L_arr_101
    s_mov_b64 exec, 1
    v_cmp_eq_u32 vcc, 255, v4
    s_cbranch_vccz L_arr_101_x
    v_mov_b32 v5, 8
    buffer_load_dwordx3 v[4:6], v5, s[8:11], 0 offen offset:8 sc1
    s_waitcnt vmcnt(0)
    v_cmp_lt_u32 vcc, v4, v5
    v_mov_b32 v4, 0x2001
    v_lshlrev_b32 v6, 1, v6
    v_cndmask_b32 v4, 1, v4, vcc
    v_or_b32 v4, v4, v6
    v_mov_b32 v5, 252
    buffer_store_dword v4, v5, s[8:11], 0 offen sc1
L_arr_101_x:
    s_mov_b64 exec, -1
L_arr_101:
    s_mov_b32 s63, 7
L_xw_soon:
    s_cmp_lt_u32 s64, 288
    s_cbranch_scc0 L_xw_ffn
    s_mov_b32 s69, 0
    s_mov_b32 s65, 12288
    s_mov_b32 s68, 393216
    s_mov_b32 s78, 31
    s_mov_b32 s79, -1
    s_cmp_lt_u32 s64, 96
    s_cselect_b32 s12, s28, s30
    s_cselect_b32 s13, s29, s31
    s_cselect_b32 s56, 0, 96
    s_mov_b32 s67, 88080384
    s_cselect_b32 s67, s67, 113246208
    s_cmp_lt_u32 s64, 192
    s_cselect_b32 s12, s12, s32
    s_cselect_b32 s13, s13, s33
    s_cselect_b32 s56, s56, 192
    s_cselect_b32 s67, s67, 138412032
    s_mov_b32 s14, 7864320
    s_mov_b32 s15, 0x20000
    s_mov_b32 s16, s12
    s_mov_b32 s17, s13
    s_mov_b32 s18, s14
    s_mov_b32 s19, 0x20000
    s_sub_u32 s56, s64, s56
    s_lshl_b32 s57, s56, 12
    s_add_u32 s67, s67, s57
    s_lshl_b32 s57, s56, 7
    v_lshrrev_b32 v4, 3, v1
    v_mul_u32_u24 v4, 12288, v4
    v_and_b32 v5, 7, v1
    v_lshl_add_u32 v4, v5, 4, v4
    v_add_u32 v10, s57, v4
    v_add_u32 v11, 98304, v10
    v_and_b32 v4, 1, v2
    v_lshlrev_b32 v4, 11, v4
    v_lshrrev_b32 v5, 1, v2
    v_lshl_add_u32 v4, v5, 10, v4
    v_lshrrev_b32 v5, 2, v3
    v_lshl_add_u32 v4, v5, 7, v4
    s_mov_b32 s57, 512
    s_mov_b32 s58, 64
    s_branch L_xw_go
L_xw_ffn:
    s_mov_b32 s69, 1
    s_mov_b32 s65, 3072
    s_mov_b32 s68, 98304
    s_mov_b32 s78, 31
    s_mov_b32 s79, -1
    s_mov_b32 s12, s40
    s_mov_b32 s13, s41
    s_mov_b32 s14, 1966080
    s_mov_b32 s15, 0x20000
    s_mov_b32 s16, s42
    s_mov_b32 s17, s43
    s_mov_b32 s18, 1966080
    s_mov_b32 s19, 0x20000
    s_sub_u32 s56, s64, 288
    s_lshl_b32 s67, s56, 11
    s_add_u32 s67, s67, 34603008
    s_lshl_b32 s57, s56, 6
    v_lshrrev_b32 v4, 2, v1
    v_mul_u32_u24 v4, 3072, v4
    v_and_b32 v5, 3, v1
    v_lshl_add_u32 v4, v5, 4, v4
    v_add_u32 v10, s57, v4
    v_mov_b32 v11, v10
    v_lshrrev_b32 v4, 2, v3
    v_lshl_add_u32 v4, v2, 3, v4
    v_lshlrev_b32 v4, 6, v4
    s_mov_b32 s57, 256
    s_mov_b32 s58, 2048
L_xw_go:
    s_mul_i32 s70, s53, 40960
    s_lshl_b32 s71, s65, 4
    s_mov_b32 s72, 0
    v_and_b32 v5, 3, v3
    v_lshl_add_u32 v4, v5, 3, v4
    v_add_u32 v20, s70, v4
    v_add_u32 v21, s57, v20
    v_add_u32 v22, s58, v20
    v_add_u32 v23, s58, v21
    s_add_u32 m0, s70, 0
    s_nop 0
    buffer_load_dwordx4 v10, s[12:15], s72 offen lds
    s_add_u32 m0, s70, 2048
    s_nop 0
    buffer_load_dwordx4 v11, s[16:19], s72 offen lds
    s_add_u32 s72, s72, s71
    s_add_u32 m0, s70, 1024
    s_nop 0
    buffer_load_dwordx4 v10, s[12:15], s72 offen lds
    s_add_u32 m0, s70, 3072
    s_nop 0
    buffer_load_dwordx4 v11, s[16:19], s72 offen lds
    s_add_u32 s72, s72, s71
    s_add_u32 m0, s70, 4096
    s_nop 0
    buffer_load_dwordx4 v10, s[12:15], s72 offen lds
    s_add_u32 m0, s70, 6144
    s_nop 0
    buffer_load_dwordx4 v11, s[16:19], s72 offen lds
    s_add_u32 s72, s72, s71
    s_add_u32 m0, s70, 5120
    s_nop 0
    buffer_load_dwordx4 v10, s[12:15], s72 offen lds
    s_add_u32 m0, s70, 7168
    s_nop 0
    buffer_load_dwordx4 v11, s[16:19], s72 offen lds
    s_add_u32 s72, s72, s71
    s_add_u32 m0, s70, 8192
    s_nop 0
    buffer_load_dwordx4 v10, s[12:15], s72 offen lds
    s_add_u32 m0, s70, 10240
    s_nop 0
    buffer_load_dwordx4 v11, s[16:19], s72 offen lds
    s_add_u32 s72, s72, s71
    s_add_u32 m0, s70, 9216
    s_nop 0
    buffer_load_dwordx4 v10, s[12:15], s72 offen lds
    s_add_u32 m0, s70, 11264
    s_nop 0
    buffer_load_dwordx4 v11, s[16:19], s72 offen lds
    s_add_u32 s72, s72, s71
    s_waitcnt vmcnt(12)
    s_barrier
    s_cmp_eq_u32 s53, s63
    s_cbranch_scc0 L_arr_102
    s_mov_b64 exec, 1
    v_mov_b32 v7, 1
    v_mov_b32 v5, 8
    buffer_atomic_add v7, v5, s[8:11], 0 offen sc0
    s_mov_b64 exec, -1
L_arr_102:
    s_add_u32 m0, s70, 12288
    s_nop 0
    buffer_load_dwordx4 v10, s[12:15], s72 offen lds
    s_add_u32 m0, s70, 14336
    s_nop 0
    buffer_load_dwordx4 v11, s[16:19], s72 offen lds
    s_add_u32 s72, s72, s71
    s_add_u32 m0, s70, 13312
    s_nop 0
    buffer_load_dwordx4 v10, s[12:15], s72 offen lds
    s_add_u32 m0, s70, 15360
    s_nop 0
    buffer_load_dwordx4 v11, s[16:19], s72 offen lds
    s_add_u32 s72, s72, s71
    s_add_u32 m0, s70, 16384
    s_nop 0
    buffer_load_dwordx4 v10, s[12:15], s72 offen lds
    s_add_u32 m0, s70, 18432
    s_nop 0
    buffer_load_dwordx4 v11, s[16:19], s72 offen lds
    s_add_u32 s72, s72, s71
    s_add_u32 m0, s70, 17408
    s_nop 0
    buffer_load_dwordx4 v10, s[12:15], s72 offen lds
    s_add_u32 m0, s70, 19456
    s_nop 0
    buffer_load_dwordx4 v11, s[16:19], s72 offen lds
    s_add_u32 s72, s72, s71
    s_add_u32 m0, s70, 20480
    s_nop 0
    buffer_load_dwordx4 v10, s[12:15], s72 offen lds
    s_add_u32 m0, s70, 22528
    s_nop 0
    buffer_load_dwordx4 v11, s[16:19], s72 offen lds
    s_add_u32 s72, s72, s71
    s_add_u32 m0, s70, 21504
    s_nop 0
    buffer_load_dwordx4 v10, s[12:15], s72 offen lds
    s_add_u32 m0, s70, 23552
    s_nop 0
    buffer_load_dwordx4 v11, s[16:19], s72 offen lds
    s_add_u32 s72, s72, s71
    s_add_u32 m0, s70, 24576
    s_nop 0
    buffer_load_dwordx4 v10, s[12:15], s72 offen lds
    s_add_u32 m0, s70, 26624
    s_nop 0
    buffer_load_dwordx4 v11, s[16:19], s72 offen lds
    s_add_u32 s72, s72, s71
    s_add_u32 m0, s70, 25600
    s_nop 0
    buffer_load_dwordx4 v10, s[12:15], s72 offen lds
    s_add_u32 m0, s70, 27648
    s_nop 0
    buffer_load_dwordx4 v11, s[16:19], s72 offen lds
    s_add_u32 s72, s72, s71
    s_add_u32 m0, s70, 28672
    s_nop 0
    buffer_load_dwordx4 v10, s[12:15], s72 offen lds
    s_add_u32 m0, s70, 30720
    s_nop 0
    buffer_load_dwordx4 v11, s[16:19], s72 offen lds
    s_add_u32 s72, s72, s71
    s_add_u32 m0, s70, 29696
    s_nop 0
    buffer_load_dwordx4 v10, s[12:15], s72 offen lds
    s_add_u32 m0, s70, 31744
    s_nop 0
    buffer_load_dwordx4 v11, s[16:19], s72 offen lds
    s_add_u32 s72, s72, s71
    s_add_u32 m0, s70, 32768
    s_nop 0
    buffer_load_dwordx4 v10, s[12:15], s72 offen lds
    s_add_u32 m0, s70, 34816
    s_nop 0
    buffer_load_dwordx4 v11, s[16:19], s72 offen lds
    s_add_u32 s72, s72, s71
    s_add_u32 m0, s70, 33792
    s_nop 0
    buffer_load_dwordx4 v10, s[12:15], s72 offen lds
    s_add_u32 m0, s70, 35840
    s_nop 0
    buffer_load_dwordx4 v11, s[16:19], s72 offen lds
    s_add_u32 s72, s72, s71
    s_add_u32 m0, s70, 36864
    s_nop 0
    buffer_load_dwordx4 v10, s[12:15], s72 offen lds
    s_add_u32 m0, s70, 38912
    s_nop 0
    buffer_load_dwordx4 v11, s[16:19], s72 offen lds
    s_add_u32 s72, s72, s71
    s_add_u32 m0, s70, 37888
    s_nop 0
    buffer_load_dwordx4 v10, s[12:15], s72 offen lds
    s_add_u32 m0, s70, 39936
    s_nop 0
    buffer_load_dwordx4 v11, s[16:19], s72 offen lds
    s_add_u32 s72, s72, s71
    s_waitcnt vmcnt(36)
    ds_read_b64_tr_b16 v[192:193], v20 offset:0
    ds_read_b64_tr_b16 v[194:195], v21 offset:0
    ds_read_b64_tr_b16 v[196:197], v20 offset:32
    ds_read_b64_tr_b16 v[198:199], v21 offset:32
    ds_read_b64_tr_b16 v[200:201], v22 offset:0
    ds_read_b64_tr_b16 v[202:203], v23 offset:0
    ds_read_b64_tr_b16 v[204:205], v22 offset:32
    ds_read_b64_tr_b16 v[206:207], v23 offset:32
    s_waitcnt lgkmcnt(0)
    s_add_u32 m0, s70, 0
    s_nop 0
    buffer_load_dwordx4 v10, s[12:15], s72 offen lds
    s_add_u32 m0, s70, 2048
    s_nop 0
    buffer_load_dwordx4 v11, s[16:19], s72 offen lds
    s_add_u32 s72, s72, s71
    s_add_u32 m0, s70, 1024
    s_nop 0
    buffer_load_dwordx4 v10, s[12:15], s72 offen lds
    s_add_u32 m0, s70, 3072
    s_nop 0
    buffer_load_dwordx4 v11, s[16:19], s72 offen lds
    s_add_u32 s72, s72, s71
    s_waitcnt vmcnt(36)
    ds_read_b64_tr_b16 v[208:209], v20 offset:4096
    ds_read_b64_tr_b16 v[210:211], v21 offset:4096
    ds_read_b64_tr_b16 v[212:213], v20 offset:4128
    ds_read_b64_tr_b16 v[214:215], v21 offset:4128
    ds_read_b64_tr_b16 v[216:217], v22 offset:4096
    ds_read_b64_tr_b16 v[218:219], v23 offset:4096
    ds_read_b64_tr_b16 v[220:221], v22 offset:4128
    ds_read_b64_tr_b16 v[222:223], v23 offset:4128
    s_waitcnt lgkmcnt(0)
    s_add_u32 m0, s70, 4096
    s_nop 0
    buffer_load_dwordx4 v10, s[12:15], s72 offen lds
    s_add_u32 m0, s70, 6144
    s_nop 0
    buffer_load_dwordx4 v11, s[16:19], s72 offen lds
    s_add_u32 s72, s72, s71
    s_add_u32 m0, s70, 5120
    s_nop 0
    buffer_load_dwordx4 v10, s[12:15], s72 offen lds
    s_add_u32 m0, s70, 7168
    s_nop 0
    buffer_load_dwordx4 v11, s[16:19], s72 offen lds
    s_add_u32 s72, s72, s71
    s_waitcnt vmcnt(36)
    ds_read_b64_tr_b16 v[224:225], v20 offset:8192
    ds_read_b64_tr_b16 v[226:227], v21 offset:8192
    ds_read_b64_tr_b16 v[228:229], v20 offset:8224
    ds_read_b64_tr_b16 v[230:231], v21 offset:8224
    ds_read_b64_tr_b16 v[232:233], v22 offset:8192
    ds_read_b64_tr_b16 v[234:235], v23 offset:8192
    ds_read_b64_tr_b16 v[236:237], v22 offset:8224
    ds_read_b64_tr_b16 v[238:239], v23 offset:8224
    s_waitcnt lgkmcnt(0)
    s_add_u32 m0, s70, 8192
    s_nop 0
    buffer_load_dwordx4 v10, s[12:15], s72 offen lds
    s_add_u32 m0, s70, 10240
    s_nop 0
    buffer_load_dwordx4 v11, s[16:19], s72 offen lds
    s_add_u32 s72, s72, s71
    s_add_u32 m0, s70, 9216
    s_nop 0
    buffer_load_dwordx4 v10, s[12:15], s72 offen lds
    s_add_u32 m0, s70, 11264
    s_nop 0
    buffer_load_dwordx4 v11, s[16:19], s72 offen lds
    s_add_u32 s72, s72, s71
    s_waitcnt vmcnt(36)
    s_cmp_eq_u32 s53, s63
    s_cbranch_scc0 L_arr_103
    s_mov_b64 exec, 1
    v_cmp_eq_u32 vcc, 255, v7
    s_cbranch_vccz L_arr_103_x
    v_mov_b32 v5, 8
    buffer_load_dwordx3 v[4:6], v5, s[8:11], 0 offen offset:8 sc1
    s_waitcnt vmcnt(0)
    v_cmp_lt_u32 vcc, v4, v5
    v_mov_b32 v4, 0x2001
    v_lshlrev_b32 v6, 1, v6
    v_cndmask_b32 v4, 1, v4, vcc
    v_or_b32 v4, v4, v6
    v_mov_b32 v5, 252
    buffer_store_dword v4, v5, s[8:11], 0 offen sc1
L_arr_103_x:
    s_mov_b64 exec, -1
L_arr_103:
    ds_read_b64_tr_b16 v[240:241], v20 offset:12288
    ds_read_b64_tr_b16 v[242:243], v21 offset:12288
    ds_read_b64_tr_b16 v[244:245], v20 offset:12320
    ds_read_b64_tr_b16 v[246:247], v21 offset:12320
    ds_read_b64_tr_b16 v[248:249], v22 offset:12288
    ds_read_b64_tr_b16 v[250:251], v23 offset:12288
    ds_read_b64_tr_b16 v[252:253], v22 offset:12320
    ds_read_b64_tr_b16 v[254:255], v23 offset:12320
    s_waitcnt lgkmcnt(0)
    s_add_u32 m0, s70, 12288
    s_nop 0
    buffer_load_dwordx4 v10, s[12:15], s72 offen lds
    s_add_u32 m0, s70, 14336
    s_nop 0
    buffer_load_dwordx4 v11, s[16:19], s72 offen lds
    s_add_u32 s72, s72, s71
    s_add_u32 m0, s70, 13312
    s_nop 0
    buffer_load_dwordx4 v10, s[12:15], s72 offen lds
    s_add_u32 m0, s70, 15360
    s_nop 0
    buffer_load_dwordx4 v11, s[16:19], s72 offen lds
    s_add_u32 s72, s72, s71
    s_waitcnt vmcnt(36)
    ds_read_b64_tr_b16 a[0:1], v20 offset:16384
    ds_read_b64_tr_b16 a[2:3], v21 offset:16384
    ds_read_b64_tr_b16 a[4:5], v20 offset:16416
    ds_read_b64_tr_b16 a[6:7], v21 offset:16416
    ds_read_b64_tr_b16 a[8:9], v22 offset:16384
    ds_read_b64_tr_b16 a[10:11], v23 offset:16384
    ds_read_b64_tr_b16 a[12:13], v22 offset:16416
    ds_read_b64_tr_b16 a[14:15], v23 offset:16416
    s_waitcnt lgkmcnt(0)
    s_add_u32 m0, s70, 16384
    s_nop 0
    buffer_load_dwordx4 v10, s[12:15], s72 offen lds
    s_add_u32 m0, s70, 18432
    s_nop 0
    buffer_load_dwordx4 v11, s[16:19], s72 offen lds
    s_add_u32 s72, s72, s71
    s_add_u32 m0, s70, 17408
    s_nop 0
    buffer_load_dwordx4 v10, s[12:15], s72 offen lds
    s_add_u32 m0, s70, 19456
    s_nop 0
    buffer_load_dwordx4 v11, s[16:19], s72 offen lds
    s_add_u32 s72, s72, s71
    s_waitcnt vmcnt(36)
    ds_read_b64_tr_b16 a[16:17], v20 offset:20480
    ds_read_b64_tr_b16 a[18:19], v21 offset:20480
    ds_read_b64_tr_b16 a[20:21], v20 offset:20512
    ds_read_b64_tr_b16 a[22:23], v21 offset:20512
    ds_read_b64_tr_b16 a[24:25], v22 offset:20480
    ds_read_b64_tr_b16 a[26:27], v23 offset:20480
    ds_read_b64_tr_b16 a[28:29], v22 offset:20512
    ds_read_b64_tr_b16 a[30:31], v23 offset:20512
    s_waitcnt lgkmcnt(0)
    s_add_u32 m0, s70, 20480
    s_nop 0
    buffer_load_dwordx4 v10, s[12:15], s72 offen lds
    s_add_u32 m0, s70, 22528
    s_nop 0
    buffer_load_dwordx4 v11, s[16:19], s72 offen lds
    s_add_u32 s72, s72, s71
    s_add_u32 m0, s70, 21504
    s_nop 0
    buffer_load_dwordx4 v10, s[12:15], s72 offen lds
    s_add_u32 m0, s70, 23552
    s_nop 0
    buffer_load_dwordx4 v11, s[16:19], s72 offen lds
    s_add_u32 s72, s72, s71
    s_waitcnt vmcnt(36)
    ds_read_b64_tr_b16 a[32:33], v20 offset:24576
    ds_read_b64_tr_b16 a[34:35], v21 offset:24576
    ds_read_b64_tr_b16 a[36:37], v20 offset:24608
    ds_read_b64_tr_b16 a[38:39], v21 offset:24608
    ds_read_b64_tr_b16 a[40:41], v22 offset:24576
    ds_read_b64_tr_b16 a[42:43], v23 offset:24576
    ds_read_b64_tr_b16 a[44:45], v22 offset:24608
    ds_read_b64_tr_b16 a[46:47], v23 offset:24608
    s_waitcnt lgkmcnt(0)
    s_add_u32 m0, s70, 24576
    s_nop 0
    buffer_load_dwordx4 v10, s[12:15], s72 offen lds
    s_add_u32 m0, s70, 26624
    s_nop 0
    buffer_load_dwordx4 v11, s[16:19], s72 offen lds
    s_add_u32 s72, s72, s71
    s_add_u32 m0, s70, 25600
    s_nop 0
    buffer_load_dwordx4 v10, s[12:15], s72 offen lds
    s_add_u32 m0, s70, 27648
    s_nop 0
    buffer_load_dwordx4 v11, s[16:19], s72 offen lds
    s_add_u32 s72, s72, s71
    s_waitcnt vmcnt(36)
    ds_read_b64_tr_b16 a[48:49], v20 offset:28672
    ds_read_b64_tr_b16 a[50:51], v21 offset:28672
    ds_read_b64_tr_b16 a[52:53], v20 offset:28704
    ds_read_b64_tr_b16 a[54:55], v21 offset:28704
    ds_read_b64_tr_b16 a[56:57], v22 offset:28672
    ds_read_b64_tr_b16 a[58:59], v23 offset:28672
    ds_read_b64_tr_b16 a[60:61], v22 offset:28704
    ds_read_b64_tr_b16 a[62:63], v23 offset:28704
    s_waitcnt lgkmcnt(0)
    s_add_u32 m0, s70, 28672
    s_nop 0
    buffer_load_dwordx4 v10, s[12:15], s72 offen lds
    s_add_u32 m0, s70, 30720
    s_nop 0
    buffer_load_dwordx4 v11, s[16:19], s72 offen lds
    s_add_u32 s72, s72, s71
    s_add_u32 m0, s70, 29696
    s_nop 0
    buffer_load_dwordx4 v10, s[12:15], s72 offen lds
    s_add_u32 m0, s70, 31744
    s_nop 0
    buffer_load_dwordx4 v11, s[16:19], s72 offen lds
    s_add_u32 s72, s72, s71
    s_waitcnt vmcnt(36)
    ds_read_b64_tr_b16 a[64:65], v20 offset:32768
    ds_read_b64_tr_b16 a[66:67], v21 offset:32768
    ds_read_b64_tr_b16 a[68:69], v20 offset:32800
    ds_read_b64_tr_b16 a[70:71], v21 offset:32800
    ds_read_b64_tr_b16 a[72:73], v22 offset:32768
    ds_read_b64_tr_b16 a[74:75], v23 offset:32768
    ds_read_b64_tr_b16 a[76:77], v22 offset:32800
    ds_read_b64_tr_b16 a[78:79], v23 offset:32800
    s_waitcnt lgkmcnt(0)
    s_add_u32 m0, s70, 32768
    s_nop 0
    buffer_load_dwordx4 v10, s[12:15], s72 offen lds
    s_add_u32 m0, s70, 34816
    s_nop 0
    buffer_load_dwordx4 v11, s[16:19], s72 offen lds
    s_add_u32 s72, s72, s71
    s_add_u32 m0, s70, 33792
    s_nop 0
    buffer_load_dwordx4 v10, s[12:15], s72 offen lds
    s_add_u32 m0, s70, 35840
    s_nop 0
    buffer_load_dwordx4 v11, s[16:19], s72 offen lds
    s_add_u32 s72, s72, s71
    s_waitcnt vmcnt(36)
    ds_read_b64_tr_b16 a[80:81], v20 offset:36864
    ds_read_b64_tr_b16 a[82:83], v21 offset:36864
    ds_read_b64_tr_b16 a[84:85], v20 offset:36896
    ds_read_b64_tr_b16 a[86:87], v21 offset:36896
    ds_read_b64_tr_b16 a[88:89], v22 offset:36864
    ds_read_b64_tr_b16 a[90:91], v23 offset:36864
    ds_read_b64_tr_b16 a[92:93], v22 offset:36896
    ds_read_b64_tr_b16 a[94:95], v23 offset:36896
    s_waitcnt lgkmcnt(0)
    s_add_u32 m0, s70, 36864
    s_nop 0
    buffer_load_dwordx4 v10, s[12:15], s72 offen lds
    s_add_u32 m0, s70, 38912
    s_nop 0
    buffer_load_dwordx4 v11, s[16:19], s72 offen lds
    s_add_u32 s72, s72, s71
    s_add_u32 m0, s70, 37888
    s_nop 0
    buffer_load_dwordx4 v10, s[12:15], s72 offen lds
    s_add_u32 m0, s70, 39936
    s_nop 0
    buffer_load_dwordx4 v11, s[16:19], s72 offen lds
    s_add_u32 s72, s72, s71
    s_waitcnt vmcnt(36)
    ds_read_b64_tr_b16 a[96:97], v20 offset:0
    ds_read_b64_tr_b16 a[98:99], v21 offset:0
    ds_read_b64_tr_b16 a[100:101], v20 offset:32
    ds_read_b64_tr_b16 a[102:103], v21 offset:32
    ds_read_b64_tr_b16 a[104:105], v22 offset:0
    ds_read_b64_tr_b16 a[106:107], v23 offset:0
    ds_read_b64_tr_b16 a[108:109], v22 offset:32
    ds_read_b64_tr_b16 a[110:111], v23 offset:32
    s_waitcnt lgkmcnt(0)
    s_waitcnt vmcnt(32)
    ds_read_b64_tr_b16 a[112:113], v20 offset:4096
    ds_read_b64_tr_b16 a[114:115], v21 offset:4096
    ds_read_b64_tr_b16 a[116:117], v20 offset:4128
    ds_read_b64_tr_b16 a[118:119], v21 offset:4128
    ds_read_b64_tr_b16 a[120:121], v22 offset:4096
    ds_read_b64_tr_b16 a[122:123], v23 offset:4096
    ds_read_b64_tr_b16 a[124:125], v22 offset:4128
    ds_read_b64_tr_b16 a[126:127], v23 offset:4128
    s_waitcnt lgkmcnt(0)
    s_waitcnt vmcnt(28)
    ds_read_b64_tr_b16 a[128:129], v20 offset:8192
    ds_read_b64_tr_b16 a[130:131], v21 offset:8192
    ds_read_b64_tr_b16 a[132:133], v20 offset:8224
    ds_read_b64_tr_b16 a[134:135], v21 offset:8224
    ds_read_b64_tr_b16 a[136:137], v22 offset:8192
    ds_read_b64_tr_b16 a[138:139], v23 offset:8192
    ds_read_b64_tr_b16 a[140:141], v22 offset:8224
    ds_read_b64_tr_b16 a[142:143], v23 offset:8224
    s_waitcnt lgkmcnt(0)
    s_waitcnt vmcnt(24)
    ds_read_b64_tr_b16 a[144:145], v20 offset:12288
    ds_read_b64_tr_b16 a[146:147], v21 offset:12288
    ds_read_b64_tr_b16 a[148:149], v20 offset:12320
    ds_read_b64_tr_b16 a[150:151], v21 offset:12320
    ds_read_b64_tr_b16 a[152:153], v22 offset:12288
    ds_read_b64_tr_b16 a[154:155], v23 offset:12288
    ds_read_b64_tr_b16 a[156:157], v22 offset:12320
    ds_read_b64_tr_b16 a[158:159], v23 offset:12320
    s_waitcnt lgkmcnt(0)
    s_waitcnt vmcnt(20)
    ds_read_b64_tr_b16 a[160:161], v20 offset:16384
    ds_read_b64_tr_b16 a[162:163], v21 offset:16384
    ds_read_b64_tr_b16 a[164:165], v20 offset:16416
    ds_read_b64_tr_b16 a[166:167], v21 offset:16416
    ds_read_b64_tr_b16 a[168:169], v22 offset:16384
    ds_read_b64_tr_b16 a[170:171], v23 offset:16384
    ds_read_b64_tr_b16 a[172:173], v22 offset:16416
    ds_read_b64_tr_b16 a[174:175], v23 offset:16416
    s_waitcnt lgkmcnt(0)
    s_waitcnt vmcnt(16)
    ds_read_b64_tr_b16 a[176:177], v20 offset:20480
    ds_read_b64_tr_b16 a[178:179], v21 offset:20480
    ds_read_b64_tr_b16 a[180:181], v20 offset:20512
    ds_read_b64_tr_b16 a[182:183], v21 offset:20512
    ds_read_b64_tr_b16 a[184:185], v22 offset:20480
    ds_read_b64_tr_b16 a[186:187], v23 offset:20480
    ds_read_b64_tr_b16 a[188:189], v22 offset:20512
    ds_read_b64_tr_b16 a[190:191], v23 offset:20512
    s_waitcnt lgkmcnt(0)
    s_waitcnt vmcnt(12)
    ds_read_b64_tr_b16 a[192:193], v20 offset:24576
    ds_read_b64_tr_b16 a[194:195], v21 offset:24576
    ds_read_b64_tr_b16 a[196:197], v20 offset:24608
    ds_read_b64_tr_b16 a[198:199], v21 offset:24608
    ds_read_b64_tr_b16 a[200:201], v22 offset:24576
    ds_read_b64_tr_b16 a[202:203], v23 offset:24576
    ds_read_b64_tr_b16 a[204:205], v22 offset:24608
    ds_read_b64_tr_b16 a[206:207], v23 offset:24608
    s_waitcnt lgkmcnt(0)
    s_waitcnt vmcnt(8)
    ds_read_b64_tr_b16 a[208:209], v20 offset:28672
    ds_read_b64_tr_b16 a[210:211], v21 offset:28672
    ds_read_b64_tr_b16 a[212:213], v20 offset:28704
    ds_read_b64_tr_b16 a[214:215], v21 offset:28704
    ds_read_b64_tr_b16 a[216:217], v22 offset:28672
    ds_read_b64_tr_b16 a[218:219], v23 offset:28672
    ds_read_b64_tr_b16 a[220:221], v22 offset:28704
    ds_read_b64_tr_b16 a[222:223], v23 offset:28704
    s_waitcnt lgkmcnt(0)
    s_waitcnt vmcnt(4)
    ds_read_b64_tr_b16 a[224:225], v20 offset:32768
    ds_read_b64_tr_b16 a[226:227], v21 offset:32768
    ds_read_b64_tr_b16 a[228:229], v20 offset:32800
    ds_read_b64_tr_b16 a[230:231], v21 offset:32800
    ds_read_b64_tr_b16 a[232:233], v22 offset:32768
    ds_read_b64_tr_b16 a[234:235], v23 offset:32768
    ds_read_b64_tr_b16 a[236:237], v22 offset:32800
    ds_read_b64_tr_b16 a[238:239], v23 offset:32800
    s_waitcnt lgkmcnt(0)
    s_waitcnt vmcnt(0)
    ds_read_b64_tr_b16 a[240:241], v20 offset:36864
    ds_read_b64_tr_b16 a[242:243], v21 offset:36864
    ds_read_b64_tr_b16 a[244:245], v20 offset:36896
    ds_read_b64_tr_b16 a[246:247], v21 offset:36896
    ds_read_b64_tr_b16 a[248:249], v22 offset:36864
    ds_read_b64_tr_b16 a[250:251], v23 offset:36864
    ds_read_b64_tr_b16 a[252:253], v22 offset:36896
    ds_read_b64_tr_b16 a[254:255], v23 offset:36896
    s_waitcnt lgkmcnt(0)
    s_mov_b32 s96, 2000000
    v_mov_b32 v5, 252
L_aw_104:
    buffer_load_dword v4, v5, s[8:11], 0 offen sc1
    s_sub_u32 s96, s96, 1
    s_cbranch_scc1 L_fail
    s_waitcnt vmcnt(0)
    v_cmp_eq_u32 vcc, 0, v4
    s_cbranch_vccz L_aw_104_d
    s_sleep 16
    s_branch L_aw_104
L_aw_104_d:
    v_readfirstlane_b32 s61, v4
    s_nop 3
    s_and_b32 s60, s61, 8192
    s_and_b32 s3, s61, 2
    s_barrier
    v_lshlrev_b32 v13, 4, v1
    s_mul_i32 s70, s53, 10240
    s_add_u32 s72, s70, 23068672
    s_mov_b32 s73, s70
    s_mov_b32 s74, 0
    s_mov_b32 s55, 0
    s_add_u32 s75, s72, 0
    s_add_u32 m0, s73, 0
    s_nop 0
    buffer_load_dwordx4 v13, s[4:7], s75 offen sc1 lds
    s_add_u32 s75, s72, 1024
    s_add_u32 m0, s73, 1024
    s_nop 0
    buffer_load_dwordx4 v13, s[4:7], s75 offen sc1 lds
    s_add_u32 s75, s72, 2048
    s_add_u32 m0, s73, 2048
    s_nop 0
    buffer_load_dwordx4 v13, s[4:7], s75 offen sc1 lds
    s_add_u32 s75, s72, 3072
    s_add_u32 m0, s73, 3072
    s_nop 0
    buffer_load_dwordx4 v13, s[4:7], s75 offen sc1 lds
    s_add_u32 s75, s72, 4096
    s_add_u32 m0, s73, 4096
    s_nop 0
    buffer_load_dwordx4 v13, s[4:7], s75 offen sc1 lds
    s_add_u32 s75, s72, 5120
    s_add_u32 m0, s73, 5120
    s_nop 0
    buffer_load_dwordx4 v13, s[4:7], s75 offen sc1 lds
    s_add_u32 s75, s72, 6144
    s_add_u32 m0, s73, 6144
    s_nop 0
    buffer_load_dwordx4 v13, s[4:7], s75 offen sc1 lds
    s_add_u32 s75, s72, 7168
    s_add_u32 m0, s73, 7168
    s_nop 0
    buffer_load_dwordx4 v13, s[4:7], s75 offen sc1 lds
    s_add_u32 s75, s72, 8192
    s_add_u32 m0, s73, 8192
    s_nop 0
    buffer_load_dwordx4 v13, s[4:7], s75 offen sc1 lds
    s_add_u32 s75, s72, 9216
    s_add_u32 m0, s73, 9216
    s_nop 0
    buffer_load_dwordx4 v13, s[4:7], s75 offen sc1 lds
    s_add_u32 s72, s72, 40960
    s_add_u32 s73, s73, 40960
    s_cmp_lt_u32 s73, 122880
    s_cselect_b32 s73, s73, s70
    s_add_u32 s75, s72, 0
    s_add_u32 m0, s73, 0
    s_nop 0
    buffer_load_dwordx4 v13, s[4:7], s75 offen sc1 lds
    s_add_u32 s75, s72, 1024
    s_add_u32 m0, s73, 1024
    s_nop 0
    buffer_load_dwordx4 v13, s[4:7], s75 offen sc1 lds
    s_add_u32 s75, s72, 2048
    s_add_u32 m0, s73, 2048
    s_nop 0
    buffer_load_dwordx4 v13, s[4:7], s75 offen sc1 lds
    s_add_u32 s75, s72, 3072
    s_add_u32 m0, s73, 3072
    s_nop 0
    buffer_load_dwordx4 v13, s[4:7], s75 offen sc1 lds
    s_add_u32 s75, s72, 4096
    s_add_u32 m0, s73, 4096
    s_nop 0
    buffer_load_dwordx4 v13, s[4:7], s75 offen sc1 lds
    s_add_u32 s75, s72, 5120
    s_add_u32 m0, s73, 5120
    s_nop 0
    buffer_load_dwordx4 v13, s[4:7], s75 offen sc1 lds
    s_add_u32 s75, s72, 6144
    s_add_u32 m0, s73, 6144
    s_nop 0
    buffer_load_dwordx4 v13, s[4:7], s75 offen sc1 lds
    s_add_u32 s75, s72, 7168
    s_add_u32 m0, s73, 7168
    s_nop 0
    buffer_load_dwordx4 v13, s[4:7], s75 offen sc1 lds
    s_add_u32 s75, s72, 8192
    s_add_u32 m0, s73, 8192
    s_nop 0
    buffer_load_dwordx4 v13, s[4:7], s75 offen sc1 lds
    s_add_u32 s75, s72, 9216
    s_add_u32 m0, s73, 9216
    s_nop 0
    buffer_load_dwordx4 v13, s[4:7], s75 offen sc1 lds
    s_add_u32 s72, s72, 40960
    s_add_u32 s73, s73, 40960
    s_cmp_lt_u32 s73, 122880
    s_cselect_b32 s73, s73, s70
    s_mov_b32 s76, 0xbdd2d3e8
    s_mov_b32 s77, 0xc0135761
    v_mov_b32 v15, s77
    v_add_u32 v16, 0x40000000, v13
    s_mul_i32 s56, s68, s79
    s_add_u32 s67, s67, s56
    v_mov_b32 v17, 18972672
    v_mov_b32 v18, 0
    s_waitcnt vmcnt(10)
    s_barrier
    s_cmp_eq_u32 s69, 0
    s_cbranch_scc0 L_xf_loop
L_xw_loop:
    s_sub_u32 s79, s55, 13
    s_max_i32 s79, s79, 0
    s_waitcnt vmcnt(10)
    v_cmp_gt_u32 vcc, s79, v18
    s_cbranch_vccz L_xw_go_109
    s_mov_b32 s96, 2000000
L_wf_110:
    buffer_load_dword v18, v17, s[4:7], 0 offen sc1
    s_sub_u32 s96, s96, 1
    s_cbranch_scc1 L_fail
    s_waitcnt vmcnt(0)
    v_cmp_gt_u32 vcc, s79, v18
    s_cbranch_vccz L_wf_110_d
    s_sleep 16
    s_branch L_wf_110
L_wf_110_d:
L_xw_go_109:
    v_add_u32 v14, s74, v13
    ds_read_b128 v[32:35], v14 offset:0
    ds_read_b128 v[36:39], v14 offset:1024
    ds_read_b128 v[40:43], v14 offset:2048
    ds_read_b128 v[44:47], v14 offset:3072
    ds_read_b128 v[48:51], v14 offset:4096
    ds_read_b128 v[52:55], v14 offset:5120
    s_waitcnt lgkmcnt(4)
    v_mfma_f32_16x16x32_bf16 v[64:67], v[192:195], v[32:35], 0
    v_mfma_f32_16x16x32_bf16 v[68:71], v[196:199], v[32:35], 0
    v_mfma_f32_16x16x32_bf16 v[72:75], v[200:203], v[32:35], 0
    v_cvt_pk_bf16_f32 v128, v96, v97
    v_cvt_pk_bf16_f32 v129, v98, v99
    v_mfma_f32_16x16x32_bf16 v[76:79], v[204:207], v[32:35], 0
    v_cvt_pk_bf16_f32 v130, v100, v101
    v_cvt_pk_bf16_f32 v131, v102, v103
    v_mfma_f32_16x16x32_bf16 v[80:83], v[192:195], v[36:39], 0
    buffer_store_dwordx4 v[128:131], v16, s[4:7], s67 offen offset:0 sc1
    v_mfma_f32_16x16x32_bf16 v[84:87], v[196:199], v[36:39], 0
    v_cvt_pk_bf16_f32 v132, v104, v105
    v_cvt_pk_bf16_f32 v133, v106, v107
    v_mfma_f32_16x16x32_bf16 v[88:91], v[200:203], v[36:39], 0
    v_cvt_pk_bf16_f32 v134, v108, v109
    v_cvt_pk_bf16_f32 v135, v110, v111
    v_mfma_f32_16x16x32_bf16 v[92:95], v[204:207], v[36:39], 0
    buffer_store_dwordx4 v[132:135], v16, s[4:7], s67 offen offset:2048 sc1
    ds_read_b128 v[32:35], v14 offset:6144
    ds_read_b128 v[36:39], v14 offset:7168
    s_waitcnt lgkmcnt(4)
    v_mfma_f32_16x16x32_bf16 v[64:67], v[208:211], v[40:43], v[64:67]
    v_cvt_pk_bf16_f32 v136, v112, v113
    v_cvt_pk_bf16_f32 v137, v114, v115
    v_mfma_f32_16x16x32_bf16 v[68:71], v[212:215], v[40:43], v[68:71]
    v_cvt_pk_bf16_f32 v138, v116, v117
    v_cvt_pk_bf16_f32 v139, v118, v119
    v_mfma_f32_16x16x32_bf16 v[72:75], v[216:219], v[40:43], v[72:75]
    buffer_store_dwordx4 v[136:139], v16, s[4:7], s67 offen offset:1024 sc1
    v_mfma_f32_16x16x32_bf16 v[76:79], v[220:223], v[40:43], v[76:79]
    v_cvt_pk_bf16_f32 v140, v120, v121
    v_cvt_pk_bf16_f32 v141, v122, v123
    v_mfma_f32_16x16x32_bf16 v[80:83], v[208:211], v[44:47], v[80:83]
    v_cvt_pk_bf16_f32 v142, v124, v125
    v_cvt_pk_bf16_f32 v143, v126, v127
    v_mfma_f32_16x16x32_bf16 v[84:87], v[212:215], v[44:47], v[84:87]
    buffer_store_dwordx4 v[140:143], v16, s[4:7], s67 offen offset:3072 sc1
    v_mfma_f32_16x16x32_bf16 v[88:91], v[216:219], v[44:47], v[88:91]
    v_mfma_f32_16x16x32_bf16 v[92:95], v[220:223], v[44:47], v[92:95]
    ds_read_b128 v[40:43], v14 offset:8192
    ds_read_b128 v[44:47], v14 offset:9216
    s_waitcnt lgkmcnt(4)
    v_mfma_f32_16x16x32_bf16 v[64:67], v[224:227], v[48:51], v[64:67]
    v_mfma_f32_16x16x32_bf16 v[68:71], v[228:231], v[48:51], v[68:71]
    v_mfma_f32_16x16x32_bf16 v[72:75], v[232:235], v[48:51], v[72:75]
    v_mfma_f32_16x16x32_bf16 v[76:79], v[236:239], v[48:51], v[76:79]
    v_mfma_f32_16x16x32_bf16 v[80:83], v[224:227], v[52:55], v[80:83]
    v_mfma_f32_16x16x32_bf16 v[84:87], v[228:231], v[52:55], v[84:87]
    v_mfma_f32_16x16x32_bf16 v[88:91], v[232:235], v[52:55], v[88:91]
    v_mfma_f32_16x16x32_bf16 v[92:95], v[236:239], v[52:55], v[92:95]
    ds_read_b128 v[48:51], v14 offset:10240
    ds_read_b128 v[52:55], v14 offset:11264
    s_waitcnt lgkmcnt(4)
    v_mfma_f32_16x16x32_bf16 v[64:67], v[240:243], v[32:35], v[64:67]
    v_mfma_f32_16x16x32_bf16 v[68:71], v[244:247], v[32:35], v[68:71]
    v_mfma_f32_16x16x32_bf16 v[72:75], v[248:251], v[32:35], v[72:75]
    v_mfma_f32_16x16x32_bf16 v[76:79], v[252:255], v[32:35], v[76:79]
    v_mfma_f32_16x16x32_bf16 v[80:83], v[240:243], v[36:39], v[80:83]
    v_mfma_f32_16x16x32_bf16 v[84:87], v[244:247], v[36:39], v[84:87]
    v_mfma_f32_16x16x32_bf16 v[88:91], v[248:251], v[36:39], v[88:91]
    v_mfma_f32_16x16x32_bf16 v[92:95], v[252:255], v[36:39], v[92:95]
    ds_read_b128 v[32:35], v14 offset:12288
    ds_read_b128 v[36:39], v14 offset:13312
    s_waitcnt lgkmcnt(4)
    v_mfma_f32_16x16x32_bf16 v[64:67], a[0:3], v[40:43], v[64:67]
    v_mfma_f32_16x16x32_bf16 v[68:71], a[4:7], v[40:43], v[68:71]
    v_mfma_f32_16x16x32_bf16 v[72:75], a[8:11], v[40:43], v[72:75]
    v_mfma_f32_16x16x32_bf16 v[76:79], a[12:15], v[40:43], v[76:79]
    v_mfma_f32_16x16x32_bf16 v[80:83], a[0:3], v[44:47], v[80:83]
    v_mfma_f32_16x16x32_bf16 v[84:87], a[4:7], v[44:47], v[84:87]
    v_mfma_f32_16x16x32_bf16 v[88:91], a[8:11], v[44:47], v[88:91]
    v_mfma_f32_16x16x32_bf16 v[92:95], a[12:15], v[44:47], v[92:95]
    ds_read_b128 v[40:43], v14 offset:14336
    ds_read_b128 v[44:47], v14 offset:15360
    s_waitcnt lgkmcnt(4)
    v_mfma_f32_16x16x32_bf16 v[64:67], a[16:19], v[48:51], v[64:67]
    v_mfma_f32_16x16x32_bf16 v[68:71], a[20:23], v[48:51], v[68:71]
    v_mfma_f32_16x16x32_bf16 v[72:75], a[24:27], v[48:51], v[72:75]
    v_mfma_f32_16x16x32_bf16 v[76:79], a[28:31], v[48:51], v[76:79]
    v_mfma_f32_16x16x32_bf16 v[80:83], a[16:19], v[52:55], v[80:83]
    v_mfma_f32_16x16x32_bf16 v[84:87], a[20:23], v[52:55], v[84:87]
    v_mfma_f32_16x16x32_bf16 v[88:91], a[24:27], v[52:55], v[88:91]
    v_mfma_f32_16x16x32_bf16 v[92:95], a[28:31], v[52:55], v[92:95]
    ds_read_b128 v[48:51], v14 offset:16384
    ds_read_b128 v[52:55], v14 offset:17408
    s_waitcnt lgkmcnt(4)
    v_mfma_f32_16x16x32_bf16 v[64:67], a[32:35], v[32:35], v[64:67]
    v_mfma_f32_16x16x32_bf16 v[68:71], a[36:39], v[32:35], v[68:71]
    v_mfma_f32_16x16x32_bf16 v[72:75], a[40:43], v[32:35], v[72:75]
    v_mfma_f32_16x16x32_bf16 v[76:79], a[44:47], v[32:35], v[76:79]
    v_mfma_f32_16x16x32_bf16 v[80:83], a[32:35], v[36:39], v[80:83]
    v_mfma_f32_16x16x32_bf16 v[84:87], a[36:39], v[36:39], v[84:87]
    v_mfma_f32_16x16x32_bf16 v[88:91], a[40:43], v[36:39], v[88:91]
    v_mfma_f32_16x16x32_bf16 v[92:95], a[44:47], v[36:39], v[92:95]
    ds_read_b128 v[32:35], v14 offset:18432
    ds_read_b128 v[36:39], v14 offset:19456
    s_waitcnt lgkmcnt(4)
    v_mfma_f32_16x16x32_bf16 v[64:67], a[48:51], v[40:43], v[64:67]
    v_mfma_f32_16x16x32_bf16 v[68:71], a[52:55], v[40:43], v[68:71]
    v_mfma_f32_16x16x32_bf16 v[72:75], a[56:59], v[40:43], v[72:75]
    v_mfma_f32_16x16x32_bf16 v[76:79], a[60:63], v[40:43], v[76:79]
    v_mfma_f32_16x16x32_bf16 v[80:83], a[48:51], v[44:47], v[80:83]
    v_mfma_f32_16x16x32_bf16 v[84:87], a[52:55], v[44:47], v[84:87]
    v_mfma_f32_16x16x32_bf16 v[88:91], a[56:59], v[44:47], v[88:91]
    v_mfma_f32_16x16x32_bf16 v[92:95], a[60:63], v[44:47], v[92:95]
    s_waitcnt vmcnt(0)
    v_mov_b32 v4, s55
    buffer_store_dword v4, v8, s[4:7], s66 offen sc1
    ds_read_b128 v[40:43], v14 offset:20480
    ds_read_b128 v[44:47], v14 offset:21504
    s_waitcnt lgkmcnt(4)
    v_mfma_f32_16x16x32_bf16 v[64:67], a[64:67], v[48:51], v[64:67]
    v_mfma_f32_16x16x32_bf16 v[68:71], a[68:71], v[48:51], v[68:71]
    v_mfma_f32_16x16x32_bf16 v[72:75], a[72:75], v[48:51], v[72:75]
    v_mfma_f32_16x16x32_bf16 v[76:79], a[76:79], v[48:51], v[76:79]
    v_mfma_f32_16x16x32_bf16 v[80:83], a[64:67], v[52:55], v[80:83]
    v_mfma_f32_16x16x32_bf16 v[84:87], a[68:71], v[52:55], v[84:87]
    v_mfma_f32_16x16x32_bf16 v[88:91], a[72:75], v[52:55], v[88:91]
    v_mfma_f32_16x16x32_bf16 v[92:95], a[76:79], v[52:55], v[92:95]
    buffer_load_dword v18, v17, s[4:7], 0 offen sc1
    ds_read_b128 v[48:51], v14 offset:22528
    ds_read_b128 v[52:55], v14 offset:23552
    s_waitcnt lgkmcnt(4)
    v_mfma_f32_16x16x32_bf16 v[64:67], a[80:83], v[32:35], v[64:67]
    v_mfma_f32_16x16x32_bf16 v[68:71], a[84:87], v[32:35], v[68:71]
    v_mfma_f32_16x16x32_bf16 v[72:75], a[88:91], v[32:35], v[72:75]
    v_mfma_f32_16x16x32_bf16 v[76:79], a[92:95], v[32:35], v[76:79]
    v_mfma_f32_16x16x32_bf16 v[80:83], a[80:83], v[36:39], v[80:83]
    v_mfma_f32_16x16x32_bf16 v[84:87], a[84:87], v[36:39], v[84:87]
    v_mfma_f32_16x16x32_bf16 v[88:91], a[88:91], v[36:39], v[88:91]
    v_mfma_f32_16x16x32_bf16 v[92:95], a[92:95], v[36:39], v[92:95]
    s_waitcnt vmcnt(6)
    s_barrier
    ds_read_b128 v[32:35], v14 offset:24576
    ds_read_b128 v[36:39], v14 offset:25600
    s_waitcnt lgkmcnt(4)
    v_mfma_f32_16x16x32_bf16 v[64:67], a[96:99], v[40:43], v[64:67]
    v_mfma_f32_16x16x32_bf16 v[68:71], a[100:103], v[40:43], v[68:71]
    v_mfma_f32_16x16x32_bf16 v[72:75], a[104:107], v[40:43], v[72:75]
    v_mfma_f32_16x16x32_bf16 v[76:79], a[108:111], v[40:43], v[76:79]
    s_add_u32 s75, s72, 0
    s_add_u32 m0, s73, 0
    s_nop 0
    buffer_load_dwordx4 v13, s[4:7], s75 offen sc1 lds
    v_mfma_f32_16x16x32_bf16 v[80:83], a[96:99], v[44:47], v[80:83]
    v_mfma_f32_16x16x32_bf16 v[84:87], a[100:103], v[44:47], v[84:87]
    v_mfma_f32_16x16x32_bf16 v[88:91], a[104:107], v[44:47], v[88:91]
    v_mfma_f32_16x16x32_bf16 v[92:95], a[108:111], v[44:47], v[92:95]
    ds_read_b128 v[40:43], v14 offset:26624
    ds_read_b128 v[44:47], v14 offset:27648
    s_waitcnt lgkmcnt(4)
    v_mfma_f32_16x16x32_bf16 v[64:67], a[112:115], v[48:51], v[64:67]
    v_mfma_f32_16x16x32_bf16 v[68:71], a[116:119], v[48:51], v[68:71]
    v_mfma_f32_16x16x32_bf16 v[72:75], a[120:123], v[48:51], v[72:75]
    v_mfma_f32_16x16x32_bf16 v[76:79], a[124:127], v[48:51], v[76:79]
    s_add_u32 s75, s72, 1024
    s_add_u32 m0, s73, 1024
    s_nop 0
    buffer_load_dwordx4 v13, s[4:7], s75 offen sc1 lds
    v_mfma_f32_16x16x32_bf16 v[80:83], a[112:115], v[52:55], v[80:83]
    v_mfma_f32_16x16x32_bf16 v[84:87], a[116:119], v[52:55], v[84:87]
    v_mfma_f32_16x16x32_bf16 v[88:91], a[120:123], v[52:55], v[88:91]
    v_mfma_f32_16x16x32_bf16 v[92:95], a[124:127], v[52:55], v[92:95]
    ds_read_b128 v[48:51], v14 offset:28672
    ds_read_b128 v[52:55], v14 offset:29696
    s_waitcnt lgkmcnt(4)
    v_mfma_f32_16x16x32_bf16 v[64:67], a[128:131], v[32:35], v[64:67]
    v_mfma_f32_16x16x32_bf16 v[68:71], a[132:135], v[32:35], v[68:71]
    v_mfma_f32_16x16x32_bf16 v[72:75], a[136:139], v[32:35], v[72:75]
    v_mfma_f32_16x16x32_bf16 v[76:79], a[140:143], v[32:35], v[76:79]
    s_add_u32 s75, s72, 2048
    s_add_u32 m0, s73, 2048
    s_nop 0
    buffer_load_dwordx4 v13, s[4:7], s75 offen sc1 lds
    v_mfma_f32_16x16x32_bf16 v[80:83], a[128:131], v[36:39], v[80:83]
    v_mfma_f32_16x16x32_bf16 v[84:87], a[132:135], v[36:39], v[84:87]
    v_mfma_f32_16x16x32_bf16 v[88:91], a[136:139], v[36:39], v[88:91]
    v_mfma_f32_16x16x32_bf16 v[92:95], a[140:143], v[36:39], v[92:95]
    ds_read_b128 v[32:35], v14 offset:30720
    ds_read_b128 v[36:39], v14 offset:31744
    s_waitcnt lgkmcnt(4)
    v_mfma_f32_16x16x32_bf16 v[64:67], a[144:147], v[40:43], v[64:67]
    v_mfma_f32_16x16x32_bf16 v[68:71], a[148:151], v[40:43], v[68:71]
    v_mfma_f32_16x16x32_bf16 v[72:75], a[152:155], v[40:43], v[72:75]
    v_mfma_f32_16x16x32_bf16 v[76:79], a[156:159], v[40:43], v[76:79]
    s_add_u32 s75, s72, 3072
    s_add_u32 m0, s73, 3072
    s_nop 0
    buffer_load_dwordx4 v13, s[4:7], s75 offen sc1 lds
    v_mfma_f32_16x16x32_bf16 v[80:83], a[144:147], v[44:47], v[80:83]
    v_mfma_f32_16x16x32_bf16 v[84:87], a[148:151], v[44:47], v[84:87]
    v_mfma_f32_16x16x32_bf16 v[88:91], a[152:155], v[44:47], v[88:91]
    v_mfma_f32_16x16x32_bf16 v[92:95], a[156:159], v[44:47], v[92:95]
    ds_read_b128 v[40:43], v14 offset:32768
    ds_read_b128 v[44:47], v14 offset:33792
    s_waitcnt lgkmcnt(4)
    v_mfma_f32_16x16x32_bf16 v[64:67], a[160:163], v[48:51], v[64:67]
    v_mfma_f32_16x16x32_bf16 v[68:71], a[164:167], v[48:51], v[68:71]
    v_mfma_f32_16x16x32_bf16 v[72:75], a[168:171], v[48:51], v[72:75]
    v_mfma_f32_16x16x32_bf16 v[76:79], a[172:175], v[48:51], v[76:79]
    s_add_u32 s75, s72, 4096
    s_add_u32 m0, s73, 4096
    s_nop 0
    buffer_load_dwordx4 v13, s[4:7], s75 offen sc1 lds
    v_mfma_f32_16x16x32_bf16 v[80:83], a[160:163], v[52:55], v[80:83]
    v_mfma_f32_16x16x32_bf16 v[84:87], a[164:167], v[52:55], v[84:87]
    v_mfma_f32_16x16x32_bf16 v[88:91], a[168:171], v[52:55], v[88:91]
    v_mfma_f32_16x16x32_bf16 v[92:95], a[172:175], v[52:55], v[92:95]
    ds_read_b128 v[48:51], v14 offset:34816
    ds_read_b128 v[52:55], v14 offset:35840
    s_waitcnt lgkmcnt(4)
    v_mfma_f32_16x16x32_bf16 v[64:67], a[176:179], v[32:35], v[64:67]
    v_mfma_f32_16x16x32_bf16 v[68:71], a[180:183], v[32:35], v[68:71]
    v_mfma_f32_16x16x32_bf16 v[72:75], a[184:187], v[32:35], v[72:75]
    v_mfma_f32_16x16x32_bf16 v[76:79], a[188:191], v[32:35], v[76:79]
    s_add_u32 s75, s72, 5120
    s_add_u32 m0, s73, 5120
    s_nop 0
    buffer_load_dwordx4 v13, s[4:7], s75 offen sc1 lds
    v_mfma_f32_16x16x32_bf16 v[80:83], a[176:179], v[36:39], v[80:83]
    v_mfma_f32_16x16x32_bf16 v[84:87], a[180:183], v[36:39], v[84:87]
    v_mfma_f32_16x16x32_bf16 v[88:91], a[184:187], v[36:39], v[88:91]
    v_mfma_f32_16x16x32_bf16 v[92:95], a[188:191], v[36:39], v[92:95]
    ds_read_b128 v[32:35], v14 offset:36864
    ds_read_b128 v[36:39], v14 offset:37888
    s_waitcnt lgkmcnt(4)
    v_mfma_f32_16x16x32_bf16 v[64:67], a[192:195], v[40:43], v[64:67]
    v_mfma_f32_16x16x32_bf16 v[68:71], a[196:199], v[40:43], v[68:71]
    v_mfma_f32_16x16x32_bf16 v[72:75], a[200:203], v[40:43], v[72:75]
    v_mfma_f32_16x16x32_bf16 v[76:79], a[204:207], v[40:43], v[76:79]
    s_add_u32 s75, s72, 6144
    s_add_u32 m0, s73, 6144
    s_nop 0
    buffer_load_dwordx4 v13, s[4:7], s75 offen sc1 lds
    v_mfma_f32_16x16x32_bf16 v[80:83], a[192:195], v[44:47], v[80:83]
    v_mfma_f32_16x16x32_bf16 v[84:87], a[196:199], v[44:47], v[84:87]
    v_mfma_f32_16x16x32_bf16 v[88:91], a[200:203], v[44:47], v[88:91]
    v_mfma_f32_16x16x32_bf16 v[92:95], a[204:207], v[44:47], v[92:95]
    ds_read_b128 v[40:43], v14 offset:38912
    ds_read_b128 v[44:47], v14 offset:39936
    s_waitcnt lgkmcnt(4)
    v_mfma_f32_16x16x32_bf16 v[64:67], a[208:211], v[48:51], v[64:67]
    v_mfma_f32_16x16x32_bf16 v[68:71], a[212:215], v[48:51], v[68:71]
    v_mfma_f32_16x16x32_bf16 v[72:75], a[216:219], v[48:51], v[72:75]
    v_mfma_f32_16x16x32_bf16 v[76:79], a[220:223], v[48:51], v[76:79]
    s_add_u32 s75, s72, 7168
    s_add_u32 m0, s73, 7168
    s_nop 0
    buffer_load_dwordx4 v13, s[4:7], s75 offen sc1 lds
    v_mfma_f32_16x16x32_bf16 v[80:83], a[208:211], v[52:55], v[80:83]
    v_mfma_f32_16x16x32_bf16 v[84:87], a[212:215], v[52:55], v[84:87]
    v_mfma_f32_16x16x32_bf16 v[88:91], a[216:219], v[52:55], v[88:91]
    v_mfma_f32_16x16x32_bf16 v[92:95], a[220:223], v[52:55], v[92:95]
    s_waitcnt lgkmcnt(2)
    v_mfma_f32_16x16x32_bf16 v[64:67], a[224:227], v[32:35], v[64:67]
    v_mfma_f32_16x16x32_bf16 v[68:71], a[228:231], v[32:35], v[68:71]
    v_mfma_f32_16x16x32_bf16 v[72:75], a[232:235], v[32:35], v[72:75]
    v_mfma_f32_16x16x32_bf16 v[76:79], a[236:239], v[32:35], v[76:79]
    s_add_u32 s75, s72, 8192
    s_add_u32 m0, s73, 8192
    s_nop 0
    buffer_load_dwordx4 v13, s[4:7], s75 offen sc1 lds
    v_mfma_f32_16x16x32_bf16 v[80:83], a[224:227], v[36:39], v[80:83]
    v_mfma_f32_16x16x32_bf16 v[84:87], a[228:231], v[36:39], v[84:87]
    v_mfma_f32_16x16x32_bf16 v[88:91], a[232:235], v[36:39], v[88:91]
    v_mfma_f32_16x16x32_bf16 v[92:95], a[236:239], v[36:39], v[92:95]
    s_waitcnt lgkmcnt(0)
    v_mfma_f32_16x16x32_bf16 v[64:67], a[240:243], v[40:43], v[64:67]
    v_mfma_f32_16x16x32_bf16 v[68:71], a[244:247], v[40:43], v[68:71]
    v_mfma_f32_16x16x32_bf16 v[72:75], a[248:251], v[40:43], v[72:75]
    v_mfma_f32_16x16x32_bf16 v[76:79], a[252:255], v[40:43], v[76:79]
    s_add_u32 s75, s72, 9216
    s_add_u32 m0, s73, 9216
    s_nop 0
    buffer_load_dwordx4 v13, s[4:7], s75 offen sc1 lds
    v_mfma_f32_16x16x32_bf16 v[80:83], a[240:243], v[44:47], v[80:83]
    v_mfma_f32_16x16x32_bf16 v[84:87], a[244:247], v[44:47], v[84:87]
    v_mfma_f32_16x16x32_bf16 v[88:91], a[248:251], v[44:47], v[88:91]
    v_mfma_f32_16x16x32_bf16 v[92:95], a[252:255], v[44:47], v[92:95]
    s_add_u32 s72, s72, 40960
    s_add_u32 s73, s73, 40960
    s_cmp_lt_u32 s73, 122880
    s_cselect_b32 s73, s73, s70
    v_mov_b32 v16, v13
    s_add_u32 s67, s67, s68
    s_bitset0_b32 s67, s78
    s_add_u32 s74, s74, 40960
    s_cmp_lt_u32 s74, 122880
    s_cselect_b32 s74, s74, 0
    s_add_u32 s55, s55, 1
    s_sub_u32 s79, s55, 13
    s_max_i32 s79, s79, 0
    s_waitcnt vmcnt(10)
    v_cmp_gt_u32 vcc, s79, v18
    s_cbranch_vccz L_xw_go_111
    s_mov_b32 s96, 2000000
L_wf_112:
    buffer_load_dword v18, v17, s[4:7], 0 offen sc1
    s_sub_u32 s96, s96, 1
    s_cbranch_scc1 L_fail
    s_waitcnt vmcnt(0)
    v_cmp_gt_u32 vcc, s79, v18
    s_cbranch_vccz L_wf_112_d
    s_sleep 16
    s_branch L_wf_112
L_wf_112_d:
L_xw_go_111:
    v_add_u32 v14, s74, v13
    ds_read_b128 v[32:35], v14 offset:0
    ds_read_b128 v[36:39], v14 offset:1024
    ds_read_b128 v[40:43], v14 offset:2048
    ds_read_b128 v[44:47], v14 offset:3072
    ds_read_b128 v[48:51], v14 offset:4096
    ds_read_b128 v[52:55], v14 offset:5120
    s_waitcnt lgkmcnt(4)
    v_mfma_f32_16x16x32_bf16 v[96:99], v[192:195], v[32:35], 0
    v_mfma_f32_16x16x32_bf16 v[100:103], v[196:199], v[32:35], 0
    v_mfma_f32_16x16x32_bf16 v[104:107], v[200:203], v[32:35], 0
    v_cvt_pk_bf16_f32 v128, v64, v65
    v_cvt_pk_bf16_f32 v129, v66, v67
    v_mfma_f32_16x16x32_bf16 v[108:111], v[204:207], v[32:35], 0
    v_cvt_pk_bf16_f32 v130, v68, v69
    v_cvt_pk_bf16_f32 v131, v70, v71
    v_mfma_f32_16x16x32_bf16 v[112:115], v[192:195], v[36:39], 0
    buffer_store_dwordx4 v[128:131], v16, s[4:7], s67 offen offset:0 sc1
    v_mfma_f32_16x16x32_bf16 v[116:119], v[196:199], v[36:39], 0
    v_cvt_pk_bf16_f32 v132, v72, v73
    v_cvt_pk_bf16_f32 v133, v74, v75
    v_mfma_f32_16x16x32_bf16 v[120:123], v[200:203], v[36:39], 0
    v_cvt_pk_bf16_f32 v134, v76, v77
    v_cvt_pk_bf16_f32 v135, v78, v79
    v_mfma_f32_16x16x32_bf16 v[124:127], v[204:207], v[36:39], 0
    buffer_store_dwordx4 v[132:135], v16, s[4:7], s67 offen offset:2048 sc1
    ds_read_b128 v[32:35], v14 offset:6144
    ds_read_b128 v[36:39], v14 offset:7168
    s_waitcnt lgkmcnt(4)
    v_mfma_f32_16x16x32_bf16 v[96:99], v[208:211], v[40:43], v[96:99]
    v_cvt_pk_bf16_f32 v136, v80, v81
    v_cvt_pk_bf16_f32 v137, v82, v83
    v_mfma_f32_16x16x32_bf16 v[100:103], v[212:215], v[40:43], v[100:103]
    v_cvt_pk_bf16_f32 v138, v84, v85
    v_cvt_pk_bf16_f32 v139, v86, v87
    v_mfma_f32_16x16x32_bf16 v[104:107], v[216:219], v[40:43], v[104:107]
    buffer_store_dwordx4 v[136:139], v16, s[4:7], s67 offen offset:1024 sc1
    v_mfma_f32_16x16x32_bf16 v[108:111], v[220:223], v[40:43], v[108:111]
    v_cvt_pk_bf16_f32 v140, v88, v89
    v_cvt_pk_bf16_f32 v141, v90, v91
    v_mfma_f32_16x16x32_bf16 v[112:115], v[208:211], v[44:47], v[112:115]
    v_cvt_pk_bf16_f32 v142, v92, v93
    v_cvt_pk_bf16_f32 v143, v94, v95
    v_mfma_f32_16x16x32_bf16 v[116:119], v[212:215], v[44:47], v[116:119]
    buffer_store_dwordx4 v[140:143], v16, s[4:7], s67 offen offset:3072 sc1
    v_mfma_f32_16x16x32_bf16 v[120:123], v[216:219], v[44:47], v[120:123]
    v_mfma_f32_16x16x32_bf16 v[124:127], v[220:223], v[44:47], v[124:127]
    ds_read_b128 v[40:43], v14 offset:8192
    ds_read_b128 v[44:47], v14 offset:9216
    s_waitcnt lgkmcnt(4)
    v_mfma_f32_16x16x32_bf16 v[96:99], v[224:227], v[48:51], v[96:99]
    v_mfma_f32_16x16x32_bf16 v[100:103], v[228:231], v[48:51], v[100:103]
    v_mfma_f32_16x16x32_bf16 v[104:107], v[232:235], v[48:51], v[104:107]
    v_mfma_f32_16x16x32_bf16 v[108:111], v[236:239], v[48:51], v[108:111]
    v_mfma_f32_16x16x32_bf16 v[112:115], v[224:227], v[52:55], v[112:115]
    v_mfma_f32_16x16x32_bf16 v[116:119], v[228:231], v[52:55], v[116:119]
    v_mfma_f32_16x16x32_bf16 v[120:123], v[232:235], v[52:55], v[120:123]
    v_mfma_f32_16x16x32_bf16 v[124:127], v[236:239], v[52:55], v[124:127]
    ds_read_b128 v[48:51], v14 offset:10240
    ds_read_b128 v[52:55], v14 offset:11264
    s_waitcnt lgkmcnt(4)
    v_mfma_f32_16x16x32_bf16 v[96:99], v[240:243], v[32:35], v[96:99]
    v_mfma_f32_16x16x32_bf16 v[100:103], v[244:247], v[32:35], v[100:103]
    v_mfma_f32_16x16x32_bf16 v[104:107], v[248:251], v[32:35], v[104:107]
    v_mfma_f32_16x16x32_bf16 v[108:111], v[252:255], v[32:35], v[108:111]
    v_mfma_f32_16x16x32_bf16 v[112:115], v[240:243], v[36:39], v[112:115]
    v_mfma_f32_16x16x32_bf16 v[116:119], v[244:247], v[36:39], v[116:119]
    v_mfma_f32_16x16x32_bf16 v[120:123], v[248:251], v[36:39], v[120:123]
    v_mfma_f32_16x16x32_bf16 v[124:127], v[252:255], v[36:39], v[124:127]
    ds_read_b128 v[32:35], v14 offset:12288
    ds_read_b128 v[36:39], v14 offset:13312
    s_waitcnt lgkmcnt(4)
    v_mfma_f32_16x16x32_bf16 v[96:99], a[0:3], v[40:43], v[96:99]
    v_mfma_f32_16x16x32_bf16 v[100:103], a[4:7], v[40:43], v[100:103]
    v_mfma_f32_16x16x32_bf16 v[104:107], a[8:11], v[40:43], v[104:107]
    v_mfma_f32_16x16x32_bf16 v[108:111], a[12:15], v[40:43], v[108:111]
    v_mfma_f32_16x16x32_bf16 v[112:115], a[0:3], v[44:47], v[112:115]
    v_mfma_f32_16x16x32_bf16 v[116:119], a[4:7], v[44:47], v[116:119]
    v_mfma_f32_16x16x32_bf16 v[120:123], a[8:11], v[44:47], v[120:123]
    v_mfma_f32_16x16x32_bf16 v[124:127], a[12:15], v[44:47], v[124:127]
    ds_read_b128 v[40:43], v14 offset:14336
    ds_read_b128 v[44:47], v14 offset:15360
    s_waitcnt lgkmcnt(4)
    v_mfma_f32_16x16x32_bf16 v[96:99], a[16:19], v[48:51], v[96:99]
    v_mfma_f32_16x16x32_bf16 v[100:103], a[20:23], v[48:51], v[100:103]
    v_mfma_f32_16x16x32_bf16 v[104:107], a[24:27], v[48:51], v[104:107]
    v_mfma_f32_16x16x32_bf16 v[108:111], a[28:31], v[48:51], v[108:111]
    v_mfma_f32_16x16x32_bf16 v[112:115], a[16:19], v[52:55], v[112:115]
    v_mfma_f32_16x16x32_bf16 v[116:119], a[20:23], v[52:55], v[116:119]
    v_mfma_f32_16x16x32_bf16 v[120:123], a[24:27], v[52:55], v[120:123]
    v_mfma_f32_16x16x32_bf16 v[124:127], a[28:31], v[52:55], v[124:127]
    ds_read_b128 v[48:51], v14 offset:16384
    ds_read_b128 v[52:55], v14 offset:17408
    s_waitcnt lgkmcnt(4)
    v_mfma_f32_16x16x32_bf16 v[96:99], a[32:35], v[32:35], v[96:99]
    v_mfma_f32_16x16x32_bf16 v[100:103], a[36:39], v[32:35], v[100:103]
    v_mfma_f32_16x16x32_bf16 v[104:107], a[40:43], v[32:35], v[104:107]
    v_mfma_f32_16x16x32_bf16 v[108:111], a[44:47], v[32:35], v[108:111]
    v_mfma_f32_16x16x32_bf16 v[112:115], a[32:35], v[36:39], v[112:115]
    v_mfma_f32_16x16x32_bf16 v[116:119], a[36:39], v[36:39], v[116:119]
    v_mfma_f32_16x16x32_bf16 v[120:123], a[40:43], v[36:39], v[120:123]
    v_mfma_f32_16x16x32_bf16 v[124:127], a[44:47], v[36:39], v[124:127]
    ds_read_b128 v[32:35], v14 offset:18432
    ds_read_b128 v[36:39], v14 offset:19456
    s_waitcnt lgkmcnt(4)
    v_mfma_f32_16x16x32_bf16 v[96:99], a[48:51], v[40:43], v[96:99]
    v_mfma_f32_16x16x32_bf16 v[100:103], a[52:55], v[40:43], v[100:103]
    v_mfma_f32_16x16x32_bf16 v[104:107], a[56:59], v[40:43], v[104:107]
    v_mfma_f32_16x16x32_bf16 v[108:111], a[60:63], v[40:43], v[108:111]
    v_mfma_f32_16x16x32_bf16 v[112:115], a[48:51], v[44:47], v[112:115]
    v_mfma_f32_16x16x32_bf16 v[116:119], a[52:55], v[44:47], v[116:119]
    v_mfma_f32_16x16x32_bf16 v[120:123], a[56:59], v[44:47], v[120:123]
    v_mfma_f32_16x16x32_bf16 v[124:127], a[60:63], v[44:47], v[124:127]
    s_waitcnt vmcnt(0)
    v_mov_b32 v4, s55
    buffer_store_dword v4, v8, s[4:7], s66 offen sc1
    ds_read_b128 v[40:43], v14 offset:20480
    ds_read_b128 v[44:47], v14 offset:21504
    s_waitcnt lgkmcnt(4)
    v_mfma_f32_16x16x32_bf16 v[96:99], a[64:67], v[48:51], v[96:99]
    v_mfma_f32_16x16x32_bf16 v[100:103], a[68:71], v[48:51], v[100:103]
    v_mfma_f32_16x16x32_bf16 v[104:107], a[72:75], v[48:51], v[104:107]
    v_mfma_f32_16x16x32_bf16 v[108:111], a[76:79], v[48:51], v[108:111]
    v_mfma_f32_16x16x32_bf16 v[112:115], a[64:67], v[52:55], v[112:115]
    v_mfma_f32_16x16x32_bf16 v[116:119], a[68:71], v[52:55], v[116:119]
    v_mfma_f32_16x16x32_bf16 v[120:123], a[72:75], v[52:55], v[120:123]
    v_mfma_f32_16x16x32_bf16 v[124:127], a[76:79], v[52:55], v[124:127]
    buffer_load_dword v18, v17, s[4:7], 0 offen sc1
    ds_read_b128 v[48:51], v14 offset:22528
    ds_read_b128 v[52:55], v14 offset:23552
    s_waitcnt lgkmcnt(4)
    v_mfma_f32_16x16x32_bf16 v[96:99], a[80:83], v[32:35], v[96:99]
    v_mfma_f32_16x16x32_bf16 v[100:103], a[84:87], v[32:35], v[100:103]
    v_mfma_f32_16x16x32_bf16 v[104:107], a[88:91], v[32:35], v[104:107]
    v_mfma_f32_16x16x32_bf16 v[108:111], a[92:95], v[32:35], v[108:111]
    v_mfma_f32_16x16x32_bf16 v[112:115], a[80:83], v[36:39], v[112:115]
    v_mfma_f32_16x16x32_bf16 v[116:119], a[84:87], v[36:39], v[116:119]
    v_mfma_f32_16x16x32_bf16 v[120:123], a[88:91], v[36:39], v[120:123]
    v_mfma_f32_16x16x32_bf16 v[124:127], a[92:95], v[36:39], v[124:127]
    s_waitcnt vmcnt(6)
    s_barrier
    ds_read_b128 v[32:35], v14 offset:24576
    ds_read_b128 v[36:39], v14 offset:25600
    s_waitcnt lgkmcnt(4)
    v_mfma_f32_16x16x32_bf16 v[96:99], a[96:99], v[40:43], v[96:99]
    v_mfma_f32_16x16x32_bf16 v[100:103], a[100:103], v[40:43], v[100:103]
    v_mfma_f32_16x16x32_bf16 v[104:107], a[104:107], v[40:43], v[104:107]
    v_mfma_f32_16x16x32_bf16 v[108:111], a[108:111], v[40:43], v[108:111]
    s_add_u32 s75, s72, 0
    s_add_u32 m0, s73, 0
    s_nop 0
    buffer_load_dwordx4 v13, s[4:7], s75 offen sc1 lds
    v_mfma_f32_16x16x32_bf16 v[112:115], a[96:99], v[44:47], v[112:115]
    v_mfma_f32_16x16x32_bf16 v[116:119], a[100:103], v[44:47], v[116:119]
    v_mfma_f32_16x16x32_bf16 v[120:123], a[104:107], v[44:47], v[120:123]
    v_mfma_f32_16x16x32_bf16 v[124:127], a[108:111], v[44:47], v[124:127]
    ds_read_b128 v[40:43], v14 offset:26624
    ds_read_b128 v[44:47], v14 offset:27648
    s_waitcnt lgkmcnt(4)
    v_mfma_f32_16x16x32_bf16 v[96:99], a[112:115], v[48:51], v[96:99]
    v_mfma_f32_16x16x32_bf16 v[100:103], a[116:119], v[48:51], v[100:103]
    v_mfma_f32_16x16x32_bf16 v[104:107], a[120:123], v[48:51], v[104:107]
    v_mfma_f32_16x16x32_bf16 v[108:111], a[124:127], v[48:51], v[108:111]
    s_add_u32 s75, s72, 1024
    s_add_u32 m0, s73, 1024
    s_nop 0
    buffer_load_dwordx4 v13, s[4:7], s75 offen sc1 lds
    v_mfma_f32_16x16x32_bf16 v[112:115], a[112:115], v[52:55], v[112:115]
    v_mfma_f32_16x16x32_bf16 v[116:119], a[116:119], v[52:55], v[116:119]
    v_mfma_f32_16x16x32_bf16 v[120:123], a[120:123], v[52:55], v[120:123]
    v_mfma_f32_16x16x32_bf16 v[124:127], a[124:127], v[52:55], v[124:127]
    ds_read_b128 v[48:51], v14 offset:28672
    ds_read_b128 v[52:55], v14 offset:29696
    s_waitcnt lgkmcnt(4)
    v_mfma_f32_16x16x32_bf16 v[96:99], a[128:131], v[32:35], v[96:99]
    v_mfma_f32_16x16x32_bf16 v[100:103], a[132:135], v[32:35], v[100:103]
    v_mfma_f32_16x16x32_bf16 v[104:107], a[136:139], v[32:35], v[104:107]
    v_mfma_f32_16x16x32_bf16 v[108:111], a[140:143], v[32:35], v[108:111]
    s_add_u32 s75, s72, 2048
    s_add_u32 m0, s73, 2048
    s_nop 0
    buffer_load_dwordx4 v13, s[4:7], s75 offen sc1 lds
    v_mfma_f32_16x16x32_bf16 v[112:115], a[128:131], v[36:39], v[112:115]
    v_mfma_f32_16x16x32_bf16 v[116:119], a[132:135], v[36:39], v[116:119]
    v_mfma_f32_16x16x32_bf16 v[120:123], a[136:139], v[36:39], v[120:123]
    v_mfma_f32_16x16x32_bf16 v[124:127], a[140:143], v[36:39], v[124:127]
    ds_read_b128 v[32:35], v14 offset:30720
    ds_read_b128 v[36:39], v14 offset:31744
    s_waitcnt lgkmcnt(4)
    v_mfma_f32_16x16x32_bf16 v[96:99], a[144:147], v[40:43], v[96:99]
    v_mfma_f32_16x16x32_bf16 v[100:103], a[148:151], v[40:43], v[100:103]
    v_mfma_f32_16x16x32_bf16 v[104:107], a[152:155], v[40:43], v[104:107]
    v_mfma_f32_16x16x32_bf16 v[108:111], a[156:159], v[40:43], v[108:111]
    s_add_u32 s75, s72, 3072
    s_add_u32 m0, s73, 3072
    s_nop 0
    buffer_load_dwordx4 v13, s[4:7], s75 offen sc1 lds
    v_mfma_f32_16x16x32_bf16 v[112:115], a[144:147], v[44:47], v[112:115]
    v_mfma_f32_16x16x32_bf16 v[116:119], a[148:151], v[44:47], v[116:119]
    v_mfma_f32_16x16x32_bf16 v[120:123], a[152:155], v[44:47], v[120:123]
    v_mfma_f32_16x16x32_bf16 v[124:127], a[156:159], v[44:47], v[124:127]
    ds_read_b128 v[40:43], v14 offset:32768
    ds_read_b128 v[44:47], v14 offset:33792
    s_waitcnt lgkmcnt(4)
    v_mfma_f32_16x16x32_bf16 v[96:99], a[160:163], v[48:51], v[96:99]
    v_mfma_f32_16x16x32_bf16 v[100:103], a[164:167], v[48:51], v[100:103]
    v_mfma_f32_16x16x32_bf16 v[104:107], a[168:171], v[48:51], v[104:107]
    v_mfma_f32_16x16x32_bf16 v[108:111], a[172:175], v[48:51], v[108:111]
    s_add_u32 s75, s72, 4096
    s_add_u32 m0, s73, 4096
    s_nop 0
    buffer_load_dwordx4 v13, s[4:7], s75 offen sc1 lds
    v_mfma_f32_16x16x32_bf16 v[112:115], a[160:163], v[52:55], v[112:115]
    v_mfma_f32_16x16x32_bf16 v[116:119], a[164:167], v[52:55], v[116:119]
    v_mfma_f32_16x16x32_bf16 v[120:123], a[168:171], v[52:55], v[120:123]
    v_mfma_f32_16x16x32_bf16 v[124:127], a[172:175], v[52:55], v[124:127]
    ds_read_b128 v[48:51], v14 offset:34816
    ds_read_b128 v[52:55], v14 offset:35840
    s_waitcnt lgkmcnt(4)
    v_mfma_f32_16x16x32_bf16 v[96:99], a[176:179], v[32:35], v[96:99]
    v_mfma_f32_16x16x32_bf16 v[100:103], a[180:183], v[32:35], v[100:103]
    v_mfma_f32_16x16x32_bf16 v[104:107], a[184:187], v[32:35], v[104:107]
    v_mfma_f32_16x16x32_bf16 v[108:111], a[188:191], v[32:35], v[108:111]
    s_add_u32 s75, s72, 5120
    s_add_u32 m0, s73, 5120
    s_nop 0
    buffer_load_dwordx4 v13, s[4:7], s75 offen sc1 lds
    v_mfma_f32_16x16x32_bf16 v[112:115], a[176:179], v[36:39], v[112:115]
    v_mfma_f32_16x16x32_bf16 v[116:119], a[180:183], v[36:39], v[116:119]
    v_mfma_f32_16x16x32_bf16 v[120:123], a[184:187], v[36:39], v[120:123]
    v_mfma_f32_16x16x32_bf16 v[124:127], a[188:191], v[36:39], v[124:127]
    ds_read_b128 v[32:35], v14 offset:36864
    ds_read_b128 v[36:39], v14 offset:37888
    s_waitcnt lgkmcnt(4)
    v_mfma_f32_16x16x32_bf16 v[96:99], a[192:195], v[40:43], v[96:99]
    v_mfma_f32_16x16x32_bf16 v[100:103], a[196:199], v[40:43], v[100:103]
    v_mfma_f32_16x16x32_bf16 v[104:107], a[200:203], v[40:43], v[104:107]
    v_mfma_f32_16x16x32_bf16 v[108:111], a[204:207], v[40:43], v[108:111]
    s_add_u32 s75, s72, 6144
    s_add_u32 m0, s73, 6144
    s_nop 0
    buffer_load_dwordx4 v13, s[4:7], s75 offen sc1 lds
    v_mfma_f32_16x16x32_bf16 v[112:115], a[192:195], v[44:47], v[112:115]
    v_mfma_f32_16x16x32_bf16 v[116:119], a[196:199], v[44:47], v[116:119]
    v_mfma_f32_16x16x32_bf16 v[120:123], a[200:203], v[44:47], v[120:123]
    v_mfma_f32_16x16x32_bf16 v[124:127], a[204:207], v[44:47], v[124:127]
    ds_read_b128 v[40:43], v14 offset:38912
    ds_read_b128 v[44:47], v14 offset:39936
    s_waitcnt lgkmcnt(4)
    v_mfma_f32_16x16x32_bf16 v[96:99], a[208:211], v[48:51], v[96:99]
    v_mfma_f32_16x16x32_bf16 v[100:103], a[212:215], v[48:51], v[100:103]
    v_mfma_f32_16x16x32_bf16 v[104:107], a[216:219], v[48:51], v[104:107]
    v_mfma_f32_16x16x32_bf16 v[108:111], a[220:223], v[48:51], v[108:111]
    s_add_u32 s75, s72, 7168
    s_add_u32 m0, s73, 7168
    s_nop 0
    buffer_load_dwordx4 v13, s[4:7], s75 offen sc1 lds
    v_mfma_f32_16x16x32_bf16 v[112:115], a[208:211], v[52:55], v[112:115]
    v_mfma_f32_16x16x32_bf16 v[116:119], a[212:215], v[52:55], v[116:119]
    v_mfma_f32_16x16x32_bf16 v[120:123], a[216:219], v[52:55], v[120:123]
    v_mfma_f32_16x16x32_bf16 v[124:127], a[220:223], v[52:55], v[124:127]
    s_waitcnt lgkmcnt(2)
    v_mfma_f32_16x16x32_bf16 v[96:99], a[224:227], v[32:35], v[96:99]
    v_mfma_f32_16x16x32_bf16 v[100:103], a[228:231], v[32:35], v[100:103]
    v_mfma_f32_16x16x32_bf16 v[104:107], a[232:235], v[32:35], v[104:107]
    v_mfma_f32_16x16x32_bf16 v[108:111], a[236:239], v[32:35], v[108:111]
    s_add_u32 s75, s72, 8192
    s_add_u32 m0, s73, 8192
    s_nop 0
    buffer_load_dwordx4 v13, s[4:7], s75 offen sc1 lds
    v_mfma_f32_16x16x32_bf16 v[112:115], a[224:227], v[36:39], v[112:115]
    v_mfma_f32_16x16x32_bf16 v[116:119], a[228:231], v[36:39], v[116:119]
    v_mfma_f32_16x16x32_bf16 v[120:123], a[232:235], v[36:39], v[120:123]
    v_mfma_f32_16x16x32_bf16 v[124:127], a[236:239], v[36:39], v[124:127]
    s_waitcnt lgkmcnt(0)
    v_mfma_f32_16x16x32_bf16 v[96:99], a[240:243], v[40:43], v[96:99]
    v_mfma_f32_16x16x32_bf16 v[100:103], a[244:247], v[40:43], v[100:103]
    v_mfma_f32_16x16x32_bf16 v[104:107], a[248:251], v[40:43], v[104:107]
    v_mfma_f32_16x16x32_bf16 v[108:111], a[252:255], v[40:43], v[108:111]
    s_add_u32 s75, s72, 9216
    s_add_u32 m0, s73, 9216
    s_nop 0
    buffer_load_dwordx4 v13, s[4:7], s75 offen sc1 lds
    v_mfma_f32_16x16x32_bf16 v[112:115], a[240:243], v[44:47], v[112:115]
    v_mfma_f32_16x16x32_bf16 v[116:119], a[244:247], v[44:47], v[116:119]
    v_mfma_f32_16x16x32_bf16 v[120:123], a[248:251], v[44:47], v[120:123]
    v_mfma_f32_16x16x32_bf16 v[124:127], a[252:255], v[44:47], v[124:127]
    s_add_u32 s72, s72, 40960
    s_add_u32 s73, s73, 40960
    s_cmp_lt_u32 s73, 122880
    s_cselect_b32 s73, s73, s70
    v_mov_b32 v16, v13
    s_add_u32 s67, s67, s68
    s_bitset0_b32 s67, s78
    s_add_u32 s74, s74, 40960
    s_cmp_lt_u32 s74, 122880
    s_cselect_b32 s74, s74, 0
    s_add_u32 s55, s55, 1
    s_cmp_lt_u32 s55, 64
    s_cbranch_scc1 L_xw_loop
    s_nop 7
    v_cvt_pk_bf16_f32 v128, v96, v97
    v_cvt_pk_bf16_f32 v129, v98, v99
    v_cvt_pk_bf16_f32 v130, v100, v101
    v_cvt_pk_bf16_f32 v131, v102, v103
    buffer_store_dwordx4 v[128:131], v16, s[4:7], s67 offen offset:0 sc1
    v_cvt_pk_bf16_f32 v132, v104, v105
    v_cvt_pk_bf16_f32 v133, v106, v107
    v_cvt_pk_bf16_f32 v134, v108, v109
    v_cvt_pk_bf16_f32 v135, v110, v111
    buffer_store_dwordx4 v[132:135], v16, s[4:7], s67 offen offset:2048 sc1
    v_cvt_pk_bf16_f32 v136, v112, v113
    v_cvt_pk_bf16_f32 v137, v114, v115
    v_cvt_pk_bf16_f32 v138, v116, v117
    v_cvt_pk_bf16_f32 v139, v118, v119
    buffer_store_dwordx4 v[136:139], v16, s[4:7], s67 offen offset:1024 sc1
    v_cvt_pk_bf16_f32 v140, v120, v121
    v_cvt_pk_bf16_f32 v141, v122, v123
    v_cvt_pk_bf16_f32 v142, v124, v125
    v_cvt_pk_bf16_f32 v143, v126, v127
    buffer_store_dwordx4 v[140:143], v16, s[4:7], s67 offen offset:3072 sc1
    s_waitcnt vmcnt(0)
    v_mov_b32 v4, 64
    buffer_store_dword v4, v8, s[4:7], s66 offen sc1
    s_branch L_end
L_xf_loop:
    s_sub_u32 s79, s55, 13
    s_max_i32 s79, s79, 0
    s_waitcnt vmcnt(12)
    v_cmp_gt_u32 vcc, s79, v18
    s_cbranch_vccz L_xw_go_117
    s_mov_b32 s96, 2000000
L_wf_118:
    buffer_load_dword v18, v17, s[4:7], 0 offen sc1
    s_sub_u32 s96, s96, 1
    s_cbranch_scc1 L_fail
    s_waitcnt vmcnt(0)
    v_cmp_gt_u32 vcc, s79, v18
    s_cbranch_vccz L_wf_118_d
    s_sleep 16
    s_branch L_wf_118
L_wf_118_d:
L_xw_go_117:
    v_add_u32 v14, s74, v13
    ds_read_b128 v[32:35], v14 offset:0
    ds_read_b128 v[36:39], v14 offset:1024
    ds_read_b128 v[40:43], v14 offset:2048
    ds_read_b128 v[44:47], v14 offset:3072
    ds_read_b128 v[48:51], v14 offset:4096
    ds_read_b128 v[52:55], v14 offset:5120
    s_waitcnt lgkmcnt(4)
    v_mfma_f32_16x16x32_bf16 v[64:67], v[192:195], v[32:35], 0
    v_mfma_f32_16x16x32_bf16 v[68:71], v[196:199], v[32:35], 0
    v_mfma_f32_16x16x32_bf16 v[72:75], v[200:203], v[32:35], 0
    v_mul_f32 v144, v96, v96
    v_mul_f32 v145, v97, v97
    v_mfma_f32_16x16x32_bf16 v[76:79], v[204:207], v[32:35], 0
    v_mul_f32 v146, v98, v98
    v_mul_f32 v147, v99, v99
    v_mfma_f32_16x16x32_bf16 v[80:83], v[192:195], v[36:39], 0
    v_mul_f32 v148, v100, v100
    v_mul_f32 v149, v101, v101
    v_mfma_f32_16x16x32_bf16 v[84:87], v[196:199], v[36:39], 0
    v_mul_f32 v150, v102, v102
    v_mul_f32 v151, v103, v103
    v_mfma_f32_16x16x32_bf16 v[88:91], v[200:203], v[36:39], 0
    v_fma_f32 v144, v144, s76, v15
    v_fma_f32 v145, v145, s76, v15
    v_mfma_f32_16x16x32_bf16 v[92:95], v[204:207], v[36:39], 0
    v_fma_f32 v146, v146, s76, v15
    v_fma_f32 v147, v147, s76, v15
    ds_read_b128 v[32:35], v14 offset:6144
    ds_read_b128 v[36:39], v14 offset:7168
    s_waitcnt lgkmcnt(4)
    v_mfma_f32_16x16x32_bf16 v[64:67], v[208:211], v[40:43], v[64:67]
    v_fma_f32 v148, v148, s76, v15
    v_fma_f32 v149, v149, s76, v15
    v_mfma_f32_16x16x32_bf16 v[68:71], v[212:215], v[40:43], v[68:71]
    v_fma_f32 v150, v150, s76, v15
    v_fma_f32 v151, v151, s76, v15
    v_mfma_f32_16x16x32_bf16 v[72:75], v[216:219], v[40:43], v[72:75]
    v_mul_f32 v144, v144, v96
    v_mul_f32 v145, v145, v97
    v_mfma_f32_16x16x32_bf16 v[76:79], v[220:223], v[40:43], v[76:79]
    v_mul_f32 v146, v146, v98
    v_mul_f32 v147, v147, v99
    v_mfma_f32_16x16x32_bf16 v[80:83], v[208:211], v[44:47], v[80:83]
    v_mul_f32 v148, v148, v100
    v_mul_f32 v149, v149, v101
    v_mfma_f32_16x16x32_bf16 v[84:87], v[212:215], v[44:47], v[84:87]
    v_mul_f32 v150, v150, v102
    v_mul_f32 v151, v151, v103
    v_mfma_f32_16x16x32_bf16 v[88:91], v[216:219], v[44:47], v[88:91]
    v_exp_f32 v144, v144
    v_mfma_f32_16x16x32_bf16 v[92:95], v[220:223], v[44:47], v[92:95]
    v_exp_f32 v145, v145
    ds_read_b128 v[40:43], v14 offset:8192
    ds_read_b128 v[44:47], v14 offset:9216
    s_waitcnt lgkmcnt(4)
    v_mfma_f32_16x16x32_bf16 v[64:67], v[224:227], v[48:51], v[64:67]
    v_exp_f32 v146, v146
    v_mfma_f32_16x16x32_bf16 v[68:71], v[228:231], v[48:51], v[68:71]
    v_exp_f32 v147, v147
    v_mfma_f32_16x16x32_bf16 v[72:75], v[232:235], v[48:51], v[72:75]
    v_exp_f32 v148, v148
    v_mfma_f32_16x16x32_bf16 v[76:79], v[236:239], v[48:51], v[76:79]
    v_exp_f32 v149, v149
    v_mfma_f32_16x16x32_bf16 v[80:83], v[224:227], v[52:55], v[80:83]
    v_exp_f32 v150, v150
    v_mfma_f32_16x16x32_bf16 v[84:87], v[228:231], v[52:55], v[84:87]
    v_exp_f32 v151, v151
    v_mfma_f32_16x16x32_bf16 v[88:91], v[232:235], v[52:55], v[88:91]
    v_mul_f32 v96, v96, v104
    v_mul_f32 v97, v97, v105
    v_mfma_f32_16x16x32_bf16 v[92:95], v[236:239], v[52:55], v[92:95]
    v_mul_f32 v98, v98, v106
    v_mul_f32 v99, v99, v107
    ds_read_b128 v[48:51], v14 offset:10240
    ds_read_b128 v[52:55], v14 offset:11264
    s_waitcnt lgkmcnt(4)
    v_mfma_f32_16x16x32_bf16 v[64:67], v[240:243], v[32:35], v[64:67]
    v_mul_f32 v100, v100, v108
    v_mul_f32 v101, v101, v109
    v_mfma_f32_16x16x32_bf16 v[68:71], v[244:247], v[32:35], v[68:71]
    v_mul_f32 v102, v102, v110
    v_mul_f32 v103, v103, v111
    v_mfma_f32_16x16x32_bf16 v[72:75], v[248:251], v[32:35], v[72:75]
    v_add_f32 v144, 1.0, v144
    v_add_f32 v145, 1.0, v145
    v_mfma_f32_16x16x32_bf16 v[76:79], v[252:255], v[32:35], v[76:79]
    v_add_f32 v146, 1.0, v146
    v_add_f32 v147, 1.0, v147
    v_mfma_f32_16x16x32_bf16 v[80:83], v[240:243], v[36:39], v[80:83]
    v_add_f32 v148, 1.0, v148
    v_add_f32 v149, 1.0, v149
    v_mfma_f32_16x16x32_bf16 v[84:87], v[244:247], v[36:39], v[84:87]
    v_add_f32 v150, 1.0, v150
    v_add_f32 v151, 1.0, v151
    v_mfma_f32_16x16x32_bf16 v[88:91], v[248:251], v[36:39], v[88:91]
    v_rcp_f32 v144, v144
    v_mfma_f32_16x16x32_bf16 v[92:95], v[252:255], v[36:39], v[92:95]
    v_rcp_f32 v145, v145
    ds_read_b128 v[32:35], v14 offset:12288
    ds_read_b128 v[36:39], v14 offset:13312
    s_waitcnt lgkmcnt(4)
    v_mfma_f32_16x16x32_bf16 v[64:67], a[0:3], v[40:43], v[64:67]
    v_rcp_f32 v146, v146
    v_mfma_f32_16x16x32_bf16 v[68:71], a[4:7], v[40:43], v[68:71]
    v_rcp_f32 v147, v147
    v_mfma_f32_16x16x32_bf16 v[72:75], a[8:11], v[40:43], v[72:75]
    v_rcp_f32 v148, v148
    v_mfma_f32_16x16x32_bf16 v[76:79], a[12:15], v[40:43], v[76:79]
    v_rcp_f32 v149, v149
    v_mfma_f32_16x16x32_bf16 v[80:83], a[0:3], v[44:47], v[80:83]
    v_rcp_f32 v150, v150
    v_mfma_f32_16x16x32_bf16 v[84:87], a[4:7], v[44:47], v[84:87]
    v_rcp_f32 v151, v151
    v_mfma_f32_16x16x32_bf16 v[88:91], a[8:11], v[44:47], v[88:91]
    v_mul_f32 v96, v96, v144
    v_mul_f32 v97, v97, v145
    v_mfma_f32_16x16x32_bf16 v[92:95], a[12:15], v[44:47], v[92:95]
    v_mul_f32 v98, v98, v146
    v_mul_f32 v99, v99, v147
    ds_read_b128 v[40:43], v14 offset:14336
    ds_read_b128 v[44:47], v14 offset:15360
    s_waitcnt lgkmcnt(4)
    v_mfma_f32_16x16x32_bf16 v[64:67], a[16:19], v[48:51], v[64:67]
    v_mul_f32 v100, v100, v148
    v_mul_f32 v101, v101, v149
    v_mfma_f32_16x16x32_bf16 v[68:71], a[20:23], v[48:51], v[68:71]
    v_mul_f32 v102, v102, v150
    v_mul_f32 v103, v103, v151
    v_mfma_f32_16x16x32_bf16 v[72:75], a[24:27], v[48:51], v[72:75]
    v_cvt_pk_bf16_f32 v128, v96, v97
    v_cvt_pk_bf16_f32 v129, v98, v99
    v_mfma_f32_16x16x32_bf16 v[76:79], a[28:31], v[48:51], v[76:79]
    v_cvt_pk_bf16_f32 v130, v100, v101
    v_cvt_pk_bf16_f32 v131, v102, v103
    v_mfma_f32_16x16x32_bf16 v[80:83], a[16:19], v[52:55], v[80:83]
    buffer_store_dwordx4 v[128:131], v16, s[4:7], s67 offen offset:0 sc1
    v_mfma_f32_16x16x32_bf16 v[84:87], a[20:23], v[52:55], v[84:87]
    v_mul_f32 v144, v112, v112
    v_mul_f32 v145, v113, v113
    v_mfma_f32_16x16x32_bf16 v[88:91], a[24:27], v[52:55], v[88:91]
    v_mul_f32 v146, v114, v114
    v_mul_f32 v147, v115, v115
    v_mfma_f32_16x16x32_bf16 v[92:95], a[28:31], v[52:55], v[92:95]
    v_mul_f32 v148, v116, v116
    v_mul_f32 v149, v117, v117
    ds_read_b128 v[48:51], v14 offset:16384
    ds_read_b128 v[52:55], v14 offset:17408
    s_waitcnt lgkmcnt(4)
    v_mfma_f32_16x16x32_bf16 v[64:67], a[32:35], v[32:35], v[64:67]
    v_mul_f32 v150, v118, v118
    v_mul_f32 v151, v119, v119
    v_mfma_f32_16x16x32_bf16 v[68:71], a[36:39], v[32:35], v[68:71]
    v_fma_f32 v144, v144, s76, v15
    v_fma_f32 v145, v145, s76, v15
    v_mfma_f32_16x16x32_bf16 v[72:75], a[40:43], v[32:35], v[72:75]
    v_fma_f32 v146, v146, s76, v15
    v_fma_f32 v147, v147, s76, v15
    v_mfma_f32_16x16x32_bf16 v[76:79], a[44:47], v[32:35], v[76:79]
    v_fma_f32 v148, v148, s76, v15
    v_fma_f32 v149, v149, s76, v15
    v_mfma_f32_16x16x32_bf16 v[80:83], a[32:35], v[36:39], v[80:83]
    v_fma_f32 v150, v150, s76, v15
    v_fma_f32 v151, v151, s76, v15
    v_mfma_f32_16x16x32_bf16 v[84:87], a[36:39], v[36:39], v[84:87]
    v_mul_f32 v144, v144, v112
    v_mul_f32 v145, v145, v113
    v_mfma_f32_16x16x32_bf16 v[88:91], a[40:43], v[36:39], v[88:91]
    v_mul_f32 v146, v146, v114
    v_mul_f32 v147, v147, v115
    v_mfma_f32_16x16x32_bf16 v[92:95], a[44:47], v[36:39], v[92:95]
    v_mul_f32 v148, v148, v116
    v_mul_f32 v149, v149, v117
    ds_read_b128 v[32:35], v14 offset:18432
    ds_read_b128 v[36:39], v14 offset:19456
    s_waitcnt lgkmcnt(4)
    v_mfma_f32_16x16x32_bf16 v[64:67], a[48:51], v[40:43], v[64:67]
    v_mul_f32 v150, v150, v118
    v_mul_f32 v151, v151, v119
    v_mfma_f32_16x16x32_bf16 v[68:71], a[52:55], v[40:43], v[68:71]
    v_exp_f32 v144, v144
    v_mfma_f32_16x16x32_bf16 v[72:75], a[56:59], v[40:43], v[72:75]
    v_exp_f32 v145, v145
    v_mfma_f32_16x16x32_bf16 v[76:79], a[60:63], v[40:43], v[76:79]
    v_exp_f32 v146, v146
    v_mfma_f32_16x16x32_bf16 v[80:83], a[48:51], v[44:47], v[80:83]
    v_exp_f32 v147, v147
    v_mfma_f32_16x16x32_bf16 v[84:87], a[52:55], v[44:47], v[84:87]
    v_exp_f32 v148, v148
    v_mfma_f32_16x16x32_bf16 v[88:91], a[56:59], v[44:47], v[88:91]
    v_exp_f32 v149, v149
    v_mfma_f32_16x16x32_bf16 v[92:95], a[60:63], v[44:47], v[92:95]
    v_exp_f32 v150, v150
    ds_read_b128 v[40:43], v14 offset:20480
    ds_read_b128 v[44:47], v14 offset:21504
    s_waitcnt lgkmcnt(4)
    v_mfma_f32_16x16x32_bf16 v[64:67], a[64:67], v[48:51], v[64:67]
    v_exp_f32 v151, v151
    v_mfma_f32_16x16x32_bf16 v[68:71], a[68:71], v[48:51], v[68:71]
    v_mul_f32 v112, v112, v120
    v_mul_f32 v113, v113, v121
    v_mfma_f32_16x16x32_bf16 v[72:75], a[72:75], v[48:51], v[72:75]
    v_mul_f32 v114, v114, v122
    v_mul_f32 v115, v115, v123
    v_mfma_f32_16x16x32_bf16 v[76:79], a[76:79], v[48:51], v[76:79]
    v_mul_f32 v116, v116, v124
    v_mul_f32 v117, v117, v125
    v_mfma_f32_16x16x32_bf16 v[80:83], a[64:67], v[52:55], v[80:83]
    v_mul_f32 v118, v118, v126
    v_mul_f32 v119, v119, v127
    v_mfma_f32_16x16x32_bf16 v[84:87], a[68:71], v[52:55], v[84:87]
    v_add_f32 v144, 1.0, v144
    v_add_f32 v145, 1.0, v145
    v_mfma_f32_16x16x32_bf16 v[88:91], a[72:75], v[52:55], v[88:91]
    v_add_f32 v146, 1.0, v146
    v_add_f32 v147, 1.0, v147
    v_mfma_f32_16x16x32_bf16 v[92:95], a[76:79], v[52:55], v[92:95]
    v_add_f32 v148, 1.0, v148
    v_add_f32 v149, 1.0, v149
    buffer_load_dword v18, v17, s[4:7], 0 offen sc1
    ds_read_b128 v[48:51], v14 offset:22528
    ds_read_b128 v[52:55], v14 offset:23552
    s_waitcnt lgkmcnt(4)
    v_mfma_f32_16x16x32_bf16 v[64:67], a[80:83], v[32:35], v[64:67]
    v_add_f32 v150, 1.0, v150
    v_add_f32 v151, 1.0, v151
    v_mfma_f32_16x16x32_bf16 v[68:71], a[84:87], v[32:35], v[68:71]
    v_rcp_f32 v144, v144
    v_mfma_f32_16x16x32_bf16 v[72:75], a[88:91], v[32:35], v[72:75]
    v_rcp_f32 v145, v145
    v_mfma_f32_16x16x32_bf16 v[76:79], a[92:95], v[32:35], v[76:79]
    v_rcp_f32 v146, v146
    v_mfma_f32_16x16x32_bf16 v[80:83], a[80:83], v[36:39], v[80:83]
    v_rcp_f32 v147, v147
    v_mfma_f32_16x16x32_bf16 v[84:87], a[84:87], v[36:39], v[84:87]
    v_rcp_f32 v148, v148
    v_mfma_f32_16x16x32_bf16 v[88:91], a[88:91], v[36:39], v[88:91]
    v_rcp_f32 v149, v149
    v_mfma_f32_16x16x32_bf16 v[92:95], a[92:95], v[36:39], v[92:95]
    v_rcp_f32 v150, v150
    s_waitcnt vmcnt(2)
    s_barrier
    ds_read_b128 v[32:35], v14 offset:24576
    ds_read_b128 v[36:39], v14 offset:25600
    s_waitcnt lgkmcnt(4)
    v_mfma_f32_16x16x32_bf16 v[64:67], a[96:99], v[40:43], v[64:67]
    v_rcp_f32 v151, v151
    v_mfma_f32_16x16x32_bf16 v[68:71], a[100:103], v[40:43], v[68:71]
    v_mul_f32 v112, v112, v144
    v_mul_f32 v113, v113, v145
    v_mfma_f32_16x16x32_bf16 v[72:75], a[104:107], v[40:43], v[72:75]
    v_mul_f32 v114, v114, v146
    v_mul_f32 v115, v115, v147
    v_mfma_f32_16x16x32_bf16 v[76:79], a[108:111], v[40:43], v[76:79]
    v_mul_f32 v116, v116, v148
    v_mul_f32 v117, v117, v149
    s_add_u32 s75, s72, 0
    s_add_u32 m0, s73, 0
    s_nop 0
    buffer_load_dwordx4 v13, s[4:7], s75 offen sc1 lds
    v_mfma_f32_16x16x32_bf16 v[80:83], a[96:99], v[44:47], v[80:83]
    v_mul_f32 v118, v118, v150
    v_mul_f32 v119, v119, v151
    v_mfma_f32_16x16x32_bf16 v[84:87], a[100:103], v[44:47], v[84:87]
    v_cvt_pk_bf16_f32 v132, v112, v113
    v_cvt_pk_bf16_f32 v133, v114, v115
    v_mfma_f32_16x16x32_bf16 v[88:91], a[104:107], v[44:47], v[88:91]
    v_cvt_pk_bf16_f32 v134, v116, v117
    v_cvt_pk_bf16_f32 v135, v118, v119
    v_mfma_f32_16x16x32_bf16 v[92:95], a[108:111], v[44:47], v[92:95]
    buffer_store_dwordx4 v[132:135], v16, s[4:7], s67 offen offset:1024 sc1
    ds_read_b128 v[40:43], v14 offset:26624
    ds_read_b128 v[44:47], v14 offset:27648
    s_waitcnt lgkmcnt(4)
    v_mfma_f32_16x16x32_bf16 v[64:67], a[112:115], v[48:51], v[64:67]
    v_mfma_f32_16x16x32_bf16 v[68:71], a[116:119], v[48:51], v[68:71]
    v_mfma_f32_16x16x32_bf16 v[72:75], a[120:123], v[48:51], v[72:75]
    v_mfma_f32_16x16x32_bf16 v[76:79], a[124:127], v[48:51], v[76:79]
    s_add_u32 s75, s72, 1024
    s_add_u32 m0, s73, 1024
    s_nop 0
    buffer_load_dwordx4 v13, s[4:7], s75 offen sc1 lds
    v_mfma_f32_16x16x32_bf16 v[80:83], a[112:115], v[52:55], v[80:83]
    v_mfma_f32_16x16x32_bf16 v[84:87], a[116:119], v[52:55], v[84:87]
    v_mfma_f32_16x16x32_bf16 v[88:91], a[120:123], v[52:55], v[88:91]
    v_mfma_f32_16x16x32_bf16 v[92:95], a[124:127], v[52:55], v[92:95]
    ds_read_b128 v[48:51], v14 offset:28672
    ds_read_b128 v[52:55], v14 offset:29696
    s_waitcnt lgkmcnt(4)
    v_mfma_f32_16x16x32_bf16 v[64:67], a[128:131], v[32:35], v[64:67]
    v_mfma_f32_16x16x32_bf16 v[68:71], a[132:135], v[32:35], v[68:71]
    v_mfma_f32_16x16x32_bf16 v[72:75], a[136:139], v[32:35], v[72:75]
    v_mfma_f32_16x16x32_bf16 v[76:79], a[140:143], v[32:35], v[76:79]
    s_add_u32 s75, s72, 2048
    s_add_u32 m0, s73, 2048
    s_nop 0
    buffer_load_dwordx4 v13, s[4:7], s75 offen sc1 lds
    v_mfma_f32_16x16x32_bf16 v[80:83], a[128:131], v[36:39], v[80:83]
    v_mfma_f32_16x16x32_bf16 v[84:87], a[132:135], v[36:39], v[84:87]
    v_mfma_f32_16x16x32_bf16 v[88:91], a[136:139], v[36:39], v[88:91]
    v_mfma_f32_16x16x32_bf16 v[92:95], a[140:143], v[36:39], v[92:95]
    ds_read_b128 v[32:35], v14 offset:30720
    ds_read_b128 v[36:39], v14 offset:31744
    s_waitcnt lgkmcnt(4)
    v_mfma_f32_16x16x32_bf16 v[64:67], a[144:147], v[40:43], v[64:67]
    v_mfma_f32_16x16x32_bf16 v[68:71], a[148:151], v[40:43], v[68:71]
    v_mfma_f32_16x16x32_bf16 v[72:75], a[152:155], v[40:43], v[72:75]
    v_mfma_f32_16x16x32_bf16 v[76:79], a[156:159], v[40:43], v[76:79]
    s_add_u32 s75, s72, 3072
    s_add_u32 m0, s73, 3072
    s_nop 0
    buffer_load_dwordx4 v13, s[4:7], s75 offen sc1 lds
    v_mfma_f32_16x16x32_bf16 v[80:83], a[144:147], v[44:47], v[80:83]
    v_mfma_f32_16x16x32_bf16 v[84:87], a[148:151], v[44:47], v[84:87]
    v_mfma_f32_16x16x32_bf16 v[88:91], a[152:155], v[44:47], v[88:91]
    v_mfma_f32_16x16x32_bf16 v[92:95], a[156:159], v[44:47], v[92:95]
    ds_read_b128 v[40:43], v14 offset:32768
    ds_read_b128 v[44:47], v14 offset:33792
    s_waitcnt lgkmcnt(4)
    v_mfma_f32_16x16x32_bf16 v[64:67], a[160:163], v[48:51], v[64:67]
    v_mfma_f32_16x16x32_bf16 v[68:71], a[164:167], v[48:51], v[68:71]
    v_mfma_f32_16x16x32_bf16 v[72:75], a[168:171], v[48:51], v[72:75]
    v_mfma_f32_16x16x32_bf16 v[76:79], a[172:175], v[48:51], v[76:79]
    s_add_u32 s75, s72, 4096
    s_add_u32 m0, s73, 4096
    s_nop 0
    buffer_load_dwordx4 v13, s[4:7], s75 offen sc1 lds
    v_mfma_f32_16x16x32_bf16 v[80:83], a[160:163], v[52:55], v[80:83]
    v_mfma_f32_16x16x32_bf16 v[84:87], a[164:167], v[52:55], v[84:87]
    v_mfma_f32_16x16x32_bf16 v[88:91], a[168:171], v[52:55], v[88:91]
    v_mfma_f32_16x16x32_bf16 v[92:95], a[172:175], v[52:55], v[92:95]
    ds_read_b128 v[48:51], v14 offset:34816
    ds_read_b128 v[52:55], v14 offset:35840
    s_waitcnt lgkmcnt(4)
    v_mfma_f32_16x16x32_bf16 v[64:67], a[176:179], v[32:35], v[64:67]
    v_mfma_f32_16x16x32_bf16 v[68:71], a[180:183], v[32:35], v[68:71]
    v_mfma_f32_16x16x32_bf16 v[72:75], a[184:187], v[32:35], v[72:75]
    v_mfma_f32_16x16x32_bf16 v[76:79], a[188:191], v[32:35], v[76:79]
    s_add_u32 s75, s72, 5120
    s_add_u32 m0, s73, 5120
    s_nop 0
    buffer_load_dwordx4 v13, s[4:7], s75 offen sc1 lds
    v_mfma_f32_16x16x32_bf16 v[80:83], a[176:179], v[36:39], v[80:83]
    v_mfma_f32_16x16x32_bf16 v[84:87], a[180:183], v[36:39], v[84:87]
    v_mfma_f32_16x16x32_bf16 v[88:91], a[184:187], v[36:39], v[88:91]
    v_mfma_f32_16x16x32_bf16 v[92:95], a[188:191], v[36:39], v[92:95]
    ds_read_b128 v[32:35], v14 offset:36864
    ds_read_b128 v[36:39], v14 offset:37888
    s_waitcnt lgkmcnt(4)
    v_mfma_f32_16x16x32_bf16 v[64:67], a[192:195], v[40:43], v[64:67]
    v_mfma_f32_16x16x32_bf16 v[68:71], a[196:199], v[40:43], v[68:71]
    v_mfma_f32_16x16x32_bf16 v[72:75], a[200:203], v[40:43], v[72:75]
    v_mfma_f32_16x16x32_bf16 v[76:79], a[204:207], v[40:43], v[76:79]
    s_add_u32 s75, s72, 6144
    s_add_u32 m0, s73, 6144
    s_nop 0
    buffer_load_dwordx4 v13, s[4:7], s75 offen sc1 lds
    v_mfma_f32_16x16x32_bf16 v[80:83], a[192:195], v[44:47], v[80:83]
    v_mfma_f32_16x16x32_bf16 v[84:87], a[196:199], v[44:47], v[84:87]
    v_mfma_f32_16x16x32_bf16 v[88:91], a[200:203], v[44:47], v[88:91]
    v_mfma_f32_16x16x32_bf16 v[92:95], a[204:207], v[44:47], v[92:95]
    ds_read_b128 v[40:43], v14 offset:38912
    ds_read_b128 v[44:47], v14 offset:39936
    s_waitcnt lgkmcnt(4)
    v_mfma_f32_16x16x32_bf16 v[64:67], a[208:211], v[48:51], v[64:67]
    v_mfma_f32_16x16x32_bf16 v[68:71], a[212:215], v[48:51], v[68:71]
    v_mfma_f32_16x16x32_bf16 v[72:75], a[216:219], v[48:51], v[72:75]
    v_mfma_f32_16x16x32_bf16 v[76:79], a[220:223], v[48:51], v[76:79]
    s_add_u32 s75, s72, 7168
    s_add_u32 m0, s73, 7168
    s_nop 0
    buffer_load_dwordx4 v13, s[4:7], s75 offen sc1 lds
    v_mfma_f32_16x16x32_bf16 v[80:83], a[208:211], v[52:55], v[80:83]
    v_mfma_f32_16x16x32_bf16 v[84:87], a[212:215], v[52:55], v[84:87]
    v_mfma_f32_16x16x32_bf16 v[88:91], a[216:219], v[52:55], v[88:91]
    v_mfma_f32_16x16x32_bf16 v[92:95], a[220:223], v[52:55], v[92:95]
    s_waitcnt vmcnt(7)
    v_mov_b32 v4, s55
    buffer_store_dword v4, v8, s[4:7], s66 offen sc1
    s_waitcnt lgkmcnt(2)
    v_mfma_f32_16x16x32_bf16 v[64:67], a[224:227], v[32:35], v[64:67]
    v_mfma_f32_16x16x32_bf16 v[68:71], a[228:231], v[32:35], v[68:71]
    v_mfma_f32_16x16x32_bf16 v[72:75], a[232:235], v[32:35], v[72:75]
    v_mfma_f32_16x16x32_bf16 v[76:79], a[236:239], v[32:35], v[76:79]
    s_add_u32 s75, s72, 8192
    s_add_u32 m0, s73, 8192
    s_nop 0
    buffer_load_dwordx4 v13, s[4:7], s75 offen sc1 lds
    v_mfma_f32_16x16x32_bf16 v[80:83], a[224:227], v[36:39], v[80:83]
    v_mfma_f32_16x16x32_bf16 v[84:87], a[228:231], v[36:39], v[84:87]
    v_mfma_f32_16x16x32_bf16 v[88:91], a[232:235], v[36:39], v[88:91]
    v_mfma_f32_16x16x32_bf16 v[92:95], a[236:239], v[36:39], v[92:95]
    s_waitcnt lgkmcnt(0)
    v_mfma_f32_16x16x32_bf16 v[64:67], a[240:243], v[40:43], v[64:67]
    v_mfma_f32_16x16x32_bf16 v[68:71], a[244:247], v[40:43], v[68:71]
    v_mfma_f32_16x16x32_bf16 v[72:75], a[248:251], v[40:43], v[72:75]
    v_mfma_f32_16x16x32_bf16 v[76:79], a[252:255], v[40:43], v[76:79]
    s_add_u32 s75, s72, 9216
    s_add_u32 m0, s73, 9216
    s_nop 0
    buffer_load_dwordx4 v13, s[4:7], s75 offen sc1 lds
    v_mfma_f32_16x16x32_bf16 v[80:83], a[240:243], v[44:47], v[80:83]
    v_mfma_f32_16x16x32_bf16 v[84:87], a[244:247], v[44:47], v[84:87]
    v_mfma_f32_16x16x32_bf16 v[88:91], a[248:251], v[44:47], v[88:91]
    v_mfma_f32_16x16x32_bf16 v[92:95], a[252:255], v[44:47], v[92:95]
    s_add_u32 s72, s72, 40960
    s_add_u32 s73, s73, 40960
    s_cmp_lt_u32 s73, 122880
    s_cselect_b32 s73, s73, s70
    v_mov_b32 v16, v13
    s_add_u32 s67, s67, s68
    s_bitset0_b32 s67, s78
    s_add_u32 s74, s74, 40960
    s_cmp_lt_u32 s74, 122880
    s_cselect_b32 s74, s74, 0
    s_add_u32 s55, s55, 1
    s_sub_u32 s79, s55, 13
    s_max_i32 s79, s79, 0
    s_waitcnt vmcnt(12)
    v_cmp_gt_u32 vcc, s79, v18
    s_cbranch_vccz L_xw_go_119
    s_mov_b32 s96, 2000000
L_wf_120:
    buffer_load_dword v18, v17, s[4:7], 0 offen sc1
    s_sub_u32 s96, s96, 1
    s_cbranch_scc1 L_fail
    s_waitcnt vmcnt(0)
    v_cmp_gt_u32 vcc, s79, v18
    s_cbranch_vccz L_wf_120_d
    s_sleep 16
    s_branch L_wf_120
L_wf_120_d:
L_xw_go_119:
    v_add_u32 v14, s74, v13
    ds_read_b128 v[32:35], v14 offset:0
    ds_read_b128 v[36:39], v14 offset:1024
    ds_read_b128 v[40:43], v14 offset:2048
    ds_read_b128 v[44:47], v14 offset:3072
    ds_read_b128 v[48:51], v14 offset:4096
    ds_read_b128 v[52:55], v14 offset:5120
    s_waitcnt lgkmcnt(4)
    v_mfma_f32_16x16x32_bf16 v[96:99], v[192:195], v[32:35], 0
    v_mfma_f32_16x16x32_bf16 v[100:103], v[196:199], v[32:35], 0
    v_mfma_f32_16x16x32_bf16 v[104:107], v[200:203], v[32:35], 0
    v_mul_f32 v144, v64, v64
    v_mul_f32 v145, v65, v65
    v_mfma_f32_16x16x32_bf16 v[108:111], v[204:207], v[32:35], 0
    v_mul_f32 v146, v66, v66
    v_mul_f32 v147, v67, v67
    v_mfma_f32_16x16x32_bf16 v[112:115], v[192:195], v[36:39], 0
    v_mul_f32 v148, v68, v68
    v_mul_f32 v149, v69, v69
    v_mfma_f32_16x16x32_bf16 v[116:119], v[196:199], v[36:39], 0
    v_mul_f32 v150, v70, v70
    v_mul_f32 v151, v71, v71
    v_mfma_f32_16x16x32_bf16 v[120:123], v[200:203], v[36:39], 0
    v_fma_f32 v144, v144, s76, v15
    v_fma_f32 v145, v145, s76, v15
    v_mfma_f32_16x16x32_bf16 v[124:127], v[204:207], v[36:39], 0
    v_fma_f32 v146, v146, s76, v15
    v_fma_f32 v147, v147, s76, v15
    ds_read_b128 v[32:35], v14 offset:6144
    ds_read_b128 v[36:39], v14 offset:7168
    s_waitcnt lgkmcnt(4)
    v_mfma_f32_16x16x32_bf16 v[96:99], v[208:211], v[40:43], v[96:99]
    v_fma_f32 v148, v148, s76, v15
    v_fma_f32 v149, v149, s76, v15
    v_mfma_f32_16x16x32_bf16 v[100:103], v[212:215], v[40:43], v[100:103]
    v_fma_f32 v150, v150, s76, v15
    v_fma_f32 v151, v151, s76, v15
    v_mfma_f32_16x16x32_bf16 v[104:107], v[216:219], v[40:43], v[104:107]
    v_mul_f32 v144, v144, v64
    v_mul_f32 v145, v145, v65
    v_mfma_f32_16x16x32_bf16 v[108:111], v[220:223], v[40:43], v[108:111]
    v_mul_f32 v146, v146, v66
    v_mul_f32 v147, v147, v67
    v_mfma_f32_16x16x32_bf16 v[112:115], v[208:211], v[44:47], v[112:115]
    v_mul_f32 v148, v148, v68
    v_mul_f32 v149, v149, v69
    v_mfma_f32_16x16x32_bf16 v[116:119], v[212:215], v[44:47], v[116:119]
    v_mul_f32 v150, v150, v70
    v_mul_f32 v151, v151, v71
    v_mfma_f32_16x16x32_bf16 v[120:123], v[216:219], v[44:47], v[120:123]
    v_exp_f32 v144, v144
    v_mfma_f32_16x16x32_bf16 v[124:127], v[220:223], v[44:47], v[124:127]
    v_exp_f32 v145, v145
    ds_read_b128 v[40:43], v14 offset:8192
    ds_read_b128 v[44:47], v14 offset:9216
    s_waitcnt lgkmcnt(4)
    v_mfma_f32_16x16x32_bf16 v[96:99], v[224:227], v[48:51], v[96:99]
    v_exp_f32 v146, v146
    v_mfma_f32_16x16x32_bf16 v[100:103], v[228:231], v[48:51], v[100:103]
    v_exp_f32 v147, v147
    v_mfma_f32_16x16x32_bf16 v[104:107], v[232:235], v[48:51], v[104:107]
    v_exp_f32 v148, v148
    v_mfma_f32_16x16x32_bf16 v[108:111], v[236:239], v[48:51], v[108:111]
    v_exp_f32 v149, v149
    v_mfma_f32_16x16x32_bf16 v[112:115], v[224:227], v[52:55], v[112:115]
    v_exp_f32 v150, v150
    v_mfma_f32_16x16x32_bf16 v[116:119], v[228:231], v[52:55], v[116:119]
    v_exp_f32 v151, v151
    v_mfma_f32_16x16x32_bf16 v[120:123], v[232:235], v[52:55], v[120:123]
    v_mul_f32 v64, v64, v72
    v_mul_f32 v65, v65, v73
    v_mfma_f32_16x16x32_bf16 v[124:127], v[236:239], v[52:55], v[124:127]
    v_mul_f32 v66, v66, v74
    v_mul_f32 v67, v67, v75
    ds_read_b128 v[48:51], v14 offset:10240
    ds_read_b128 v[52:55], v14 offset:11264
    s_waitcnt lgkmcnt(4)
    v_mfma_f32_16x16x32_bf16 v[96:99], v[240:243], v[32:35], v[96:99]
    v_mul_f32 v68, v68, v76
    v_mul_f32 v69, v69, v77
    v_mfma_f32_16x16x32_bf16 v[100:103], v[244:247], v[32:35], v[100:103]
    v_mul_f32 v70, v70, v78
    v_mul_f32 v71, v71, v79
    v_mfma_f32_16x16x32_bf16 v[104:107], v[248:251], v[32:35], v[104:107]
    v_add_f32 v144, 1.0, v144
    v_add_f32 v145, 1.0, v145
    v_mfma_f32_16x16x32_bf16 v[108:111], v[252:255], v[32:35], v[108:111]
    v_add_f32 v146, 1.0, v146
    v_add_f32 v147, 1.0, v147
    v_mfma_f32_16x16x32_bf16 v[112:115], v[240:243], v[36:39], v[112:115]
    v_add_f32 v148, 1.0, v148
    v_add_f32 v149, 1.0, v149
    v_mfma_f32_16x16x32_bf16 v[116:119], v[244:247], v[36:39], v[116:119]
    v_add_f32 v150, 1.0, v150
    v_add_f32 v151, 1.0, v151
    v_mfma_f32_16x16x32_bf16 v[120:123], v[248:251], v[36:39], v[120:123]
    v_rcp_f32 v144, v144
    v_mfma_f32_16x16x32_bf16 v[124:127], v[252:255], v[36:39], v[124:127]
    v_rcp_f32 v145, v145
    ds_read_b128 v[32:35], v14 offset:12288
    ds_read_b128 v[36:39], v14 offset:13312
    s_waitcnt lgkmcnt(4)
    v_mfma_f32_16x16x32_bf16 v[96:99], a[0:3], v[40:43], v[96:99]
    v_rcp_f32 v146, v146
    v_mfma_f32_16x16x32_bf16 v[100:103], a[4:7], v[40:43], v[100:103]
    v_rcp_f32 v147, v147
    v_mfma_f32_16x16x32_bf16 v[104:107], a[8:11], v[40:43], v[104:107]
    v_rcp_f32 v148, v148
    v_mfma_f32_16x16x32_bf16 v[108:111], a[12:15], v[40:43], v[108:111]
    v_rcp_f32 v149, v149
    v_mfma_f32_16x16x32_bf16 v[112:115], a[0:3], v[44:47], v[112:115]
    v_rcp_f32 v150, v150
    v_mfma_f32_16x16x32_bf16 v[116:119], a[4:7], v[44:47], v[116:119]
    v_rcp_f32 v151, v151
    v_mfma_f32_16x16x32_bf16 v[120:123], a[8:11], v[44:47], v[120:123]
    v_mul_f32 v64, v64, v144
    v_mul_f32 v65, v65, v145
    v_mfma_f32_16x16x32_bf16 v[124:127], a[12:15], v[44:47], v[124:127]
    v_mul_f32 v66, v66, v146
    v_mul_f32 v67, v67, v147
    ds_read_b128 v[40:43], v14 offset:14336
    ds_read_b128 v[44:47], v14 offset:15360
    s_waitcnt lgkmcnt(4)
    v_mfma_f32_16x16x32_bf16 v[96:99], a[16:19], v[48:51], v[96:99]
    v_mul_f32 v68, v68, v148
    v_mul_f32 v69, v69, v149
    v_mfma_f32_16x16x32_bf16 v[100:103], a[20:23], v[48:51], v[100:103]
    v_mul_f32 v70, v70, v150
    v_mul_f32 v71, v71, v151
    v_mfma_f32_16x16x32_bf16 v[104:107], a[24:27], v[48:51], v[104:107]
    v_cvt_pk_bf16_f32 v128, v64, v65
    v_cvt_pk_bf16_f32 v129, v66, v67
    v_mfma_f32_16x16x32_bf16 v[108:111], a[28:31], v[48:51], v[108:111]
    v_cvt_pk_bf16_f32 v130, v68, v69
    v_cvt_pk_bf16_f32 v131, v70, v71
    v_mfma_f32_16x16x32_bf16 v[112:115], a[16:19], v[52:55], v[112:115]
    buffer_store_dwordx4 v[128:131], v16, s[4:7], s67 offen offset:0 sc1
    v_mfma_f32_16x16x32_bf16 v[116:119], a[20:23], v[52:55], v[116:119]
    v_mul_f32 v144, v80, v80
    v_mul_f32 v145, v81, v81
    v_mfma_f32_16x16x32_bf16 v[120:123], a[24:27], v[52:55], v[120:123]
    v_mul_f32 v146, v82, v82
    v_mul_f32 v147, v83, v83
    v_mfma_f32_16x16x32_bf16 v[124:127], a[28:31], v[52:55], v[124:127]
    v_mul_f32 v148, v84, v84
    v_mul_f32 v149, v85, v85
    ds_read_b128 v[48:51], v14 offset:16384
    ds_read_b128 v[52:55], v14 offset:17408
    s_waitcnt lgkmcnt(4)
    v_mfma_f32_16x16x32_bf16 v[96:99], a[32:35], v[32:35], v[96:99]
    v_mul_f32 v150, v86, v86
    v_mul_f32 v151, v87, v87
    v_mfma_f32_16x16x32_bf16 v[100:103], a[36:39], v[32:35], v[100:103]
    v_fma_f32 v144, v144, s76, v15
    v_fma_f32 v145, v145, s76, v15
    v_mfma_f32_16x16x32_bf16 v[104:107], a[40:43], v[32:35], v[104:107]
    v_fma_f32 v146, v146, s76, v15
    v_fma_f32 v147, v147, s76, v15
    v_mfma_f32_16x16x32_bf16 v[108:111], a[44:47], v[32:35], v[108:111]
    v_fma_f32 v148, v148, s76, v15
    v_fma_f32 v149, v149, s76, v15
    v_mfma_f32_16x16x32_bf16 v[112:115], a[32:35], v[36:39], v[112:115]
    v_fma_f32 v150, v150, s76, v15
    v_fma_f32 v151, v151, s76, v15
    v_mfma_f32_16x16x32_bf16 v[116:119], a[36:39], v[36:39], v[116:119]
    v_mul_f32 v144, v144, v80
    v_mul_f32 v145, v145, v81
    v_mfma_f32_16x16x32_bf16 v[120:123], a[40:43], v[36:39], v[120:123]
    v_mul_f32 v146, v146, v82
    v_mul_f32 v147, v147, v83
    v_mfma_f32_16x16x32_bf16 v[124:127], a[44:47], v[36:39], v[124:127]
    v_mul_f32 v148, v148, v84
    v_mul_f32 v149, v149, v85
    ds_read_b128 v[32:35], v14 offset:18432
    ds_read_b128 v[36:39], v14 offset:19456
    s_waitcnt lgkmcnt(4)
    v_mfma_f32_16x16x32_bf16 v[96:99], a[48:51], v[40:43], v[96:99]
    v_mul_f32 v150, v150, v86
    v_mul_f32 v151, v151, v87
    v_mfma_f32_16x16x32_bf16 v[100:103], a[52:55], v[40:43], v[100:103]
    v_exp_f32 v144, v144
    v_mfma_f32_16x16x32_bf16 v[104:107], a[56:59], v[40:43], v[104:107]
    v_exp_f32 v145, v145
    v_mfma_f32_16x16x32_bf16 v[108:111], a[60:63], v[40:43], v[108:111]
    v_exp_f32 v146, v146
    v_mfma_f32_16x16x32_bf16 v[112:115], a[48:51], v[44:47], v[112:115]
    v_exp_f32 v147, v147
    v_mfma_f32_16x16x32_bf16 v[116:119], a[52:55], v[44:47], v[116:119]
    v_exp_f32 v148, v148
    v_mfma_f32_16x16x32_bf16 v[120:123], a[56:59], v[44:47], v[120:123]
    v_exp_f32 v149, v149
    v_mfma_f32_16x16x32_bf16 v[124:127], a[60:63], v[44:47], v[124:127]
    v_exp_f32 v150, v150
    ds_read_b128 v[40:43], v14 offset:20480
    ds_read_b128 v[44:47], v14 offset:21504
    s_waitcnt lgkmcnt(4)
    v_mfma_f32_16x16x32_bf16 v[96:99], a[64:67], v[48:51], v[96:99]
    v_exp_f32 v151, v151
    v_mfma_f32_16x16x32_bf16 v[100:103], a[68:71], v[48:51], v[100:103]
    v_mul_f32 v80, v80, v88
    v_mul_f32 v81, v81, v89
    v_mfma_f32_16x16x32_bf16 v[104:107], a[72:75], v[48:51], v[104:107]
    v_mul_f32 v82, v82, v90
    v_mul_f32 v83, v83, v91
    v_mfma_f32_16x16x32_bf16 v[108:111], a[76:79], v[48:51], v[108:111]
    v_mul_f32 v84, v84, v92
    v_mul_f32 v85, v85, v93
    v_mfma_f32_16x16x32_bf16 v[112:115], a[64:67], v[52:55], v[112:115]
    v_mul_f32 v86, v86, v94
    v_mul_f32 v87, v87, v95
    v_mfma_f32_16x16x32_bf16 v[116:119], a[68:71], v[52:55], v[116:119]
    v_add_f32 v144, 1.0, v144
    v_add_f32 v145, 1.0, v145
    v_mfma_f32_16x16x32_bf16 v[120:123], a[72:75], v[52:55], v[120:123]
    v_add_f32 v146, 1.0, v146
    v_add_f32 v147, 1.0, v147
    v_mfma_f32_16x16x32_bf16 v[124:127], a[76:79], v[52:55], v[124:127]
    v_add_f32 v148, 1.0, v148
    v_add_f32 v149, 1.0, v149
    buffer_load_dword v18, v17, s[4:7], 0 offen sc1
    ds_read_b128 v[48:51], v14 offset:22528
    ds_read_b128 v[52:55], v14 offset:23552
    s_waitcnt lgkmcnt(4)
    v_mfma_f32_16x16x32_bf16 v[96:99], a[80:83], v[32:35], v[96:99]
    v_add_f32 v150, 1.0, v150
    v_add_f32 v151, 1.0, v151
    v_mfma_f32_16x16x32_bf16 v[100:103], a[84:87], v[32:35], v[100:103]
    v_rcp_f32 v144, v144
    v_mfma_f32_16x16x32_bf16 v[104:107], a[88:91], v[32:35], v[104:107]
    v_rcp_f32 v145, v145
    v_mfma_f32_16x16x32_bf16 v[108:111], a[92:95], v[32:35], v[108:111]
    v_rcp_f32 v146, v146
    v_mfma_f32_16x16x32_bf16 v[112:115], a[80:83], v[36:39], v[112:115]
    v_rcp_f32 v147, v147
    v_mfma_f32_16x16x32_bf16 v[116:119], a[84:87], v[36:39], v[116:119]
    v_rcp_f32 v148, v148
    v_mfma_f32_16x16x32_bf16 v[120:123], a[88:91], v[36:39], v[120:123]
    v_rcp_f32 v149, v149
    v_mfma_f32_16x16x32_bf16 v[124:127], a[92:95], v[36:39], v[124:127]
    v_rcp_f32 v150, v150
    s_waitcnt vmcnt(2)
    s_barrier
    ds_read_b128 v[32:35], v14 offset:24576
    ds_read_b128 v[36:39], v14 offset:25600
    s_waitcnt lgkmcnt(4)
    v_mfma_f32_16x16x32_bf16 v[96:99], a[96:99], v[40:43], v[96:99]
    v_rcp_f32 v151, v151
    v_mfma_f32_16x16x32_bf16 v[100:103], a[100:103], v[40:43], v[100:103]
    v_mul_f32 v80, v80, v144
    v_mul_f32 v81, v81, v145
    v_mfma_f32_16x16x32_bf16 v[104:107], a[104:107], v[40:43], v[104:107]
    v_mul_f32 v82, v82, v146
    v_mul_f32 v83, v83, v147
    v_mfma_f32_16x16x32_bf16 v[108:111], a[108:111], v[40:43], v[108:111]
    v_mul_f32 v84, v84, v148
    v_mul_f32 v85, v85, v149
    s_add_u32 s75, s72, 0
    s_add_u32 m0, s73, 0
    s_nop 0
    buffer_load_dwordx4 v13, s[4:7], s75 offen sc1 lds
    v_mfma_f32_16x16x32_bf16 v[112:115], a[96:99], v[44:47], v[112:115]
    v_mul_f32 v86, v86, v150
    v_mul_f32 v87, v87, v151
    v_mfma_f32_16x16x32_bf16 v[116:119], a[100:103], v[44:47], v[116:119]
    v_cvt_pk_bf16_f32 v132, v80, v81
    v_cvt_pk_bf16_f32 v133, v82, v83
    v_mfma_f32_16x16x32_bf16 v[120:123], a[104:107], v[44:47], v[120:123]
    v_cvt_pk_bf16_f32 v134, v84, v85
    v_cvt_pk_bf16_f32 v135, v86, v87
    v_mfma_f32_16x16x32_bf16 v[124:127], a[108:111], v[44:47], v[124:127]
    buffer_store_dwordx4 v[132:135], v16, s[4:7], s67 offen offset:1024 sc1
    ds_read_b128 v[40:43], v14 offset:26624
    ds_read_b128 v[44:47], v14 offset:27648
    s_waitcnt lgkmcnt(4)
    v_mfma_f32_16x16x32_bf16 v[96:99], a[112:115], v[48:51], v[96:99]
    v_mfma_f32_16x16x32_bf16 v[100:103], a[116:119], v[48:51], v[100:103]
    v_mfma_f32_16x16x32_bf16 v[104:107], a[120:123], v[48:51], v[104:107]
    v_mfma_f32_16x16x32_bf16 v[108:111], a[124:127], v[48:51], v[108:111]
    s_add_u32 s75, s72, 1024
    s_add_u32 m0, s73, 1024
    s_nop 0
    buffer_load_dwordx4 v13, s[4:7], s75 offen sc1 lds
    v_mfma_f32_16x16x32_bf16 v[112:115], a[112:115], v[52:55], v[112:115]
    v_mfma_f32_16x16x32_bf16 v[116:119], a[116:119], v[52:55], v[116:119]
    v_mfma_f32_16x16x32_bf16 v[120:123], a[120:123], v[52:55], v[120:123]
    v_mfma_f32_16x16x32_bf16 v[124:127], a[124:127], v[52:55], v[124:127]
    ds_read_b128 v[48:51], v14 offset:28672
    ds_read_b128 v[52:55], v14 offset:29696
    s_waitcnt lgkmcnt(4)
    v_mfma_f32_16x16x32_bf16 v[96:99], a[128:131], v[32:35], v[96:99]
    v_mfma_f32_16x16x32_bf16 v[100:103], a[132:135], v[32:35], v[100:103]
    v_mfma_f32_16x16x32_bf16 v[104:107], a[136:139], v[32:35], v[104:107]
    v_mfma_f32_16x16x32_bf16 v[108:111], a[140:143], v[32:35], v[108:111]
    s_add_u32 s75, s72, 2048
    s_add_u32 m0, s73, 2048
    s_nop 0
    buffer_load_dwordx4 v13, s[4:7], s75 offen sc1 lds
    v_mfma_f32_16x16x32_bf16 v[112:115], a[128:131], v[36:39], v[112:115]
    v_mfma_f32_16x16x32_bf16 v[116:119], a[132:135], v[36:39], v[116:119]
    v_mfma_f32_16x16x32_bf16 v[120:123], a[136:139], v[36:39], v[120:123]
    v_mfma_f32_16x16x32_bf16 v[124:127], a[140:143], v[36:39], v[124:127]
    ds_read_b128 v[32:35], v14 offset:30720
    ds_read_b128 v[36:39], v14 offset:31744
    s_waitcnt lgkmcnt(4)
    v_mfma_f32_16x16x32_bf16 v[96:99], a[144:147], v[40:43], v[96:99]
    v_mfma_f32_16x16x32_bf16 v[100:103], a[148:151], v[40:43], v[100:103]
    v_mfma_f32_16x16x32_bf16 v[104:107], a[152:155], v[40:43], v[104:107]
    v_mfma_f32_16x16x32_bf16 v[108:111], a[156:159], v[40:43], v[108:111]
    s_add_u32 s75, s72, 3072
    s_add_u32 m0, s73, 3072
    s_nop 0
    buffer_load_dwordx4 v13, s[4:7], s75 offen sc1 lds
    v_mfma_f32_16x16x32_bf16 v[112:115], a[144:147], v[44:47], v[112:115]
    v_mfma_f32_16x16x32_bf16 v[116:119], a[148:151], v[44:47], v[116:119]
    v_mfma_f32_16x16x32_bf16 v[120:123], a[152:155], v[44:47], v[120:123]
    v_mfma_f32_16x16x32_bf16 v[124:127], a[156:159], v[44:47], v[124:127]
    ds_read_b128 v[40:43], v14 offset:32768
    ds_read_b128 v[44:47], v14 offset:33792
    s_waitcnt lgkmcnt(4)
    v_mfma_f32_16x16x32_bf16 v[96:99], a[160:163], v[48:51], v[96:99]
    v_mfma_f32_16x16x32_bf16 v[100:103], a[164:167], v[48:51], v[100:103]
    v_mfma_f32_16x16x32_bf16 v[104:107], a[168:171], v[48:51], v[104:107]
    v_mfma_f32_16x16x32_bf16 v[108:111], a[172:175], v[48:51], v[108:111]
    s_add_u32 s75, s72, 4096
    s_add_u32 m0, s73, 4096
    s_nop 0
    buffer_load_dwordx4 v13, s[4:7], s75 offen sc1 lds
    v_mfma_f32_16x16x32_bf16 v[112:115], a[160:163], v[52:55], v[112:115]
    v_mfma_f32_16x16x32_bf16 v[116:119], a[164:167], v[52:55], v[116:119]
    v_mfma_f32_16x16x32_bf16 v[120:123], a[168:171], v[52:55], v[120:123]
    v_mfma_f32_16x16x32_bf16 v[124:127], a[172:175], v[52:55], v[124:127]
    ds_read_b128 v[48:51], v14 offset:34816
    ds_read_b128 v[52:55], v14 offset:35840
    s_waitcnt lgkmcnt(4)
    v_mfma_f32_16x16x32_bf16 v[96:99], a[176:179], v[32:35], v[96:99]
    v_mfma_f32_16x16x32_bf16 v[100:103], a[180:183], v[32:35], v[100:103]
    v_mfma_f32_16x16x32_bf16 v[104:107], a[184:187], v[32:35], v[104:107]
    v_mfma_f32_16x16x32_bf16 v[108:111], a[188:191], v[32:35], v[108:111]
    s_add_u32 s75, s72, 5120
    s_add_u32 m0, s73, 5120
    s_nop 0
    buffer_load_dwordx4 v13, s[4:7], s75 offen sc1 lds
    v_mfma_f32_16x16x32_bf16 v[112:115], a[176:179], v[36:39], v[112:115]
    v_mfma_f32_16x16x32_bf16 v[116:119], a[180:183], v[36:39], v[116:119]
    v_mfma_f32_16x16x32_bf16 v[120:123], a[184:187], v[36:39], v[120:123]
    v_mfma_f32_16x16x32_bf16 v[124:127], a[188:191], v[36:39], v[124:127]
    ds_read_b128 v[32:35], v14 offset:36864
    ds_read_b128 v[36:39], v14 offset:37888
    s_waitcnt lgkmcnt(4)
    v_mfma_f32_16x16x32_bf16 v[96:99], a[192:195], v[40:43], v[96:99]
    v_mfma_f32_16x16x32_bf16 v[100:103], a[196:199], v[40:43], v[100:103]
    v_mfma_f32_16x16x32_bf16 v[104:107], a[200:203], v[40:43], v[104:107]
    v_mfma_f32_16x16x32_bf16 v[108:111], a[204:207], v[40:43], v[108:111]
    s_add_u32 s75, s72, 6144
    s_add_u32 m0, s73, 6144
    s_nop 0
    buffer_load_dwordx4 v13, s[4:7], s75 offen sc1 lds
    v_mfma_f32_16x16x32_bf16 v[112:115], a[192:195], v[44:47], v[112:115]
    v_mfma_f32_16x16x32_bf16 v[116:119], a[196:199], v[44:47], v[116:119]
    v_mfma_f32_16x16x32_bf16 v[120:123], a[200:203], v[44:47], v[120:123]
    v_mfma_f32_16x16x32_bf16 v[124:127], a[204:207], v[44:47], v[124:127]
    ds_read_b128 v[40:43], v14 offset:38912
    ds_read_b128 v[44:47], v14 offset:39936
    s_waitcnt lgkmcnt(4)
    v_mfma_f32_16x16x32_bf16 v[96:99], a[208:211], v[48:51], v[96:99]
    v_mfma_f32_16x16x32_bf16 v[100:103], a[212:215], v[48:51], v[100:103]
    v_mfma_f32_16x16x32_bf16 v[104:107], a[216:219], v[48:51], v[104:107]
    v_mfma_f32_16x16x32_bf16 v[108:111], a[220:223], v[48:51], v[108:111]
    s_add_u32 s75, s72, 7168
    s_add_u32 m0, s73, 7168
    s_nop 0
    buffer_load_dwordx4 v13, s[4:7], s75 offen sc1 lds
    v_mfma_f32_16x16x32_bf16 v[112:115], a[208:211], v[52:55], v[112:115]
    v_mfma_f32_16x16x32_bf16 v[116:119], a[212:215], v[52:55], v[116:119]
    v_mfma_f32_16x16x32_bf16 v[120:123], a[216:219], v[52:55], v[120:123]
    v_mfma_f32_16x16x32_bf16 v[124:127], a[220:223], v[52:55], v[124:127]
    s_waitcnt vmcnt(7)
    v_mov_b32 v4, s55
    buffer_store_dword v4, v8, s[4:7], s66 offen sc1
    s_waitcnt lgkmcnt(2)
    v_mfma_f32_16x16x32_bf16 v[96:99], a[224:227], v[32:35], v[96:99]
    v_mfma_f32_16x16x32_bf16 v[100:103], a[228:231], v[32:35], v[100:103]
    v_mfma_f32_16x16x32_bf16 v[104:107], a[232:235], v[32:35], v[104:107]
    v_mfma_f32_16x16x32_bf16 v[108:111], a[236:239], v[32:35], v[108:111]
    s_add_u32 s75, s72, 8192
    s_add_u32 m0, s73, 8192
    s_nop 0
    buffer_load_dwordx4 v13, s[4:7], s75 offen sc1 lds
    v_mfma_f32_16x16x32_bf16 v[112:115], a[224:227], v[36:39], v[112:115]
    v_mfma_f32_16x16x32_bf16 v[116:119], a[228:231], v[36:39], v[116:119]
    v_mfma_f32_16x16x32_bf16 v[120:123], a[232:235], v[36:39], v[120:123]
    v_mfma_f32_16x16x32_bf16 v[124:127], a[236:239], v[36:39], v[124:127]
    s_waitcnt lgkmcnt(0)
    v_mfma_f32_16x16x32_bf16 v[96:99], a[240:243], v[40:43], v[96:99]
    v_mfma_f32_16x16x32_bf16 v[100:103], a[244:247], v[40:43], v[100:103]
    v_mfma_f32_16x16x32_bf16 v[104:107], a[248:251], v[40:43], v[104:107]
    v_mfma_f32_16x16x32_bf16 v[108:111], a[252:255], v[40:43], v[108:111]
    s_add_u32 s75, s72, 9216
    s_add_u32 m0, s73, 9216
    s_nop 0
    buffer_load_dwordx4 v13, s[4:7], s75 offen sc1 lds
    v_mfma_f32_16x16x32_bf16 v[112:115], a[240:243], v[44:47], v[112:115]
    v_mfma_f32_16x16x32_bf16 v[116:119], a[244:247], v[44:47], v[116:119]
    v_mfma_f32_16x16x32_bf16 v[120:123], a[248:251], v[44:47], v[120:123]
    v_mfma_f32_16x16x32_bf16 v[124:127], a[252:255], v[44:47], v[124:127]
    s_add_u32 s72, s72, 40960
    s_add_u32 s73, s73, 40960
    s_cmp_lt_u32 s73, 122880
    s_cselect_b32 s73, s73, s70
    v_mov_b32 v16, v13
    s_add_u32 s67, s67, s68
    s_bitset0_b32 s67, s78
    s_add_u32 s74, s74, 40960
    s_cmp_lt_u32 s74, 122880
    s_cselect_b32 s74, s74, 0
    s_add_u32 s55, s55, 1
    s_cmp_lt_u32 s55, 64
    s_cbranch_scc1 L_xf_loop
    s_nop 7
    v_mul_f32 v144, v96, v96
    v_mul_f32 v145, v97, v97
    v_mul_f32 v146, v98, v98
    v_mul_f32 v147, v99, v99
    v_mul_f32 v148, v100, v100
    v_mul_f32 v149, v101, v101
    v_mul_f32 v150, v102, v102
    v_mul_f32 v151, v103, v103
    v_fma_f32 v144, v144, s76, v15
    v_fma_f32 v145, v145, s76, v15
    v_fma_f32 v146, v146, s76, v15
    v_fma_f32 v147, v147, s76, v15
    v_fma_f32 v148, v148, s76, v15
    v_fma_f32 v149, v149, s76, v15
    v_fma_f32 v150, v150, s76, v15
    v_fma_f32 v151, v151, s76, v15
    v_mul_f32 v144, v144, v96
    v_mul_f32 v145, v145, v97
    v_mul_f32 v146, v146, v98
    v_mul_f32 v147, v147, v99
    v_mul_f32 v148, v148, v100
    v_mul_f32 v149, v149, v101
    v_mul_f32 v150, v150, v102
    v_mul_f32 v151, v151, v103
    v_exp_f32 v144, v144
    s_nop 0
    v_exp_f32 v145, v145
    s_nop 0
    v_exp_f32 v146, v146
    s_nop 0
    v_exp_f32 v147, v147
    s_nop 0
    v_exp_f32 v148, v148
    s_nop 0
    v_exp_f32 v149, v149
    s_nop 0
    v_exp_f32 v150, v150
    s_nop 0
    v_exp_f32 v151, v151
    s_nop 0
    v_mul_f32 v96, v96, v104
    v_mul_f32 v97, v97, v105
    v_mul_f32 v98, v98, v106
    v_mul_f32 v99, v99, v107
    v_mul_f32 v100, v100, v108
    v_mul_f32 v101, v101, v109
    v_mul_f32 v102, v102, v110
    v_mul_f32 v103, v103, v111
    v_add_f32 v144, 1.0, v144
    v_add_f32 v145, 1.0, v145
    v_add_f32 v146, 1.0, v146
    v_add_f32 v147, 1.0, v147
    v_add_f32 v148, 1.0, v148
    v_add_f32 v149, 1.0, v149
    v_add_f32 v150, 1.0, v150
    v_add_f32 v151, 1.0, v151
    v_rcp_f32 v144, v144
    s_nop 0
    v_rcp_f32 v145, v145
    s_nop 0
    v_rcp_f32 v146, v146
    s_nop 0
    v_rcp_f32 v147, v147
    s_nop 0
    v_rcp_f32 v148, v148
    s_nop 0
    v_rcp_f32 v149, v149
    s_nop 0
    v_rcp_f32 v150, v150
    s_nop 0
    v_rcp_f32 v151, v151
    s_nop 0
    v_mul_f32 v96, v96, v144
    v_mul_f32 v97, v97, v145
    v_mul_f32 v98, v98, v146
    v_mul_f32 v99, v99, v147
    v_mul_f32 v100, v100, v148
    v_mul_f32 v101, v101, v149
    v_mul_f32 v102, v102, v150
    v_mul_f32 v103, v103, v151
    v_cvt_pk_bf16_f32 v128, v96, v97
    v_cvt_pk_bf16_f32 v129, v98, v99
    v_cvt_pk_bf16_f32 v130, v100, v101
    v_cvt_pk_bf16_f32 v131, v102, v103
    buffer_store_dwordx4 v[128:131], v16, s[4:7], s67 offen offset:0 sc1
    v_mul_f32 v144, v112, v112
    v_mul_f32 v145, v113, v113
    v_mul_f32 v146, v114, v114
    v_mul_f32 v147, v115, v115
    v_mul_f32 v148, v116, v116
    v_mul_f32 v149, v117, v117
    v_mul_f32 v150, v118, v118
    v_mul_f32 v151, v119, v119
    v_fma_f32 v144, v144, s76, v15
    v_fma_f32 v145, v145, s76, v15
    v_fma_f32 v146, v146, s76, v15
    v_fma_f32 v147, v147, s76, v15
    v_fma_f32 v148, v148, s76, v15
    v_fma_f32 v149, v149, s76, v15
    v_fma_f32 v150, v150, s76, v15
    v_fma_f32 v151, v151, s76, v15
    v_mul_f32 v144, v144, v112
    v_mul_f32 v145, v145, v113
    v_mul_f32 v146, v146, v114
    v_mul_f32 v147, v147, v115
    v_mul_f32 v148, v148, v116
    v_mul_f32 v149, v149, v117
    v_mul_f32 v150, v150, v118
    v_mul_f32 v151, v151, v119
    v_exp_f32 v144, v144
    s_nop 0
    v_exp_f32 v145, v145
    s_nop 0
    v_exp_f32 v146, v146
    s_nop 0
    v_exp_f32 v147, v147
    s_nop 0
    v_exp_f32 v148, v148
    s_nop 0
    v_exp_f32 v149, v149
    s_nop 0
    v_exp_f32 v150, v150
    s_nop 0
    v_exp_f32 v151, v151
    s_nop 0
    v_mul_f32 v112, v112, v120
    v_mul_f32 v113, v113, v121
    v_mul_f32 v114, v114, v122
    v_mul_f32 v115, v115, v123
    v_mul_f32 v116, v116, v124
    v_mul_f32 v117, v117, v125
    v_mul_f32 v118, v118, v126
    v_mul_f32 v119, v119, v127
    v_add_f32 v144, 1.0, v144
    v_add_f32 v145, 1.0, v145
    v_add_f32 v146, 1.0, v146
    v_add_f32 v147, 1.0, v147
    v_add_f32 v148, 1.0, v148
    v_add_f32 v149, 1.0, v149
    v_add_f32 v150, 1.0, v150
    v_add_f32 v151, 1.0, v151
    v_rcp_f32 v144, v144
    s_nop 0
    v_rcp_f32 v145, v145
    s_nop 0
    v_rcp_f32 v146, v146
    s_nop 0
    v_rcp_f32 v147, v147
    s_nop 0
    v_rcp_f32 v148, v148
    s_nop 0
    v_rcp_f32 v149, v149
    s_nop 0
    v_rcp_f32 v150, v150
    s_nop 0
    v_rcp_f32 v151, v151
    s_nop 0
    v_mul_f32 v112, v112, v144
    v_mul_f32 v113, v113, v145
    v_mul_f32 v114, v114, v146
    v_mul_f32 v115, v115, v147
    v_mul_f32 v116, v116, v148
    v_mul_f32 v117, v117, v149
    v_mul_f32 v118, v118, v150
    v_mul_f32 v119, v119, v151
    v_cvt_pk_bf16_f32 v132, v112, v113
    v_cvt_pk_bf16_f32 v133, v114, v115
    v_cvt_pk_bf16_f32 v134, v116, v117
    v_cvt_pk_bf16_f32 v135, v118, v119
    buffer_store_dwordx4 v[132:135], v16, s[4:7], s67 offen offset:1024 sc1
    s_waitcnt vmcnt(0)
    v_mov_b32 v4, 64
    buffer_store_dword v4, v8, s[4:7], s66 offen sc1
    s_branch L_end
L_fail:
    s_waitcnt vmcnt(0) lgkmcnt(0)
    s_mov_b64 exec, 1
    v_mov_b32 v4, s52
    v_add_u32 v4, 1, v4
    v_mov_b32 v5, 12
    buffer_store_dword v4, v5, s[8:11], 0 offen
L_end:
    s_endpgm
L_hot_end:
L_s_slow:
    ds_read_b128 v[108:111], v15 offset:0
    ds_read_b128 v[112:115], v15 offset:1024
    ds_read_b128 v[116:119], v15 offset:2048
    ds_read_b128 v[120:123], v15 offset:3072
    v_mov_b32 v44, 0
    v_mov_b32 v45, 0
    v_mov_b32 v46, 0
    v_mov_b32 v47, 0
    v_mov_b32 v48, 0
    v_mov_b32 v49, 0
    v_mov_b32 v50, 0
    v_mov_b32 v51, 0
    v_mov_b32 v52, 0
    v_mov_b32 v53, 0
    v_mov_b32 v54, 0
    v_mov_b32 v55, 0
    v_mov_b32 v56, 0
    v_mov_b32 v57, 0
    v_mov_b32 v58, 0
    v_mov_b32 v59, 0
    v_mov_b32 v60, 0
    v_mov_b32 v61, 0
    v_mov_b32 v62, 0
    v_mov_b32 v63, 0
    v_mov_b32 v64, 0
    v_mov_b32 v65, 0
    v_mov_b32 v66, 0
    v_mov_b32 v67, 0
    s_waitcnt lgkmcnt(0)
L_s_loop_w:
    s_lshl_b32 s59, s55, 1
    buffer_load_dword v4, v8, s[4:7], s79 offen sc1
    s_waitcnt vmcnt(0)
    v_mov_b32 v5, s55
    buffer_store_dword v5, v8, s[4:7], s66 offen sc1
    v_cmp_gt_u32 vcc, s59, v4
    s_cbranch_vccz L_wf_5_d_w
    s_mov_b32 s96, 2000000
L_wf_5_w:
    buffer_load_dword v4, v8, s[4:7], s79 offen sc1
    s_sub_u32 s96, s96, 1
    s_cbranch_scc1 L_fail
    s_waitcnt vmcnt(0)
    v_cmp_gt_u32 vcc, s59, v4
    s_cbranch_vccnz L_wf_5_w
L_wf_5_d_w:
    s_mov_b32 s96, 2000000
    buffer_load_dwordx4 v[98:101], v10, s[4:7], s71 offen sc1
    buffer_load_dwordx4 v[102:105], v10, s[4:7], s71 offen offset:1024 sc1
    buffer_load_dwordx2 v[106:107], v11, s[4:7], s71 offen sc1
    s_branch L_s_poll_w
L_s_pollB_z_w:
    s_nop 7
    v_mov_b32 v44, 0
    v_mov_b32 v45, 0
    v_mov_b32 v46, 0
    v_mov_b32 v47, 0
    v_mov_b32 v48, 0
    v_mov_b32 v49, 0
    v_mov_b32 v50, 0
    v_mov_b32 v51, 0
    v_mov_b32 v52, 0
    v_mov_b32 v53, 0
    v_mov_b32 v54, 0
    v_mov_b32 v55, 0
L_s_pollB_w:
    buffer_load_dwordx4 v[98:101], v10, s[4:7], s71 offen sc1
    buffer_load_dwordx4 v[102:105], v10, s[4:7], s71 offen offset:1024 sc1
    buffer_load_dwordx2 v[106:107], v11, s[4:7], s71 offen sc1
    s_sub_u32 s96, s96, 1
    s_cbranch_scc1 L_fail
    s_waitcnt vmcnt(3)
    v_max3_u32 v7, v83, v87, v89
    v_cmp_eq_u32 vcc, -1, v7
    s_cbranch_vccnz L_s_poll_w
    v_smfmac_f32_16x16x64_bf16 v[44:47], v[80:83], v[128:135], v9
    ds_write_b128 v12, v[80:83]
    v_max3_u32 v7, v80, v81, v82
    v_smfmac_f32_16x16x64_bf16 v[48:51], v[80:83], v[136:143], v9
    ds_write_b128 v12, v[84:87] offset:1024
    v_max3_u32 v7, v7, v84, v85
    v_smfmac_f32_16x16x64_bf16 v[52:55], v[80:83], v[144:151], v9
    ds_write_b64 v13, v[88:89]
    v_max3_u32 v7, v7, v86, v88
    v_smfmac_f32_16x16x64_bf16 v[44:47], v[84:87], v[152:159], v9
    v_cmp_eq_u32 vcc, -1, v7
    v_smfmac_f32_16x16x64_bf16 v[48:51], v[84:87], v[160:167], v9
    s_cbranch_vccnz L_s_poll_z_w
    v_smfmac_f32_16x16x64_bf16 v[52:55], v[84:87], v[168:175], v9
    s_waitcnt lgkmcnt(0)
    s_barrier
    ds_read_b128 v[32:35], v28 offset:0
    ds_read_b128 v[36:39], v28 offset:1024
    ds_read_b128 v[40:43], v29 offset:0
    v_smfmac_f32_16x16x64_bf16 v[56:59], v[80:83], v[108:115], v9
    ds_read_b128 v[108:111], v15 offset:4096
    ds_read_b128 v[112:115], v15 offset:5120
    v_smfmac_f32_16x16x64_bf16 v[60:63], v[80:83], a[72:79], v9
    v_smfmac_f32_16x16x64_bf16 v[64:67], v[80:83], a[80:87], v9
    s_branch L_s_main_w
L_s_poll_z_w:
    s_nop 7
    v_mov_b32 v44, 0
    v_mov_b32 v45, 0
    v_mov_b32 v46, 0
    v_mov_b32 v47, 0
    v_mov_b32 v48, 0
    v_mov_b32 v49, 0
    v_mov_b32 v50, 0
    v_mov_b32 v51, 0
    v_mov_b32 v52, 0
    v_mov_b32 v53, 0
    v_mov_b32 v54, 0
    v_mov_b32 v55, 0
L_s_poll_w:
    buffer_load_dwordx4 v[80:83], v10, s[4:7], s71 offen sc1
    buffer_load_dwordx4 v[84:87], v10, s[4:7], s71 offen offset:1024 sc1
    buffer_load_dwordx2 v[88:89], v11, s[4:7], s71 offen sc1
    s_waitcnt vmcnt(3)
    v_max3_u32 v7, v101, v105, v107
    v_cmp_eq_u32 vcc, -1, v7
    s_cbranch_vccnz L_s_pollB_w
    v_smfmac_f32_16x16x64_bf16 v[44:47], v[98:101], v[128:135], v9
    ds_write_b128 v12, v[98:101]
    v_max3_u32 v7, v98, v99, v100
    v_smfmac_f32_16x16x64_bf16 v[48:51], v[98:101], v[136:143], v9
    ds_write_b128 v12, v[102:105] offset:1024
    v_max3_u32 v7, v7, v102, v103
    v_smfmac_f32_16x16x64_bf16 v[52:55], v[98:101], v[144:151], v9
    ds_write_b64 v13, v[106:107]
    v_max3_u32 v7, v7, v104, v106
    v_smfmac_f32_16x16x64_bf16 v[44:47], v[102:105], v[152:159], v9
    v_cmp_eq_u32 vcc, -1, v7
    v_smfmac_f32_16x16x64_bf16 v[48:51], v[102:105], v[160:167], v9
    s_cbranch_vccnz L_s_pollB_z_w
    v_smfmac_f32_16x16x64_bf16 v[52:55], v[102:105], v[168:175], v9
    s_waitcnt lgkmcnt(0)
    s_barrier
    ds_read_b128 v[32:35], v28 offset:0
    ds_read_b128 v[36:39], v28 offset:1024
    ds_read_b128 v[40:43], v29 offset:0
    v_smfmac_f32_16x16x64_bf16 v[56:59], v[98:101], v[108:115], v9
    ds_read_b128 v[108:111], v15 offset:4096
    ds_read_b128 v[112:115], v15 offset:5120
    v_smfmac_f32_16x16x64_bf16 v[60:63], v[98:101], a[72:79], v9
    v_smfmac_f32_16x16x64_bf16 v[64:67], v[98:101], a[80:87], v9
L_s_main_w:
    s_waitcnt lgkmcnt(4)
    v_smfmac_f32_16x16x64_bf16 v[44:47], v[32:35], v[176:183], v9
    v_smfmac_f32_16x16x64_bf16 v[48:51], v[32:35], v[116:123], v9
    ds_read_b128 v[116:119], v15 offset:6144
    ds_read_b128 v[120:123], v15 offset:7168
    v_smfmac_f32_16x16x64_bf16 v[52:55], v[32:35], v[184:191], v9
    ds_read_b128 v[32:35], v29 offset:1024
    s_waitcnt lgkmcnt(6)
    v_smfmac_f32_16x16x64_bf16 v[44:47], v[36:39], v[192:199], v9
    buffer_load_dword v2, v24, s[4:7], 0 offen sc1
    v_smfmac_f32_16x16x64_bf16 v[48:51], v[36:39], v[200:207], v9
    v_smfmac_f32_16x16x64_bf16 v[52:55], v[36:39], v[208:215], v9
    ds_read_b128 v[36:39], v30 offset:0
    s_waitcnt lgkmcnt(4)
    v_smfmac_f32_16x16x64_bf16 v[44:47], v[40:43], v[108:115], v9
    ds_read_b128 v[108:111], v15 offset:8192
    ds_read_b128 v[112:115], v15 offset:9216
    v_smfmac_f32_16x16x64_bf16 v[48:51], v[40:43], v[216:223], v9
    v_smfmac_f32_16x16x64_bf16 v[52:55], v[40:43], v[224:231], v9
    ds_read_b128 v[40:43], v30 offset:1024
    s_waitcnt lgkmcnt(4)
    v_smfmac_f32_16x16x64_bf16 v[44:47], v[32:35], v[232:239], v9
    v_smfmac_f32_16x16x64_bf16 v[48:51], v[32:35], v[116:123], v9
    ds_read_b128 v[116:119], v15 offset:10240
    ds_read_b128 v[120:123], v15 offset:11264
    v_smfmac_f32_16x16x64_bf16 v[52:55], v[32:35], v[240:247], v9
    ds_read_b128 v[32:35], v14 offset:8192
    s_waitcnt lgkmcnt(6)
    v_smfmac_f32_16x16x64_bf16 v[44:47], v[36:39], v[248:255], v9
    v_smfmac_f32_16x16x64_bf16 v[48:51], v[36:39], a[0:7], v9
    v_smfmac_f32_16x16x64_bf16 v[52:55], v[36:39], a[8:15], v9
    ds_read_b128 v[36:39], v14 offset:9216
    s_waitcnt lgkmcnt(5)
    s_waitcnt lgkmcnt(4)
    v_smfmac_f32_16x16x64_bf16 v[44:47], v[40:43], v[108:115], v9
    ds_read_b128 v[108:111], v15 offset:12288
    ds_read_b128 v[112:115], v15 offset:13312
    s_waitcnt vmcnt(1)
    v_smfmac_f32_16x16x64_bf16 v[48:51], v[40:43], a[16:23], v9
    s_waitcnt lgkmcnt(3)
    v_smfmac_f32_16x16x64_bf16 v[44:47], v[32:35], a[32:39], v9
    v_smfmac_f32_16x16x64_bf16 v[48:51], v[32:35], a[40:47], v9
    s_waitcnt lgkmcnt(2)
    v_smfmac_f32_16x16x64_bf16 v[44:47], v[36:39], v[116:123], v9
    ds_read_b128 v[116:119], v15 offset:14336
    ds_read_b128 v[120:123], v15 offset:15360
    v_smfmac_f32_16x16x64_bf16 v[48:51], v[36:39], a[56:63], v9
    v_smfmac_f32_16x16x64_bf16 v[52:55], v[40:43], a[24:31], v9
    v_smfmac_f32_16x16x64_bf16 v[52:55], v[32:35], a[48:55], v9
    v_cvt_pk_bf16_f32 v92, v44, v45
    v_cvt_pk_bf16_f32 v93, v46, v47
    v_smfmac_f32_16x16x64_bf16 v[52:55], v[36:39], a[64:71], v9
    s_nop 0
    v_mfma_f32_16x16x16_bf16 v[44:47], v[92:93], v[16:17], 0
    v_cvt_pk_bf16_f32 v94, v48, v49
    v_cvt_pk_bf16_f32 v95, v50, v51
    s_waitcnt lgkmcnt(2)
    v_smfmac_f32_16x16x64_bf16 v[56:59], v[102:105], v[108:115], v9
    ds_read_b128 v[108:111], v15 offset:16384
    ds_read_b128 v[112:115], v15 offset:17408
    s_nop 0
    v_mfma_f32_16x16x16_bf16 v[48:51], v[94:95], v[16:17], 0
    v_cvt_pk_bf16_f32 v96, v52, v53
    v_cvt_pk_bf16_f32 v97, v54, v55
    v_smfmac_f32_16x16x64_bf16 v[60:63], v[102:105], a[88:95], v9
    s_nop 0
    v_mfma_f32_16x16x16_bf16 v[52:55], v[96:97], v[16:17], 0
    v_cvt_pk_bf16_f32 v86, v44, v45
    v_cvt_pk_bf16_f32 v87, v46, v47
    v_smfmac_f32_16x16x64_bf16 v[64:67], v[102:105], a[96:103], v9
    v_cvt_pk_bf16_f32 v88, v48, v49
    v_cvt_pk_bf16_f32 v89, v50, v51
    v_smfmac_f32_16x16x64_bf16 v[56:59], v[40:43], a[200:207], v9
    s_nop 0
    v_mfma_f32_16x16x32_bf16 v[44:47], v[68:71], v[86:89], 0
    v_mfma_f32_16x16x32_bf16 v[48:51], v[72:75], v[86:89], 0
    v_cvt_pk_bf16_f32 v90, v52, v53
    v_cvt_pk_bf16_f32 v91, v54, v55
    s_waitcnt lgkmcnt(2)
    v_smfmac_f32_16x16x64_bf16 v[60:63], v[40:43], v[116:123], v9
    ds_read_b128 v[116:119], v15 offset:18432
    ds_read_b128 v[120:123], v15 offset:19456
    v_smfmac_f32_16x16x64_bf16 v[64:67], v[40:43], a[208:215], v9
    ds_read_b128 v[40:43], v28 offset:0
    v_mfma_f32_16x16x16_bf16 v[44:47], v[76:77], v[90:91], v[44:47]
    v_mfma_f32_16x16x16_bf16 v[48:51], v[78:79], v[90:91], v[48:51]
    v_smfmac_f32_16x16x64_bf16 v[56:59], v[32:35], a[216:223], v9
    v_smfmac_f32_16x16x64_bf16 v[60:63], v[32:35], a[224:231], v9
    v_smfmac_f32_16x16x64_bf16 v[64:67], v[32:35], a[232:239], v9
    ds_read_b128 v[32:35], v28 offset:1024
    v_cndmask_b32 v92, v48, v44, s[74:75]
    v_cndmask_b32 v93, v49, v45, s[74:75]
    v_cndmask_b32 v94, v50, v46, s[74:75]
    v_cndmask_b32 v95, v51, v47, s[74:75]
    ds_write_b128 v18, v[92:95]
    s_waitcnt lgkmcnt(5)
    v_smfmac_f32_16x16x64_bf16 v[56:59], v[36:39], v[108:115], v9
    ds_read_b128 v[108:111], v15 offset:20480
    ds_read_b128 v[112:115], v15 offset:21504
    v_smfmac_f32_16x16x64_bf16 v[60:63], v[36:39], a[240:247], v9
    v_smfmac_f32_16x16x64_bf16 v[64:67], v[36:39], a[248:255], v9
    ds_read_b128 v[36:39], v29 offset:0
    s_waitcnt lgkmcnt(5)
    v_smfmac_f32_16x16x64_bf16 v[56:59], v[40:43], a[104:111], v9
    v_smfmac_f32_16x16x64_bf16 v[60:63], v[40:43], v[116:123], v9
    ds_read_b128 v[116:119], v15 offset:22528
    ds_read_b128 v[120:123], v15 offset:23552
    v_smfmac_f32_16x16x64_bf16 v[64:67], v[40:43], a[112:119], v9
    ds_read_b128 v[40:43], v29 offset:1024
    s_waitcnt lgkmcnt(7)
    v_smfmac_f32_16x16x64_bf16 v[56:59], v[32:35], a[120:127], v9
    s_waitcnt lgkmcnt(6)
    s_barrier
    ds_read_b64 v[92:93], v31 offset:0
    ds_read_b64 v[94:95], v31 offset:1152
    ds_read_b64 v[96:97], v31 offset:2304
    ds_read_b64 v[98:99], v31 offset:3456
    v_smfmac_f32_16x16x64_bf16 v[60:63], v[32:35], a[128:135], v9
    v_smfmac_f32_16x16x64_bf16 v[64:67], v[32:35], a[136:143], v9
    ds_read_b128 v[32:35], v30 offset:0
    s_waitcnt lgkmcnt(9)
    s_waitcnt lgkmcnt(8)
    v_smfmac_f32_16x16x64_bf16 v[56:59], v[36:39], v[108:115], v9
    v_smfmac_f32_16x16x64_bf16 v[60:63], v[36:39], a[144:151], v9
    s_waitcnt lgkmcnt(5)
    v_smfmac_f32_16x16x64_bf16 v[56:59], v[40:43], a[160:167], v9
    s_waitcnt lgkmcnt(3)
    v_add_f32 v92, v92, v94
    v_add_f32 v93, v93, v95
    v_smfmac_f32_16x16x64_bf16 v[60:63], v[40:43], a[168:175], v9
    s_waitcnt lgkmcnt(1)
    v_add_f32 v96, v96, v98
    v_add_f32 v97, v97, v99
    s_waitcnt lgkmcnt(0)
    v_smfmac_f32_16x16x64_bf16 v[56:59], v[32:35], v[116:123], v9
    v_add_f32 v92, v92, v96
    v_add_f32 v93, v93, v97
    v_max_f32 v5, v92, v93
    v_smfmac_f32_16x16x64_bf16 v[60:63], v[32:35], a[184:191], v9
    s_nop 0
    v_max_f32_dpp v5, v5, v5 quad_perm:[1,0,3,2] row_mask:0xf bank_mask:0xf
    v_smfmac_f32_16x16x64_bf16 v[64:67], v[36:39], a[152:159], v9
    s_nop 0
    v_max_f32_dpp v5, v5, v5 quad_perm:[2,3,0,1] row_mask:0xf bank_mask:0xf
    v_smfmac_f32_16x16x64_bf16 v[64:67], v[40:43], a[176:183], v9
    s_nop 0
    v_max_f32_dpp v5, v5, v5 row_half_mirror row_mask:0xf bank_mask:0xf
    v_cvt_pk_bf16_f32 v100, v56, v57
    v_cvt_pk_bf16_f32 v101, v58, v59
    v_smfmac_f32_16x16x64_bf16 v[64:67], v[32:35], a[192:199], v9
    s_nop 0
    v_max_f32_dpp v5, v5, v5 row_mirror row_mask:0xf bank_mask:0xf
    v_cvt_pk_bf16_f32 v102, v60, v61
    v_cvt_pk_bf16_f32 v103, v62, v63
    v_mfma_f32_16x16x16_bf16 v[56:59], v[100:101], v[124:125], 0
    v_mul_f32 v5, s78, v5
    v_mfma_f32_16x16x16_bf16 v[60:63], v[102:103], v[124:125], 0
    v_fma_f32 v92, v92, s78, -v5
    v_fma_f32 v93, v93, s78, -v5
    v_exp_f32 v92, v92
    v_cvt_pk_bf16_f32 v126, v64, v65
    v_cvt_pk_bf16_f32 v127, v66, v67
    v_exp_f32 v93, v93
    s_cmp_lt_u32 s53, 2
    v_mfma_f32_16x16x16_bf16 v[64:67], v[126:127], v[124:125], 0
    v_cvt_pk_bf16_f32 v96, v92, v93
    buffer_store_dword v96, v22, s[4:7], s64 offen sc1
    v_cvt_pk_bf16_f32 v80, v56, v57
    v_cvt_pk_bf16_f32 v81, v58, v59
    v_cvt_pk_bf16_f32 v82, v60, v61
    v_cvt_pk_bf16_f32 v83, v62, v63
    v_add_f32 v6, v92, v93
    s_nop 0
    v_mfma_f32_16x16x32_bf16 v[52:55], v[80:83], v[86:89], 0
    v_cvt_pk_bf16_f32 v84, v64, v65
    v_cvt_pk_bf16_f32 v85, v66, v67
    v_add_f32_dpp v6, v6, v6 quad_perm:[1,0,3,2] row_mask:0xf bank_mask:0xf
    s_nop 1
    v_add_f32_dpp v6, v6, v6 quad_perm:[2,3,0,1] row_mask:0xf bank_mask:0xf
    v_mfma_f32_16x16x16_bf16 v[52:55], v[84:85], v[90:91], v[52:55]
    s_nop 0
    v_add_f32_dpp v6, v6, v6 row_half_mirror row_mask:0xf bank_mask:0xf
    s_nop 1
    v_add_f32_dpp v6, v6, v6 row_mirror row_mask:0xf bank_mask:0xf
    s_nop 2
    ds_write_b64 v20, v[52:53]
    s_waitcnt lgkmcnt(0)
    s_barrier
    s_cbranch_scc0 L_s_nolate_w
    ds_read2_b64 v[100:103], v21 offset0:0 offset1:72
    s_waitcnt lgkmcnt(0)
    v_add_f32 v100, v100, v102
    v_add_f32 v101, v101, v103
    s_nop 0
    v_add_f32_dpp v100, v100, v100 row_ror:8 row_mask:0xf bank_mask:0xf
    v_add_f32_dpp v101, v101, v101 row_ror:8 row_mask:0xf bank_mask:0xf
    v_fma_f32 v102, v100, s78, -v5
    v_fma_f32 v103, v101, s78, -v5
    v_exp_f32 v104, v102
    v_exp_f32 v105, v103
    v_max_f32 v102, v102, v103
    v_add_f32 v106, v104, v105
    v_cmp_nge_f32 vcc, s62, v102
    v_cndmask_b32 v104, v104, v26, s[76:77]
    v_add_f32_dpp v106, v106, v106 quad_perm:[1,0,3,2] row_mask:0xf bank_mask:0xf
    v_cndmask_b32 v105, v105, v27, s[76:77]
    s_cbranch_vccnz L_s_exact_w
    v_add_f32_dpp v106, v106, v106 quad_perm:[2,3,0,1] row_mask:0xf bank_mask:0xf
    v_add_f32 v106, v106, v6
L_s_norm_w:
    v_rcp_f32 v106, v106
    s_nop 0
    v_mul_f32 v104, v104, v106
    v_mul_f32 v105, v105, v106
    v_cvt_pk_bf16_f32 v100, v104, v105
    v_min_u32 v100, -2, v100
    buffer_store_dword v100, v23, s[4:7], s65 offen sc1
L_s_nolate_w:
    s_barrier
    ds_read_b128 v[108:111], v15 offset:0
    ds_read_b128 v[112:115], v15 offset:1024
    ds_read_b128 v[116:119], v15 offset:2048
    ds_read_b128 v[120:123], v15 offset:3072
    v_mov_b32 v44, 0
    v_mov_b32 v45, 0
    v_mov_b32 v46, 0
    v_mov_b32 v47, 0
    v_mov_b32 v48, 0
    v_mov_b32 v49, 0
    v_mov_b32 v50, 0
    v_mov_b32 v51, 0
    v_mov_b32 v52, 0
    v_mov_b32 v53, 0
    v_mov_b32 v54, 0
    v_mov_b32 v55, 0
    v_mov_b32 v56, 0
    v_mov_b32 v57, 0
    v_mov_b32 v58, 0
    v_mov_b32 v59, 0
    v_mov_b32 v60, 0
    v_mov_b32 v61, 0
    v_mov_b32 v62, 0
    v_mov_b32 v63, 0
    v_mov_b32 v64, 0
    v_mov_b32 v65, 0
    v_mov_b32 v66, 0
    v_mov_b32 v67, 0
    s_waitcnt lgkmcnt(0)
    v_mov_b32 v92, -1
    v_mov_b32 v93, -1
    s_add_u32 s56, s64, 1048576
    s_bitset0_b32 s56, 21
    s_add_u32 s57, s65, 1048576
    s_bitset0_b32 s57, 21
    buffer_store_dword v92, v22, s[4:7], s56 offen sc1
    buffer_store_dword v92, v23, s[4:7], s57 offen sc1
    buffer_store_dwordx4 v[80:83], v19, s[4:7], s69 offen sc1
    buffer_store_dwordx2 v[84:85], v25, s[4:7], s70 offen sc1
    s_add_u32 s73, s55, 2
    s_min_u32 s73, s73, 64
    s_waitcnt vmcnt(5)
    v_cmp_gt_u32 vcc, s73, v2
    s_cbranch_vccnz L_s_kwait_w
L_s_kok_w:
    buffer_load_dwordx4 v[68:71], v19, s[4:7], s67 offen sc1
    buffer_load_dwordx4 v[72:75], v19, s[4:7], s67 offen offset:1024 sc1
    s_add_u32 s67, s67, 393216
    buffer_load_dwordx2 v[76:77], v25, s[4:7], s68 offen sc1
    buffer_load_dwordx2 v[78:79], v25, s[4:7], s68 offen offset:1024 sc1
    s_add_u32 s68, s68, 393216
    s_add_u32 s69, s69, 262144
    s_bitset0_b32 s69, 20
    s_add_u32 s70, s70, 262144
    s_bitset0_b32 s70, 20
    s_add_u32 s64, s64, 524288
    s_bitset0_b32 s64, 21
    s_add_u32 s65, s65, 524288
    s_bitset0_b32 s65, 21
    s_add_u32 s71, s71, 524288
    s_bitset0_b32 s71, 21
    s_add_u32 s55, s55, 1
    s_cmp_lt_u32 s55, 64
    s_cbranch_scc1 L_s_loop_w
    s_waitcnt vmcnt(0)
    v_mov_b32 v4, s55
    buffer_store_dword v4, v8, s[4:7], s66 offen sc1
    s_branch L_end
L_s_kwait_w:
    s_mov_b32 s96, 2000000
L_wf_6_w:
    buffer_load_dword v2, v24, s[4:7], 0 offen sc1
    s_sub_u32 s96, s96, 1
    s_cbranch_scc1 L_fail
    s_waitcnt vmcnt(0)
    v_cmp_gt_u32 vcc, s73, v2
    s_cbranch_vccz L_wf_6_d_w
    s_sleep 4
    s_branch L_wf_6_w
L_wf_6_d_w:
    s_branch L_s_kok_w
L_s_exact_w:
    v_max_f32 v102, v100, v101
    s_nop 1
    v_max_f32_dpp v102, v102, v102 quad_perm:[1,0,3,2] row_mask:0xf bank_mask:0xf
    s_nop 1
    v_max_f32_dpp v102, v102, v102 quad_perm:[2,3,0,1] row_mask:0xf bank_mask:0xf
    v_mul_f32 v102, s78, v102
    v_max_f32 v102, v102, v5
    v_fma_f32 v104, v100, s78, -v102
    v_fma_f32 v105, v101, s78, -v102
    v_sub_f32 v103, v5, v102
    v_exp_f32 v104, v104
    v_exp_f32 v105, v105
    v_exp_f32 v103, v103
    v_add_f32 v106, v104, v105
    v_mul_f32 v100, v26, v103
    v_mul_f32 v101, v27, v103
    v_add_f32_dpp v106, v106, v106 quad_perm:[1,0,3,2] row_mask:0xf bank_mask:0xf
    v_cndmask_b32 v104, v104, v100, s[76:77]
    v_cndmask_b32 v105, v105, v101, s[76:77]
    v_add_f32_dpp v106, v106, v106 quad_perm:[2,3,0,1] row_mask:0xf bank_mask:0xf
    v_fmac_f32 v106, v6, v103
    s_branch L_s_norm_w
L_c_slow:
L_c_loop_w:
    s_add_u32 s69, s70, 0
    s_lshr_b32 s97, s69, 8
    s_xor_b32 s97, s97, s60
    s_and_b32 s97, s97, 8192
    s_add_u32 s69, s69, s97
    s_add_u32 s71, s69, s77
    s_add_u32 s48, s69, 1048576
    s_add_u32 s49, s71, 1048576
    v_mov_b32 v132, 0
    v_mov_b32 v133, 0
    v_mov_b32 v134, 0
    v_mov_b32 v135, 0
    s_add_u32 s64, s64, 524288
    s_bitset0_b32 s64, 21
    s_add_u32 s62, s55, 1
    s_lshl_b32 s62, s62, 1
    v_mov_b32 v18, s62
    v_add_u32 v63, -1, v18
    s_waitcnt vmcnt(0) lgkmcnt(0)
    s_barrier
L_c_re0_w:
    s_mov_b32 s96, 2000000
L_poll_11_w:
    buffer_load_dwordx4 v[28:31], v13, s[4:7], s65 offen offset:0 sc1
    buffer_load_dwordx4 v[32:35], v13, s[4:7], s65 offen offset:1024 sc1
    buffer_load_dwordx4 v[36:39], v13, s[4:7], s65 offen offset:2048 sc1
    buffer_load_dwordx4 v[40:43], v13, s[4:7], s65 offen offset:3072 sc1
    s_sub_u32 s96, s96, 1
    s_cbranch_scc1 L_fail
    s_waitcnt vmcnt(0)
    v_max3_u32 v7, v31, v35, v39
    v_max_u32 v7, v7, v43
    v_cmp_eq_u32 vcc, -1, v7
    s_cbranch_vccnz L_poll_11_w
    v_mfma_f32_16x16x32_bf16 v[84:87], v[28:31], a[0:3], 0
    v_max3_u32 v7, v7, v28, v29
    v_max_u32 v7, v7, v30
    v_mfma_f32_16x16x32_bf16 v[88:91], v[28:31], a[4:7], 0
    v_max3_u32 v7, v7, v32, v33
    v_max_u32 v7, v7, v34
    buffer_load_dwordx4 v[68:71], v10, s[4:7], s67 offen offset:0 sc1
    buffer_load_dwordx4 v[76:79], v10, s[4:7], s67 offen offset:1024 sc1
    v_mfma_f32_16x16x32_bf16 v[92:95], v[32:35], a[8:11], 0
    v_max3_u32 v7, v7, v36, v37
    v_max_u32 v7, v7, v38
    v_mfma_f32_16x16x32_bf16 v[96:99], v[32:35], a[12:15], 0
    v_max3_u32 v7, v7, v40, v41
    v_max_u32 v7, v7, v42
    v_cmp_eq_u32 vcc, -1, v7
    s_cbranch_vccnz L_c_re0_w
    buffer_load_dwordx4 v[116:119], v66, s[4:7], s66 offen sc1
    buffer_load_dwordx4 v[120:123], v66, s[4:7], s66 offen offset:1024 sc1
    v_mfma_f32_16x16x32_bf16 v[100:103], v[36:39], a[16:19], 0
    v_cndmask_b32 v84, v88, v84, s[46:47]
    v_cndmask_b32 v85, v89, v85, s[46:47]
    v_mfma_f32_16x16x32_bf16 v[104:107], v[36:39], a[20:23], 0
    v_cndmask_b32 v86, v90, v86, s[46:47]
    v_cndmask_b32 v87, v91, v87, s[46:47]
    v_mfma_f32_16x16x32_bf16 v[108:111], v[40:43], a[24:27], 0
    v_cvt_pk_bf16_f32 v72, v84, v85
    v_cvt_pk_bf16_f32 v73, v86, v87
    v_mfma_f32_16x16x32_bf16 v[112:115], v[40:43], a[28:31], 0
    v_cndmask_b32 v92, v96, v92, s[46:47]
    v_cndmask_b32 v93, v97, v93, s[46:47]
    v_cndmask_b32 v94, v98, v94, s[46:47]
    v_cndmask_b32 v95, v99, v95, s[46:47]
    v_cvt_pk_bf16_f32 v74, v92, v93
    v_cvt_pk_bf16_f32 v75, v94, v95
    v_cndmask_b32 v100, v104, v100, s[46:47]
    v_cndmask_b32 v101, v105, v101, s[46:47]
    v_cndmask_b32 v102, v106, v102, s[46:47]
    v_cndmask_b32 v103, v107, v103, s[46:47]
    v_cvt_pk_bf16_f32 v80, v100, v101
    v_cvt_pk_bf16_f32 v81, v102, v103
    v_cndmask_b32 v108, v112, v108, s[46:47]
    v_cndmask_b32 v109, v113, v109, s[46:47]
    v_cndmask_b32 v110, v114, v110, s[46:47]
    v_cndmask_b32 v111, v115, v111, s[46:47]
    v_cvt_pk_bf16_f32 v82, v108, v109
    v_cvt_pk_bf16_f32 v83, v110, v111
    s_waitcnt vmcnt(2)
    v_max3_u32 v7, v68, v69, v70
    v_max3_u32 v7, v7, v71, v76
    v_max3_u32 v7, v7, v77, v78
    v_max_u32 v7, v7, v79
    v_cmp_eq_u32 vcc, -1, v7
    s_cbranch_vccz L_c_zok0_w
    s_mov_b32 s96, 2000000
L_poll_12_w:
    buffer_load_dwordx4 v[68:71], v10, s[4:7], s67 offen offset:0 sc1
    buffer_load_dwordx4 v[76:79], v10, s[4:7], s67 offen offset:1024 sc1
    buffer_load_dwordx4 v[116:119], v66, s[4:7], s66 offen sc1
    buffer_load_dwordx4 v[120:123], v66, s[4:7], s66 offen offset:1024 sc1
    s_sub_u32 s96, s96, 1
    s_cbranch_scc1 L_fail
    s_waitcnt vmcnt(0)
    v_max3_u32 v7, v68, v69, v70
    v_max3_u32 v7, v7, v71, v76
    v_max3_u32 v7, v7, v77, v78
    v_max_u32 v7, v7, v79
    v_cmp_eq_u32 vcc, -1, v7
    s_cbranch_vccnz L_poll_12_w
L_c_zok0_w:
    s_mov_b32 s96, 2000000
L_c_lp0_w:
    s_waitcnt vmcnt(0)
    v_smfmac_f32_16x16x64_bf16 v[132:135], v[116:119], v[68:75], v9
    v_smfmac_f32_16x16x64_bf16 v[132:135], v[120:123], v[76:83], v9
    v_max3_u32 v7, v116, v117, v118
    v_max3_u32 v7, v7, v119, v120
    v_max3_u32 v7, v7, v121, v122
    v_max_u32 v7, v7, v123
    v_cmp_eq_u32 vcc, -1, v7
    s_cbranch_vccz L_c_red0_w
    buffer_load_dwordx4 v[116:119], v66, s[4:7], s66 offen sc1
    buffer_load_dwordx4 v[120:123], v66, s[4:7], s66 offen offset:1024 sc1
    s_nop 1
    v_mov_b32 v132, 0
    v_mov_b32 v133, 0
    v_mov_b32 v134, 0
    v_mov_b32 v135, 0
    s_sub_u32 s96, s96, 1
    s_cbranch_scc1 L_fail
    s_branch L_c_lp0_w
L_c_red0_w:
    s_nop 1
    v_permlane32_swap_b32 v132, v134
    v_permlane32_swap_b32 v133, v135
    v_add_f32 v132, v132, v134
    v_add_f32 v133, v133, v135
    v_cvt_pk_bf16_f32 v132, v132, v133
    buffer_store_dword v132, v12, s[4:7], s71 offen sc1
    ds_read_b128 v[160:163], v10 offset:0
    ds_read_b128 v[164:167], v10 offset:1024
    ds_read_b128 v[168:171], v10 offset:2048
    ds_read_b128 v[172:175], v10 offset:3072
    ds_read_b128 v[176:179], v10 offset:4096
    ds_read_b128 v[180:183], v10 offset:5120
    ds_read_b128 v[184:187], v10 offset:6144
    ds_read_b128 v[188:191], v10 offset:7168
    ds_read_b128 v[192:195], v10 offset:8192
    ds_read_b128 v[196:199], v10 offset:9216
    ds_read_b128 v[200:203], v10 offset:10240
    ds_read_b128 v[204:207], v10 offset:11264
    ds_read_b128 v[208:211], v10 offset:12288
    ds_read_b128 v[212:215], v10 offset:13312
    ds_read_b128 v[216:219], v10 offset:14336
    ds_read_b128 v[220:223], v10 offset:15360
    s_waitcnt lgkmcnt(15)
    v_mfma_f32_16x16x32_bf16 v[152:155], a[80:83], v[160:163], 0
    s_waitcnt lgkmcnt(14)
    v_mfma_f32_16x16x32_bf16 v[152:155], a[84:87], v[164:167], v[152:155]
    s_waitcnt lgkmcnt(13)
    v_mfma_f32_16x16x32_bf16 v[152:155], a[88:91], v[168:171], v[152:155]
    s_waitcnt lgkmcnt(12)
    v_mfma_f32_16x16x32_bf16 v[152:155], a[92:95], v[172:175], v[152:155]
    s_waitcnt lgkmcnt(11)
    v_mfma_f32_16x16x32_bf16 v[152:155], a[96:99], v[176:179], v[152:155]
    s_waitcnt lgkmcnt(10)
    v_mfma_f32_16x16x32_bf16 v[152:155], a[100:103], v[180:183], v[152:155]
    s_waitcnt lgkmcnt(9)
    v_mfma_f32_16x16x32_bf16 v[152:155], a[104:107], v[184:187], v[152:155]
    s_waitcnt lgkmcnt(8)
    v_mfma_f32_16x16x32_bf16 v[152:155], a[108:111], v[188:191], v[152:155]
    s_waitcnt lgkmcnt(7)
    v_mfma_f32_16x16x16_bf16 v[148:151], a[80:81], v[192:193], 0
    v_mfma_f32_16x16x16_bf16 v[148:151], a[84:85], v[194:195], v[148:151]
    s_waitcnt lgkmcnt(6)
    v_mfma_f32_16x16x16_bf16 v[148:151], a[88:89], v[196:197], v[148:151]
    v_mfma_f32_16x16x16_bf16 v[148:151], a[92:93], v[198:199], v[148:151]
    s_waitcnt lgkmcnt(5)
    v_mfma_f32_16x16x16_bf16 v[148:151], a[96:97], v[200:201], v[148:151]
    v_mfma_f32_16x16x16_bf16 v[148:151], a[100:101], v[202:203], v[148:151]
    s_waitcnt lgkmcnt(4)
    v_mfma_f32_16x16x16_bf16 v[148:151], a[104:105], v[204:205], v[148:151]
    v_mfma_f32_16x16x16_bf16 v[148:151], a[108:109], v[206:207], v[148:151]
    s_waitcnt lgkmcnt(0)
    v_mfma_f32_16x16x32_bf16 v[152:155], a[112:115], v[216:219], v[152:155]
    v_mfma_f32_16x16x32_bf16 v[152:155], a[116:119], v[220:223], v[152:155]
    v_accvgpr_write_b32 a32, v68
    v_accvgpr_write_b32 a33, v69
    v_accvgpr_write_b32 a34, v70
    v_accvgpr_write_b32 a35, v71
    v_accvgpr_write_b32 a36, v76
    v_accvgpr_write_b32 a37, v77
    v_accvgpr_write_b32 a38, v78
    v_accvgpr_write_b32 a39, v79
    s_add_u32 s65, s65, 524288
    s_bitset0_b32 s65, 21
    s_add_u32 s66, s66, 524288
    s_bitset0_b32 s66, 21
    s_add_u32 s67, s67, 524288
    s_bitset0_b32 s67, 21
    s_add_u32 s57, s64, 1048576
    s_bitset0_b32 s57, 21
    s_add_u32 s55, s55, 1
    buffer_load_dwordx4 v[136:139], v10, s[4:7], s69 offen sc1
    s_cmp_eq_u32 s75, 0
    s_cbranch_scc0 L_c_nh_14_w
    buffer_store_dword v18, v8, s[4:7], s79 offen sc1
L_c_nh_14_w:
    s_nop 3
    v_mfma_f32_16x16x32_bf16 v[148:151], a[112:115], v[208:211], v[148:151]
    v_mfma_f32_16x16x32_bf16 v[148:151], a[116:119], v[212:215], v[148:151]
    s_mov_b32 s96, 2000000
    s_branch L_c_x_13_q_w
L_c_x_13_w:
    buffer_load_dwordx4 v[136:139], v10, s[4:7], s69 offen sc1
    s_sub_u32 s96, s96, 1
    s_cbranch_scc1 L_fail
L_c_x_13_q_w:
    s_waitcnt vmcnt(0)
    v_mfma_f32_16x16x32_bf16 v[232:235], v[244:247], v[136:139], 0
    v_max3_u32 v7, v136, v137, v138
    v_max_u32 v7, v7, v139
    v_cmp_eq_u32 vcc, -1, v7
    s_cbranch_vccnz L_c_x_13_w
    s_nop 3
    v_cvt_pk_bf16_f32 v232, v232, v233
    v_min_u32 v232, -2, v232
    buffer_store_dword v232, v12, s[4:7], s64 offen sc1
    s_barrier
    s_sub_u32 s58, s55, 1
    s_add_u32 s59, s55, 1
    s_min_u32 s40, s59, 64
    s_cmp_lt_u32 s55, 3
    s_cbranch_scc1 L_c_early0_w
    s_sub_u32 s42, s55, 3
    v_cmp_gt_u32 vcc, s40, v16
    s_cbranch_vccnz L_c_rw0_w
L_c_rok0_w:
    buffer_load_dword v61, v25, s[4:7], 0 offen sc1
    buffer_load_dword v16, v60, s[4:7], 0 offen sc1
    s_cmp_eq_u32 s53, 0
    s_cbranch_scc0 L_c_pg_15_w
    v_mov_b32 v4, s42
    buffer_store_dword v4, v8, s[4:7], s72 offen sc1
L_c_pg_15_w:
    s_add_u32 s59, s68, 4096
    buffer_load_dwordx4 a[40:43], v10, s[4:7], s68 offen offset:0 sc1
    buffer_load_dwordx4 a[44:47], v10, s[4:7], s68 offen offset:1024 sc1
    buffer_load_dwordx4 a[48:51], v10, s[4:7], s68 offen offset:2048 sc1
    buffer_load_dwordx4 a[52:55], v10, s[4:7], s68 offen offset:3072 sc1
    buffer_load_dwordx4 a[56:59], v10, s[4:7], s59 offen offset:0 sc1
    buffer_load_dwordx4 a[60:63], v10, s[4:7], s59 offen offset:1024 sc1
    buffer_load_dwordx4 a[64:67], v10, s[4:7], s59 offen offset:2048 sc1
    buffer_load_dwordx4 a[68:71], v10, s[4:7], s59 offen offset:3072 sc1
    s_add_u32 s68, s68, 1310720
    v_cvt_pk_bf16_f32 v156, v148, v149
    v_cvt_pk_bf16_f32 v157, v150, v151
    v_cvt_pk_bf16_f32 v158, v152, v153
    v_cvt_pk_bf16_f32 v159, v154, v155
    buffer_store_dwordx4 v[156:159], v10, s[4:7], s36 offen sc1
    s_add_u32 s36, s36, 163840
    buffer_store_dword v26, v12, s[4:7], s57 offen sc1
    s_add_u32 s56, s70, 524288
    s_bitset0_b32 s56, 20
    s_add_u32 s56, s56, 0
    s_lshr_b32 s97, s56, 8
    s_xor_b32 s97, s97, s60
    s_and_b32 s97, s97, 8192
    s_add_u32 s56, s56, s97
    s_add_u32 s56, s56, s77
    buffer_store_dword v26, v12, s[4:7], s56 offen sc1
    s_add_u32 s70, s70, 262144
    s_bitset0_b32 s70, 20
    s_waitcnt vmcnt(12)
    v_cmp_gt_u32 vcc, s58, v61
    s_cbranch_vccnz L_c_tw0_w
L_c_tok0_w:
    s_add_u32 m0, s45, 16384
    s_nop 0
    buffer_load_dwordx4 v10, s[4:7], s41 offen offset:0 sc1 lds
    buffer_load_dwordx4 v10, s[4:7], s41 offen offset:1024 sc1 lds
    buffer_load_dwordx4 v10, s[4:7], s41 offen offset:2048 sc1 lds
    buffer_load_dwordx4 v10, s[4:7], s41 offen offset:3072 sc1 lds
    s_add_u32 s41, s41, 524288
    s_bitset0_b32 s41, 21
L_c_next0_w:
    s_add_u32 s69, s70, 0
    s_lshr_b32 s97, s69, 8
    s_xor_b32 s97, s97, s60
    s_and_b32 s97, s97, 8192
    s_add_u32 s69, s69, s97
    s_add_u32 s71, s69, s77
    s_add_u32 s48, s69, 1048576
    s_add_u32 s49, s71, 1048576
    v_mov_b32 v132, 0
    v_mov_b32 v133, 0
    v_mov_b32 v134, 0
    v_mov_b32 v135, 0
    s_add_u32 s64, s64, 524288
    s_bitset0_b32 s64, 21
    s_add_u32 s62, s55, 1
    s_lshl_b32 s62, s62, 1
    v_mov_b32 v18, s62
    v_add_u32 v63, -1, v18
    s_waitcnt vmcnt(0) lgkmcnt(0)
    s_barrier
L_c_re1_w:
    s_mov_b32 s96, 2000000
L_poll_16_w:
    buffer_load_dwordx4 v[28:31], v13, s[4:7], s65 offen offset:0 sc1
    buffer_load_dwordx4 v[32:35], v13, s[4:7], s65 offen offset:1024 sc1
    buffer_load_dwordx4 v[36:39], v13, s[4:7], s65 offen offset:2048 sc1
    buffer_load_dwordx4 v[40:43], v13, s[4:7], s65 offen offset:3072 sc1
    s_sub_u32 s96, s96, 1
    s_cbranch_scc1 L_fail
    s_waitcnt vmcnt(0)
    v_max3_u32 v7, v31, v35, v39
    v_max_u32 v7, v7, v43
    v_cmp_eq_u32 vcc, -1, v7
    s_cbranch_vccnz L_poll_16_w
    v_mfma_f32_16x16x32_bf16 v[84:87], v[28:31], a[40:43], 0
    v_max3_u32 v7, v7, v28, v29
    v_max_u32 v7, v7, v30
    v_mfma_f32_16x16x32_bf16 v[88:91], v[28:31], a[44:47], 0
    v_max3_u32 v7, v7, v32, v33
    v_max_u32 v7, v7, v34
    buffer_load_dwordx4 v[68:71], v10, s[4:7], s67 offen offset:0 sc1
    buffer_load_dwordx4 v[76:79], v10, s[4:7], s67 offen offset:1024 sc1
    v_mfma_f32_16x16x32_bf16 v[92:95], v[32:35], a[48:51], 0
    v_max3_u32 v7, v7, v36, v37
    v_max_u32 v7, v7, v38
    v_mfma_f32_16x16x32_bf16 v[96:99], v[32:35], a[52:55], 0
    v_max3_u32 v7, v7, v40, v41
    v_max_u32 v7, v7, v42
    v_cmp_eq_u32 vcc, -1, v7
    s_cbranch_vccnz L_c_re1_w
    buffer_load_dwordx4 v[116:119], v66, s[4:7], s66 offen sc1
    buffer_load_dwordx4 v[120:123], v66, s[4:7], s66 offen offset:1024 sc1
    v_mfma_f32_16x16x32_bf16 v[100:103], v[36:39], a[56:59], 0
    v_cndmask_b32 v84, v88, v84, s[46:47]
    v_cndmask_b32 v85, v89, v85, s[46:47]
    v_mfma_f32_16x16x32_bf16 v[104:107], v[36:39], a[60:63], 0
    v_cndmask_b32 v86, v90, v86, s[46:47]
    v_cndmask_b32 v87, v91, v87, s[46:47]
    v_mfma_f32_16x16x32_bf16 v[108:111], v[40:43], a[64:67], 0
    v_cvt_pk_bf16_f32 v72, v84, v85
    v_cvt_pk_bf16_f32 v73, v86, v87
    v_mfma_f32_16x16x32_bf16 v[112:115], v[40:43], a[68:71], 0
    v_cndmask_b32 v92, v96, v92, s[46:47]
    v_cndmask_b32 v93, v97, v93, s[46:47]
    v_cndmask_b32 v94, v98, v94, s[46:47]
    v_cndmask_b32 v95, v99, v95, s[46:47]
    v_cvt_pk_bf16_f32 v74, v92, v93
    v_cvt_pk_bf16_f32 v75, v94, v95
    v_cndmask_b32 v100, v104, v100, s[46:47]
    v_cndmask_b32 v101, v105, v101, s[46:47]
    v_cndmask_b32 v102, v106, v102, s[46:47]
    v_cndmask_b32 v103, v107, v103, s[46:47]
    v_cvt_pk_bf16_f32 v80, v100, v101
    v_cvt_pk_bf16_f32 v81, v102, v103
    v_cndmask_b32 v108, v112, v108, s[46:47]
    v_cndmask_b32 v109, v113, v109, s[46:47]
    v_cndmask_b32 v110, v114, v110, s[46:47]
    v_cndmask_b32 v111, v115, v111, s[46:47]
    v_cvt_pk_bf16_f32 v82, v108, v109
    v_cvt_pk_bf16_f32 v83, v110, v111
    s_waitcnt vmcnt(2)
    v_max3_u32 v7, v68, v69, v70
    v_max3_u32 v7, v7, v71, v76
    v_max3_u32 v7, v7, v77, v78
    v_max_u32 v7, v7, v79
    v_cmp_eq_u32 vcc, -1, v7
    s_cbranch_vccz L_c_zok1_w
    s_mov_b32 s96, 2000000
L_poll_17_w:
    buffer_load_dwordx4 v[68:71], v10, s[4:7], s67 offen offset:0 sc1
    buffer_load_dwordx4 v[76:79], v10, s[4:7], s67 offen offset:1024 sc1
    buffer_load_dwordx4 v[116:119], v66, s[4:7], s66 offen sc1
    buffer_load_dwordx4 v[120:123], v66, s[4:7], s66 offen offset:1024 sc1
    s_sub_u32 s96, s96, 1
    s_cbranch_scc1 L_fail
    s_waitcnt vmcnt(0)
    v_max3_u32 v7, v68, v69, v70
    v_max3_u32 v7, v7, v71, v76
    v_max3_u32 v7, v7, v77, v78
    v_max_u32 v7, v7, v79
    v_cmp_eq_u32 vcc, -1, v7
    s_cbranch_vccnz L_poll_17_w
L_c_zok1_w:
    s_mov_b32 s96, 2000000
L_c_lp1_w:
    s_waitcnt vmcnt(0)
    v_smfmac_f32_16x16x64_bf16 v[132:135], v[116:119], v[68:75], v9
    v_smfmac_f32_16x16x64_bf16 v[132:135], v[120:123], v[76:83], v9
    v_max3_u32 v7, v116, v117, v118
    v_max3_u32 v7, v7, v119, v120
    v_max3_u32 v7, v7, v121, v122
    v_max_u32 v7, v7, v123
    v_cmp_eq_u32 vcc, -1, v7
    s_cbranch_vccz L_c_red1_w
    buffer_load_dwordx4 v[116:119], v66, s[4:7], s66 offen sc1
    buffer_load_dwordx4 v[120:123], v66, s[4:7], s66 offen offset:1024 sc1
    s_nop 1
    v_mov_b32 v132, 0
    v_mov_b32 v133, 0
    v_mov_b32 v134, 0
    v_mov_b32 v135, 0
    s_sub_u32 s96, s96, 1
    s_cbranch_scc1 L_fail
    s_branch L_c_lp1_w
L_c_red1_w:
    s_nop 1
    v_permlane32_swap_b32 v132, v134
    v_permlane32_swap_b32 v133, v135
    v_add_f32 v132, v132, v134
    v_add_f32 v133, v133, v135
    v_cvt_pk_bf16_f32 v132, v132, v133
    buffer_store_dword v132, v12, s[4:7], s71 offen sc1
    ds_read_b128 v[160:163], v10 offset:16384
    ds_read_b128 v[164:167], v10 offset:17408
    ds_read_b128 v[168:171], v10 offset:18432
    ds_read_b128 v[172:175], v10 offset:19456
    ds_read_b128 v[176:179], v10 offset:20480
    ds_read_b128 v[180:183], v10 offset:21504
    ds_read_b128 v[184:187], v10 offset:22528
    ds_read_b128 v[188:191], v10 offset:23552
    ds_read_b128 v[192:195], v10 offset:24576
    ds_read_b128 v[196:199], v10 offset:25600
    ds_read_b128 v[200:203], v10 offset:26624
    ds_read_b128 v[204:207], v10 offset:27648
    ds_read_b128 v[208:211], v10 offset:28672
    ds_read_b128 v[212:215], v10 offset:29696
    ds_read_b128 v[216:219], v10 offset:30720
    ds_read_b128 v[220:223], v10 offset:31744
    s_waitcnt lgkmcnt(15)
    v_mfma_f32_16x16x32_bf16 v[152:155], a[120:123], v[160:163], 0
    s_waitcnt lgkmcnt(14)
    v_mfma_f32_16x16x32_bf16 v[152:155], a[124:127], v[164:167], v[152:155]
    s_waitcnt lgkmcnt(13)
    v_mfma_f32_16x16x32_bf16 v[152:155], a[128:131], v[168:171], v[152:155]
    s_waitcnt lgkmcnt(12)
    v_mfma_f32_16x16x32_bf16 v[152:155], a[132:135], v[172:175], v[152:155]
    s_waitcnt lgkmcnt(11)
    v_mfma_f32_16x16x32_bf16 v[152:155], a[136:139], v[176:179], v[152:155]
    s_waitcnt lgkmcnt(10)
    v_mfma_f32_16x16x32_bf16 v[152:155], a[140:143], v[180:183], v[152:155]
    s_waitcnt lgkmcnt(9)
    v_mfma_f32_16x16x32_bf16 v[152:155], a[144:147], v[184:187], v[152:155]
    s_waitcnt lgkmcnt(8)
    v_mfma_f32_16x16x32_bf16 v[152:155], a[148:151], v[188:191], v[152:155]
    s_waitcnt lgkmcnt(7)
    v_mfma_f32_16x16x16_bf16 v[148:151], a[120:121], v[192:193], 0
    v_mfma_f32_16x16x16_bf16 v[148:151], a[124:125], v[194:195], v[148:151]
    s_waitcnt lgkmcnt(6)
    v_mfma_f32_16x16x16_bf16 v[148:151], a[128:129], v[196:197], v[148:151]
    v_mfma_f32_16x16x16_bf16 v[148:151], a[132:133], v[198:199], v[148:151]
    s_waitcnt lgkmcnt(5)
    v_mfma_f32_16x16x16_bf16 v[148:151], a[136:137], v[200:201], v[148:151]
    v_mfma_f32_16x16x16_bf16 v[148:151], a[140:141], v[202:203], v[148:151]
    s_waitcnt lgkmcnt(4)
    v_mfma_f32_16x16x16_bf16 v[148:151], a[144:145], v[204:205], v[148:151]
    v_mfma_f32_16x16x16_bf16 v[148:151], a[148:149], v[206:207], v[148:151]
    s_waitcnt lgkmcnt(0)
    v_mfma_f32_16x16x32_bf16 v[152:155], a[152:155], v[216:219], v[152:155]
    v_mfma_f32_16x16x32_bf16 v[152:155], a[156:159], v[220:223], v[152:155]
    v_accvgpr_write_b32 a72, v68
    v_accvgpr_write_b32 a73, v69
    v_accvgpr_write_b32 a74, v70
    v_accvgpr_write_b32 a75, v71
    v_accvgpr_write_b32 a76, v76
    v_accvgpr_write_b32 a77, v77
    v_accvgpr_write_b32 a78, v78
    v_accvgpr_write_b32 a79, v79
    s_add_u32 s65, s65, 524288
    s_bitset0_b32 s65, 21
    s_add_u32 s66, s66, 524288
    s_bitset0_b32 s66, 21
    s_add_u32 s67, s67, 524288
    s_bitset0_b32 s67, 21
    s_add_u32 s57, s64, 1048576
    s_bitset0_b32 s57, 21
    s_add_u32 s55, s55, 1
    buffer_load_dwordx4 v[136:139], v10, s[4:7], s69 offen sc1
    s_cmp_eq_u32 s75, 0
    s_cbranch_scc0 L_c_nh_19_w
    buffer_store_dword v18, v8, s[4:7], s79 offen sc1
L_c_nh_19_w:
    s_nop 3
    v_mfma_f32_16x16x32_bf16 v[148:151], a[152:155], v[208:211], v[148:151]
    v_mfma_f32_16x16x32_bf16 v[148:151], a[156:159], v[212:215], v[148:151]
    s_mov_b32 s96, 2000000
    s_branch L_c_x_18_q_w
L_c_x_18_w:
    buffer_load_dwordx4 v[136:139], v10, s[4:7], s69 offen sc1
    s_sub_u32 s96, s96, 1
    s_cbranch_scc1 L_fail
L_c_x_18_q_w:
    s_waitcnt vmcnt(0)
    v_mfma_f32_16x16x32_bf16 v[232:235], v[244:247], v[136:139], 0
    v_max3_u32 v7, v136, v137, v138
    v_max_u32 v7, v7, v139
    v_cmp_eq_u32 vcc, -1, v7
    s_cbranch_vccnz L_c_x_18_w
    s_nop 3
    v_cvt_pk_bf16_f32 v232, v232, v233
    v_min_u32 v232, -2, v232
    buffer_store_dword v232, v12, s[4:7], s64 offen sc1
    s_barrier
    s_sub_u32 s58, s55, 1
    s_add_u32 s59, s55, 1
    s_min_u32 s40, s59, 64
    s_cmp_lt_u32 s55, 3
    s_cbranch_scc1 L_c_early1_w
    s_sub_u32 s42, s55, 3
    v_cmp_gt_u32 vcc, s40, v16
    s_cbranch_vccnz L_c_rw1_w
L_c_rok1_w:
    buffer_load_dword v61, v25, s[4:7], 0 offen sc1
    buffer_load_dword v16, v60, s[4:7], 0 offen sc1
    s_cmp_eq_u32 s53, 0
    s_cbranch_scc0 L_c_pg_20_w
    v_mov_b32 v4, s42
    buffer_store_dword v4, v8, s[4:7], s72 offen sc1
L_c_pg_20_w:
    s_add_u32 s59, s68, 4096
    buffer_load_dwordx4 a[80:83], v10, s[4:7], s68 offen offset:0 sc1
    buffer_load_dwordx4 a[84:87], v10, s[4:7], s68 offen offset:1024 sc1
    buffer_load_dwordx4 a[88:91], v10, s[4:7], s68 offen offset:2048 sc1
    buffer_load_dwordx4 a[92:95], v10, s[4:7], s68 offen offset:3072 sc1
    buffer_load_dwordx4 a[96:99], v10, s[4:7], s59 offen offset:0 sc1
    buffer_load_dwordx4 a[100:103], v10, s[4:7], s59 offen offset:1024 sc1
    buffer_load_dwordx4 a[104:107], v10, s[4:7], s59 offen offset:2048 sc1
    buffer_load_dwordx4 a[108:111], v10, s[4:7], s59 offen offset:3072 sc1
    s_add_u32 s68, s68, 1310720
    v_cvt_pk_bf16_f32 v156, v148, v149
    v_cvt_pk_bf16_f32 v157, v150, v151
    v_cvt_pk_bf16_f32 v158, v152, v153
    v_cvt_pk_bf16_f32 v159, v154, v155
    buffer_store_dwordx4 v[156:159], v10, s[4:7], s36 offen sc1
    s_add_u32 s36, s36, 163840
    buffer_store_dword v26, v12, s[4:7], s57 offen sc1
    s_add_u32 s56, s70, 524288
    s_bitset0_b32 s56, 20
    s_add_u32 s56, s56, 0
    s_lshr_b32 s97, s56, 8
    s_xor_b32 s97, s97, s60
    s_and_b32 s97, s97, 8192
    s_add_u32 s56, s56, s97
    s_add_u32 s56, s56, s77
    buffer_store_dword v26, v12, s[4:7], s56 offen sc1
    s_add_u32 s70, s70, 262144
    s_bitset0_b32 s70, 20
    s_waitcnt vmcnt(12)
    v_cmp_gt_u32 vcc, s58, v61
    s_cbranch_vccnz L_c_tw1_w
L_c_tok1_w:
    s_add_u32 m0, s45, 0
    s_nop 0
    buffer_load_dwordx4 v10, s[4:7], s41 offen offset:0 sc1 lds
    buffer_load_dwordx4 v10, s[4:7], s41 offen offset:1024 sc1 lds
    buffer_load_dwordx4 v10, s[4:7], s41 offen offset:2048 sc1 lds
    buffer_load_dwordx4 v10, s[4:7], s41 offen offset:3072 sc1 lds
    s_add_u32 s41, s41, 524288
    s_bitset0_b32 s41, 21
L_c_next1_w:
    s_add_u32 s69, s70, 0
    s_lshr_b32 s97, s69, 8
    s_xor_b32 s97, s97, s60
    s_and_b32 s97, s97, 8192
    s_add_u32 s69, s69, s97
    s_add_u32 s71, s69, s77
    s_add_u32 s48, s69, 1048576
    s_add_u32 s49, s71, 1048576
    v_mov_b32 v132, 0
    v_mov_b32 v133, 0
    v_mov_b32 v134, 0
    v_mov_b32 v135, 0
    s_add_u32 s64, s64, 524288
    s_bitset0_b32 s64, 21
    s_add_u32 s62, s55, 1
    s_lshl_b32 s62, s62, 1
    v_mov_b32 v18, s62
    v_add_u32 v63, -1, v18
    s_waitcnt vmcnt(0) lgkmcnt(0)
    s_barrier
L_c_re2_w:
    s_mov_b32 s96, 2000000
L_poll_21_w:
    buffer_load_dwordx4 v[28:31], v13, s[4:7], s65 offen offset:0 sc1
    buffer_load_dwordx4 v[32:35], v13, s[4:7], s65 offen offset:1024 sc1
    buffer_load_dwordx4 v[36:39], v13, s[4:7], s65 offen offset:2048 sc1
    buffer_load_dwordx4 v[40:43], v13, s[4:7], s65 offen offset:3072 sc1
    s_sub_u32 s96, s96, 1
    s_cbranch_scc1 L_fail
    s_waitcnt vmcnt(0)
    v_max3_u32 v7, v31, v35, v39
    v_max_u32 v7, v7, v43
    v_cmp_eq_u32 vcc, -1, v7
    s_cbranch_vccnz L_poll_21_w
    v_mfma_f32_16x16x32_bf16 v[84:87], v[28:31], a[80:83], 0
    v_max3_u32 v7, v7, v28, v29
    v_max_u32 v7, v7, v30
    v_mfma_f32_16x16x32_bf16 v[88:91], v[28:31], a[84:87], 0
    v_max3_u32 v7, v7, v32, v33
    v_max_u32 v7, v7, v34
    buffer_load_dwordx4 v[68:71], v10, s[4:7], s67 offen offset:0 sc1
    buffer_load_dwordx4 v[76:79], v10, s[4:7], s67 offen offset:1024 sc1
    v_mfma_f32_16x16x32_bf16 v[92:95], v[32:35], a[88:91], 0
    v_max3_u32 v7, v7, v36, v37
    v_max_u32 v7, v7, v38
    v_mfma_f32_16x16x32_bf16 v[96:99], v[32:35], a[92:95], 0
    v_max3_u32 v7, v7, v40, v41
    v_max_u32 v7, v7, v42
    v_cmp_eq_u32 vcc, -1, v7
    s_cbranch_vccnz L_c_re2_w
    buffer_load_dwordx4 v[116:119], v66, s[4:7], s66 offen sc1
    buffer_load_dwordx4 v[120:123], v66, s[4:7], s66 offen offset:1024 sc1
    v_mfma_f32_16x16x32_bf16 v[100:103], v[36:39], a[96:99], 0
    v_cndmask_b32 v84, v88, v84, s[46:47]
    v_cndmask_b32 v85, v89, v85, s[46:47]
    v_mfma_f32_16x16x32_bf16 v[104:107], v[36:39], a[100:103], 0
    v_cndmask_b32 v86, v90, v86, s[46:47]
    v_cndmask_b32 v87, v91, v87, s[46:47]
    v_mfma_f32_16x16x32_bf16 v[108:111], v[40:43], a[104:107], 0
    v_cvt_pk_bf16_f32 v72, v84, v85
    v_cvt_pk_bf16_f32 v73, v86, v87
    v_mfma_f32_16x16x32_bf16 v[112:115], v[40:43], a[108:111], 0
    v_cndmask_b32 v92, v96, v92, s[46:47]
    v_cndmask_b32 v93, v97, v93, s[46:47]
    v_cndmask_b32 v94, v98, v94, s[46:47]
    v_cndmask_b32 v95, v99, v95, s[46:47]
    v_cvt_pk_bf16_f32 v74, v92, v93
    v_cvt_pk_bf16_f32 v75, v94, v95
    v_cndmask_b32 v100, v104, v100, s[46:47]
    v_cndmask_b32 v101, v105, v101, s[46:47]
    v_cndmask_b32 v102, v106, v102, s[46:47]
    v_cndmask_b32 v103, v107, v103, s[46:47]
    v_cvt_pk_bf16_f32 v80, v100, v101
    v_cvt_pk_bf16_f32 v81, v102, v103
    v_cndmask_b32 v108, v112, v108, s[46:47]
    v_cndmask_b32 v109, v113, v109, s[46:47]
    v_cndmask_b32 v110, v114, v110, s[46:47]
    v_cndmask_b32 v111, v115, v111, s[46:47]
    v_cvt_pk_bf16_f32 v82, v108, v109
    v_cvt_pk_bf16_f32 v83, v110, v111
    s_waitcnt vmcnt(2)
    v_max3_u32 v7, v68, v69, v70
    v_max3_u32 v7, v7, v71, v76
    v_max3_u32 v7, v7, v77, v78
    v_max_u32 v7, v7, v79
    v_cmp_eq_u32 vcc, -1, v7
    s_cbranch_vccz L_c_zok2_w
    s_mov_b32 s96, 2000000
L_poll_22_w:
    buffer_load_dwordx4 v[68:71], v10, s[4:7], s67 offen offset:0 sc1
    buffer_load_dwordx4 v[76:79], v10, s[4:7], s67 offen offset:1024 sc1
    buffer_load_dwordx4 v[116:119], v66, s[4:7], s66 offen sc1
    buffer_load_dwordx4 v[120:123], v66, s[4:7], s66 offen offset:1024 sc1
    s_sub_u32 s96, s96, 1
    s_cbranch_scc1 L_fail
    s_waitcnt vmcnt(0)
    v_max3_u32 v7, v68, v69, v70
    v_max3_u32 v7, v7, v71, v76
    v_max3_u32 v7, v7, v77, v78
    v_max_u32 v7, v7, v79
    v_cmp_eq_u32 vcc, -1, v7
    s_cbranch_vccnz L_poll_22_w
L_c_zok2_w:
    s_mov_b32 s96, 2000000
L_c_lp2_w:
    s_waitcnt vmcnt(0)
    v_smfmac_f32_16x16x64_bf16 v[132:135], v[116:119], v[68:75], v9
    v_smfmac_f32_16x16x64_bf16 v[132:135], v[120:123], v[76:83], v9
    v_max3_u32 v7, v116, v117, v118
    v_max3_u32 v7, v7, v119, v120
    v_max3_u32 v7, v7, v121, v122
    v_max_u32 v7, v7, v123
    v_cmp_eq_u32 vcc, -1, v7
    s_cbranch_vccz L_c_red2_w
    buffer_load_dwordx4 v[116:119], v66, s[4:7], s66 offen sc1
    buffer_load_dwordx4 v[120:123], v66, s[4:7], s66 offen offset:1024 sc1
    s_nop 1
    v_mov_b32 v132, 0
    v_mov_b32 v133, 0
    v_mov_b32 v134, 0
    v_mov_b32 v135, 0
    s_sub_u32 s96, s96, 1
    s_cbranch_scc1 L_fail
    s_branch L_c_lp2_w
L_c_red2_w:
    s_nop 1
    v_permlane32_swap_b32 v132, v134
    v_permlane32_swap_b32 v133, v135
    v_add_f32 v132, v132, v134
    v_add_f32 v133, v133, v135
    v_cvt_pk_bf16_f32 v132, v132, v133
    buffer_store_dword v132, v12, s[4:7], s71 offen sc1
    ds_read_b128 v[160:163], v10 offset:0
    ds_read_b128 v[164:167], v10 offset:1024
    ds_read_b128 v[168:171], v10 offset:2048
    ds_read_b128 v[172:175], v10 offset:3072
    ds_read_b128 v[176:179], v10 offset:4096
    ds_read_b128 v[180:183], v10 offset:5120
    ds_read_b128 v[184:187], v10 offset:6144
    ds_read_b128 v[188:191], v10 offset:7168
    ds_read_b128 v[192:195], v10 offset:8192
    ds_read_b128 v[196:199], v10 offset:9216
    ds_read_b128 v[200:203], v10 offset:10240
    ds_read_b128 v[204:207], v10 offset:11264
    ds_read_b128 v[208:211], v10 offset:12288
    ds_read_b128 v[212:215], v10 offset:13312
    ds_read_b128 v[216:219], v10 offset:14336
    ds_read_b128 v[220:223], v10 offset:15360
    s_waitcnt lgkmcnt(15)
    v_mfma_f32_16x16x32_bf16 v[152:155], a[0:3], v[160:163], 0
    s_waitcnt lgkmcnt(14)
    v_mfma_f32_16x16x32_bf16 v[152:155], a[4:7], v[164:167], v[152:155]
    s_waitcnt lgkmcnt(13)
    v_mfma_f32_16x16x32_bf16 v[152:155], a[8:11], v[168:171], v[152:155]
    s_waitcnt lgkmcnt(12)
    v_mfma_f32_16x16x32_bf16 v[152:155], a[12:15], v[172:175], v[152:155]
    s_waitcnt lgkmcnt(11)
    v_mfma_f32_16x16x32_bf16 v[152:155], a[16:19], v[176:179], v[152:155]
    s_waitcnt lgkmcnt(10)
    v_mfma_f32_16x16x32_bf16 v[152:155], a[20:23], v[180:183], v[152:155]
    s_waitcnt lgkmcnt(9)
    v_mfma_f32_16x16x32_bf16 v[152:155], a[24:27], v[184:187], v[152:155]
    s_waitcnt lgkmcnt(8)
    v_mfma_f32_16x16x32_bf16 v[152:155], a[28:31], v[188:191], v[152:155]
    s_waitcnt lgkmcnt(7)
    v_mfma_f32_16x16x16_bf16 v[148:151], a[0:1], v[192:193], 0
    v_mfma_f32_16x16x16_bf16 v[148:151], a[4:5], v[194:195], v[148:151]
    s_waitcnt lgkmcnt(6)
    v_mfma_f32_16x16x16_bf16 v[148:151], a[8:9], v[196:197], v[148:151]
    v_mfma_f32_16x16x16_bf16 v[148:151], a[12:13], v[198:199], v[148:151]
    s_waitcnt lgkmcnt(5)
    v_mfma_f32_16x16x16_bf16 v[148:151], a[16:17], v[200:201], v[148:151]
    v_mfma_f32_16x16x16_bf16 v[148:151], a[20:21], v[202:203], v[148:151]
    s_waitcnt lgkmcnt(4)
    v_mfma_f32_16x16x16_bf16 v[148:151], a[24:25], v[204:205], v[148:151]
    v_mfma_f32_16x16x16_bf16 v[148:151], a[28:29], v[206:207], v[148:151]
    s_waitcnt lgkmcnt(0)
    v_mfma_f32_16x16x32_bf16 v[152:155], a[32:35], v[216:219], v[152:155]
    v_mfma_f32_16x16x32_bf16 v[152:155], a[36:39], v[220:223], v[152:155]
    v_accvgpr_write_b32 a112, v68
    v_accvgpr_write_b32 a113, v69
    v_accvgpr_write_b32 a114, v70
    v_accvgpr_write_b32 a115, v71
    v_accvgpr_write_b32 a116, v76
    v_accvgpr_write_b32 a117, v77
    v_accvgpr_write_b32 a118, v78
    v_accvgpr_write_b32 a119, v79
    s_add_u32 s65, s65, 524288
    s_bitset0_b32 s65, 21
    s_add_u32 s66, s66, 524288
    s_bitset0_b32 s66, 21
    s_add_u32 s67, s67, 524288
    s_bitset0_b32 s67, 21
    s_add_u32 s57, s64, 1048576
    s_bitset0_b32 s57, 21
    s_add_u32 s55, s55, 1
    buffer_load_dwordx4 v[136:139], v10, s[4:7], s69 offen sc1
    s_cmp_eq_u32 s75, 0
    s_cbranch_scc0 L_c_nh_24_w
    buffer_store_dword v18, v8, s[4:7], s79 offen sc1
L_c_nh_24_w:
    s_nop 3
    v_mfma_f32_16x16x32_bf16 v[148:151], a[32:35], v[208:211], v[148:151]
    v_mfma_f32_16x16x32_bf16 v[148:151], a[36:39], v[212:215], v[148:151]
    s_mov_b32 s96, 2000000
    s_branch L_c_x_23_q_w
L_c_x_23_w:
    buffer_load_dwordx4 v[136:139], v10, s[4:7], s69 offen sc1
    s_sub_u32 s96, s96, 1
    s_cbranch_scc1 L_fail
L_c_x_23_q_w:
    s_waitcnt vmcnt(0)
    v_mfma_f32_16x16x32_bf16 v[232:235], v[244:247], v[136:139], 0
    v_max3_u32 v7, v136, v137, v138
    v_max_u32 v7, v7, v139
    v_cmp_eq_u32 vcc, -1, v7
    s_cbranch_vccnz L_c_x_23_w
    s_nop 3
    v_cvt_pk_bf16_f32 v232, v232, v233
    v_min_u32 v232, -2, v232
    buffer_store_dword v232, v12, s[4:7], s64 offen sc1
    s_barrier
    s_sub_u32 s58, s55, 1
    s_add_u32 s59, s55, 1
    s_min_u32 s40, s59, 64
    s_cmp_lt_u32 s55, 3
    s_cbranch_scc1 L_c_early2_w
    s_sub_u32 s42, s55, 3
    v_cmp_gt_u32 vcc, s40, v16
    s_cbranch_vccnz L_c_rw2_w
L_c_rok2_w:
    buffer_load_dword v61, v25, s[4:7], 0 offen sc1
    buffer_load_dword v16, v60, s[4:7], 0 offen sc1
    s_cmp_eq_u32 s53, 0
    s_cbranch_scc0 L_c_pg_25_w
    v_mov_b32 v4, s42
    buffer_store_dword v4, v8, s[4:7], s72 offen sc1
L_c_pg_25_w:
    s_add_u32 s59, s68, 4096
    buffer_load_dwordx4 a[120:123], v10, s[4:7], s68 offen offset:0 sc1
    buffer_load_dwordx4 a[124:127], v10, s[4:7], s68 offen offset:1024 sc1
    buffer_load_dwordx4 a[128:131], v10, s[4:7], s68 offen offset:2048 sc1
    buffer_load_dwordx4 a[132:135], v10, s[4:7], s68 offen offset:3072 sc1
    buffer_load_dwordx4 a[136:139], v10, s[4:7], s59 offen offset:0 sc1
    buffer_load_dwordx4 a[140:143], v10, s[4:7], s59 offen offset:1024 sc1
    buffer_load_dwordx4 a[144:147], v10, s[4:7], s59 offen offset:2048 sc1
    buffer_load_dwordx4 a[148:151], v10, s[4:7], s59 offen offset:3072 sc1
    s_add_u32 s68, s68, 1310720
    v_cvt_pk_bf16_f32 v156, v148, v149
    v_cvt_pk_bf16_f32 v157, v150, v151
    v_cvt_pk_bf16_f32 v158, v152, v153
    v_cvt_pk_bf16_f32 v159, v154, v155
    buffer_store_dwordx4 v[156:159], v10, s[4:7], s36 offen sc1
    s_add_u32 s36, s36, 163840
    buffer_store_dword v26, v12, s[4:7], s57 offen sc1
    s_add_u32 s56, s70, 524288
    s_bitset0_b32 s56, 20
    s_add_u32 s56, s56, 0
    s_lshr_b32 s97, s56, 8
    s_xor_b32 s97, s97, s60
    s_and_b32 s97, s97, 8192
    s_add_u32 s56, s56, s97
    s_add_u32 s56, s56, s77
    buffer_store_dword v26, v12, s[4:7], s56 offen sc1
    s_add_u32 s70, s70, 262144
    s_bitset0_b32 s70, 20
    s_waitcnt vmcnt(12)
    v_cmp_gt_u32 vcc, s58, v61
    s_cbranch_vccnz L_c_tw2_w
L_c_tok2_w:
    s_add_u32 m0, s45, 16384
    s_nop 0
    buffer_load_dwordx4 v10, s[4:7], s41 offen offset:0 sc1 lds
    buffer_load_dwordx4 v10, s[4:7], s41 offen offset:1024 sc1 lds
    buffer_load_dwordx4 v10, s[4:7], s41 offen offset:2048 sc1 lds
    buffer_load_dwordx4 v10, s[4:7], s41 offen offset:3072 sc1 lds
    s_add_u32 s41, s41, 524288
    s_bitset0_b32 s41, 21
L_c_next2_w:
    s_cmp_lt_u32 s55, 63
    s_cbranch_scc0 L_c_drain_w
    s_add_u32 s69, s70, 0
    s_lshr_b32 s97, s69, 8
    s_xor_b32 s97, s97, s60
    s_and_b32 s97, s97, 8192
    s_add_u32 s69, s69, s97
    s_add_u32 s71, s69, s77
    s_add_u32 s48, s69, 1048576
    s_add_u32 s49, s71, 1048576
    v_mov_b32 v132, 0
    v_mov_b32 v133, 0
    v_mov_b32 v134, 0
    v_mov_b32 v135, 0
    s_add_u32 s64, s64, 524288
    s_bitset0_b32 s64, 21
    s_add_u32 s62, s55, 1
    s_lshl_b32 s62, s62, 1
    v_mov_b32 v18, s62
    v_add_u32 v63, -1, v18
    s_waitcnt vmcnt(0) lgkmcnt(0)
    s_barrier
L_c_re3_w:
    s_mov_b32 s96, 2000000
L_poll_26_w:
    buffer_load_dwordx4 v[28:31], v13, s[4:7], s65 offen offset:0 sc1
    buffer_load_dwordx4 v[32:35], v13, s[4:7], s65 offen offset:1024 sc1
    buffer_load_dwordx4 v[36:39], v13, s[4:7], s65 offen offset:2048 sc1
    buffer_load_dwordx4 v[40:43], v13, s[4:7], s65 offen offset:3072 sc1
    s_sub_u32 s96, s96, 1
    s_cbranch_scc1 L_fail
    s_waitcnt vmcnt(0)
    v_max3_u32 v7, v31, v35, v39
    v_max_u32 v7, v7, v43
    v_cmp_eq_u32 vcc, -1, v7
    s_cbranch_vccnz L_poll_26_w
    v_mfma_f32_16x16x32_bf16 v[84:87], v[28:31], a[120:123], 0
    v_max3_u32 v7, v7, v28, v29
    v_max_u32 v7, v7, v30
    v_mfma_f32_16x16x32_bf16 v[88:91], v[28:31], a[124:127], 0
    v_max3_u32 v7, v7, v32, v33
    v_max_u32 v7, v7, v34
    buffer_load_dwordx4 v[68:71], v10, s[4:7], s67 offen offset:0 sc1
    buffer_load_dwordx4 v[76:79], v10, s[4:7], s67 offen offset:1024 sc1
    v_mfma_f32_16x16x32_bf16 v[92:95], v[32:35], a[128:131], 0
    v_max3_u32 v7, v7, v36, v37
    v_max_u32 v7, v7, v38
    v_mfma_f32_16x16x32_bf16 v[96:99], v[32:35], a[132:135], 0
    v_max3_u32 v7, v7, v40, v41
    v_max_u32 v7, v7, v42
    v_cmp_eq_u32 vcc, -1, v7
    s_cbranch_vccnz L_c_re3_w
    buffer_load_dwordx4 v[116:119], v66, s[4:7], s66 offen sc1
    buffer_load_dwordx4 v[120:123], v66, s[4:7], s66 offen offset:1024 sc1
    v_mfma_f32_16x16x32_bf16 v[100:103], v[36:39], a[136:139], 0
    v_cndmask_b32 v84, v88, v84, s[46:47]
    v_cndmask_b32 v85, v89, v85, s[46:47]
    v_mfma_f32_16x16x32_bf16 v[104:107], v[36:39], a[140:143], 0
    v_cndmask_b32 v86, v90, v86, s[46:47]
    v_cndmask_b32 v87, v91, v87, s[46:47]
    v_mfma_f32_16x16x32_bf16 v[108:111], v[40:43], a[144:147], 0
    v_cvt_pk_bf16_f32 v72, v84, v85
    v_cvt_pk_bf16_f32 v73, v86, v87
    v_mfma_f32_16x16x32_bf16 v[112:115], v[40:43], a[148:151], 0
    v_cndmask_b32 v92, v96, v92, s[46:47]
    v_cndmask_b32 v93, v97, v93, s[46:47]
    v_cndmask_b32 v94, v98, v94, s[46:47]
    v_cndmask_b32 v95, v99, v95, s[46:47]
    v_cvt_pk_bf16_f32 v74, v92, v93
    v_cvt_pk_bf16_f32 v75, v94, v95
    v_cndmask_b32 v100, v104, v100, s[46:47]
    v_cndmask_b32 v101, v105, v101, s[46:47]
    v_cndmask_b32 v102, v106, v102, s[46:47]
    v_cndmask_b32 v103, v107, v103, s[46:47]
    v_cvt_pk_bf16_f32 v80, v100, v101
    v_cvt_pk_bf16_f32 v81, v102, v103
    v_cndmask_b32 v108, v112, v108, s[46:47]
    v_cndmask_b32 v109, v113, v109, s[46:47]
    v_cndmask_b32 v110, v114, v110, s[46:47]
    v_cndmask_b32 v111, v115, v111, s[46:47]
    v_cvt_pk_bf16_f32 v82, v108, v109
    v_cvt_pk_bf16_f32 v83, v110, v111
    s_waitcnt vmcnt(2)
    v_max3_u32 v7, v68, v69, v70
    v_max3_u32 v7, v7, v71, v76
    v_max3_u32 v7, v7, v77, v78
    v_max_u32 v7, v7, v79
    v_cmp_eq_u32 vcc, -1, v7
    s_cbranch_vccz L_c_zok3_w
    s_mov_b32 s96, 2000000
L_poll_27_w:
    buffer_load_dwordx4 v[68:71], v10, s[4:7], s67 offen offset:0 sc1
    buffer_load_dwordx4 v[76:79], v10, s[4:7], s67 offen offset:1024 sc1
    buffer_load_dwordx4 v[116:119], v66, s[4:7], s66 offen sc1
    buffer_load_dwordx4 v[120:123], v66, s[4:7], s66 offen offset:1024 sc1
    s_sub_u32 s96, s96, 1
    s_cbranch_scc1 L_fail
    s_waitcnt vmcnt(0)
    v_max3_u32 v7, v68, v69, v70
    v_max3_u32 v7, v7, v71, v76
    v_max3_u32 v7, v7, v77, v78
    v_max_u32 v7, v7, v79
    v_cmp_eq_u32 vcc, -1, v7
    s_cbranch_vccnz L_poll_27_w
L_c_zok3_w:
    s_mov_b32 s96, 2000000
L_c_lp3_w:
    s_waitcnt vmcnt(0)
    v_smfmac_f32_16x16x64_bf16 v[132:135], v[116:119], v[68:75], v9
    v_smfmac_f32_16x16x64_bf16 v[132:135], v[120:123], v[76:83], v9
    v_max3_u32 v7, v116, v117, v118
    v_max3_u32 v7, v7, v119, v120
    v_max3_u32 v7, v7, v121, v122
    v_max_u32 v7, v7, v123
    v_cmp_eq_u32 vcc, -1, v7
    s_cbranch_vccz L_c_red3_w
    buffer_load_dwordx4 v[116:119], v66, s[4:7], s66 offen sc1
    buffer_load_dwordx4 v[120:123], v66, s[4:7], s66 offen offset:1024 sc1
    s_nop 1
    v_mov_b32 v132, 0
    v_mov_b32 v133, 0
    v_mov_b32 v134, 0
    v_mov_b32 v135, 0
    s_sub_u32 s96, s96, 1
    s_cbranch_scc1 L_fail
    s_branch L_c_lp3_w
L_c_red3_w:
    s_nop 1
    v_permlane32_swap_b32 v132, v134
    v_permlane32_swap_b32 v133, v135
    v_add_f32 v132, v132, v134
    v_add_f32 v133, v133, v135
    v_cvt_pk_bf16_f32 v132, v132, v133
    buffer_store_dword v132, v12, s[4:7], s71 offen sc1
    ds_read_b128 v[160:163], v10 offset:16384
    ds_read_b128 v[164:167], v10 offset:17408
    ds_read_b128 v[168:171], v10 offset:18432
    ds_read_b128 v[172:175], v10 offset:19456
    ds_read_b128 v[176:179], v10 offset:20480
    ds_read_b128 v[180:183], v10 offset:21504
    ds_read_b128 v[184:187], v10 offset:22528
    ds_read_b128 v[188:191], v10 offset:23552
    ds_read_b128 v[192:195], v10 offset:24576
    ds_read_b128 v[196:199], v10 offset:25600
    ds_read_b128 v[200:203], v10 offset:26624
    ds_read_b128 v[204:207], v10 offset:27648
    ds_read_b128 v[208:211], v10 offset:28672
    ds_read_b128 v[212:215], v10 offset:29696
    ds_read_b128 v[216:219], v10 offset:30720
    ds_read_b128 v[220:223], v10 offset:31744
    s_waitcnt lgkmcnt(15)
    v_mfma_f32_16x16x32_bf16 v[152:155], a[40:43], v[160:163], 0
    s_waitcnt lgkmcnt(14)
    v_mfma_f32_16x16x32_bf16 v[152:155], a[44:47], v[164:167], v[152:155]
    s_waitcnt lgkmcnt(13)
    v_mfma_f32_16x16x32_bf16 v[152:155], a[48:51], v[168:171], v[152:155]
    s_waitcnt lgkmcnt(12)
    v_mfma_f32_16x16x32_bf16 v[152:155], a[52:55], v[172:175], v[152:155]
    s_waitcnt lgkmcnt(11)
    v_mfma_f32_16x16x32_bf16 v[152:155], a[56:59], v[176:179], v[152:155]
    s_waitcnt lgkmcnt(10)
    v_mfma_f32_16x16x32_bf16 v[152:155], a[60:63], v[180:183], v[152:155]
    s_waitcnt lgkmcnt(9)
    v_mfma_f32_16x16x32_bf16 v[152:155], a[64:67], v[184:187], v[152:155]
    s_waitcnt lgkmcnt(8)
    v_mfma_f32_16x16x32_bf16 v[152:155], a[68:71], v[188:191], v[152:155]
    s_waitcnt lgkmcnt(7)
    v_mfma_f32_16x16x16_bf16 v[148:151], a[40:41], v[192:193], 0
    v_mfma_f32_16x16x16_bf16 v[148:151], a[44:45], v[194:195], v[148:151]
    s_waitcnt lgkmcnt(6)
    v_mfma_f32_16x16x16_bf16 v[148:151], a[48:49], v[196:197], v[148:151]
    v_mfma_f32_16x16x16_bf16 v[148:151], a[52:53], v[198:199], v[148:151]
    s_waitcnt lgkmcnt(5)
    v_mfma_f32_16x16x16_bf16 v[148:151], a[56:57], v[200:201], v[148:151]
    v_mfma_f32_16x16x16_bf16 v[148:151], a[60:61], v[202:203], v[148:151]
    s_waitcnt lgkmcnt(4)
    v_mfma_f32_16x16x16_bf16 v[148:151], a[64:65], v[204:205], v[148:151]
    v_mfma_f32_16x16x16_bf16 v[148:151], a[68:69], v[206:207], v[148:151]
    s_waitcnt lgkmcnt(0)
    v_mfma_f32_16x16x32_bf16 v[152:155], a[72:75], v[216:219], v[152:155]
    v_mfma_f32_16x16x32_bf16 v[152:155], a[76:79], v[220:223], v[152:155]
    v_accvgpr_write_b32 a152, v68
    v_accvgpr_write_b32 a153, v69
    v_accvgpr_write_b32 a154, v70
    v_accvgpr_write_b32 a155, v71
    v_accvgpr_write_b32 a156, v76
    v_accvgpr_write_b32 a157, v77
    v_accvgpr_write_b32 a158, v78
    v_accvgpr_write_b32 a159, v79
    s_add_u32 s65, s65, 524288
    s_bitset0_b32 s65, 21
    s_add_u32 s66, s66, 524288
    s_bitset0_b32 s66, 21
    s_add_u32 s67, s67, 524288
    s_bitset0_b32 s67, 21
    s_add_u32 s57, s64, 1048576
    s_bitset0_b32 s57, 21
    s_add_u32 s55, s55, 1
    buffer_load_dwordx4 v[136:139], v10, s[4:7], s69 offen sc1
    s_cmp_eq_u32 s75, 0
    s_cbranch_scc0 L_c_nh_29_w
    buffer_store_dword v18, v8, s[4:7], s79 offen sc1
L_c_nh_29_w:
    s_nop 3
    v_mfma_f32_16x16x32_bf16 v[148:151], a[72:75], v[208:211], v[148:151]
    v_mfma_f32_16x16x32_bf16 v[148:151], a[76:79], v[212:215], v[148:151]
    s_mov_b32 s96, 2000000
    s_branch L_c_x_28_q_w
L_c_x_28_w:
    buffer_load_dwordx4 v[136:139], v10, s[4:7], s69 offen sc1
    s_sub_u32 s96, s96, 1
    s_cbranch_scc1 L_fail
L_c_x_28_q_w:
    s_waitcnt vmcnt(0)
    v_mfma_f32_16x16x32_bf16 v[232:235], v[244:247], v[136:139], 0
    v_max3_u32 v7, v136, v137, v138
    v_max_u32 v7, v7, v139
    v_cmp_eq_u32 vcc, -1, v7
    s_cbranch_vccnz L_c_x_28_w
    s_nop 3
    v_cvt_pk_bf16_f32 v232, v232, v233
    v_min_u32 v232, -2, v232
    buffer_store_dword v232, v12, s[4:7], s64 offen sc1
    s_barrier
    s_sub_u32 s58, s55, 1
    s_add_u32 s59, s55, 1
    s_min_u32 s40, s59, 64
    s_cmp_lt_u32 s55, 3
    s_cbranch_scc1 L_c_early3_w
    s_sub_u32 s42, s55, 3
    v_cmp_gt_u32 vcc, s40, v16
    s_cbranch_vccnz L_c_rw3_w
L_c_rok3_w:
    buffer_load_dword v61, v25, s[4:7], 0 offen sc1
    buffer_load_dword v16, v60, s[4:7], 0 offen sc1
    s_cmp_eq_u32 s53, 0
    s_cbranch_scc0 L_c_pg_30_w
    v_mov_b32 v4, s42
    buffer_store_dword v4, v8, s[4:7], s72 offen sc1
L_c_pg_30_w:
    s_add_u32 s59, s68, 4096
    buffer_load_dwordx4 a[0:3], v10, s[4:7], s68 offen offset:0 sc1
    buffer_load_dwordx4 a[4:7], v10, s[4:7], s68 offen offset:1024 sc1
    buffer_load_dwordx4 a[8:11], v10, s[4:7], s68 offen offset:2048 sc1
    buffer_load_dwordx4 a[12:15], v10, s[4:7], s68 offen offset:3072 sc1
    buffer_load_dwordx4 a[16:19], v10, s[4:7], s59 offen offset:0 sc1
    buffer_load_dwordx4 a[20:23], v10, s[4:7], s59 offen offset:1024 sc1
    buffer_load_dwordx4 a[24:27], v10, s[4:7], s59 offen offset:2048 sc1
    buffer_load_dwordx4 a[28:31], v10, s[4:7], s59 offen offset:3072 sc1
    s_add_u32 s68, s68, 1310720
    v_cvt_pk_bf16_f32 v156, v148, v149
    v_cvt_pk_bf16_f32 v157, v150, v151
    v_cvt_pk_bf16_f32 v158, v152, v153
    v_cvt_pk_bf16_f32 v159, v154, v155
    buffer_store_dwordx4 v[156:159], v10, s[4:7], s36 offen sc1
    s_add_u32 s36, s36, 163840
    buffer_store_dword v26, v12, s[4:7], s57 offen sc1
    s_add_u32 s56, s70, 524288
    s_bitset0_b32 s56, 20
    s_add_u32 s56, s56, 0
    s_lshr_b32 s97, s56, 8
    s_xor_b32 s97, s97, s60
    s_and_b32 s97, s97, 8192
    s_add_u32 s56, s56, s97
    s_add_u32 s56, s56, s77
    buffer_store_dword v26, v12, s[4:7], s56 offen sc1
    s_add_u32 s70, s70, 262144
    s_bitset0_b32 s70, 20
    s_waitcnt vmcnt(12)
    v_cmp_gt_u32 vcc, s58, v61
    s_cbranch_vccnz L_c_tw3_w
L_c_tok3_w:
    s_add_u32 m0, s45, 0
    s_nop 0
    buffer_load_dwordx4 v10, s[4:7], s41 offen offset:0 sc1 lds
    buffer_load_dwordx4 v10, s[4:7], s41 offen offset:1024 sc1 lds
    buffer_load_dwordx4 v10, s[4:7], s41 offen offset:2048 sc1 lds
    buffer_load_dwordx4 v10, s[4:7], s41 offen offset:3072 sc1 lds
    s_add_u32 s41, s41, 524288
    s_bitset0_b32 s41, 21
L_c_next3_w:
    s_branch L_c_loop_w
L_c_early0_w:
    buffer_store_dword v26, v12, s[4:7], s57 offen sc1
    s_add_u32 s56, s70, 524288
    s_bitset0_b32 s56, 20
    s_add_u32 s56, s56, 0
    s_lshr_b32 s97, s56, 8
    s_xor_b32 s97, s97, s60
    s_and_b32 s97, s97, 8192
    s_add_u32 s56, s56, s97
    s_add_u32 s56, s56, s77
    buffer_store_dword v26, v12, s[4:7], s56 offen sc1
    s_add_u32 s70, s70, 262144
    s_bitset0_b32 s70, 20
    s_mov_b32 s96, 2000000
L_wf_31_w:
    buffer_load_dword v16, v60, s[4:7], 0 offen sc1
    s_sub_u32 s96, s96, 1
    s_cbranch_scc1 L_fail
    s_waitcnt vmcnt(0)
    v_cmp_gt_u32 vcc, s40, v16
    s_cbranch_vccz L_wf_31_d_w
    s_sleep 2
    s_branch L_wf_31_w
L_wf_31_d_w:
    s_add_u32 s59, s68, 4096
    buffer_load_dwordx4 a[40:43], v10, s[4:7], s68 offen offset:0 sc1
    buffer_load_dwordx4 a[44:47], v10, s[4:7], s68 offen offset:1024 sc1
    buffer_load_dwordx4 a[48:51], v10, s[4:7], s68 offen offset:2048 sc1
    buffer_load_dwordx4 a[52:55], v10, s[4:7], s68 offen offset:3072 sc1
    buffer_load_dwordx4 a[56:59], v10, s[4:7], s59 offen offset:0 sc1
    buffer_load_dwordx4 a[60:63], v10, s[4:7], s59 offen offset:1024 sc1
    buffer_load_dwordx4 a[64:67], v10, s[4:7], s59 offen offset:2048 sc1
    buffer_load_dwordx4 a[68:71], v10, s[4:7], s59 offen offset:3072 sc1
    s_add_u32 s68, s68, 1310720
    s_branch L_c_next0_w
L_c_rw0_w:
    s_mov_b32 s96, 2000000
L_wf_32_w:
    buffer_load_dword v16, v60, s[4:7], 0 offen sc1
    s_sub_u32 s96, s96, 1
    s_cbranch_scc1 L_fail
    s_waitcnt vmcnt(0)
    v_cmp_gt_u32 vcc, s40, v16
    s_cbranch_vccz L_wf_32_d_w
    s_sleep 2
    s_branch L_wf_32_w
L_wf_32_d_w:
    s_branch L_c_rok0_w
L_c_tw0_w:
    s_mov_b32 s96, 2000000
L_wf_33_w:
    buffer_load_dword v61, v25, s[4:7], 0 offen sc1
    s_sub_u32 s96, s96, 1
    s_cbranch_scc1 L_fail
    s_waitcnt vmcnt(0)
    v_cmp_gt_u32 vcc, s58, v61
    s_cbranch_vccz L_wf_33_d_w
    s_sleep 2
    s_branch L_wf_33_w
L_wf_33_d_w:
    s_branch L_c_tok0_w
L_c_early1_w:
    buffer_store_dword v26, v12, s[4:7], s57 offen sc1
    s_add_u32 s56, s70, 524288
    s_bitset0_b32 s56, 20
    s_add_u32 s56, s56, 0
    s_lshr_b32 s97, s56, 8
    s_xor_b32 s97, s97, s60
    s_and_b32 s97, s97, 8192
    s_add_u32 s56, s56, s97
    s_add_u32 s56, s56, s77
    buffer_store_dword v26, v12, s[4:7], s56 offen sc1
    s_add_u32 s70, s70, 262144
    s_bitset0_b32 s70, 20
    s_mov_b32 s96, 2000000
L_wf_34_w:
    buffer_load_dword v16, v60, s[4:7], 0 offen sc1
    s_sub_u32 s96, s96, 1
    s_cbranch_scc1 L_fail
    s_waitcnt vmcnt(0)
    v_cmp_gt_u32 vcc, s40, v16
    s_cbranch_vccz L_wf_34_d_w
    s_sleep 2
    s_branch L_wf_34_w
L_wf_34_d_w:
    s_add_u32 s59, s68, 4096
    buffer_load_dwordx4 a[80:83], v10, s[4:7], s68 offen offset:0 sc1
    buffer_load_dwordx4 a[84:87], v10, s[4:7], s68 offen offset:1024 sc1
    buffer_load_dwordx4 a[88:91], v10, s[4:7], s68 offen offset:2048 sc1
    buffer_load_dwordx4 a[92:95], v10, s[4:7], s68 offen offset:3072 sc1
    buffer_load_dwordx4 a[96:99], v10, s[4:7], s59 offen offset:0 sc1
    buffer_load_dwordx4 a[100:103], v10, s[4:7], s59 offen offset:1024 sc1
    buffer_load_dwordx4 a[104:107], v10, s[4:7], s59 offen offset:2048 sc1
    buffer_load_dwordx4 a[108:111], v10, s[4:7], s59 offen offset:3072 sc1
    s_add_u32 s68, s68, 1310720
    s_mov_b32 s96, 2000000
L_wf_35_w:
    buffer_load_dword v61, v25, s[4:7], 0 offen sc1
    s_sub_u32 s96, s96, 1
    s_cbranch_scc1 L_fail
    s_waitcnt vmcnt(0)
    v_cmp_gt_u32 vcc, s58, v61
    s_cbranch_vccz L_wf_35_d_w
    s_sleep 2
    s_branch L_wf_35_w
L_wf_35_d_w:
    s_add_u32 m0, s45, 0
    s_nop 0
    buffer_load_dwordx4 v10, s[4:7], s41 offen offset:0 sc1 lds
    buffer_load_dwordx4 v10, s[4:7], s41 offen offset:1024 sc1 lds
    buffer_load_dwordx4 v10, s[4:7], s41 offen offset:2048 sc1 lds
    buffer_load_dwordx4 v10, s[4:7], s41 offen offset:3072 sc1 lds
    s_add_u32 s41, s41, 524288
    s_bitset0_b32 s41, 21
    s_branch L_c_next1_w
L_c_rw1_w:
    s_mov_b32 s96, 2000000
L_wf_36_w:
    buffer_load_dword v16, v60, s[4:7], 0 offen sc1
    s_sub_u32 s96, s96, 1
    s_cbranch_scc1 L_fail
    s_waitcnt vmcnt(0)
    v_cmp_gt_u32 vcc, s40, v16
    s_cbranch_vccz L_wf_36_d_w
    s_sleep 2
    s_branch L_wf_36_w
L_wf_36_d_w:
    s_branch L_c_rok1_w
L_c_tw1_w:
    s_mov_b32 s96, 2000000
L_wf_37_w:
    buffer_load_dword v61, v25, s[4:7], 0 offen sc1
    s_sub_u32 s96, s96, 1
    s_cbranch_scc1 L_fail
    s_waitcnt vmcnt(0)
    v_cmp_gt_u32 vcc, s58, v61
    s_cbranch_vccz L_wf_37_d_w
    s_sleep 2
    s_branch L_wf_37_w
L_wf_37_d_w:
    s_branch L_c_tok1_w
L_c_early2_w:
    buffer_store_dword v26, v12, s[4:7], s57 offen sc1
    s_add_u32 s56, s70, 524288
    s_bitset0_b32 s56, 20
    s_add_u32 s56, s56, 0
    s_lshr_b32 s97, s56, 8
    s_xor_b32 s97, s97, s60
    s_and_b32 s97, s97, 8192
    s_add_u32 s56, s56, s97
    s_add_u32 s56, s56, s77
    buffer_store_dword v26, v12, s[4:7], s56 offen sc1
    s_add_u32 s70, s70, 262144
    s_bitset0_b32 s70, 20
    s_mov_b32 s96, 2000000
L_wf_38_w:
    buffer_load_dword v16, v60, s[4:7], 0 offen sc1
    s_sub_u32 s96, s96, 1
    s_cbranch_scc1 L_fail
    s_waitcnt vmcnt(0)
    v_cmp_gt_u32 vcc, s40, v16
    s_cbranch_vccz L_wf_38_d_w
    s_sleep 2
    s_branch L_wf_38_w
L_wf_38_d_w:
    s_add_u32 s59, s68, 4096
    buffer_load_dwordx4 a[120:123], v10, s[4:7], s68 offen offset:0 sc1
    buffer_load_dwordx4 a[124:127], v10, s[4:7], s68 offen offset:1024 sc1
    buffer_load_dwordx4 a[128:131], v10, s[4:7], s68 offen offset:2048 sc1
    buffer_load_dwordx4 a[132:135], v10, s[4:7], s68 offen offset:3072 sc1
    buffer_load_dwordx4 a[136:139], v10, s[4:7], s59 offen offset:0 sc1
    buffer_load_dwordx4 a[140:143], v10, s[4:7], s59 offen offset:1024 sc1
    buffer_load_dwordx4 a[144:147], v10, s[4:7], s59 offen offset:2048 sc1
    buffer_load_dwordx4 a[148:151], v10, s[4:7], s59 offen offset:3072 sc1
    s_add_u32 s68, s68, 1310720
    s_branch L_c_next2_w
L_c_rw2_w:
    s_mov_b32 s96, 2000000
L_wf_39_w:
    buffer_load_dword v16, v60, s[4:7], 0 offen sc1
    s_sub_u32 s96, s96, 1
    s_cbranch_scc1 L_fail
    s_waitcnt vmcnt(0)
    v_cmp_gt_u32 vcc, s40, v16
    s_cbranch_vccz L_wf_39_d_w
    s_sleep 2
    s_branch L_wf_39_w
L_wf_39_d_w:
    s_branch L_c_rok2_w
L_c_tw2_w:
    s_mov_b32 s96, 2000000
L_wf_40_w:
    buffer_load_dword v61, v25, s[4:7], 0 offen sc1
    s_sub_u32 s96, s96, 1
    s_cbranch_scc1 L_fail
    s_waitcnt vmcnt(0)
    v_cmp_gt_u32 vcc, s58, v61
    s_cbranch_vccz L_wf_40_d_w
    s_sleep 2
    s_branch L_wf_40_w
L_wf_40_d_w:
    s_branch L_c_tok2_w
L_c_early3_w:
    buffer_store_dword v26, v12, s[4:7], s57 offen sc1
    s_add_u32 s56, s70, 524288
    s_bitset0_b32 s56, 20
    s_add_u32 s56, s56, 0
    s_lshr_b32 s97, s56, 8
    s_xor_b32 s97, s97, s60
    s_and_b32 s97, s97, 8192
    s_add_u32 s56, s56, s97
    s_add_u32 s56, s56, s77
    buffer_store_dword v26, v12, s[4:7], s56 offen sc1
    s_add_u32 s70, s70, 262144
    s_bitset0_b32 s70, 20
    s_mov_b32 s96, 2000000
L_wf_41_w:
    buffer_load_dword v16, v60, s[4:7], 0 offen sc1
    s_sub_u32 s96, s96, 1
    s_cbranch_scc1 L_fail
    s_waitcnt vmcnt(0)
    v_cmp_gt_u32 vcc, s40, v16
    s_cbranch_vccz L_wf_41_d_w
    s_sleep 2
    s_branch L_wf_41_w
L_wf_41_d_w:
    s_add_u32 s59, s68, 4096
    buffer_load_dwordx4 a[0:3], v10, s[4:7], s68 offen offset:0 sc1
    buffer_load_dwordx4 a[4:7], v10, s[4:7], s68 offen offset:1024 sc1
    buffer_load_dwordx4 a[8:11], v10, s[4:7], s68 offen offset:2048 sc1
    buffer_load_dwordx4 a[12:15], v10, s[4:7], s68 offen offset:3072 sc1
    buffer_load_dwordx4 a[16:19], v10, s[4:7], s59 offen offset:0 sc1
    buffer_load_dwordx4 a[20:23], v10, s[4:7], s59 offen offset:1024 sc1
    buffer_load_dwordx4 a[24:27], v10, s[4:7], s59 offen offset:2048 sc1
    buffer_load_dwordx4 a[28:31], v10, s[4:7], s59 offen offset:3072 sc1
    s_add_u32 s68, s68, 1310720
    s_branch L_c_next3_w
L_c_rw3_w:
    s_mov_b32 s96, 2000000
L_wf_42_w:
    buffer_load_dword v16, v60, s[4:7], 0 offen sc1
    s_sub_u32 s96, s96, 1
    s_cbranch_scc1 L_fail
    s_waitcnt vmcnt(0)
    v_cmp_gt_u32 vcc, s40, v16
    s_cbranch_vccz L_wf_42_d_w
    s_sleep 2
    s_branch L_wf_42_w
L_wf_42_d_w:
    s_branch L_c_rok3_w
L_c_tw3_w:
    s_mov_b32 s96, 2000000
L_wf_43_w:
    buffer_load_dword v61, v25, s[4:7], 0 offen sc1
    s_sub_u32 s96, s96, 1
    s_cbranch_scc1 L_fail
    s_waitcnt vmcnt(0)
    v_cmp_gt_u32 vcc, s58, v61
    s_cbranch_vccz L_wf_43_d_w
    s_sleep 2
    s_branch L_wf_43_w
L_wf_43_d_w:
    s_branch L_c_tok3_w
L_c_drain_w:
    s_waitcnt vmcnt(0)
    s_barrier
    s_cmp_eq_u32 s53, 0
    s_cbranch_scc0 L_c_pg_44_w
    v_mov_b32 v4, 61
    buffer_store_dword v4, v8, s[4:7], s72 offen sc1
L_c_pg_44_w:
    ds_read_b128 v[160:163], v10 offset:16384
    ds_read_b128 v[164:167], v10 offset:17408
    ds_read_b128 v[168:171], v10 offset:18432
    ds_read_b128 v[172:175], v10 offset:19456
    ds_read_b128 v[176:179], v10 offset:20480
    ds_read_b128 v[180:183], v10 offset:21504
    ds_read_b128 v[184:187], v10 offset:22528
    ds_read_b128 v[188:191], v10 offset:23552
    ds_read_b128 v[192:195], v10 offset:24576
    ds_read_b128 v[196:199], v10 offset:25600
    ds_read_b128 v[200:203], v10 offset:26624
    ds_read_b128 v[204:207], v10 offset:27648
    ds_read_b128 v[208:211], v10 offset:28672
    ds_read_b128 v[212:215], v10 offset:29696
    ds_read_b128 v[216:219], v10 offset:30720
    ds_read_b128 v[220:223], v10 offset:31744
    s_waitcnt lgkmcnt(15)
    v_mfma_f32_16x16x32_bf16 v[152:155], a[40:43], v[160:163], 0
    s_waitcnt lgkmcnt(14)
    v_mfma_f32_16x16x32_bf16 v[152:155], a[44:47], v[164:167], v[152:155]
    s_waitcnt lgkmcnt(13)
    v_mfma_f32_16x16x32_bf16 v[152:155], a[48:51], v[168:171], v[152:155]
    s_waitcnt lgkmcnt(12)
    v_mfma_f32_16x16x32_bf16 v[152:155], a[52:55], v[172:175], v[152:155]
    s_waitcnt lgkmcnt(11)
    v_mfma_f32_16x16x32_bf16 v[152:155], a[56:59], v[176:179], v[152:155]
    s_waitcnt lgkmcnt(10)
    v_mfma_f32_16x16x32_bf16 v[152:155], a[60:63], v[180:183], v[152:155]
    s_waitcnt lgkmcnt(9)
    v_mfma_f32_16x16x32_bf16 v[152:155], a[64:67], v[184:187], v[152:155]
    s_waitcnt lgkmcnt(8)
    v_mfma_f32_16x16x32_bf16 v[152:155], a[68:71], v[188:191], v[152:155]
    s_waitcnt lgkmcnt(7)
    v_mfma_f32_16x16x16_bf16 v[148:151], a[40:41], v[192:193], 0
    v_mfma_f32_16x16x16_bf16 v[148:151], a[44:45], v[194:195], v[148:151]
    s_waitcnt lgkmcnt(6)
    v_mfma_f32_16x16x16_bf16 v[148:151], a[48:49], v[196:197], v[148:151]
    v_mfma_f32_16x16x16_bf16 v[148:151], a[52:53], v[198:199], v[148:151]
    s_waitcnt lgkmcnt(5)
    v_mfma_f32_16x16x16_bf16 v[148:151], a[56:57], v[200:201], v[148:151]
    v_mfma_f32_16x16x16_bf16 v[148:151], a[60:61], v[202:203], v[148:151]
    s_waitcnt lgkmcnt(4)
    v_mfma_f32_16x16x16_bf16 v[148:151], a[64:65], v[204:205], v[148:151]
    v_mfma_f32_16x16x16_bf16 v[148:151], a[68:69], v[206:207], v[148:151]
    s_waitcnt lgkmcnt(0)
    v_mfma_f32_16x16x32_bf16 v[152:155], a[72:75], v[216:219], v[152:155]
    v_mfma_f32_16x16x32_bf16 v[152:155], a[76:79], v[220:223], v[152:155]
    s_nop 3
    v_mfma_f32_16x16x32_bf16 v[148:151], a[72:75], v[208:211], v[148:151]
    v_mfma_f32_16x16x32_bf16 v[148:151], a[76:79], v[212:215], v[148:151]
    s_nop 7
    v_cvt_pk_bf16_f32 v156, v148, v149
    v_cvt_pk_bf16_f32 v157, v150, v151
    v_cvt_pk_bf16_f32 v158, v152, v153
    v_cvt_pk_bf16_f32 v159, v154, v155
    buffer_store_dwordx4 v[156:159], v10, s[4:7], s36 offen sc1
    s_add_u32 s36, s36, 163840
    s_mov_b32 s58, 63
    s_mov_b32 s96, 2000000
L_wf_45_w:
    buffer_load_dword v61, v25, s[4:7], 0 offen sc1
    s_sub_u32 s96, s96, 1
    s_cbranch_scc1 L_fail
    s_waitcnt vmcnt(0)
    v_cmp_gt_u32 vcc, s58, v61
    s_cbranch_vccz L_wf_45_d_w
    s_sleep 2
    s_branch L_wf_45_w
L_wf_45_d_w:
    s_add_u32 m0, s45, 0
    s_nop 0
    buffer_load_dwordx4 v10, s[4:7], s41 offen offset:0 sc1 lds
    buffer_load_dwordx4 v10, s[4:7], s41 offen offset:1024 sc1 lds
    buffer_load_dwordx4 v10, s[4:7], s41 offen offset:2048 sc1 lds
    buffer_load_dwordx4 v10, s[4:7], s41 offen offset:3072 sc1 lds
    s_add_u32 s41, s41, 524288
    s_bitset0_b32 s41, 21
    s_waitcnt vmcnt(0)
    s_barrier
    s_cmp_eq_u32 s53, 0
    s_cbranch_scc0 L_c_pg_46_w
    v_mov_b32 v4, 62
    buffer_store_dword v4, v8, s[4:7], s72 offen sc1
L_c_pg_46_w:
    ds_read_b128 v[160:163], v10 offset:0
    ds_read_b128 v[164:167], v10 offset:1024
    ds_read_b128 v[168:171], v10 offset:2048
    ds_read_b128 v[172:175], v10 offset:3072
    ds_read_b128 v[176:179], v10 offset:4096
    ds_read_b128 v[180:183], v10 offset:5120
    ds_read_b128 v[184:187], v10 offset:6144
    ds_read_b128 v[188:191], v10 offset:7168
    ds_read_b128 v[192:195], v10 offset:8192
    ds_read_b128 v[196:199], v10 offset:9216
    ds_read_b128 v[200:203], v10 offset:10240
    ds_read_b128 v[204:207], v10 offset:11264
    ds_read_b128 v[208:211], v10 offset:12288
    ds_read_b128 v[212:215], v10 offset:13312
    ds_read_b128 v[216:219], v10 offset:14336
    ds_read_b128 v[220:223], v10 offset:15360
    s_waitcnt lgkmcnt(15)
    v_mfma_f32_16x16x32_bf16 v[152:155], a[80:83], v[160:163], 0
    s_waitcnt lgkmcnt(14)
    v_mfma_f32_16x16x32_bf16 v[152:155], a[84:87], v[164:167], v[152:155]
    s_waitcnt lgkmcnt(13)
    v_mfma_f32_16x16x32_bf16 v[152:155], a[88:91], v[168:171], v[152:155]
    s_waitcnt lgkmcnt(12)
    v_mfma_f32_16x16x32_bf16 v[152:155], a[92:95], v[172:175], v[152:155]
    s_waitcnt lgkmcnt(11)
    v_mfma_f32_16x16x32_bf16 v[152:155], a[96:99], v[176:179], v[152:155]
    s_waitcnt lgkmcnt(10)
    v_mfma_f32_16x16x32_bf16 v[152:155], a[100:103], v[180:183], v[152:155]
    s_waitcnt lgkmcnt(9)
    v_mfma_f32_16x16x32_bf16 v[152:155], a[104:107], v[184:187], v[152:155]
    s_waitcnt lgkmcnt(8)
    v_mfma_f32_16x16x32_bf16 v[152:155], a[108:111], v[188:191], v[152:155]
    s_waitcnt lgkmcnt(7)
    v_mfma_f32_16x16x16_bf16 v[148:151], a[80:81], v[192:193], 0
    v_mfma_f32_16x16x16_bf16 v[148:151], a[84:85], v[194:195], v[148:151]
    s_waitcnt lgkmcnt(6)
    v_mfma_f32_16x16x16_bf16 v[148:151], a[88:89], v[196:197], v[148:151]
    v_mfma_f32_16x16x16_bf16 v[148:151], a[92:93], v[198:199], v[148:151]
    s_waitcnt lgkmcnt(5)
    v_mfma_f32_16x16x16_bf16 v[148:151], a[96:97], v[200:201], v[148:151]
    v_mfma_f32_16x16x16_bf16 v[148:151], a[100:101], v[202:203], v[148:151]
    s_waitcnt lgkmcnt(4)
    v_mfma_f32_16x16x16_bf16 v[148:151], a[104:105], v[204:205], v[148:151]
    v_mfma_f32_16x16x16_bf16 v[148:151], a[108:109], v[206:207], v[148:151]
    s_waitcnt lgkmcnt(0)
    v_mfma_f32_16x16x32_bf16 v[152:155], a[112:115], v[216:219], v[152:155]
    v_mfma_f32_16x16x32_bf16 v[152:155], a[116:119], v[220:223], v[152:155]
    s_nop 3
    v_mfma_f32_16x16x32_bf16 v[148:151], a[112:115], v[208:211], v[148:151]
    v_mfma_f32_16x16x32_bf16 v[148:151], a[116:119], v[212:215], v[148:151]
    s_nop 7
    v_cvt_pk_bf16_f32 v156, v148, v149
    v_cvt_pk_bf16_f32 v157, v150, v151
    v_cvt_pk_bf16_f32 v158, v152, v153
    v_cvt_pk_bf16_f32 v159, v154, v155
    buffer_store_dwordx4 v[156:159], v10, s[4:7], s36 offen sc1
    s_add_u32 s36, s36, 163840
    s_waitcnt vmcnt(0)
    s_barrier
    s_cmp_eq_u32 s53, 0
    s_cbranch_scc0 L_c_pg_47_w
    v_mov_b32 v4, 63
    buffer_store_dword v4, v8, s[4:7], s72 offen sc1
L_c_pg_47_w:
    s_mov_b32 s96, 2000000
L_poll_48_w:
    buffer_load_dwordx4 v[68:71], v10, s[4:7], s67 offen offset:0 sc1
    buffer_load_dwordx4 v[76:79], v10, s[4:7], s67 offen offset:1024 sc1
    s_sub_u32 s96, s96, 1
    s_cbranch_scc1 L_fail
    s_waitcnt vmcnt(0)
    v_max3_u32 v7, v68, v69, v70
    v_max3_u32 v7, v7, v71, v76
    v_max3_u32 v7, v7, v77, v78
    v_max_u32 v7, v7, v79
    v_cmp_eq_u32 vcc, -1, v7
    s_cbranch_vccz L_poll_48_d_w
    s_sleep 1
    s_branch L_poll_48_w
L_poll_48_d_w:
    v_accvgpr_write_b32 a152, v68
    v_accvgpr_write_b32 a153, v69
    v_accvgpr_write_b32 a154, v70
    v_accvgpr_write_b32 a155, v71
    v_accvgpr_write_b32 a156, v76
    v_accvgpr_write_b32 a157, v77
    v_accvgpr_write_b32 a158, v78
    v_accvgpr_write_b32 a159, v79
    s_mov_b32 s58, 64
    s_mov_b32 s96, 2000000
L_wf_49_w:
    buffer_load_dword v61, v25, s[4:7], 0 offen sc1
    s_sub_u32 s96, s96, 1
    s_cbranch_scc1 L_fail
    s_waitcnt vmcnt(0)
    v_cmp_gt_u32 vcc, s58, v61
    s_cbranch_vccz L_wf_49_d_w
    s_sleep 2
    s_branch L_wf_49_w
L_wf_49_d_w:
    s_add_u32 m0, s45, 16384
    s_nop 0
    buffer_load_dwordx4 v10, s[4:7], s41 offen offset:0 sc1 lds
    buffer_load_dwordx4 v10, s[4:7], s41 offen offset:1024 sc1 lds
    buffer_load_dwordx4 v10, s[4:7], s41 offen offset:2048 sc1 lds
    buffer_load_dwordx4 v10, s[4:7], s41 offen offset:3072 sc1 lds
    s_add_u32 s41, s41, 524288
    s_bitset0_b32 s41, 21
    s_waitcnt vmcnt(0)
    s_barrier
    s_cmp_eq_u32 s53, 0
    s_cbranch_scc0 L_c_pg_50_w
    v_mov_b32 v4, 64
    buffer_store_dword v4, v8, s[4:7], s72 offen sc1
L_c_pg_50_w:
    ds_read_b128 v[160:163], v10 offset:16384
    ds_read_b128 v[164:167], v10 offset:17408
    ds_read_b128 v[168:171], v10 offset:18432
    ds_read_b128 v[172:175], v10 offset:19456
    ds_read_b128 v[176:179], v10 offset:20480
    ds_read_b128 v[180:183], v10 offset:21504
    ds_read_b128 v[184:187], v10 offset:22528
    ds_read_b128 v[188:191], v10 offset:23552
    ds_read_b128 v[192:195], v10 offset:24576
    ds_read_b128 v[196:199], v10 offset:25600
    ds_read_b128 v[200:203], v10 offset:26624
    ds_read_b128 v[204:207], v10 offset:27648
    ds_read_b128 v[208:211], v10 offset:28672
    ds_read_b128 v[212:215], v10 offset:29696
    ds_read_b128 v[216:219], v10 offset:30720
    ds_read_b128 v[220:223], v10 offset:31744
    s_waitcnt lgkmcnt(15)
    v_mfma_f32_16x16x32_bf16 v[152:155], a[120:123], v[160:163], 0
    s_waitcnt lgkmcnt(14)
    v_mfma_f32_16x16x32_bf16 v[152:155], a[124:127], v[164:167], v[152:155]
    s_waitcnt lgkmcnt(13)
    v_mfma_f32_16x16x32_bf16 v[152:155], a[128:131], v[168:171], v[152:155]
    s_waitcnt lgkmcnt(12)
    v_mfma_f32_16x16x32_bf16 v[152:155], a[132:135], v[172:175], v[152:155]
    s_waitcnt lgkmcnt(11)
    v_mfma_f32_16x16x32_bf16 v[152:155], a[136:139], v[176:179], v[152:155]
    s_waitcnt lgkmcnt(10)
    v_mfma_f32_16x16x32_bf16 v[152:155], a[140:143], v[180:183], v[152:155]
    s_waitcnt lgkmcnt(9)
    v_mfma_f32_16x16x32_bf16 v[152:155], a[144:147], v[184:187], v[152:155]
    s_waitcnt lgkmcnt(8)
    v_mfma_f32_16x16x32_bf16 v[152:155], a[148:151], v[188:191], v[152:155]
    s_waitcnt lgkmcnt(7)
    v_mfma_f32_16x16x16_bf16 v[148:151], a[120:121], v[192:193], 0
    v_mfma_f32_16x16x16_bf16 v[148:151], a[124:125], v[194:195], v[148:151]
    s_waitcnt lgkmcnt(6)
    v_mfma_f32_16x16x16_bf16 v[148:151], a[128:129], v[196:197], v[148:151]
    v_mfma_f32_16x16x16_bf16 v[148:151], a[132:133], v[198:199], v[148:151]
    s_waitcnt lgkmcnt(5)
    v_mfma_f32_16x16x16_bf16 v[148:151], a[136:137], v[200:201], v[148:151]
    v_mfma_f32_16x16x16_bf16 v[148:151], a[140:141], v[202:203], v[148:151]
    s_waitcnt lgkmcnt(4)
    v_mfma_f32_16x16x16_bf16 v[148:151], a[144:145], v[204:205], v[148:151]
    v_mfma_f32_16x16x16_bf16 v[148:151], a[148:149], v[206:207], v[148:151]
    s_waitcnt lgkmcnt(0)
    v_mfma_f32_16x16x32_bf16 v[152:155], a[152:155], v[216:219], v[152:155]
    v_mfma_f32_16x16x32_bf16 v[152:155], a[156:159], v[220:223], v[152:155]
    s_nop 3
    v_mfma_f32_16x16x32_bf16 v[148:151], a[152:155], v[208:211], v[148:151]
    v_mfma_f32_16x16x32_bf16 v[148:151], a[156:159], v[212:215], v[148:151]
    s_nop 7
    v_cvt_pk_bf16_f32 v156, v148, v149
    v_cvt_pk_bf16_f32 v157, v150, v151
    v_cvt_pk_bf16_f32 v158, v152, v153
    v_cvt_pk_bf16_f32 v159, v154, v155
    v_min_u32 v156, -2, v156
    v_min_u32 v157, -2, v157
    v_min_u32 v158, -2, v158
    v_min_u32 v159, -2, v159
    buffer_store_dwordx4 v[156:159], v10, s[4:7], s36 offen sc1
    s_add_u32 s36, s36, 163840
    s_branch L_end
L_v_slow:
    ds_read_b128 v[88:91], v15 offset:0
    ds_read_b128 v[92:95], v15 offset:1024
    ds_read_b128 v[96:99], v15 offset:2048
    ds_read_b128 v[100:103], v15 offset:3072
    v_mov_b32 v56, 0
    v_mov_b32 v57, 0
    v_mov_b32 v58, 0
    v_mov_b32 v59, 0
    v_mov_b32 v60, 0
    v_mov_b32 v61, 0
    v_mov_b32 v62, 0
    v_mov_b32 v63, 0
    v_mov_b32 v64, 0
    v_mov_b32 v65, 0
    v_mov_b32 v66, 0
    v_mov_b32 v67, 0
    s_waitcnt lgkmcnt(0)
L_v_loop_w:
    s_lshl_b32 s59, s55, 1
    s_mov_b32 s96, 2000000
L_wf_54_w:
    buffer_load_dword v4, v23, s[4:7], s79 offen sc1
    s_sub_u32 s96, s96, 1
    s_cbranch_scc1 L_fail
    s_waitcnt vmcnt(0)
    v_cmp_gt_u32 vcc, s59, v4
    s_cbranch_vccnz L_wf_54_w
L_wf_54_d_w:
    s_mov_b32 s96, 2000000
    s_branch L_v_poll_w
L_v_poll_z_w:
    s_nop 7
    v_mov_b32 v56, 0
    v_mov_b32 v57, 0
    v_mov_b32 v58, 0
    v_mov_b32 v59, 0
    v_mov_b32 v60, 0
    v_mov_b32 v61, 0
    v_mov_b32 v62, 0
    v_mov_b32 v63, 0
    v_mov_b32 v64, 0
    v_mov_b32 v65, 0
    v_mov_b32 v66, 0
    v_mov_b32 v67, 0
L_v_poll_w:
    buffer_load_dwordx4 v[68:71], v10, s[4:7], s71 offen sc1
    buffer_load_dwordx4 v[72:75], v10, s[4:7], s71 offen offset:1024 sc1
    buffer_load_dwordx2 v[76:77], v11, s[4:7], s71 offen sc1
    s_sub_u32 s96, s96, 1
    s_cbranch_scc1 L_fail
    s_waitcnt vmcnt(0)
    v_max3_u32 v8, v71, v75, v77
    v_cmp_eq_u32 vcc, -1, v8
    s_cbranch_vccnz L_v_poll_w
    v_smfmac_f32_16x16x64_bf16 v[56:59], v[68:71], a[88:95], v9
    ds_write_b128 v12, v[68:71]
    v_max3_u32 v8, v68, v69, v70
    v_smfmac_f32_16x16x64_bf16 v[60:63], v[68:71], a[96:103], v9
    ds_write_b128 v12, v[72:75] offset:1024
    v_max3_u32 v8, v8, v72, v73
    v_smfmac_f32_16x16x64_bf16 v[64:67], v[68:71], a[104:111], v9
    ds_write_b64 v13, v[76:77]
    v_max3_u32 v8, v8, v74, v76
    v_smfmac_f32_16x16x64_bf16 v[56:59], v[72:75], a[112:119], v9
    v_cmp_eq_u32 vcc, -1, v8
    v_smfmac_f32_16x16x64_bf16 v[60:63], v[72:75], a[120:127], v9
    s_cbranch_vccnz L_v_poll_z_w
    s_waitcnt lgkmcnt(0)
    s_barrier
    ds_read_b128 v[24:27], v20 offset:0
    ds_read_b128 v[28:31], v20 offset:1024
    ds_read_b128 v[32:35], v21 offset:0
    v_smfmac_f32_16x16x64_bf16 v[64:67], v[72:75], v[88:95], v9
    ds_read_b128 v[88:91], v15 offset:4096
    ds_read_b128 v[92:95], v15 offset:5120
    s_waitcnt lgkmcnt(4)
    v_smfmac_f32_16x16x64_bf16 v[56:59], v[24:27], a[128:135], v9
    ds_read_b128 v[36:39], v21 offset:1024
    v_smfmac_f32_16x16x64_bf16 v[60:63], v[24:27], a[136:143], v9
    s_waitcnt lgkmcnt(4)
    v_smfmac_f32_16x16x64_bf16 v[56:59], v[28:31], v[96:103], v9
    ds_read_b128 v[96:99], v15 offset:6144
    ds_read_b128 v[100:103], v15 offset:7168
    ds_read_b128 v[40:43], v22 offset:0
    v_smfmac_f32_16x16x64_bf16 v[60:63], v[28:31], a[144:151], v9
    v_mov_b32 v68, 0
    s_waitcnt lgkmcnt(6)
    v_smfmac_f32_16x16x64_bf16 v[56:59], v[32:35], a[152:159], v9
    ds_read_b128 v[44:47], v22 offset:1024
    v_mov_b32 v69, 0
    s_waitcnt lgkmcnt(5)
    v_smfmac_f32_16x16x64_bf16 v[60:63], v[32:35], v[88:95], v9
    ds_read_b128 v[88:91], v15 offset:8192
    ds_read_b128 v[92:95], v15 offset:9216
    v_mov_b32 v70, 0
    s_waitcnt lgkmcnt(6)
    v_smfmac_f32_16x16x64_bf16 v[56:59], v[36:39], a[160:167], v9
    ds_read_b128 v[48:51], v14 offset:8192
    v_mov_b32 v71, 0
    v_smfmac_f32_16x16x64_bf16 v[60:63], v[36:39], a[168:175], v9
    v_mov_b32 v72, 0
    s_waitcnt lgkmcnt(5)
    s_waitcnt lgkmcnt(4)
    v_smfmac_f32_16x16x64_bf16 v[56:59], v[40:43], v[96:103], v9
    ds_read_b128 v[96:99], v15 offset:10240
    ds_read_b128 v[100:103], v15 offset:11264
    ds_read_b128 v[52:55], v14 offset:9216
    v_mov_b32 v73, 0
    v_smfmac_f32_16x16x64_bf16 v[60:63], v[40:43], a[176:183], v9
    v_mov_b32 v74, 0
    s_waitcnt lgkmcnt(6)
    v_smfmac_f32_16x16x64_bf16 v[56:59], v[44:47], a[184:191], v9
    v_mov_b32 v75, 0
    s_waitcnt lgkmcnt(4)
    v_smfmac_f32_16x16x64_bf16 v[60:63], v[44:47], v[88:95], v9
    ds_read_b128 v[88:91], v15 offset:12288
    ds_read_b128 v[92:95], v15 offset:13312
    s_waitcnt lgkmcnt(5)
    v_smfmac_f32_16x16x64_bf16 v[56:59], v[48:51], a[192:199], v9
    v_smfmac_f32_16x16x64_bf16 v[60:63], v[48:51], a[200:207], v9
    s_waitcnt lgkmcnt(3)
    s_waitcnt lgkmcnt(2)
    v_smfmac_f32_16x16x64_bf16 v[56:59], v[52:55], v[96:103], v9
    ds_read_b128 v[96:99], v15 offset:14336
    ds_read_b128 v[100:103], v15 offset:15360
    v_smfmac_f32_16x16x64_bf16 v[60:63], v[52:55], a[208:215], v9
    v_smfmac_f32_16x16x64_bf16 v[64:67], v[24:27], a[216:223], v9
    s_waitcnt lgkmcnt(2)
    v_smfmac_f32_16x16x64_bf16 v[64:67], v[28:31], v[88:95], v9
    ds_read_b128 v[88:91], v15 offset:16384
    ds_read_b128 v[92:95], v15 offset:17408
    v_smfmac_f32_16x16x64_bf16 v[64:67], v[32:35], a[224:231], v9
    v_cvt_pk_bf16_f32 v80, v56, v57
    v_cvt_pk_bf16_f32 v81, v58, v59
    v_cvt_pk_bf16_f32 v82, v60, v61
    v_cvt_pk_bf16_f32 v83, v62, v63
    v_smfmac_f32_16x16x64_bf16 v[64:67], v[36:39], a[232:239], v9
    s_nop 0
    v_mfma_f32_16x16x32_bf16 v[84:87], v[80:83], v[0:3], 0
    v_mov_b32 v56, 0
    s_waitcnt lgkmcnt(2)
    v_smfmac_f32_16x16x64_bf16 v[64:67], v[40:43], v[96:103], v9
    v_mov_b32 v57, 0
    v_smfmac_f32_16x16x64_bf16 v[64:67], v[44:47], a[240:247], v9
    v_mov_b32 v58, 0
    v_smfmac_f32_16x16x64_bf16 v[64:67], v[48:51], a[248:255], v9
    v_cvt_pk_bf16_f32 v80, v84, v85
    v_cvt_pk_bf16_f32 v81, v86, v87
    ds_write_b64 v16, v[80:81]
    s_waitcnt lgkmcnt(1)
    v_smfmac_f32_16x16x64_bf16 v[64:67], v[52:55], v[88:95], v9
    v_mov_b32 v59, 0
    v_mov_b32 v60, 0
    v_mov_b32 v61, 0
    v_mov_b32 v62, 0
    v_mov_b32 v63, 0
    v_mov_b32 v40, 0
    v_mov_b32 v41, 0
    v_mov_b32 v42, 0
    v_cvt_pk_bf16_f32 v4, v64, v65
    v_cvt_pk_bf16_f32 v5, v66, v67
    v_cvt_pk_bf16_f32 v6, v64, v65
    v_cvt_pk_bf16_f32 v7, v66, v67
    s_waitcnt lgkmcnt(0)
    s_barrier
    v_mfma_f32_16x16x32_bf16 v[84:87], v[4:7], v[0:3], 0
    ds_read_b128 v[24:27], v14 offset:10240
    ds_read_b128 v[28:31], v14 offset:12288
    v_mov_b32 v43, 0
    v_mov_b32 v44, 0
    v_mov_b32 v45, 0
    v_mov_b32 v46, 0
    v_mov_b32 v47, 0
    s_nop 0
    v_cvt_pk_bf16_f32 v82, v84, v85
    v_cvt_pk_bf16_f32 v83, v86, v87
    s_mov_b64 exec, s[76:77]
    ds_write_b64 v17, v[82:83]
    s_mov_b64 exec, -1
    s_waitcnt lgkmcnt(2)
    v_smfmac_f32_16x16x64_bf16 v[68:71], v[24:27], v[104:111], v9
    v_mov_b32 v48, 0
    v_smfmac_f32_16x16x64_bf16 v[72:75], v[24:27], v[112:119], v9
    v_mov_b32 v49, 0
    s_waitcnt lgkmcnt(1)
    v_smfmac_f32_16x16x64_bf16 v[68:71], v[28:31], a[8:15], v9
    v_mov_b32 v50, 0
    v_smfmac_f32_16x16x64_bf16 v[72:75], v[28:31], a[16:23], v9
    v_mov_b32 v51, 0
    v_smfmac_f32_16x16x64_bf16 v[56:59], v[24:27], v[120:127], v9
    v_mov_b32 v52, 0
    v_smfmac_f32_16x16x64_bf16 v[60:63], v[24:27], v[128:135], v9
    s_waitcnt lgkmcnt(0)
    s_barrier
    ds_read_b128 v[32:35], v14 offset:11264
    v_mov_b32 v53, 0
    v_smfmac_f32_16x16x64_bf16 v[56:59], v[28:31], a[24:31], v9
    v_mov_b32 v54, 0
    v_smfmac_f32_16x16x64_bf16 v[60:63], v[28:31], a[32:39], v9
    v_mov_b32 v55, 0
    v_smfmac_f32_16x16x64_bf16 v[40:43], v[24:27], v[136:143], v9
    v_mov_b32 v64, 0
    v_smfmac_f32_16x16x64_bf16 v[44:47], v[24:27], v[144:151], v9
    v_mov_b32 v65, 0
    v_smfmac_f32_16x16x64_bf16 v[40:43], v[28:31], a[40:47], v9
    v_mov_b32 v66, 0
    v_smfmac_f32_16x16x64_bf16 v[44:47], v[28:31], a[48:55], v9
    v_mov_b32 v67, 0
    s_waitcnt lgkmcnt(0)
    v_smfmac_f32_16x16x64_bf16 v[68:71], v[32:35], v[184:191], v9
    v_mov_b32 v36, 0
    v_smfmac_f32_16x16x64_bf16 v[72:75], v[32:35], v[192:199], v9
    v_mov_b32 v37, 0
    v_smfmac_f32_16x16x64_bf16 v[56:59], v[32:35], v[200:207], v9
    v_mov_b32 v38, 0
    v_smfmac_f32_16x16x64_bf16 v[60:63], v[32:35], v[208:215], v9
    v_mov_b32 v39, 0
    v_smfmac_f32_16x16x64_bf16 v[40:43], v[32:35], v[216:223], v9
    v_cvt_pk_bf16_f32 v80, v68, v69
    v_cvt_pk_bf16_f32 v81, v70, v71
    v_smfmac_f32_16x16x64_bf16 v[44:47], v[32:35], v[224:231], v9
    v_cvt_pk_bf16_f32 v82, v72, v73
    v_cvt_pk_bf16_f32 v83, v74, v75
    v_smfmac_f32_16x16x64_bf16 v[48:51], v[24:27], v[152:159], v9
    s_nop 0
    v_mfma_f32_16x16x32_bf16 v[92:95], v[0:3], v[80:83], 0
    v_smfmac_f32_16x16x64_bf16 v[52:55], v[24:27], v[160:167], v9
    v_cvt_pk_bf16_f32 v88, v56, v57
    v_cvt_pk_bf16_f32 v89, v58, v59
    v_smfmac_f32_16x16x64_bf16 v[48:51], v[32:35], v[232:239], v9
    v_cvt_pk_bf16_f32 v90, v60, v61
    v_cvt_pk_bf16_f32 v91, v62, v63
    v_smfmac_f32_16x16x64_bf16 v[52:55], v[32:35], v[240:247], v9
    v_cvt_pk_bf16_f32 v100, v92, v93
    v_cvt_pk_bf16_f32 v101, v94, v95
    s_add_u32 s56, s64, 0
    buffer_store_dwordx2 v[100:101], v19, s[4:7], s56 offen sc1
    s_nop 0
    v_mfma_f32_16x16x32_bf16 v[96:99], v[0:3], v[88:91], 0
    v_smfmac_f32_16x16x64_bf16 v[48:51], v[28:31], a[56:63], v9
    v_cvt_pk_bf16_f32 v80, v40, v41
    v_cvt_pk_bf16_f32 v81, v42, v43
    v_smfmac_f32_16x16x64_bf16 v[52:55], v[28:31], a[64:71], v9
    v_cvt_pk_bf16_f32 v82, v44, v45
    v_cvt_pk_bf16_f32 v83, v46, v47
    v_smfmac_f32_16x16x64_bf16 v[64:67], v[24:27], v[168:175], v9
    v_cvt_pk_bf16_f32 v102, v96, v97
    v_cvt_pk_bf16_f32 v103, v98, v99
    s_add_u32 s56, s64, 16384
    buffer_store_dwordx2 v[102:103], v19, s[4:7], s56 offen sc1
    s_nop 0
    v_mfma_f32_16x16x32_bf16 v[92:95], v[0:3], v[80:83], 0
    v_smfmac_f32_16x16x64_bf16 v[36:39], v[24:27], v[176:183], v9
    v_smfmac_f32_16x16x64_bf16 v[64:67], v[32:35], v[248:255], v9
    v_cvt_pk_bf16_f32 v88, v48, v49
    v_cvt_pk_bf16_f32 v89, v50, v51
    v_smfmac_f32_16x16x64_bf16 v[36:39], v[32:35], a[0:7], v9
    v_cvt_pk_bf16_f32 v100, v92, v93
    v_cvt_pk_bf16_f32 v101, v94, v95
    s_add_u32 s56, s64, 32768
    buffer_store_dwordx2 v[100:101], v19, s[4:7], s56 offen sc1
    v_cvt_pk_bf16_f32 v90, v52, v53
    v_cvt_pk_bf16_f32 v91, v54, v55
    v_smfmac_f32_16x16x64_bf16 v[64:67], v[28:31], a[72:79], v9
    s_nop 0
    v_mfma_f32_16x16x32_bf16 v[96:99], v[0:3], v[88:91], 0
    v_smfmac_f32_16x16x64_bf16 v[36:39], v[28:31], a[80:87], v9
    s_nop 5
    v_cvt_pk_bf16_f32 v80, v64, v65
    v_cvt_pk_bf16_f32 v81, v66, v67
    v_cvt_pk_bf16_f32 v82, v36, v37
    v_cvt_pk_bf16_f32 v83, v38, v39
    v_cvt_pk_bf16_f32 v102, v96, v97
    v_cvt_pk_bf16_f32 v103, v98, v99
    s_nop 0
    v_mfma_f32_16x16x32_bf16 v[92:95], v[0:3], v[80:83], 0
    s_add_u32 s56, s64, 49152
    buffer_store_dwordx2 v[102:103], v19, s[4:7], s56 offen sc1
    s_nop 5
    v_cvt_pk_bf16_f32 v100, v92, v93
    v_cvt_pk_bf16_f32 v101, v94, v95
    s_add_u32 s56, s64, 65536
    buffer_store_dwordx2 v[100:101], v19, s[4:7], s56 offen sc1
    ds_read_b128 v[88:91], v15 offset:0
    ds_read_b128 v[92:95], v15 offset:1024
    ds_read_b128 v[96:99], v15 offset:2048
    ds_read_b128 v[100:103], v15 offset:3072
    v_mov_b32 v56, 0
    v_mov_b32 v57, 0
    v_mov_b32 v58, 0
    v_mov_b32 v59, 0
    v_mov_b32 v60, 0
    v_mov_b32 v61, 0
    v_mov_b32 v62, 0
    v_mov_b32 v63, 0
    v_mov_b32 v64, 0
    v_mov_b32 v65, 0
    v_mov_b32 v66, 0
    v_mov_b32 v67, 0
    s_waitcnt lgkmcnt(0)
    v_mov_b32 v4, -1
    v_mov_b32 v5, -1
    v_mov_b32 v6, -1
    v_mov_b32 v7, -1
    s_add_u32 s57, s64, 1048576
    s_bitset0_b32 s57, 21
    s_add_u32 s56, s57, 0
    buffer_store_dwordx2 v[4:5], v19, s[4:7], s56 offen sc1
    s_add_u32 s56, s57, 16384
    buffer_store_dwordx2 v[4:5], v19, s[4:7], s56 offen sc1
    s_add_u32 s56, s57, 32768
    buffer_store_dwordx2 v[4:5], v19, s[4:7], s56 offen sc1
    s_add_u32 s56, s57, 49152
    buffer_store_dwordx2 v[4:5], v19, s[4:7], s56 offen sc1
    s_add_u32 s56, s57, 65536
    buffer_store_dwordx2 v[4:5], v19, s[4:7], s56 offen sc1
    s_add_u32 s64, s64, 524288
    s_bitset0_b32 s64, 21
    s_add_u32 s71, s71, 524288
    s_bitset0_b32 s71, 21
    s_add_u32 s55, s55, 1
    s_cmp_lt_u32 s55, 64
    s_cbranch_scc1 L_v_loop_w
    s_branch L_end
L_t_slow:
L_t_loop_w:
    s_add_u32 s73, s55, 2
    s_min_u32 s73, s73, 64
    s_waitcnt vmcnt(0)
    v_mov_b32 v4, s55
    buffer_store_dword v4, v8, s[4:7], s66 offen sc1
    buffer_load_dword v4, v10, s[4:7], 0 offen sc1
    s_mov_b32 s75, s73
    s_waitcnt vmcnt(0)
    v_cmp_gt_u32 vcc, s73, v4
    s_mov_b32 s76, 1
    s_cbranch_vccnz L_t_la_60_w
    s_mov_b32 s76, 0
    s_add_u32 s56, s67, s74
    s_add_u32 s56, s56, 0
    buffer_load_dwordx4 a[72:75], v9, s[4:7], s56 offen offset:0 sc1
    buffer_load_dwordx4 a[76:79], v9, s[4:7], s56 offen offset:2048 sc1
    s_add_u32 s56, s67, s74
    s_add_u32 s56, s56, 4096
    buffer_load_dwordx4 a[80:83], v9, s[4:7], s56 offen offset:0 sc1
    buffer_load_dwordx4 a[84:87], v9, s[4:7], s56 offen offset:2048 sc1
    s_add_u32 s56, s67, s74
    s_add_u32 s56, s56, 8192
    buffer_load_dwordx4 a[88:91], v9, s[4:7], s56 offen offset:0 sc1
    buffer_load_dwordx4 a[92:95], v9, s[4:7], s56 offen offset:2048 sc1
    s_add_u32 s56, s67, 25165824
    buffer_load_dwordx4 a[96:99], v9, s[4:7], s56 offen offset:0 sc1
    buffer_load_dwordx4 a[100:103], v9, s[4:7], s56 offen offset:2048 sc1
    s_add_u32 s56, s67, 25169920
    buffer_load_dwordx4 a[104:107], v9, s[4:7], s56 offen offset:0 sc1
    buffer_load_dwordx4 a[108:111], v9, s[4:7], s56 offen offset:2048 sc1
    s_add_u32 s56, s67, 25174016
    buffer_load_dwordx4 a[112:115], v9, s[4:7], s56 offen offset:0 sc1
    buffer_load_dwordx4 a[116:119], v9, s[4:7], s56 offen offset:2048 sc1
    s_cmp_eq_u32 s65, 0
    s_cbranch_scc1 L_t_skip_61_w
    s_add_u32 s56, s67, 25166848
    buffer_load_dwordx4 a[120:123], v9, s[4:7], s56 offen offset:0 sc1
    buffer_load_dwordx4 a[124:127], v9, s[4:7], s56 offen offset:2048 sc1
    s_add_u32 s56, s67, 25170944
    buffer_load_dwordx4 a[128:131], v9, s[4:7], s56 offen offset:0 sc1
    buffer_load_dwordx4 a[132:135], v9, s[4:7], s56 offen offset:2048 sc1
    s_add_u32 s56, s67, 25175040
    buffer_load_dwordx4 a[136:139], v9, s[4:7], s56 offen offset:0 sc1
    buffer_load_dwordx4 a[140:143], v9, s[4:7], s56 offen offset:2048 sc1
L_t_skip_61_w:
    s_add_u32 s67, s67, 393216
L_t_la_60_w:
    s_add_u32 s73, s55, 1
    v_mfma_f32_16x16x32_bf16 v[16:19], a[24:27], a[0:3], 0
    v_mfma_f32_16x16x32_bf16 v[20:23], a[48:51], a[0:3], 0
    v_mfma_f32_16x16x32_bf16 v[16:19], a[28:31], a[4:7], v[16:19]
    v_mfma_f32_16x16x32_bf16 v[20:23], a[52:55], a[4:7], v[20:23]
    v_mfma_f32_16x16x32_bf16 v[16:19], a[32:35], a[8:11], v[16:19]
    v_mfma_f32_16x16x32_bf16 v[20:23], a[56:59], a[8:11], v[20:23]
    v_mfma_f32_16x16x32_bf16 v[16:19], a[36:39], a[12:15], v[16:19]
    v_mfma_f32_16x16x32_bf16 v[20:23], a[60:63], a[12:15], v[20:23]
    v_mfma_f32_16x16x32_bf16 v[16:19], a[40:43], a[16:19], v[16:19]
    v_mfma_f32_16x16x32_bf16 v[20:23], a[64:67], a[16:19], v[20:23]
    v_mfma_f32_16x16x32_bf16 v[16:19], a[44:47], a[20:23], v[16:19]
    v_mfma_f32_16x16x32_bf16 v[20:23], a[68:71], a[20:23], v[20:23]
    s_mov_b32 s96, 2000000
L_wf_62_w:
    buffer_load_dword v4, v11, s[4:7], 0 offen sc1
    s_sub_u32 s96, s96, 1
    s_cbranch_scc1 L_fail
    s_waitcnt vmcnt(0)
    v_cmp_gt_u32 vcc, s73, v4
    s_cbranch_vccz L_wf_62_d_w
    s_sleep 2
    s_branch L_wf_62_w
L_wf_62_d_w:
    s_add_u32 s56, s68, 4096
    buffer_load_dwordx4 v[64:67], v9, s[4:7], s68 offen offset:0 sc1
    buffer_load_dwordx4 v[68:71], v9, s[4:7], s68 offen offset:1024 sc1
    buffer_load_dwordx4 v[72:75], v9, s[4:7], s68 offen offset:2048 sc1
    buffer_load_dwordx4 v[76:79], v9, s[4:7], s68 offen offset:3072 sc1
    buffer_load_dwordx4 v[80:83], v9, s[4:7], s56 offen offset:0 sc1
    buffer_load_dwordx4 v[84:87], v9, s[4:7], s56 offen offset:1024 sc1
    v_cndmask_b32 v16, v13, v16, s[24:25]
    v_cndmask_b32 v20, v13, v20, s[32:33]
    v_cndmask_b32 v17, v13, v17, s[26:27]
    v_cndmask_b32 v21, v13, v21, s[34:35]
    v_cndmask_b32 v18, v13, v18, s[28:29]
    v_cndmask_b32 v22, v13, v22, s[36:37]
    v_cndmask_b32 v19, v13, v19, s[30:31]
    v_cndmask_b32 v23, v13, v23, s[38:39]
    v_max3_f32 v28, v16, v17, v18
    v_max3_f32 v28, v28, v19, v20
    v_max3_f32 v28, v28, v21, v22
    v_max_f32 v28, v28, v23
    s_waitcnt vmcnt(5)
    v_mfma_f32_16x16x32_bf16 v[24:27], v[64:67], a[0:3], 0
    s_waitcnt vmcnt(4)
    v_mfma_f32_16x16x32_bf16 v[24:27], v[68:71], a[4:7], v[24:27]
    s_waitcnt vmcnt(3)
    v_mfma_f32_16x16x32_bf16 v[24:27], v[72:75], a[8:11], v[24:27]
    s_waitcnt vmcnt(2)
    v_mfma_f32_16x16x32_bf16 v[24:27], v[76:79], a[12:15], v[24:27]
    s_waitcnt vmcnt(1)
    v_mfma_f32_16x16x32_bf16 v[24:27], v[80:83], a[16:19], v[24:27]
    s_waitcnt vmcnt(0)
    v_mfma_f32_16x16x32_bf16 v[24:27], v[84:87], a[20:23], v[24:27]
    s_nop 7
    v_max3_f32 v28, v28, v24, v25
    v_mov_b32 v30, v28
    s_nop 1
    v_permlane16_swap_b32 v28, v30
    v_max_f32 v28, v28, v30
    v_mov_b32 v30, v28
    s_nop 1
    v_permlane32_swap_b32 v28, v30
    v_max_f32 v28, v28, v30
    v_mul_f32 v28, s78, v28
    v_fma_f32 v16, v16, s78, -v28
    v_fma_f32 v17, v17, s78, -v28
    v_fma_f32 v18, v18, s78, -v28
    v_fma_f32 v19, v19, s78, -v28
    v_fma_f32 v20, v20, s78, -v28
    v_fma_f32 v21, v21, s78, -v28
    v_fma_f32 v22, v22, s78, -v28
    v_fma_f32 v23, v23, s78, -v28
    v_fma_f32 v24, v24, s78, -v28
    v_fma_f32 v25, v25, s78, -v28
    v_exp_f32 v16, v16
    v_exp_f32 v17, v17
    v_exp_f32 v18, v18
    v_exp_f32 v19, v19
    v_exp_f32 v20, v20
    v_exp_f32 v21, v21
    v_exp_f32 v22, v22
    v_exp_f32 v23, v23
    v_exp_f32 v24, v24
    v_exp_f32 v25, v25
    v_add_f32 v29, v16, v17
    v_add_f32 v29, v29, v18
    v_add_f32 v29, v29, v19
    v_add_f32 v29, v29, v20
    v_add_f32 v29, v29, v21
    v_add_f32 v29, v29, v22
    v_add_f32 v29, v29, v23
    v_add_f32 v29, v29, v24
    v_add_f32 v29, v29, v25
    v_mov_b32 v30, v29
    s_nop 1
    v_permlane16_swap_b32 v29, v30
    v_add_f32 v29, v29, v30
    v_mov_b32 v30, v29
    s_nop 1
    v_permlane32_swap_b32 v29, v30
    v_add_f32 v29, v29, v30
    v_rcp_f32 v29, v29
    s_cmp_eq_u32 s65, 0
    v_mul_f32 v16, v16, v29
    v_mul_f32 v17, v17, v29
    v_mul_f32 v18, v18, v29
    v_mul_f32 v19, v19, v29
    v_mul_f32 v20, v20, v29
    v_mul_f32 v21, v21, v29
    v_mul_f32 v22, v22, v29
    v_mul_f32 v23, v23, v29
    v_mul_f32 v24, v24, v29
    v_mul_f32 v25, v25, v29
    v_cvt_pk_bf16_f32 v32, v16, v17
    v_cvt_pk_bf16_f32 v33, v18, v19
    v_cvt_pk_bf16_f32 v34, v20, v21
    v_cvt_pk_bf16_f32 v35, v22, v23
    v_cvt_pk_bf16_f32 v36, v24, v25
    buffer_store_dword v36, v12, s[4:7], s70 offen sc1
    s_cbranch_scc1 L_t_st_63_w
    buffer_store_dwordx4 v[32:35], v9, s[4:7], s69 offen sc1
    s_branch L_t_st_63_e_w
L_t_st_63_w:
    buffer_store_dwordx2 v[32:33], v9, s[4:7], s69 offen sc1
L_t_st_63_e_w:
    s_add_u32 s68, s68, 262144
    s_bitset0_b32 s68, 20
    s_add_u32 s69, s69, 524288
    s_bitset0_b32 s69, 21
    s_add_u32 s70, s70, 524288
    s_bitset0_b32 s70, 21
    s_add_u32 s55, s55, 1
    s_cmp_eq_u32 s76, 0
    s_cbranch_scc1 L_t_la_60_e_w
    buffer_load_dword v4, v10, s[4:7], 0 offen sc1
    s_waitcnt vmcnt(0)
    v_mov_b32 v5, s55
    buffer_store_dword v5, v8, s[4:7], s66 offen sc1
    v_cmp_gt_u32 vcc, s75, v4
    s_cbranch_vccz L_wf_64_d_w
    s_mov_b32 s96, 2000000
L_wf_64_w:
    buffer_load_dword v4, v10, s[4:7], 0 offen sc1
    s_sub_u32 s96, s96, 1
    s_cbranch_scc1 L_fail
    s_waitcnt vmcnt(0)
    v_cmp_gt_u32 vcc, s75, v4
    s_cbranch_vccz L_wf_64_d_w
    s_sleep 4
    s_branch L_wf_64_w
L_wf_64_d_w:
    s_add_u32 s56, s67, s74
    s_add_u32 s56, s56, 0
    buffer_load_dwordx4 a[72:75], v9, s[4:7], s56 offen offset:0 sc1
    buffer_load_dwordx4 a[76:79], v9, s[4:7], s56 offen offset:2048 sc1
    s_add_u32 s56, s67, s74
    s_add_u32 s56, s56, 4096
    buffer_load_dwordx4 a[80:83], v9, s[4:7], s56 offen offset:0 sc1
    buffer_load_dwordx4 a[84:87], v9, s[4:7], s56 offen offset:2048 sc1
    s_add_u32 s56, s67, s74
    s_add_u32 s56, s56, 8192
    buffer_load_dwordx4 a[88:91], v9, s[4:7], s56 offen offset:0 sc1
    buffer_load_dwordx4 a[92:95], v9, s[4:7], s56 offen offset:2048 sc1
    s_add_u32 s56, s67, 25165824
    buffer_load_dwordx4 a[96:99], v9, s[4:7], s56 offen offset:0 sc1
    buffer_load_dwordx4 a[100:103], v9, s[4:7], s56 offen offset:2048 sc1
    s_add_u32 s56, s67, 25169920
    buffer_load_dwordx4 a[104:107], v9, s[4:7], s56 offen offset:0 sc1
    buffer_load_dwordx4 a[108:111], v9, s[4:7], s56 offen offset:2048 sc1
    s_add_u32 s56, s67, 25174016
    buffer_load_dwordx4 a[112:115], v9, s[4:7], s56 offen offset:0 sc1
    buffer_load_dwordx4 a[116:119], v9, s[4:7], s56 offen offset:2048 sc1
    s_cmp_eq_u32 s65, 0
    s_cbranch_scc1 L_t_skip_65_w
    s_add_u32 s56, s67, 25166848
    buffer_load_dwordx4 a[120:123], v9, s[4:7], s56 offen offset:0 sc1
    buffer_load_dwordx4 a[124:127], v9, s[4:7], s56 offen offset:2048 sc1
    s_add_u32 s56, s67, 25170944
    buffer_load_dwordx4 a[128:131], v9, s[4:7], s56 offen offset:0 sc1
    buffer_load_dwordx4 a[132:135], v9, s[4:7], s56 offen offset:2048 sc1
    s_add_u32 s56, s67, 25175040
    buffer_load_dwordx4 a[136:139], v9, s[4:7], s56 offen offset:0 sc1
    buffer_load_dwordx4 a[140:143], v9, s[4:7], s56 offen offset:2048 sc1
L_t_skip_65_w:
    s_add_u32 s67, s67, 393216
L_t_la_60_e_w:
    s_add_u32 s73, s55, 2
    s_min_u32 s73, s73, 64
    s_waitcnt vmcnt(0)
    v_mov_b32 v4, s55
    buffer_store_dword v4, v8, s[4:7], s66 offen sc1
    buffer_load_dword v4, v10, s[4:7], 0 offen sc1
    s_mov_b32 s75, s73
    s_waitcnt vmcnt(0)
    v_cmp_gt_u32 vcc, s73, v4
    s_mov_b32 s76, 1
    s_cbranch_vccnz L_t_la_66_w
    s_mov_b32 s76, 0
    s_add_u32 s56, s67, s74
    s_add_u32 s56, s56, 0
    buffer_load_dwordx4 a[0:3], v9, s[4:7], s56 offen offset:0 sc1
    buffer_load_dwordx4 a[4:7], v9, s[4:7], s56 offen offset:2048 sc1
    s_add_u32 s56, s67, s74
    s_add_u32 s56, s56, 4096
    buffer_load_dwordx4 a[8:11], v9, s[4:7], s56 offen offset:0 sc1
    buffer_load_dwordx4 a[12:15], v9, s[4:7], s56 offen offset:2048 sc1
    s_add_u32 s56, s67, s74
    s_add_u32 s56, s56, 8192
    buffer_load_dwordx4 a[16:19], v9, s[4:7], s56 offen offset:0 sc1
    buffer_load_dwordx4 a[20:23], v9, s[4:7], s56 offen offset:2048 sc1
    s_add_u32 s56, s67, 25165824
    buffer_load_dwordx4 a[24:27], v9, s[4:7], s56 offen offset:0 sc1
    buffer_load_dwordx4 a[28:31], v9, s[4:7], s56 offen offset:2048 sc1
    s_add_u32 s56, s67, 25169920
    buffer_load_dwordx4 a[32:35], v9, s[4:7], s56 offen offset:0 sc1
    buffer_load_dwordx4 a[36:39], v9, s[4:7], s56 offen offset:2048 sc1
    s_add_u32 s56, s67, 25174016
    buffer_load_dwordx4 a[40:43], v9, s[4:7], s56 offen offset:0 sc1
    buffer_load_dwordx4 a[44:47], v9, s[4:7], s56 offen offset:2048 sc1
    s_cmp_eq_u32 s65, 0
    s_cbranch_scc1 L_t_skip_67_w
    s_add_u32 s56, s67, 25166848
    buffer_load_dwordx4 a[48:51], v9, s[4:7], s56 offen offset:0 sc1
    buffer_load_dwordx4 a[52:55], v9, s[4:7], s56 offen offset:2048 sc1
    s_add_u32 s56, s67, 25170944
    buffer_load_dwordx4 a[56:59], v9, s[4:7], s56 offen offset:0 sc1
    buffer_load_dwordx4 a[60:63], v9, s[4:7], s56 offen offset:2048 sc1
    s_add_u32 s56, s67, 25175040
    buffer_load_dwordx4 a[64:67], v9, s[4:7], s56 offen offset:0 sc1
    buffer_load_dwordx4 a[68:71], v9, s[4:7], s56 offen offset:2048 sc1
L_t_skip_67_w:
    s_add_u32 s67, s67, 393216
L_t_la_66_w:
    s_add_u32 s73, s55, 1
    v_mfma_f32_16x16x32_bf16 v[16:19], a[96:99], a[72:75], 0
    v_mfma_f32_16x16x32_bf16 v[20:23], a[120:123], a[72:75], 0
    v_mfma_f32_16x16x32_bf16 v[16:19], a[100:103], a[76:79], v[16:19]
    v_mfma_f32_16x16x32_bf16 v[20:23], a[124:127], a[76:79], v[20:23]
    v_mfma_f32_16x16x32_bf16 v[16:19], a[104:107], a[80:83], v[16:19]
    v_mfma_f32_16x16x32_bf16 v[20:23], a[128:131], a[80:83], v[20:23]
    v_mfma_f32_16x16x32_bf16 v[16:19], a[108:111], a[84:87], v[16:19]
    v_mfma_f32_16x16x32_bf16 v[20:23], a[132:135], a[84:87], v[20:23]
    v_mfma_f32_16x16x32_bf16 v[16:19], a[112:115], a[88:91], v[16:19]
    v_mfma_f32_16x16x32_bf16 v[20:23], a[136:139], a[88:91], v[20:23]
    v_mfma_f32_16x16x32_bf16 v[16:19], a[116:119], a[92:95], v[16:19]
    v_mfma_f32_16x16x32_bf16 v[20:23], a[140:143], a[92:95], v[20:23]
    s_mov_b32 s96, 2000000
L_wf_68_w:
    buffer_load_dword v4, v11, s[4:7], 0 offen sc1
    s_sub_u32 s96, s96, 1
    s_cbranch_scc1 L_fail
    s_waitcnt vmcnt(0)
    v_cmp_gt_u32 vcc, s73, v4
    s_cbranch_vccz L_wf_68_d_w
    s_sleep 2
    s_branch L_wf_68_w
L_wf_68_d_w:
    s_add_u32 s56, s68, 4096
    buffer_load_dwordx4 v[64:67], v9, s[4:7], s68 offen offset:0 sc1
    buffer_load_dwordx4 v[68:71], v9, s[4:7], s68 offen offset:1024 sc1
    buffer_load_dwordx4 v[72:75], v9, s[4:7], s68 offen offset:2048 sc1
    buffer_load_dwordx4 v[76:79], v9, s[4:7], s68 offen offset:3072 sc1
    buffer_load_dwordx4 v[80:83], v9, s[4:7], s56 offen offset:0 sc1
    buffer_load_dwordx4 v[84:87], v9, s[4:7], s56 offen offset:1024 sc1
    v_cndmask_b32 v16, v13, v16, s[24:25]
    v_cndmask_b32 v20, v13, v20, s[32:33]
    v_cndmask_b32 v17, v13, v17, s[26:27]
    v_cndmask_b32 v21, v13, v21, s[34:35]
    v_cndmask_b32 v18, v13, v18, s[28:29]
    v_cndmask_b32 v22, v13, v22, s[36:37]
    v_cndmask_b32 v19, v13, v19, s[30:31]
    v_cndmask_b32 v23, v13, v23, s[38:39]
    v_max3_f32 v28, v16, v17, v18
    v_max3_f32 v28, v28, v19, v20
    v_max3_f32 v28, v28, v21, v22
    v_max_f32 v28, v28, v23
    s_waitcnt vmcnt(5)
    v_mfma_f32_16x16x32_bf16 v[24:27], v[64:67], a[72:75], 0
    s_waitcnt vmcnt(4)
    v_mfma_f32_16x16x32_bf16 v[24:27], v[68:71], a[76:79], v[24:27]
    s_waitcnt vmcnt(3)
    v_mfma_f32_16x16x32_bf16 v[24:27], v[72:75], a[80:83], v[24:27]
    s_waitcnt vmcnt(2)
    v_mfma_f32_16x16x32_bf16 v[24:27], v[76:79], a[84:87], v[24:27]
    s_waitcnt vmcnt(1)
    v_mfma_f32_16x16x32_bf16 v[24:27], v[80:83], a[88:91], v[24:27]
    s_waitcnt vmcnt(0)
    v_mfma_f32_16x16x32_bf16 v[24:27], v[84:87], a[92:95], v[24:27]
    s_nop 7
    v_max3_f32 v28, v28, v24, v25
    v_mov_b32 v30, v28
    s_nop 1
    v_permlane16_swap_b32 v28, v30
    v_max_f32 v28, v28, v30
    v_mov_b32 v30, v28
    s_nop 1
    v_permlane32_swap_b32 v28, v30
    v_max_f32 v28, v28, v30
    v_mul_f32 v28, s78, v28
    v_fma_f32 v16, v16, s78, -v28
    v_fma_f32 v17, v17, s78, -v28
    v_fma_f32 v18, v18, s78, -v28
    v_fma_f32 v19, v19, s78, -v28
    v_fma_f32 v20, v20, s78, -v28
    v_fma_f32 v21, v21, s78, -v28
    v_fma_f32 v22, v22, s78, -v28
    v_fma_f32 v23, v23, s78, -v28
    v_fma_f32 v24, v24, s78, -v28
    v_fma_f32 v25, v25, s78, -v28
    v_exp_f32 v16, v16
    v_exp_f32 v17, v17
    v_exp_f32 v18, v18
    v_exp_f32 v19, v19
    v_exp_f32 v20, v20
    v_exp_f32 v21, v21
    v_exp_f32 v22, v22
    v_exp_f32 v23, v23
    v_exp_f32 v24, v24
    v_exp_f32 v25, v25
    v_add_f32 v29, v16, v17
    v_add_f32 v29, v29, v18
    v_add_f32 v29, v29, v19
    v_add_f32 v29, v29, v20
    v_add_f32 v29, v29, v21
    v_add_f32 v29, v29, v22
    v_add_f32 v29, v29, v23
    v_add_f32 v29, v29, v24
    v_add_f32 v29, v29, v25
    v_mov_b32 v30, v29
    s_nop 1
    v_permlane16_swap_b32 v29, v30
    v_add_f32 v29, v29, v30
    v_mov_b32 v30, v29
    s_nop 1
    v_permlane32_swap_b32 v29, v30
    v_add_f32 v29, v29, v30
    v_rcp_f32 v29, v29
    s_cmp_eq_u32 s65, 0
    v_mul_f32 v16, v16, v29
    v_mul_f32 v17, v17, v29
    v_mul_f32 v18, v18, v29
    v_mul_f32 v19, v19, v29
    v_mul_f32 v20, v20, v29
    v_mul_f32 v21, v21, v29
    v_mul_f32 v22, v22, v29
    v_mul_f32 v23, v23, v29
    v_mul_f32 v24, v24, v29
    v_mul_f32 v25, v25, v29
    v_cvt_pk_bf16_f32 v32, v16, v17
    v_cvt_pk_bf16_f32 v33, v18, v19
    v_cvt_pk_bf16_f32 v34, v20, v21
    v_cvt_pk_bf16_f32 v35, v22, v23
    v_cvt_pk_bf16_f32 v36, v24, v25
    buffer_store_dword v36, v12, s[4:7], s70 offen sc1
    s_cbranch_scc1 L_t_st_69_w
    buffer_store_dwordx4 v[32:35], v9, s[4:7], s69 offen sc1
    s_branch L_t_st_69_e_w
L_t_st_69_w:
    buffer_store_dwordx2 v[32:33], v9, s[4:7], s69 offen sc1
L_t_st_69_e_w:
    s_add_u32 s68, s68, 262144
    s_bitset0_b32 s68, 20
    s_add_u32 s69, s69, 524288
    s_bitset0_b32 s69, 21
    s_add_u32 s70, s70, 524288
    s_bitset0_b32 s70, 21
    s_add_u32 s55, s55, 1
    s_cmp_eq_u32 s76, 0
    s_cbranch_scc1 L_t_la_66_e_w
    buffer_load_dword v4, v10, s[4:7], 0 offen sc1
    s_waitcnt vmcnt(0)
    v_mov_b32 v5, s55
    buffer_store_dword v5, v8, s[4:7], s66 offen sc1
    v_cmp_gt_u32 vcc, s75, v4
    s_cbranch_vccz L_wf_70_d_w
    s_mov_b32 s96, 2000000
L_wf_70_w:
    buffer_load_dword v4, v10, s[4:7], 0 offen sc1
    s_sub_u32 s96, s96, 1
    s_cbranch_scc1 L_fail
    s_waitcnt vmcnt(0)
    v_cmp_gt_u32 vcc, s75, v4
    s_cbranch_vccz L_wf_70_d_w
    s_sleep 4
    s_branch L_wf_70_w
L_wf_70_d_w:
    s_add_u32 s56, s67, s74
    s_add_u32 s56, s56, 0
    buffer_load_dwordx4 a[0:3], v9, s[4:7], s56 offen offset:0 sc1
    buffer_load_dwordx4 a[4:7], v9, s[4:7], s56 offen offset:2048 sc1
    s_add_u32 s56, s67, s74
    s_add_u32 s56, s56, 4096
    buffer_load_dwordx4 a[8:11], v9, s[4:7], s56 offen offset:0 sc1
    buffer_load_dwordx4 a[12:15], v9, s[4:7], s56 offen offset:2048 sc1
    s_add_u32 s56, s67, s74
    s_add_u32 s56, s56, 8192
    buffer_load_dwordx4 a[16:19], v9, s[4:7], s56 offen offset:0 sc1
    buffer_load_dwordx4 a[20:23], v9, s[4:7], s56 offen offset:2048 sc1
    s_add_u32 s56, s67, 25165824
    buffer_load_dwordx4 a[24:27], v9, s[4:7], s56 offen offset:0 sc1
    buffer_load_dwordx4 a[28:31], v9, s[4:7], s56 offen offset:2048 sc1
    s_add_u32 s56, s67, 25169920
    buffer_load_dwordx4 a[32:35], v9, s[4:7], s56 offen offset:0 sc1
    buffer_load_dwordx4 a[36:39], v9, s[4:7], s56 offen offset:2048 sc1
    s_add_u32 s56, s67, 25174016
    buffer_load_dwordx4 a[40:43], v9, s[4:7], s56 offen offset:0 sc1
    buffer_load_dwordx4 a[44:47], v9, s[4:7], s56 offen offset:2048 sc1
    s_cmp_eq_u32 s65, 0
    s_cbranch_scc1 L_t_skip_71_w
    s_add_u32 s56, s67, 25166848
    buffer_load_dwordx4 a[48:51], v9, s[4:7], s56 offen offset:0 sc1
    buffer_load_dwordx4 a[52:55], v9, s[4:7], s56 offen offset:2048 sc1
    s_add_u32 s56, s67, 25170944
    buffer_load_dwordx4 a[56:59], v9, s[4:7], s56 offen offset:0 sc1
    buffer_load_dwordx4 a[60:63], v9, s[4:7], s56 offen offset:2048 sc1
    s_add_u32 s56, s67, 25175040
    buffer_load_dwordx4 a[64:67], v9, s[4:7], s56 offen offset:0 sc1
    buffer_load_dwordx4 a[68:71], v9, s[4:7], s56 offen offset:2048 sc1
L_t_skip_71_w:
    s_add_u32 s67, s67, 393216
L_t_la_66_e_w:
    s_cmp_lt_u32 s55, 64
    s_cbranch_scc1 L_t_loop_w
    s_waitcnt vmcnt(0)
    v_mov_b32 v4, s55
    buffer_store_dword v4, v8, s[4:7], s66 offen sc1
    s_branch L_end
    .p2align 2
    .type role_tab,@object
    .size role_tab, 256
role_tab:
    .byte 0, 1, 2, 3, 4, 5, 6, 7, 72, 73, 74, 75, 76, 77, 78, 79
    .byte 104, 105, 106, 107, 32, 33, 34, 35, 36, 37, 38, 39, 40, 41, 124, 128
    .byte 8, 9, 10, 11, 12, 13, 14, 15, 80, 81, 82, 83, 84, 85, 86, 87
    .byte 108, 109, 110, 111, 42, 43, 44, 45, 46, 47, 48, 49, 50, 51, 125, 129
    .byte 16, 17, 18, 19, 20, 21, 22, 23, 88, 89, 90, 91, 92, 93, 94, 95
    .byte 112, 113, 114, 115, 52, 53, 54, 55, 56, 57, 58, 59, 60, 61, 126, 130
    .byte 24, 25, 26, 27, 28, 29, 30, 31, 96, 97, 98, 99, 100, 101, 102, 103
    .byte 116, 117, 118, 119, 62, 63, 64, 65, 66, 67, 68, 69, 70, 71, 127, 131
    .byte 140, 141, 142, 143, 144, 145, 146, 147, 132, 133, 134, 135, 136, 137, 138, 139
    .byte 172, 173, 174, 175, 188, 189, 190, 191, 204, 205, 206, 207, 220, 221, 222, 223
    .byte 148, 149, 150, 151, 152, 153, 154, 155, 176, 177, 178, 179, 192, 193, 194, 195
    .byte 208, 209, 210, 211, 224, 225, 226, 227, 236, 237, 238, 239, 248, 249, 250, 251
    .byte 156, 157, 158, 159, 160, 161, 162, 163, 180, 181, 182, 183, 196, 197, 198, 199
    .byte 212, 213, 214, 215, 228, 229, 230, 231, 240, 241, 242, 243, 252, 253, 254, 255
    .byte 164, 165, 166, 167, 168, 169, 170, 171, 184, 185, 186, 187, 200, 201, 202, 203
    .byte 216, 217, 218, 219, 232, 233, 234, 235, 244, 245, 246, 247, 120, 121, 122, 123
.section .rodata,"a"
.p2align 6
.amdhsa_kernel parallel_sum__memory_aug_recurrent_mem_tr__glu_gated_geglu__prompt_kernel
  .amdhsa_next_free_vgpr 512
  .amdhsa_next_free_sgpr 102
  .amdhsa_accum_offset 256
  .amdhsa_group_segment_fixed_size 0
  .amdhsa_kernarg_size 112
  .amdhsa_user_sgpr_count 2
  .amdhsa_user_sgpr_kernarg_segment_ptr 1
  .amdhsa_system_sgpr_workgroup_id_x 1
  .amdhsa_float_denorm_mode_32 3
  .amdhsa_float_denorm_mode_16_64 3
.end_amdhsa_kernel
```
